```python
import torch

def _softmax(x, axis=-1):
    return torch.softmax(x, dim=axis)
def _gelu(x):
    return torch.nn.functional.gelu(x, approximate="tanh")
def _silu(x):
    return torch.nn.functional.silu(x)
def _sigmoid(x):
    return torch.sigmoid(x)
def _layernorm(x, axis=-1, eps=1e-5):
    m = x.mean(dim=axis, keepdim=True)
    v = x.var(dim=axis, keepdim=True, unbiased=False)
    return (x - m) / torch.sqrt(v + eps)
def _scatter_add(tgt, idx, src, axis=0):
    return tgt.clone().index_add_(axis, idx, src)
def _segment_sum(src, seg, n):
    out = torch.zeros((n,) + src.shape[1:], dtype=src.dtype)
    return out.index_add_(0, seg, src)
def _pad(x, pw):
    flat = tuple(v for pair in reversed(pw) for v in pair)
    return torch.nn.functional.pad(x, flat)

kernel_name = 'concat_heads__compressed_kv_cla__sliding_local_dilated__prompt'

def setup_inputs():

    _w = (lambda a: (lambda t: t.to(torch.bfloat16) if t.is_floating_point() else t)(torch.as_tensor(a)))
    def _A_setup():
        B, H, Sq, Sk, D, M = 1, 32, 2048, 2048, 128, 640
        Dc = 4 * D
        return {
            "x": _w((lambda *s: torch.randn(*s, dtype=torch.bfloat16) * 0.2)(B, Sq, M)),
            "c_kv": _w((lambda *s: torch.randn(*s, dtype=torch.bfloat16) * 1.6)(B, Sk, Dc)),
            "w_q": _w((lambda *s: torch.randn(*s, dtype=torch.bfloat16) * 3.2)(M, H, D) * (M ** -0.5)),
            "w_uk": _w((lambda *s: torch.randn(*s, dtype=torch.bfloat16) * 3.2)(Dc, H, D) * (Dc ** -0.5)),
            "w_uv": _w((lambda *s: torch.randn(*s, dtype=torch.bfloat16) * 1.6)(Dc, H, D) * (Dc ** -0.5)),
            "w_o": _w((lambda *s: torch.randn(*s, dtype=torch.bfloat16) * 1.6)(H, D, M) * ((H * D) ** -0.5)),
        }
    _A_in = _A_setup()

    def _B_setup():
        B, S, D = 1, 2048, 640
        return {
            "x": _w((lambda *s: torch.randn(*s, dtype=torch.bfloat16) * 0.4)(B, S, D)),
            "wqkv": _w((lambda *s: torch.randn(*s, dtype=torch.bfloat16) * 0.4)(D, 3 * D)),
            "wo": _w((lambda *s: torch.randn(*s, dtype=torch.bfloat16) * 0.05)(D, D)),
        }
    _B_in = _B_setup()

    return {
        "A_x": _A_in["x"],
        "A_c_kv": _A_in["c_kv"],
        "A_w_q": _A_in["w_q"],
        "A_w_uk": _A_in["w_uk"],
        "A_w_uv": _A_in["w_uv"],
        "A_w_o": _A_in["w_o"],
        "B_x": _B_in["x"],
        "B_wqkv": _B_in["wqkv"],
        "B_wo": _B_in["wo"],
    }

def reference(A_x, A_c_kv, A_w_q, A_w_uk, A_w_uv, A_w_o, B_x, B_wqkv, B_wo):
    def _A_ref(x, c_kv, w_q, w_uk, w_uv, w_o):
        B, Sq, M = x.shape[0], x.shape[1], x.shape[2]
        Sk = c_kv.shape[1]
        H, D = w_q.shape[1], w_q.shape[2]
        q = torch.einsum("bqm,mhd->bhqd", x, w_q)
        k = torch.einsum("bkc,chd->bhkd", c_kv, w_uk)
        v = torch.einsum("bkc,chd->bhkd", c_kv, w_uv)
        scores = torch.einsum("bhqd,bhkd->bhqk", q, k) * (D ** -0.5)
        off = Sk - Sq
        qi = torch.arange(Sq)[:, None]
        kj = torch.arange(Sk)[None, :]
        cmask = kj <= (qi + off)
        scores = torch.where(cmask[None, None], scores, -1e9)
        p = _softmax(scores, axis=-1)
        ctx = torch.einsum("bhqk,bhkd->bhqd", p, v)
        return torch.einsum("bhqd,hdm->bqm", ctx, w_o)

    def _B_ref(x, wqkv, wo):
        B, S, D = x.shape
        H = 32; Dh = D // H
        W, dil = 8, 2
        qkv = (lambda x, *d: x.permute(*d))((x @ wqkv).reshape(B, S, 3, H, Dh), 2, 0, 3, 1, 4)
        q, k, v = qkv[0], qkv[1], qkv[2]
        scale = Dh ** -0.5
        pos = torch.arange(S)
        off = torch.arange(W) * dil
        idx = pos[:, None] - off[None, :]
        mask = idx >= 0
        idx_c = torch.where(mask, idx, 0).reshape(-1)
        kg = k[:, :, idx_c, :].reshape(B, H, S, W, Dh)
        vg = v[:, :, idx_c, :].reshape(B, H, S, W, Dh)
        logits = torch.einsum("bhsd,bhswd->bhsw", q, kg) * scale
        logits = torch.where(mask[None, None, :, :], logits, -1e9)
        attn = _softmax(logits, axis=-1)
        o = torch.einsum("bhsw,bhswd->bhsd", attn, vg)
        return (lambda x, *d: x.permute(*d))(o, 0, 2, 1, 3).reshape(B, S, D) @ wo

    a = _A_ref(A_x, A_c_kv, A_w_q, A_w_uk, A_w_uv, A_w_o)
    b = _B_ref(B_x, B_wqkv, B_wo)
    return torch.concatenate([a, b], axis=-1)
```

```asm
; @launch grid=(256,1,1) block=(512,1,1) lds=163840
.amdgcn_target "amdgcn-amd-amdhsa--gfx950"
.text
.globl concat_heads__compressed_kv_cla__sliding_local_dilated__prompt_kernel
.p2align 8
.type concat_heads__compressed_kv_cla__sliding_local_dilated__prompt_kernel,@function
concat_heads__compressed_kv_cla__sliding_local_dilated__prompt_kernel:
    s_cmp_ge_u32 s2, 256
    s_cbranch_scc1 L_end
    s_load_dwordx16 s[64:79], s[0:1], 0
    s_load_dwordx8 s[80:87], s[0:1], 64
    v_mov_b32 v241, v0
    v_lshrrev_b32 v1, 6, v0
    s_and_b32 s52, s2, 7
    s_lshr_b32 s53, s2, 3
    v_readfirstlane_b32 s54, v1
    v_and_b32 v1, 63, v0
    v_lshlrev_b32 v240, 4, v1
    v_bfe_u32 v242, v241, 4, 2
    v_bfe_u32 v243, v241, 0, 3
    v_xor_b32 v242, v242, v243
    v_lshlrev_b32 v242, 4, v242
    v_bfe_u32 v243, v241, 3, 3
    v_mul_u32_u24 v243, 1024, v243
    v_add_u32 v242, v242, v243
    v_add_u32 v20, 0, v242
    v_bfe_u32 v242, v241, 4, 2
    v_xor_b32 v242, 4, v242
    v_bfe_u32 v243, v241, 0, 3
    v_xor_b32 v242, v242, v243
    v_lshlrev_b32 v242, 4, v242
    v_bfe_u32 v243, v241, 3, 3
    v_mul_u32_u24 v243, 1024, v243
    v_add_u32 v242, v242, v243
    v_add_u32 v21, 7168, v242
    v_bfe_u32 v242, v241, 4, 2
    v_bfe_u32 v243, v241, 0, 3
    v_xor_b32 v242, v242, v243
    v_lshlrev_b32 v242, 4, v242
    v_bfe_u32 v243, v241, 3, 3
    v_mul_u32_u24 v243, 1024, v243
    v_add_u32 v242, v242, v243
    v_add_u32 v22, 14336, v242
    v_bfe_u32 v242, v241, 4, 2
    v_xor_b32 v242, 4, v242
    v_bfe_u32 v243, v241, 0, 3
    v_xor_b32 v242, v242, v243
    v_lshlrev_b32 v242, 4, v242
    v_bfe_u32 v243, v241, 3, 3
    v_mul_u32_u24 v243, 1024, v243
    v_add_u32 v242, v242, v243
    v_add_u32 v23, 21504, v242
    s_and_b32 s55, s54, 2
    v_bfe_u32 v244, v241, 5, 1
    v_add_u32 v242, 0, v244
    v_lshl_add_u32 v242, v242, 2, s55
    v_bfe_u32 v243, v241, 0, 5
    v_xor_b32 v243, v243, v242
    v_lshlrev_b32 v243, 4, v243
    v_lshl_add_u32 v243, v244, 13, v243
    v_add_u32 v24, 0, v243
    v_bfe_u32 v244, v241, 5, 1
    v_add_u32 v242, 2, v244
    v_lshl_add_u32 v242, v242, 2, s55
    v_bfe_u32 v243, v241, 0, 5
    v_xor_b32 v243, v243, v242
    v_lshlrev_b32 v243, 4, v243
    v_lshl_add_u32 v243, v244, 13, v243
    v_add_u32 v25, 15360, v243
    s_and_b32 s88, s53, 7
    s_lshr_b32 s89, s53, 3
    s_lshl_b32 s59, s54, 12
    s_lshl_b32 s60, s54, 11
    s_and_b32 s3, s89, 1
    s_lshl_b32 s3, s3, 1
    s_lshl_b32 s56, s52, 2
    s_add_u32 s3, s3, s56
    s_lshl_b32 s62, s3, 8
    s_lshl_b32 s56, s54, 15
    s_add_u32 s62, s62, s56
    s_lshl_b32 s61, s88, 18
    s_add_u32 s61, s61, s56
    s_waitcnt lgkmcnt(0)
    s_mov_b32 s8, s66
    s_mov_b32 s9, s67
    s_mov_b32 s10, 2097152
    s_mov_b32 s11, 0x20000
    s_cmp_ge_u32 s89, 2
    s_cselect_b32 s12, s72, s70
    s_cselect_b32 s13, s73, s71
    s_mov_b32 s14, 4194304
    s_mov_b32 s15, 0x20000
    s_add_u32 m0, s60, 98304
    s_add_u32 s58, s62, 0
    buffer_load_dwordx4 v24, s[12:15], s58 offen offset:0  lds
    buffer_load_dwordx4 v25, s[12:15], s58 offen offset:1024  lds
    s_add_u32 m0, s59, 0
    s_add_u32 s57, s61, 0
    buffer_load_dwordx4 v20, s[8:11], s57 offen offset:0  lds
    buffer_load_dwordx4 v21, s[8:11], s57 offen offset:1024  lds
    buffer_load_dwordx4 v22, s[8:11], s57 offen offset:2048  lds
    buffer_load_dwordx4 v23, s[8:11], s57 offen offset:3072  lds
    s_barrier
    s_add_u32 m0, s60, 114688
    s_add_u32 s58, s62, 262144
    buffer_load_dwordx4 v24, s[12:15], s58 offen offset:0  lds
    buffer_load_dwordx4 v25, s[12:15], s58 offen offset:1024  lds
    s_and_b32 s55, s54, 1
    s_lshl_b32 s56, s55, 14
    v_bfe_u32 v242, v241, 4, 2
    v_add_u32 v242, 0, v242
    v_bfe_u32 v243, v241, 1, 3
    v_xor_b32 v242, v242, v243
    v_lshlrev_b32 v242, 4, v242
    v_bfe_u32 v243, v241, 0, 4
    v_lshl_add_u32 v242, v243, 7, v242
    v_add_u32 v10, s56, v242
    v_bfe_u32 v242, v241, 4, 2
    v_add_u32 v242, 4, v242
    v_bfe_u32 v243, v241, 1, 3
    v_xor_b32 v242, v242, v243
    v_lshlrev_b32 v242, 4, v242
    v_bfe_u32 v243, v241, 0, 4
    v_lshl_add_u32 v242, v243, 7, v242
    v_add_u32 v11, s56, v242
    s_and_b32 s55, s54, 6
    s_lshl_b32 s55, s55, 1
    s_add_u32 s56, s55, 0
    v_bfe_u32 v242, v241, 2, 2
    v_bfe_u32 v244, v241, 4, 1
    v_lshl_add_u32 v243, v242, 1, v244
    v_xor_b32 v243, s56, v243
    v_lshlrev_b32 v243, 5, v243
    v_bfe_u32 v244, v241, 4, 2
    v_lshl_add_u32 v242, v244, 3, v242
    v_lshl_add_u32 v243, v242, 9, v243
    v_bfe_u32 v242, v241, 0, 2
    v_lshl_add_u32 v243, v242, 3, v243
    v_add_u32 v16, 98304, v243
    s_add_u32 s56, s55, 1
    v_bfe_u32 v242, v241, 2, 2
    v_bfe_u32 v244, v241, 4, 1
    v_lshl_add_u32 v243, v242, 1, v244
    v_xor_b32 v243, s56, v243
    v_lshlrev_b32 v243, 5, v243
    v_bfe_u32 v244, v241, 4, 2
    v_lshl_add_u32 v242, v244, 3, v242
    v_lshl_add_u32 v243, v242, 9, v243
    v_bfe_u32 v242, v241, 0, 2
    v_lshl_add_u32 v243, v242, 3, v243
    v_add_u32 v17, 98304, v243
    s_add_u32 s56, s55, 2
    v_bfe_u32 v242, v241, 2, 2
    v_bfe_u32 v244, v241, 4, 1
    v_lshl_add_u32 v243, v242, 1, v244
    v_xor_b32 v243, s56, v243
    v_lshlrev_b32 v243, 5, v243
    v_bfe_u32 v244, v241, 4, 2
    v_lshl_add_u32 v242, v244, 3, v242
    v_lshl_add_u32 v243, v242, 9, v243
    v_bfe_u32 v242, v241, 0, 2
    v_lshl_add_u32 v243, v242, 3, v243
    v_add_u32 v18, 98304, v243
    s_add_u32 s56, s55, 3
    v_bfe_u32 v242, v241, 2, 2
    v_bfe_u32 v244, v241, 4, 1
    v_lshl_add_u32 v243, v242, 1, v244
    v_xor_b32 v243, s56, v243
    v_lshlrev_b32 v243, 5, v243
    v_bfe_u32 v244, v241, 4, 2
    v_lshl_add_u32 v242, v244, 3, v242
    v_lshl_add_u32 v243, v242, 9, v243
    v_bfe_u32 v242, v241, 0, 2
    v_lshl_add_u32 v243, v242, 3, v243
    v_add_u32 v19, 98304, v243
    s_add_u32 m0, s59, 32768
    s_add_u32 s57, s61, 128
    buffer_load_dwordx4 v20, s[8:11], s57 offen offset:0  lds
    buffer_load_dwordx4 v21, s[8:11], s57 offen offset:1024  lds
    buffer_load_dwordx4 v22, s[8:11], s57 offen offset:2048  lds
    buffer_load_dwordx4 v23, s[8:11], s57 offen offset:3072  lds
    s_waitcnt vmcnt(6)
    s_barrier
    ds_read_b64_tr_b16 v[192:193], v16 offset:0
    ds_read_b64_tr_b16 v[194:195], v16 offset:2048
    ds_read_b128 v[224:227], v10 offset:0
    ds_read_b64_tr_b16 v[196:197], v17 offset:0
    ds_read_b64_tr_b16 v[198:199], v17 offset:2048
    ds_read_b128 v[228:231], v10 offset:2048
    ds_read_b64_tr_b16 v[200:201], v18 offset:0
    ds_read_b64_tr_b16 v[202:203], v18 offset:2048
    ds_read_b128 v[232:235], v10 offset:4096
    ds_read_b64_tr_b16 v[204:205], v19 offset:0
    ds_read_b64_tr_b16 v[206:207], v19 offset:2048
    s_cmp_ge_u32 s89, 2
    s_cbranch_scc1 L_V
    s_waitcnt lgkmcnt(8)
    v_mfma_f32_16x16x32_bf16 v[64:67], v[192:195], v[224:227], 0
    v_add_u32 v14, 0x10000, v10
    v_add_u32 v15, 0x10000, v11
    s_mov_b32 s16, s86
    s_mov_b32 s17, s87
    s_mov_b32 s18, 268435456
    s_waitcnt lgkmcnt(6)
    v_mfma_f32_16x16x32_bf16 v[68:71], v[196:199], v[224:227], 0
    ds_read_b128 v[236:239], v10 offset:6144
    s_waitcnt lgkmcnt(4)
    v_mfma_f32_16x16x32_bf16 v[80:83], v[200:203], v[224:227], 0
    s_add_u32 m0, s60, 131072
    s_add_u32 s58, s62, 524288
    buffer_load_dwordx4 v24, s[12:15], s58 offen offset:0  lds
    buffer_load_dwordx4 v25, s[12:15], s58 offen offset:1024  lds
    s_waitcnt lgkmcnt(1)
    v_mfma_f32_16x16x32_bf16 v[84:87], v[204:207], v[224:227], 0
    s_mov_b32 s19, 0x20000
    s_mov_b32 s20, s76
    s_mov_b32 s21, s77
    s_mov_b32 s22, 2621440
    s_mov_b32 s23, 0x20000
    v_mfma_f32_16x16x32_bf16 v[92:95], v[204:207], v[228:231], 0
    s_mov_b32 s24, s78
    s_mov_b32 s25, s79
    s_mov_b32 s26, 2457600
    s_mov_b32 s27, 0x20000
    s_mov_b32 s28, s64
    v_mfma_f32_16x16x32_bf16 v[88:91], v[200:203], v[228:231], 0
    ds_read_b128 v[224:227], v10 offset:8192
    v_mfma_f32_16x16x32_bf16 v[76:79], v[196:199], v[228:231], 0
    s_mov_b32 s29, s65
    s_mov_b32 s30, 2621440
    s_mov_b32 s31, 0x20000
    s_mov_b32 s32, s68
    s_mov_b32 s33, s69
    v_mfma_f32_16x16x32_bf16 v[72:75], v[192:195], v[228:231], 0
    v_mfma_f32_16x16x32_bf16 v[96:99], v[192:195], v[232:235], 0
    s_mov_b32 s34, 5242880
    s_mov_b32 s35, 0x20000
    s_mov_b32 s36, s74
    s_mov_b32 s37, s75
    s_mov_b32 s38, 5242880
    v_mfma_f32_16x16x32_bf16 v[100:103], v[196:199], v[232:235], 0
    ds_read_b128 v[228:231], v10 offset:10240
    v_mfma_f32_16x16x32_bf16 v[112:115], v[200:203], v[232:235], 0
    s_add_u32 m0, s60, 147456
    s_add_u32 s58, s62, 786432
    buffer_load_dwordx4 v24, s[12:15], s58 offen offset:0  lds
    buffer_load_dwordx4 v25, s[12:15], s58 offen offset:1024  lds
    v_mfma_f32_16x16x32_bf16 v[116:119], v[204:207], v[232:235], 0
    s_mov_b32 s39, 0x20000
    s_mov_b32 s40, s80
    s_mov_b32 s41, s81
    s_mov_b32 s42, 819200
    s_mov_b32 s43, 0x20000
    s_waitcnt lgkmcnt(2)
    v_mfma_f32_16x16x32_bf16 v[124:127], v[204:207], v[236:239], 0
    s_mov_b32 s44, s82
    s_mov_b32 s45, s83
    s_mov_b32 s46, 5242880
    s_mov_b32 s47, 0x20000
    s_mov_b32 s48, s84
    v_mfma_f32_16x16x32_bf16 v[120:123], v[200:203], v[236:239], 0
    ds_read_b128 v[232:235], v10 offset:12288
    v_mfma_f32_16x16x32_bf16 v[108:111], v[196:199], v[236:239], 0
    s_add_u32 m0, s59, 65536
    s_add_u32 s57, s61, 256
    buffer_load_dwordx4 v20, s[8:11], s57 offen offset:0  lds
    buffer_load_dwordx4 v21, s[8:11], s57 offen offset:1024  lds
    v_mfma_f32_16x16x32_bf16 v[104:107], v[192:195], v[236:239], 0
    s_mov_b32 s49, s85
    s_mov_b32 s50, 256
    s_mov_b32 s51, 0x20000
    s_lshl_b32 s55, s2, 3
    s_add_u32 s55, s55, s54
    s_cmp_lg_u32 s55, 4
    s_cbranch_scc1 L_nonon1
    s_memrealtime s[84:85]
    s_waitcnt lgkmcnt(0)
    s_or_b32 s84, s84, 1
    v_mov_b32 v4, s84
    v_mov_b32 v5, s85
    v_mov_b32 v8, 0
    s_mov_b64 exec, 1
    buffer_store_dwordx2 v[4:5], v8, s[48:51], 0 offen sc1
    s_mov_b64 exec, -1
L_nonon1:
    s_min_u32 s55, s53, 29
    s_waitcnt lgkmcnt(2)
    v_mfma_f32_16x16x32_bf16 v[128:131], v[192:195], v[224:227], 0
    s_and_b32 s56, s52, 1
    s_mul_i32 s56, s56, 30
    s_add_u32 s55, s55, s56
    s_lshr_b32 s64, s55, 2
    s_and_b32 s65, s55, 3
    v_mfma_f32_16x16x32_bf16 v[132:135], v[196:199], v[224:227], 0
    ds_read_b128 v[236:239], v10 offset:14336
    v_mfma_f32_16x16x32_bf16 v[144:147], v[200:203], v[224:227], 0
    s_add_u32 m0, s59, 65536
    s_add_u32 s57, s61, 256
    buffer_load_dwordx4 v22, s[8:11], s57 offen offset:2048  lds
    buffer_load_dwordx4 v23, s[8:11], s57 offen offset:3072  lds
    v_mfma_f32_16x16x32_bf16 v[148:151], v[204:207], v[224:227], 0
    s_lshr_b32 s56, s52, 1
    s_lshl_b32 s56, s56, 2
    s_add_u32 s65, s65, s56
    s_lshl_b32 s55, s65, 3
    s_add_u32 s55, s55, s54
    s_waitcnt lgkmcnt(2)
    v_mfma_f32_16x16x32_bf16 v[156:159], v[204:207], v[228:231], 0
    s_waitcnt vmcnt(12)
    s_waitcnt lgkmcnt(0)
    s_barrier
    s_mul_i32 s4, s55, 20480
    s_mul_i32 s5, s54, 30720
    s_lshl_b32 s55, s64, 8
    s_add_u32 s5, s5, s55
    s_and_b32 s56, s54, 1
    v_mfma_f32_16x16x32_bf16 v[152:155], v[200:203], v[228:231], 0
    ds_read_b128 v[224:227], v11 offset:0
    ds_read_b64_tr_b16 v[208:209], v16 offset:16384
    v_mfma_f32_16x16x32_bf16 v[140:143], v[196:199], v[228:231], 0
    ds_read_b64_tr_b16 v[210:211], v16 offset:18432
    ds_read_b64_tr_b16 v[212:213], v17 offset:16384
    v_mfma_f32_16x16x32_bf16 v[136:139], v[192:195], v[228:231], 0
    s_lshl_b32 s55, s65, 1
    s_add_u32 s55, s55, s56
    s_mul_i32 s66, s55, 245760
    s_lshr_b32 s56, s54, 1
    s_lshl_b32 s55, s64, 2
    v_mfma_f32_16x16x32_bf16 v[160:163], v[192:195], v[232:235], 0
    s_add_u32 s55, s55, s56
    s_lshl_b32 s55, s55, 11
    s_add_u32 s66, s66, s55
    s_add_u32 s66, s66, 50331648
    s_lshl_b32 s95, s65, 7
    ds_read_b128 v[228:231], v11 offset:2048
    v_mfma_f32_16x16x32_bf16 v[164:167], v[196:199], v[232:235], 0
    ds_read_b64_tr_b16 v[214:215], v17 offset:18432
    ds_read_b64_tr_b16 v[216:217], v18 offset:16384
    v_mfma_f32_16x16x32_bf16 v[176:179], v[200:203], v[232:235], 0
    ds_read_b64_tr_b16 v[218:219], v18 offset:18432
    s_add_u32 m0, s60, 98304
    s_add_u32 s58, s62, 1048576
    buffer_load_dwordx4 v24, s[12:15], s58 offen offset:0  lds
    buffer_load_dwordx4 v25, s[12:15], s58 offen offset:1024  lds
    v_mfma_f32_16x16x32_bf16 v[180:183], v[204:207], v[232:235], 0
    s_lshl_b32 s55, s64, 3
    s_add_u32 s95, s95, s55
    s_add_u32 s95, s95, 73404416
    s_lshl_b32 s94, s3, 6
    s_lshr_b32 s56, s89, 1
    v_mfma_f32_16x16x32_bf16 v[188:191], v[204:207], v[236:239], 0
    s_lshl_b32 s56, s56, 3
    s_add_u32 s56, s56, s88
    s_lshl_b32 s56, s56, 3
    s_add_u32 s94, s94, s56
    s_add_u32 s94, s94, 73400320
    ds_read_b128 v[232:235], v11 offset:4096
    v_mfma_f32_16x16x32_bf16 v[184:187], v[200:203], v[236:239], 0
    ds_read_b64_tr_b16 v[220:221], v19 offset:16384
    v_mfma_f32_16x16x32_bf16 v[172:175], v[196:199], v[236:239], 0
    ds_read_b64_tr_b16 v[222:223], v19 offset:18432
    v_mfma_f32_16x16x32_bf16 v[168:171], v[192:195], v[236:239], 0
    s_lshr_b32 s56, s54, 2
    s_add_u32 s55, s3, s56
    s_lshl_b32 s63, s55, 19
    s_lshl_b32 s55, s88, 16
    s_add_u32 s63, s63, s55
    s_waitcnt lgkmcnt(8)
    v_mfma_f32_16x16x32_bf16 v[64:67], v[208:211], v[224:227], v[64:67]
    s_and_b32 s55, s54, 1
    s_lshl_b32 s55, s55, 15
    s_add_u32 s63, s63, s55
    s_and_b32 s55, s54, 2
    s_lshl_b32 s55, s55, 11
    s_waitcnt lgkmcnt(5)
    v_mfma_f32_16x16x32_bf16 v[68:71], v[212:215], v[224:227], v[68:71]
    ds_read_b128 v[236:239], v11 offset:6144
    s_waitcnt lgkmcnt(4)
    v_mfma_f32_16x16x32_bf16 v[80:83], v[216:219], v[224:227], v[80:83]
    s_add_u32 s63, s63, s55
    s_lshr_b32 s55, s89, 1
    s_lshl_b32 s55, s55, 24
    s_add_u32 s63, s63, s55
    s_and_b32 s70, s53, 3
    s_waitcnt lgkmcnt(1)
    v_mfma_f32_16x16x32_bf16 v[84:87], v[220:223], v[224:227], v[84:87]
    v_mfma_f32_16x16x32_bf16 v[92:95], v[220:223], v[228:231], v[92:95]
    s_lshl_b32 s55, s52, 2
    s_add_u32 s70, s70, s55
    s_lshr_b32 s71, s53, 2
    s_lshl_b32 s55, s71, 2
    s_add_u32 s55, s55, s54
    v_mfma_f32_16x16x32_bf16 v[88:91], v[216:219], v[228:231], v[88:91]
    ds_read_b128 v[224:227], v11 offset:8192
    v_mfma_f32_16x16x32_bf16 v[76:79], v[212:215], v[228:231], v[76:79]
    s_sub_u32 s56, 63, s55
    s_sub_u32 s55, s55, 4
    s_cmp_lt_u32 s54, 4
    s_cselect_b32 s73, s56, s55
    s_lshl_b32 s72, s73, 5
    s_mul_i32 s68, s72, 1280
    v_mfma_f32_16x16x32_bf16 v[72:75], v[208:211], v[228:231], v[72:75]
    v_mfma_f32_16x16x32_bf16 v[96:99], v[208:211], v[232:235], v[96:99]
    s_mul_i32 s99, s55, 40960
    s_add_u32 s99, s99, 163840
    s_lshl_b32 s69, s70, 8
    s_lshl_b32 s55, s54, 16
    s_add_u32 s69, s69, s55
    v_mfma_f32_16x16x32_bf16 v[100:103], v[212:215], v[232:235], v[100:103]
    ds_read_b128 v[228:231], v11 offset:10240
    v_mfma_f32_16x16x32_bf16 v[112:115], v[216:219], v[232:235], v[112:115]
    s_getpc_b64 s[90:91]
L_pc1:
    s_and_b32 s90, s90, 0xffffff80
    s_lshl_b32 s6, s53, 3
    s_add_u32 s6, s6, s54
    s_lshl_b32 s6, s6, 10
    s_min_u32 s6, s6, (L_end-L_pc1-1024)&0xffffff80
    s_add_u32 s90, s90, s6
    s_addc_u32 s91, s91, 0
    v_mov_b32 v9, s91
    v_add_co_u32 v8, vcc, s90, v240
    s_nop 1
    v_addc_co_u32 v9, vcc, 0, v9, vcc
    global_load_dwordx4 v[60:63], v[8:9], off
    v_mfma_f32_16x16x32_bf16 v[116:119], v[220:223], v[232:235], v[116:119]
    v_bfe_u32 v242, v241, 4, 2
    v_bfe_u32 v243, v241, 0, 3
    v_xor_b32 v242, v242, v243
    v_lshlrev_b32 v242, 4, v242
    v_bfe_u32 v243, v241, 3, 3
    s_waitcnt lgkmcnt(2)
    v_mfma_f32_16x16x32_bf16 v[124:127], v[220:223], v[236:239], v[124:127]
    v_mul_u32_u24 v243, 1280, v243
    v_add_u32 v242, v242, v243
    v_add_u32 v26, 0, v242
    v_bfe_u32 v242, v241, 4, 2
    v_xor_b32 v242, 4, v242
    v_mfma_f32_16x16x32_bf16 v[120:123], v[216:219], v[236:239], v[120:123]
    ds_read_b128 v[232:235], v11 offset:12288
    v_mfma_f32_16x16x32_bf16 v[108:111], v[212:215], v[236:239], v[108:111]
    v_bfe_u32 v243, v241, 0, 3
    v_xor_b32 v242, v242, v243
    v_lshlrev_b32 v242, 4, v242
    v_bfe_u32 v243, v241, 3, 3
    v_mul_u32_u24 v243, 1280, v243
    v_mfma_f32_16x16x32_bf16 v[104:107], v[208:211], v[236:239], v[104:107]
    s_waitcnt lgkmcnt(2)
    v_mfma_f32_16x16x32_bf16 v[128:131], v[208:211], v[224:227], v[128:131]
    v_add_u32 v242, v242, v243
    v_add_u32 v27, 9216, v242
    v_bfe_u32 v242, v241, 4, 2
    v_bfe_u32 v243, v241, 2, 2
    v_xor_b32 v243, v243, v242
    v_mfma_f32_16x16x32_bf16 v[132:135], v[212:215], v[224:227], v[132:135]
    ds_read_b128 v[236:239], v11 offset:14336
    v_mfma_f32_16x16x32_bf16 v[144:147], v[216:219], v[224:227], v[144:147]
    v_lshlrev_b32 v243, 6, v243
    v_bfe_u32 v244, v241, 0, 2
    v_lshl_add_u32 v243, v244, 4, v243
    v_mul_u32_u24 v242, 3840, v242
    v_add_u32 v243, v243, v242
    v_mfma_f32_16x16x32_bf16 v[148:151], v[220:223], v[224:227], v[148:151]
    s_waitcnt lgkmcnt(2)
    v_mfma_f32_16x16x32_bf16 v[156:159], v[220:223], v[228:231], v[156:159]
    s_waitcnt vmcnt(9)
    s_waitcnt lgkmcnt(0)
    s_barrier
    v_add_u32 v28, 0, v243
    v_bfe_u32 v242, v241, 4, 2
    v_bfe_u32 v243, v241, 2, 2
    v_xor_b32 v243, v243, v242
    v_lshlrev_b32 v243, 6, v243
    v_mfma_f32_16x16x32_bf16 v[152:155], v[216:219], v[228:231], v[152:155]
    ds_read_b128 v[224:227], v10 offset:32768
    ds_read_b64_tr_b16 v[192:193], v16 offset:32768
    v_mfma_f32_16x16x32_bf16 v[140:143], v[212:215], v[228:231], v[140:143]
    ds_read_b64_tr_b16 v[194:195], v16 offset:34816
    ds_read_b64_tr_b16 v[196:197], v17 offset:32768
    v_mfma_f32_16x16x32_bf16 v[136:139], v[208:211], v[228:231], v[136:139]
    v_bfe_u32 v244, v241, 0, 2
    v_lshl_add_u32 v243, v244, 4, v243
    v_mul_u32_u24 v242, 3840, v242
    v_add_u32 v243, v243, v242
    v_add_u32 v29, 14336, v243
    v_mfma_f32_16x16x32_bf16 v[160:163], v[208:211], v[232:235], v[160:163]
    s_and_b32 s55, s54, 1
    s_lshl_b32 s55, s55, 13
    v_bfe_u32 v242, v241, 5, 1
    v_add_u32 v242, 0, v242
    v_bfe_u32 v243, v241, 1, 3
    ds_read_b128 v[228:231], v10 offset:34816
    v_mfma_f32_16x16x32_bf16 v[164:167], v[212:215], v[232:235], v[164:167]
    ds_read_b64_tr_b16 v[198:199], v17 offset:34816
    ds_read_b64_tr_b16 v[200:201], v18 offset:32768
    v_mfma_f32_16x16x32_bf16 v[176:179], v[216:219], v[232:235], v[176:179]
    ds_read_b64_tr_b16 v[202:203], v18 offset:34816
    s_add_u32 m0, s60, 114688
    s_add_u32 s58, s62, 1310720
    buffer_load_dwordx4 v24, s[12:15], s58 offen offset:0  lds
    buffer_load_dwordx4 v25, s[12:15], s58 offen offset:1024  lds
    v_mfma_f32_16x16x32_bf16 v[180:183], v[220:223], v[232:235], v[180:183]
    v_xor_b32 v242, v242, v243
    v_lshlrev_b32 v242, 4, v242
    v_bfe_u32 v243, v241, 0, 5
    v_lshl_add_u32 v242, v243, 7, v242
    v_add_u32 v32, s55, v242
    v_mfma_f32_16x16x32_bf16 v[188:191], v[220:223], v[236:239], v[188:191]
    v_bfe_u32 v242, v241, 5, 1
    v_add_u32 v242, 2, v242
    v_bfe_u32 v243, v241, 1, 3
    v_xor_b32 v242, v242, v243
    v_lshlrev_b32 v242, 4, v242
    ds_read_b128 v[232:235], v10 offset:36864
    v_mfma_f32_16x16x32_bf16 v[184:187], v[216:219], v[236:239], v[184:187]
    ds_read_b64_tr_b16 v[204:205], v19 offset:32768
    v_mfma_f32_16x16x32_bf16 v[172:175], v[212:215], v[236:239], v[172:175]
    ds_read_b64_tr_b16 v[206:207], v19 offset:34816
    v_mfma_f32_16x16x32_bf16 v[168:171], v[208:211], v[236:239], v[168:171]
    v_bfe_u32 v243, v241, 0, 5
    v_lshl_add_u32 v242, v243, 7, v242
    v_add_u32 v33, s55, v242
    v_bfe_u32 v242, v241, 5, 1
    v_add_u32 v242, 4, v242
    s_waitcnt lgkmcnt(8)
    v_mfma_f32_16x16x32_bf16 v[64:67], v[192:195], v[224:227], v[64:67]
    v_bfe_u32 v243, v241, 1, 3
    v_xor_b32 v242, v242, v243
    v_lshlrev_b32 v242, 4, v242
    v_bfe_u32 v243, v241, 0, 5
    v_lshl_add_u32 v242, v243, 7, v242
    s_waitcnt lgkmcnt(5)
    v_mfma_f32_16x16x32_bf16 v[68:71], v[196:199], v[224:227], v[68:71]
    ds_read_b128 v[236:239], v10 offset:38912
    s_waitcnt lgkmcnt(4)
    v_mfma_f32_16x16x32_bf16 v[80:83], v[200:203], v[224:227], v[80:83]
    v_add_u32 v34, s55, v242
    v_bfe_u32 v242, v241, 5, 1
    v_add_u32 v242, 6, v242
    v_bfe_u32 v243, v241, 1, 3
    v_xor_b32 v242, v242, v243
    s_waitcnt lgkmcnt(1)
    v_mfma_f32_16x16x32_bf16 v[84:87], v[204:207], v[224:227], v[84:87]
    v_mfma_f32_16x16x32_bf16 v[92:95], v[204:207], v[228:231], v[92:95]
    v_lshlrev_b32 v242, 4, v242
    v_bfe_u32 v243, v241, 0, 5
    v_lshl_add_u32 v242, v243, 7, v242
    v_add_u32 v35, s55, v242
    s_lshr_b32 s56, s54, 1
    v_mfma_f32_16x16x32_bf16 v[88:91], v[200:203], v[228:231], v[88:91]
    ds_read_b128 v[224:227], v10 offset:40960
    v_mfma_f32_16x16x32_bf16 v[76:79], v[196:199], v[228:231], v[76:79]
    s_add_u32 m0, s59, 0
    s_add_u32 s57, s61, 384
    buffer_load_dwordx4 v20, s[8:11], s57 offen offset:0  lds
    buffer_load_dwordx4 v21, s[8:11], s57 offen offset:1024  lds
    v_mfma_f32_16x16x32_bf16 v[72:75], v[192:195], v[228:231], v[72:75]
    v_bfe_u32 v242, v241, 2, 2
    v_xor_b32 v243, s56, v242
    v_lshlrev_b32 v243, 6, v243
    v_bfe_u32 v244, v241, 5, 1
    v_lshl_add_u32 v242, v244, 3, v242
    v_mfma_f32_16x16x32_bf16 v[96:99], v[192:195], v[232:235], v[96:99]
    v_lshl_add_u32 v243, v242, 8, v243
    v_bfe_u32 v242, v241, 4, 1
    v_lshl_add_u32 v243, v242, 5, v243
    v_bfe_u32 v242, v241, 0, 2
    v_lshl_add_u32 v243, v242, 3, v243
    v_mfma_f32_16x16x32_bf16 v[100:103], v[196:199], v[232:235], v[100:103]
    ds_read_b128 v[228:231], v10 offset:43008
    v_mfma_f32_16x16x32_bf16 v[112:115], v[200:203], v[232:235], v[112:115]
    v_add_u32 v36, 16384, v243
    v_mfma_f32_16x16x32_bf16 v[116:119], v[204:207], v[232:235], v[116:119]
    s_waitcnt lgkmcnt(2)
    v_mfma_f32_16x16x32_bf16 v[124:127], v[204:207], v[236:239], v[124:127]
    v_mfma_f32_16x16x32_bf16 v[120:123], v[200:203], v[236:239], v[120:123]
    ds_read_b128 v[232:235], v10 offset:45056
    v_mfma_f32_16x16x32_bf16 v[108:111], v[196:199], v[236:239], v[108:111]
    v_mfma_f32_16x16x32_bf16 v[104:107], v[192:195], v[236:239], v[104:107]
    s_waitcnt lgkmcnt(2)
    v_mfma_f32_16x16x32_bf16 v[128:131], v[192:195], v[224:227], v[128:131]
    v_mfma_f32_16x16x32_bf16 v[132:135], v[196:199], v[224:227], v[132:135]
    ds_read_b128 v[236:239], v10 offset:47104
    v_mfma_f32_16x16x32_bf16 v[144:147], v[200:203], v[224:227], v[144:147]
    v_mfma_f32_16x16x32_bf16 v[148:151], v[204:207], v[224:227], v[148:151]
    s_waitcnt lgkmcnt(2)
    v_mfma_f32_16x16x32_bf16 v[156:159], v[204:207], v[228:231], v[156:159]
    s_waitcnt vmcnt(11)
    s_waitcnt lgkmcnt(0)
    s_barrier
    v_mfma_f32_16x16x32_bf16 v[152:155], v[200:203], v[228:231], v[152:155]
    ds_read_b128 v[224:227], v11 offset:32768
    ds_read_b64_tr_b16 v[208:209], v16 offset:49152
    v_mfma_f32_16x16x32_bf16 v[140:143], v[196:199], v[228:231], v[140:143]
    ds_read_b64_tr_b16 v[210:211], v16 offset:51200
    ds_read_b64_tr_b16 v[212:213], v17 offset:49152
    v_mfma_f32_16x16x32_bf16 v[136:139], v[192:195], v[228:231], v[136:139]
    v_mfma_f32_16x16x32_bf16 v[160:163], v[192:195], v[232:235], v[160:163]
    ds_read_b128 v[228:231], v11 offset:34816
    v_mfma_f32_16x16x32_bf16 v[164:167], v[196:199], v[232:235], v[164:167]
    ds_read_b64_tr_b16 v[214:215], v17 offset:51200
    ds_read_b64_tr_b16 v[216:217], v18 offset:49152
    v_mfma_f32_16x16x32_bf16 v[176:179], v[200:203], v[232:235], v[176:179]
    ds_read_b64_tr_b16 v[218:219], v18 offset:51200
    s_add_u32 m0, s60, 131072
    s_add_u32 s58, s62, 1572864
    buffer_load_dwordx4 v24, s[12:15], s58 offen offset:0  lds
    buffer_load_dwordx4 v25, s[12:15], s58 offen offset:1024  lds
    v_mfma_f32_16x16x32_bf16 v[180:183], v[204:207], v[232:235], v[180:183]
    v_mfma_f32_16x16x32_bf16 v[188:191], v[204:207], v[236:239], v[188:191]
    ds_read_b128 v[232:235], v11 offset:36864
    v_mfma_f32_16x16x32_bf16 v[184:187], v[200:203], v[236:239], v[184:187]
    ds_read_b64_tr_b16 v[220:221], v19 offset:49152
    v_mfma_f32_16x16x32_bf16 v[172:175], v[196:199], v[236:239], v[172:175]
    ds_read_b64_tr_b16 v[222:223], v19 offset:51200
    v_mfma_f32_16x16x32_bf16 v[168:171], v[192:195], v[236:239], v[168:171]
    s_waitcnt lgkmcnt(8)
    v_mfma_f32_16x16x32_bf16 v[64:67], v[208:211], v[224:227], v[64:67]
    ds_read_b128 v[236:239], v11 offset:38912
    s_waitcnt lgkmcnt(6)
    v_mfma_f32_16x16x32_bf16 v[68:71], v[212:215], v[224:227], v[68:71]
    s_waitcnt lgkmcnt(4)
    v_mfma_f32_16x16x32_bf16 v[80:83], v[216:219], v[224:227], v[80:83]
    s_waitcnt lgkmcnt(1)
    v_mfma_f32_16x16x32_bf16 v[84:87], v[220:223], v[224:227], v[84:87]
    v_mfma_f32_16x16x32_bf16 v[92:95], v[220:223], v[228:231], v[92:95]
    ds_read_b128 v[224:227], v11 offset:40960
    v_mfma_f32_16x16x32_bf16 v[88:91], v[216:219], v[228:231], v[88:91]
    v_mfma_f32_16x16x32_bf16 v[76:79], v[212:215], v[228:231], v[76:79]
    s_add_u32 m0, s59, 0
    s_add_u32 s57, s61, 384
    buffer_load_dwordx4 v22, s[8:11], s57 offen offset:2048  lds
    buffer_load_dwordx4 v23, s[8:11], s57 offen offset:3072  lds
    v_mfma_f32_16x16x32_bf16 v[72:75], v[208:211], v[228:231], v[72:75]
    v_mfma_f32_16x16x32_bf16 v[96:99], v[208:211], v[232:235], v[96:99]
    ds_read_b128 v[228:231], v11 offset:43008
    v_mfma_f32_16x16x32_bf16 v[100:103], v[212:215], v[232:235], v[100:103]
    v_mfma_f32_16x16x32_bf16 v[112:115], v[216:219], v[232:235], v[112:115]
    v_mfma_f32_16x16x32_bf16 v[116:119], v[220:223], v[232:235], v[116:119]
    s_waitcnt lgkmcnt(2)
    v_mfma_f32_16x16x32_bf16 v[124:127], v[220:223], v[236:239], v[124:127]
    ds_read_b128 v[232:235], v11 offset:45056
    v_mfma_f32_16x16x32_bf16 v[120:123], v[216:219], v[236:239], v[120:123]
    v_mfma_f32_16x16x32_bf16 v[108:111], v[212:215], v[236:239], v[108:111]
    v_mfma_f32_16x16x32_bf16 v[104:107], v[208:211], v[236:239], v[104:107]
    s_waitcnt lgkmcnt(2)
    v_mfma_f32_16x16x32_bf16 v[128:131], v[208:211], v[224:227], v[128:131]
    ds_read_b128 v[236:239], v11 offset:47104
    v_mfma_f32_16x16x32_bf16 v[132:135], v[212:215], v[224:227], v[132:135]
    v_mfma_f32_16x16x32_bf16 v[144:147], v[216:219], v[224:227], v[144:147]
    v_mfma_f32_16x16x32_bf16 v[148:151], v[220:223], v[224:227], v[148:151]
    s_waitcnt lgkmcnt(2)
    v_mfma_f32_16x16x32_bf16 v[156:159], v[220:223], v[228:231], v[156:159]
    s_waitcnt vmcnt(9)
    s_waitcnt lgkmcnt(0)
    s_barrier
    ds_read_b128 v[224:227], v14 offset:0
    v_mfma_f32_16x16x32_bf16 v[152:155], v[216:219], v[228:231], v[152:155]
    ds_read_b64_tr_b16 v[192:193], v16 offset:0
    v_mfma_f32_16x16x32_bf16 v[140:143], v[212:215], v[228:231], v[140:143]
    ds_read_b64_tr_b16 v[194:195], v16 offset:2048
    v_mfma_f32_16x16x32_bf16 v[136:139], v[208:211], v[228:231], v[136:139]
    ds_read_b64_tr_b16 v[196:197], v17 offset:0
    v_mfma_f32_16x16x32_bf16 v[160:163], v[208:211], v[232:235], v[160:163]
    ds_read_b128 v[228:231], v14 offset:2048
    ds_read_b64_tr_b16 v[198:199], v17 offset:2048
    v_mfma_f32_16x16x32_bf16 v[164:167], v[212:215], v[232:235], v[164:167]
    ds_read_b64_tr_b16 v[200:201], v18 offset:0
    v_mfma_f32_16x16x32_bf16 v[176:179], v[216:219], v[232:235], v[176:179]
    ds_read_b64_tr_b16 v[202:203], v18 offset:2048
    v_mfma_f32_16x16x32_bf16 v[180:183], v[220:223], v[232:235], v[180:183]
    s_add_u32 m0, s60, 147456
    s_add_u32 s58, s62, 1835008
    buffer_load_dwordx4 v24, s[12:15], s58 offen offset:0  lds
    buffer_load_dwordx4 v25, s[12:15], s58 offen offset:1024  lds
    v_mfma_f32_16x16x32_bf16 v[188:191], v[220:223], v[236:239], v[188:191]
    ds_read_b128 v[232:235], v14 offset:4096
    v_mfma_f32_16x16x32_bf16 v[184:187], v[216:219], v[236:239], v[184:187]
    ds_read_b64_tr_b16 v[204:205], v19 offset:0
    v_mfma_f32_16x16x32_bf16 v[172:175], v[212:215], v[236:239], v[172:175]
    ds_read_b64_tr_b16 v[206:207], v19 offset:2048
    v_mfma_f32_16x16x32_bf16 v[168:171], v[208:211], v[236:239], v[168:171]
    s_waitcnt lgkmcnt(8)
    v_mfma_f32_16x16x32_bf16 v[64:67], v[192:195], v[224:227], v[64:67]
    ds_read_b128 v[236:239], v14 offset:6144
    s_waitcnt lgkmcnt(6)
    v_mfma_f32_16x16x32_bf16 v[68:71], v[196:199], v[224:227], v[68:71]
    s_waitcnt lgkmcnt(4)
    v_mfma_f32_16x16x32_bf16 v[80:83], v[200:203], v[224:227], v[80:83]
    s_waitcnt lgkmcnt(1)
    v_mfma_f32_16x16x32_bf16 v[84:87], v[204:207], v[224:227], v[84:87]
    v_mfma_f32_16x16x32_bf16 v[92:95], v[204:207], v[228:231], v[92:95]
    ds_read_b128 v[224:227], v14 offset:8192
    v_mfma_f32_16x16x32_bf16 v[88:91], v[200:203], v[228:231], v[88:91]
    v_mfma_f32_16x16x32_bf16 v[76:79], v[196:199], v[228:231], v[76:79]
    s_add_u32 m0, s59, 32768
    s_add_u32 s57, s61, 512
    buffer_load_dwordx4 v20, s[8:11], s57 offen offset:0  lds
    buffer_load_dwordx4 v21, s[8:11], s57 offen offset:1024  lds
    v_mfma_f32_16x16x32_bf16 v[72:75], v[192:195], v[228:231], v[72:75]
    v_mfma_f32_16x16x32_bf16 v[96:99], v[192:195], v[232:235], v[96:99]
    ds_read_b128 v[228:231], v14 offset:10240
    v_mfma_f32_16x16x32_bf16 v[100:103], v[196:199], v[232:235], v[100:103]
    v_mfma_f32_16x16x32_bf16 v[112:115], v[200:203], v[232:235], v[112:115]
    v_mfma_f32_16x16x32_bf16 v[116:119], v[204:207], v[232:235], v[116:119]
    s_waitcnt lgkmcnt(2)
    v_mfma_f32_16x16x32_bf16 v[124:127], v[204:207], v[236:239], v[124:127]
    ds_read_b128 v[232:235], v14 offset:12288
    v_mfma_f32_16x16x32_bf16 v[120:123], v[200:203], v[236:239], v[120:123]
    v_mfma_f32_16x16x32_bf16 v[108:111], v[196:199], v[236:239], v[108:111]
    v_mfma_f32_16x16x32_bf16 v[104:107], v[192:195], v[236:239], v[104:107]
    s_waitcnt lgkmcnt(2)
    v_mfma_f32_16x16x32_bf16 v[128:131], v[192:195], v[224:227], v[128:131]
    ds_read_b128 v[236:239], v14 offset:14336
    v_mfma_f32_16x16x32_bf16 v[132:135], v[196:199], v[224:227], v[132:135]
    v_mfma_f32_16x16x32_bf16 v[144:147], v[200:203], v[224:227], v[144:147]
    v_mfma_f32_16x16x32_bf16 v[148:151], v[204:207], v[224:227], v[148:151]
    s_waitcnt lgkmcnt(2)
    v_mfma_f32_16x16x32_bf16 v[156:159], v[204:207], v[228:231], v[156:159]
    s_waitcnt vmcnt(10)
    s_waitcnt lgkmcnt(0)
    s_barrier
    ds_read_b128 v[224:227], v15 offset:0
    v_mfma_f32_16x16x32_bf16 v[152:155], v[200:203], v[228:231], v[152:155]
    ds_read_b64_tr_b16 v[208:209], v16 offset:16384
    v_mfma_f32_16x16x32_bf16 v[140:143], v[196:199], v[228:231], v[140:143]
    ds_read_b64_tr_b16 v[210:211], v16 offset:18432
    v_mfma_f32_16x16x32_bf16 v[136:139], v[192:195], v[228:231], v[136:139]
    ds_read_b64_tr_b16 v[212:213], v17 offset:16384
    v_mfma_f32_16x16x32_bf16 v[160:163], v[192:195], v[232:235], v[160:163]
    ds_read_b128 v[228:231], v15 offset:2048
    ds_read_b64_tr_b16 v[214:215], v17 offset:18432
    v_mfma_f32_16x16x32_bf16 v[164:167], v[196:199], v[232:235], v[164:167]
    ds_read_b64_tr_b16 v[216:217], v18 offset:16384
    v_mfma_f32_16x16x32_bf16 v[176:179], v[200:203], v[232:235], v[176:179]
    ds_read_b64_tr_b16 v[218:219], v18 offset:18432
    v_mfma_f32_16x16x32_bf16 v[180:183], v[204:207], v[232:235], v[180:183]
    s_add_u32 m0, s60, 98304
    s_add_u32 s58, s62, 2097152
    buffer_load_dwordx4 v24, s[12:15], s58 offen offset:0  lds
    buffer_load_dwordx4 v25, s[12:15], s58 offen offset:1024  lds
    v_mfma_f32_16x16x32_bf16 v[188:191], v[204:207], v[236:239], v[188:191]
    ds_read_b128 v[232:235], v15 offset:4096
    v_mfma_f32_16x16x32_bf16 v[184:187], v[200:203], v[236:239], v[184:187]
    ds_read_b64_tr_b16 v[220:221], v19 offset:16384
    v_mfma_f32_16x16x32_bf16 v[172:175], v[196:199], v[236:239], v[172:175]
    ds_read_b64_tr_b16 v[222:223], v19 offset:18432
    v_mfma_f32_16x16x32_bf16 v[168:171], v[192:195], v[236:239], v[168:171]
    s_waitcnt lgkmcnt(8)
    v_mfma_f32_16x16x32_bf16 v[64:67], v[208:211], v[224:227], v[64:67]
    ds_read_b128 v[236:239], v15 offset:6144
    s_waitcnt lgkmcnt(6)
    v_mfma_f32_16x16x32_bf16 v[68:71], v[212:215], v[224:227], v[68:71]
    s_waitcnt lgkmcnt(4)
    v_mfma_f32_16x16x32_bf16 v[80:83], v[216:219], v[224:227], v[80:83]
    s_waitcnt lgkmcnt(1)
    v_mfma_f32_16x16x32_bf16 v[84:87], v[220:223], v[224:227], v[84:87]
    v_mfma_f32_16x16x32_bf16 v[92:95], v[220:223], v[228:231], v[92:95]
    ds_read_b128 v[224:227], v15 offset:8192
    v_mfma_f32_16x16x32_bf16 v[88:91], v[216:219], v[228:231], v[88:91]
    v_mfma_f32_16x16x32_bf16 v[76:79], v[212:215], v[228:231], v[76:79]
    s_add_u32 m0, s59, 32768
    s_add_u32 s57, s61, 512
    buffer_load_dwordx4 v22, s[8:11], s57 offen offset:2048  lds
    buffer_load_dwordx4 v23, s[8:11], s57 offen offset:3072  lds
    v_mfma_f32_16x16x32_bf16 v[72:75], v[208:211], v[228:231], v[72:75]
    v_mfma_f32_16x16x32_bf16 v[96:99], v[208:211], v[232:235], v[96:99]
    ds_read_b128 v[228:231], v15 offset:10240
    v_mfma_f32_16x16x32_bf16 v[100:103], v[212:215], v[232:235], v[100:103]
    v_mfma_f32_16x16x32_bf16 v[112:115], v[216:219], v[232:235], v[112:115]
    v_mfma_f32_16x16x32_bf16 v[116:119], v[220:223], v[232:235], v[116:119]
    s_waitcnt lgkmcnt(2)
    v_mfma_f32_16x16x32_bf16 v[124:127], v[220:223], v[236:239], v[124:127]
    ds_read_b128 v[232:235], v15 offset:12288
    v_mfma_f32_16x16x32_bf16 v[120:123], v[216:219], v[236:239], v[120:123]
    v_mfma_f32_16x16x32_bf16 v[108:111], v[212:215], v[236:239], v[108:111]
    v_mfma_f32_16x16x32_bf16 v[104:107], v[208:211], v[236:239], v[104:107]
    s_waitcnt lgkmcnt(2)
    v_mfma_f32_16x16x32_bf16 v[128:131], v[208:211], v[224:227], v[128:131]
    ds_read_b128 v[236:239], v15 offset:14336
    v_mfma_f32_16x16x32_bf16 v[132:135], v[212:215], v[224:227], v[132:135]
    v_mfma_f32_16x16x32_bf16 v[144:147], v[216:219], v[224:227], v[144:147]
    v_mfma_f32_16x16x32_bf16 v[148:151], v[220:223], v[224:227], v[148:151]
    s_waitcnt lgkmcnt(2)
    v_mfma_f32_16x16x32_bf16 v[156:159], v[220:223], v[228:231], v[156:159]
    s_waitcnt vmcnt(8)
    s_waitcnt lgkmcnt(0)
    s_barrier
    ds_read_b128 v[224:227], v10 offset:0
    v_mfma_f32_16x16x32_bf16 v[152:155], v[216:219], v[228:231], v[152:155]
    ds_read_b64_tr_b16 v[192:193], v16 offset:32768
    v_mfma_f32_16x16x32_bf16 v[140:143], v[212:215], v[228:231], v[140:143]
    ds_read_b64_tr_b16 v[194:195], v16 offset:34816
    v_mfma_f32_16x16x32_bf16 v[136:139], v[208:211], v[228:231], v[136:139]
    ds_read_b64_tr_b16 v[196:197], v17 offset:32768
    v_mfma_f32_16x16x32_bf16 v[160:163], v[208:211], v[232:235], v[160:163]
    ds_read_b128 v[228:231], v10 offset:2048
    ds_read_b64_tr_b16 v[198:199], v17 offset:34816
    v_mfma_f32_16x16x32_bf16 v[164:167], v[212:215], v[232:235], v[164:167]
    ds_read_b64_tr_b16 v[200:201], v18 offset:32768
    v_mfma_f32_16x16x32_bf16 v[176:179], v[216:219], v[232:235], v[176:179]
    ds_read_b64_tr_b16 v[202:203], v18 offset:34816
    v_mfma_f32_16x16x32_bf16 v[180:183], v[220:223], v[232:235], v[180:183]
    s_add_u32 m0, s60, 114688
    s_add_u32 s58, s62, 2359296
    buffer_load_dwordx4 v24, s[12:15], s58 offen offset:0  lds
    buffer_load_dwordx4 v25, s[12:15], s58 offen offset:1024  lds
    v_mfma_f32_16x16x32_bf16 v[188:191], v[220:223], v[236:239], v[188:191]
    ds_read_b128 v[232:235], v10 offset:4096
    v_mfma_f32_16x16x32_bf16 v[184:187], v[216:219], v[236:239], v[184:187]
    ds_read_b64_tr_b16 v[204:205], v19 offset:32768
    v_mfma_f32_16x16x32_bf16 v[172:175], v[212:215], v[236:239], v[172:175]
    ds_read_b64_tr_b16 v[206:207], v19 offset:34816
    v_mfma_f32_16x16x32_bf16 v[168:171], v[208:211], v[236:239], v[168:171]
    s_waitcnt lgkmcnt(8)
    v_mfma_f32_16x16x32_bf16 v[64:67], v[192:195], v[224:227], v[64:67]
    ds_read_b128 v[236:239], v10 offset:6144
    s_waitcnt lgkmcnt(6)
    v_mfma_f32_16x16x32_bf16 v[68:71], v[196:199], v[224:227], v[68:71]
    s_waitcnt lgkmcnt(4)
    v_mfma_f32_16x16x32_bf16 v[80:83], v[200:203], v[224:227], v[80:83]
    s_waitcnt lgkmcnt(1)
    v_mfma_f32_16x16x32_bf16 v[84:87], v[204:207], v[224:227], v[84:87]
    v_mfma_f32_16x16x32_bf16 v[92:95], v[204:207], v[228:231], v[92:95]
    ds_read_b128 v[224:227], v10 offset:8192
    v_mfma_f32_16x16x32_bf16 v[88:91], v[200:203], v[228:231], v[88:91]
    v_mfma_f32_16x16x32_bf16 v[76:79], v[196:199], v[228:231], v[76:79]
    s_add_u32 m0, s59, 65536
    s_add_u32 s57, s61, 640
    buffer_load_dwordx4 v20, s[8:11], s57 offen offset:0  lds
    buffer_load_dwordx4 v21, s[8:11], s57 offen offset:1024  lds
    v_mfma_f32_16x16x32_bf16 v[72:75], v[192:195], v[228:231], v[72:75]
    v_mfma_f32_16x16x32_bf16 v[96:99], v[192:195], v[232:235], v[96:99]
    ds_read_b128 v[228:231], v10 offset:10240
    v_mfma_f32_16x16x32_bf16 v[100:103], v[196:199], v[232:235], v[100:103]
    v_mfma_f32_16x16x32_bf16 v[112:115], v[200:203], v[232:235], v[112:115]
    v_mfma_f32_16x16x32_bf16 v[116:119], v[204:207], v[232:235], v[116:119]
    s_waitcnt lgkmcnt(2)
    v_mfma_f32_16x16x32_bf16 v[124:127], v[204:207], v[236:239], v[124:127]
    ds_read_b128 v[232:235], v10 offset:12288
    v_mfma_f32_16x16x32_bf16 v[120:123], v[200:203], v[236:239], v[120:123]
    v_mfma_f32_16x16x32_bf16 v[108:111], v[196:199], v[236:239], v[108:111]
    v_mfma_f32_16x16x32_bf16 v[104:107], v[192:195], v[236:239], v[104:107]
    s_waitcnt lgkmcnt(2)
    v_mfma_f32_16x16x32_bf16 v[128:131], v[192:195], v[224:227], v[128:131]
    ds_read_b128 v[236:239], v10 offset:14336
    v_mfma_f32_16x16x32_bf16 v[132:135], v[196:199], v[224:227], v[132:135]
    v_mfma_f32_16x16x32_bf16 v[144:147], v[200:203], v[224:227], v[144:147]
    v_mfma_f32_16x16x32_bf16 v[148:151], v[204:207], v[224:227], v[148:151]
    s_waitcnt lgkmcnt(2)
    v_mfma_f32_16x16x32_bf16 v[156:159], v[204:207], v[228:231], v[156:159]
    s_waitcnt vmcnt(10)
    s_waitcnt lgkmcnt(0)
    s_barrier
    ds_read_b128 v[224:227], v11 offset:0
    v_mfma_f32_16x16x32_bf16 v[152:155], v[200:203], v[228:231], v[152:155]
    ds_read_b64_tr_b16 v[208:209], v16 offset:49152
    v_mfma_f32_16x16x32_bf16 v[140:143], v[196:199], v[228:231], v[140:143]
    ds_read_b64_tr_b16 v[210:211], v16 offset:51200
    v_mfma_f32_16x16x32_bf16 v[136:139], v[192:195], v[228:231], v[136:139]
    ds_read_b64_tr_b16 v[212:213], v17 offset:49152
    v_mfma_f32_16x16x32_bf16 v[160:163], v[192:195], v[232:235], v[160:163]
    ds_read_b128 v[228:231], v11 offset:2048
    ds_read_b64_tr_b16 v[214:215], v17 offset:51200
    v_mfma_f32_16x16x32_bf16 v[164:167], v[196:199], v[232:235], v[164:167]
    ds_read_b64_tr_b16 v[216:217], v18 offset:49152
    v_mfma_f32_16x16x32_bf16 v[176:179], v[200:203], v[232:235], v[176:179]
    ds_read_b64_tr_b16 v[218:219], v18 offset:51200
    v_mfma_f32_16x16x32_bf16 v[180:183], v[204:207], v[232:235], v[180:183]
    s_add_u32 m0, s60, 131072
    s_add_u32 s58, s62, 2621440
    buffer_load_dwordx4 v24, s[12:15], s58 offen offset:0  lds
    buffer_load_dwordx4 v25, s[12:15], s58 offen offset:1024  lds
    v_mfma_f32_16x16x32_bf16 v[188:191], v[204:207], v[236:239], v[188:191]
    ds_read_b128 v[232:235], v11 offset:4096
    v_mfma_f32_16x16x32_bf16 v[184:187], v[200:203], v[236:239], v[184:187]
    ds_read_b64_tr_b16 v[220:221], v19 offset:49152
    v_mfma_f32_16x16x32_bf16 v[172:175], v[196:199], v[236:239], v[172:175]
    ds_read_b64_tr_b16 v[222:223], v19 offset:51200
    v_mfma_f32_16x16x32_bf16 v[168:171], v[192:195], v[236:239], v[168:171]
    s_waitcnt lgkmcnt(8)
    v_mfma_f32_16x16x32_bf16 v[64:67], v[208:211], v[224:227], v[64:67]
    ds_read_b128 v[236:239], v11 offset:6144
    s_waitcnt lgkmcnt(6)
    v_mfma_f32_16x16x32_bf16 v[68:71], v[212:215], v[224:227], v[68:71]
    s_waitcnt lgkmcnt(4)
    v_mfma_f32_16x16x32_bf16 v[80:83], v[216:219], v[224:227], v[80:83]
    s_waitcnt lgkmcnt(1)
    v_mfma_f32_16x16x32_bf16 v[84:87], v[220:223], v[224:227], v[84:87]
    v_mfma_f32_16x16x32_bf16 v[92:95], v[220:223], v[228:231], v[92:95]
    ds_read_b128 v[224:227], v11 offset:8192
    v_mfma_f32_16x16x32_bf16 v[88:91], v[216:219], v[228:231], v[88:91]
    v_mfma_f32_16x16x32_bf16 v[76:79], v[212:215], v[228:231], v[76:79]
    s_add_u32 m0, s59, 65536
    s_add_u32 s57, s61, 640
    buffer_load_dwordx4 v22, s[8:11], s57 offen offset:2048  lds
    buffer_load_dwordx4 v23, s[8:11], s57 offen offset:3072  lds
    v_mfma_f32_16x16x32_bf16 v[72:75], v[208:211], v[228:231], v[72:75]
    v_mfma_f32_16x16x32_bf16 v[96:99], v[208:211], v[232:235], v[96:99]
    ds_read_b128 v[228:231], v11 offset:10240
    v_mfma_f32_16x16x32_bf16 v[100:103], v[212:215], v[232:235], v[100:103]
    v_mfma_f32_16x16x32_bf16 v[112:115], v[216:219], v[232:235], v[112:115]
    v_mfma_f32_16x16x32_bf16 v[116:119], v[220:223], v[232:235], v[116:119]
    s_waitcnt lgkmcnt(2)
    v_mfma_f32_16x16x32_bf16 v[124:127], v[220:223], v[236:239], v[124:127]
    ds_read_b128 v[232:235], v11 offset:12288
    v_mfma_f32_16x16x32_bf16 v[120:123], v[216:219], v[236:239], v[120:123]
    v_mfma_f32_16x16x32_bf16 v[108:111], v[212:215], v[236:239], v[108:111]
    v_mfma_f32_16x16x32_bf16 v[104:107], v[208:211], v[236:239], v[104:107]
    s_waitcnt lgkmcnt(2)
    v_mfma_f32_16x16x32_bf16 v[128:131], v[208:211], v[224:227], v[128:131]
    ds_read_b128 v[236:239], v11 offset:14336
    v_mfma_f32_16x16x32_bf16 v[132:135], v[212:215], v[224:227], v[132:135]
    v_mfma_f32_16x16x32_bf16 v[144:147], v[216:219], v[224:227], v[144:147]
    v_mfma_f32_16x16x32_bf16 v[148:151], v[220:223], v[224:227], v[148:151]
    s_waitcnt lgkmcnt(2)
    v_mfma_f32_16x16x32_bf16 v[156:159], v[220:223], v[228:231], v[156:159]
    s_waitcnt vmcnt(8)
    s_waitcnt lgkmcnt(0)
    s_barrier
    ds_read_b128 v[224:227], v10 offset:32768
    v_mfma_f32_16x16x32_bf16 v[152:155], v[216:219], v[228:231], v[152:155]
    ds_read_b64_tr_b16 v[192:193], v16 offset:0
    v_mfma_f32_16x16x32_bf16 v[140:143], v[212:215], v[228:231], v[140:143]
    ds_read_b64_tr_b16 v[194:195], v16 offset:2048
    v_mfma_f32_16x16x32_bf16 v[136:139], v[208:211], v[228:231], v[136:139]
    ds_read_b64_tr_b16 v[196:197], v17 offset:0
    v_mfma_f32_16x16x32_bf16 v[160:163], v[208:211], v[232:235], v[160:163]
    ds_read_b128 v[228:231], v10 offset:34816
    ds_read_b64_tr_b16 v[198:199], v17 offset:2048
    v_mfma_f32_16x16x32_bf16 v[164:167], v[212:215], v[232:235], v[164:167]
    ds_read_b64_tr_b16 v[200:201], v18 offset:0
    v_mfma_f32_16x16x32_bf16 v[176:179], v[216:219], v[232:235], v[176:179]
    ds_read_b64_tr_b16 v[202:203], v18 offset:2048
    v_mfma_f32_16x16x32_bf16 v[180:183], v[220:223], v[232:235], v[180:183]
    s_add_u32 m0, s60, 147456
    s_add_u32 s58, s62, 2883584
    buffer_load_dwordx4 v24, s[12:15], s58 offen offset:0  lds
    buffer_load_dwordx4 v25, s[12:15], s58 offen offset:1024  lds
    v_mfma_f32_16x16x32_bf16 v[188:191], v[220:223], v[236:239], v[188:191]
    ds_read_b128 v[232:235], v10 offset:36864
    v_mfma_f32_16x16x32_bf16 v[184:187], v[216:219], v[236:239], v[184:187]
    ds_read_b64_tr_b16 v[204:205], v19 offset:0
    v_mfma_f32_16x16x32_bf16 v[172:175], v[212:215], v[236:239], v[172:175]
    ds_read_b64_tr_b16 v[206:207], v19 offset:2048
    v_mfma_f32_16x16x32_bf16 v[168:171], v[208:211], v[236:239], v[168:171]
    s_waitcnt lgkmcnt(8)
    v_mfma_f32_16x16x32_bf16 v[64:67], v[192:195], v[224:227], v[64:67]
    ds_read_b128 v[236:239], v10 offset:38912
    s_waitcnt lgkmcnt(6)
    v_mfma_f32_16x16x32_bf16 v[68:71], v[196:199], v[224:227], v[68:71]
    s_waitcnt lgkmcnt(4)
    v_mfma_f32_16x16x32_bf16 v[80:83], v[200:203], v[224:227], v[80:83]
    s_waitcnt lgkmcnt(1)
    v_mfma_f32_16x16x32_bf16 v[84:87], v[204:207], v[224:227], v[84:87]
    v_mfma_f32_16x16x32_bf16 v[92:95], v[204:207], v[228:231], v[92:95]
    ds_read_b128 v[224:227], v10 offset:40960
    v_mfma_f32_16x16x32_bf16 v[88:91], v[200:203], v[228:231], v[88:91]
    v_mfma_f32_16x16x32_bf16 v[76:79], v[196:199], v[228:231], v[76:79]
    s_add_u32 m0, s59, 0
    s_add_u32 s57, s61, 768
    buffer_load_dwordx4 v20, s[8:11], s57 offen offset:0  lds
    buffer_load_dwordx4 v21, s[8:11], s57 offen offset:1024  lds
    v_mfma_f32_16x16x32_bf16 v[72:75], v[192:195], v[228:231], v[72:75]
    v_mfma_f32_16x16x32_bf16 v[96:99], v[192:195], v[232:235], v[96:99]
    ds_read_b128 v[228:231], v10 offset:43008
    v_mfma_f32_16x16x32_bf16 v[100:103], v[196:199], v[232:235], v[100:103]
    v_mfma_f32_16x16x32_bf16 v[112:115], v[200:203], v[232:235], v[112:115]
    s_lshl_b32 s6, s2, 3
    s_add_u32 s6, s6, s54
    s_mul_i32 s6, s6, 1280
    buffer_load_dwordx4 v[60:63], v240, s[20:23], s6 offen
    v_mfma_f32_16x16x32_bf16 v[116:119], v[204:207], v[232:235], v[116:119]
    s_waitcnt lgkmcnt(2)
    v_mfma_f32_16x16x32_bf16 v[124:127], v[204:207], v[236:239], v[124:127]
    ds_read_b128 v[232:235], v10 offset:45056
    v_mfma_f32_16x16x32_bf16 v[120:123], v[200:203], v[236:239], v[120:123]
    v_mfma_f32_16x16x32_bf16 v[108:111], v[196:199], v[236:239], v[108:111]
    v_mfma_f32_16x16x32_bf16 v[104:107], v[192:195], v[236:239], v[104:107]
    s_waitcnt lgkmcnt(2)
    v_mfma_f32_16x16x32_bf16 v[128:131], v[192:195], v[224:227], v[128:131]
    ds_read_b128 v[236:239], v10 offset:47104
    v_mfma_f32_16x16x32_bf16 v[132:135], v[196:199], v[224:227], v[132:135]
    v_mfma_f32_16x16x32_bf16 v[144:147], v[200:203], v[224:227], v[144:147]
    s_lshl_b32 s6, s2, 3
    s_add_u32 s6, s6, s54
    s_mul_i32 s6, s6, 1280
    s_add_u32 s6, s6, 1024
    buffer_load_dwordx4 v[60:63], v240, s[20:23], s6 offen
    v_mfma_f32_16x16x32_bf16 v[148:151], v[204:207], v[224:227], v[148:151]
    s_waitcnt lgkmcnt(2)
    v_mfma_f32_16x16x32_bf16 v[156:159], v[204:207], v[228:231], v[156:159]
    s_waitcnt vmcnt(12)
    s_waitcnt lgkmcnt(0)
    s_barrier
    ds_read_b128 v[224:227], v11 offset:32768
    v_mfma_f32_16x16x32_bf16 v[152:155], v[200:203], v[228:231], v[152:155]
    ds_read_b64_tr_b16 v[208:209], v16 offset:16384
    v_mfma_f32_16x16x32_bf16 v[140:143], v[196:199], v[228:231], v[140:143]
    ds_read_b64_tr_b16 v[210:211], v16 offset:18432
    v_mfma_f32_16x16x32_bf16 v[136:139], v[192:195], v[228:231], v[136:139]
    ds_read_b64_tr_b16 v[212:213], v17 offset:16384
    v_mfma_f32_16x16x32_bf16 v[160:163], v[192:195], v[232:235], v[160:163]
    ds_read_b128 v[228:231], v11 offset:34816
    ds_read_b64_tr_b16 v[214:215], v17 offset:18432
    v_mfma_f32_16x16x32_bf16 v[164:167], v[196:199], v[232:235], v[164:167]
    ds_read_b64_tr_b16 v[216:217], v18 offset:16384
    v_mfma_f32_16x16x32_bf16 v[176:179], v[200:203], v[232:235], v[176:179]
    ds_read_b64_tr_b16 v[218:219], v18 offset:18432
    v_mfma_f32_16x16x32_bf16 v[180:183], v[204:207], v[232:235], v[180:183]
    s_add_u32 m0, s60, 98304
    s_add_u32 s58, s62, 3145728
    buffer_load_dwordx4 v24, s[12:15], s58 offen offset:0  lds
    buffer_load_dwordx4 v25, s[12:15], s58 offen offset:1024  lds
    v_mfma_f32_16x16x32_bf16 v[188:191], v[204:207], v[236:239], v[188:191]
    ds_read_b128 v[232:235], v11 offset:36864
    v_mfma_f32_16x16x32_bf16 v[184:187], v[200:203], v[236:239], v[184:187]
    ds_read_b64_tr_b16 v[220:221], v19 offset:16384
    v_mfma_f32_16x16x32_bf16 v[172:175], v[196:199], v[236:239], v[172:175]
    ds_read_b64_tr_b16 v[222:223], v19 offset:18432
    v_mfma_f32_16x16x32_bf16 v[168:171], v[192:195], v[236:239], v[168:171]
    s_waitcnt lgkmcnt(8)
    v_mfma_f32_16x16x32_bf16 v[64:67], v[208:211], v[224:227], v[64:67]
    ds_read_b128 v[236:239], v11 offset:38912
    s_waitcnt lgkmcnt(6)
    v_mfma_f32_16x16x32_bf16 v[68:71], v[212:215], v[224:227], v[68:71]
    s_waitcnt lgkmcnt(4)
    v_mfma_f32_16x16x32_bf16 v[80:83], v[216:219], v[224:227], v[80:83]
    s_waitcnt lgkmcnt(1)
    v_mfma_f32_16x16x32_bf16 v[84:87], v[220:223], v[224:227], v[84:87]
    v_mfma_f32_16x16x32_bf16 v[92:95], v[220:223], v[228:231], v[92:95]
    ds_read_b128 v[224:227], v11 offset:40960
    v_mfma_f32_16x16x32_bf16 v[88:91], v[216:219], v[228:231], v[88:91]
    v_mfma_f32_16x16x32_bf16 v[76:79], v[212:215], v[228:231], v[76:79]
    s_add_u32 m0, s59, 0
    s_add_u32 s57, s61, 768
    buffer_load_dwordx4 v22, s[8:11], s57 offen offset:2048  lds
    buffer_load_dwordx4 v23, s[8:11], s57 offen offset:3072  lds
    v_mfma_f32_16x16x32_bf16 v[72:75], v[208:211], v[228:231], v[72:75]
    v_mfma_f32_16x16x32_bf16 v[96:99], v[208:211], v[232:235], v[96:99]
    ds_read_b128 v[228:231], v11 offset:43008
    v_mfma_f32_16x16x32_bf16 v[100:103], v[212:215], v[232:235], v[100:103]
    v_mfma_f32_16x16x32_bf16 v[112:115], v[216:219], v[232:235], v[112:115]
    s_lshl_b32 s6, s2, 3
    s_add_u32 s6, s6, s54
    s_mul_i32 s6, s6, 1200
    buffer_load_dwordx4 v[60:63], v240, s[24:27], s6 offen
    v_mfma_f32_16x16x32_bf16 v[116:119], v[220:223], v[232:235], v[116:119]
    s_waitcnt lgkmcnt(2)
    v_mfma_f32_16x16x32_bf16 v[124:127], v[220:223], v[236:239], v[124:127]
    ds_read_b128 v[232:235], v11 offset:45056
    v_mfma_f32_16x16x32_bf16 v[120:123], v[216:219], v[236:239], v[120:123]
    v_mfma_f32_16x16x32_bf16 v[108:111], v[212:215], v[236:239], v[108:111]
    v_mfma_f32_16x16x32_bf16 v[104:107], v[208:211], v[236:239], v[104:107]
    s_waitcnt lgkmcnt(2)
    v_mfma_f32_16x16x32_bf16 v[128:131], v[208:211], v[224:227], v[128:131]
    ds_read_b128 v[236:239], v11 offset:47104
    v_mfma_f32_16x16x32_bf16 v[132:135], v[212:215], v[224:227], v[132:135]
    v_mfma_f32_16x16x32_bf16 v[144:147], v[216:219], v[224:227], v[144:147]
    s_lshl_b32 s6, s2, 3
    s_add_u32 s6, s6, s54
    s_mul_i32 s6, s6, 1200
    s_add_u32 s6, s6, 1024
    buffer_load_dwordx4 v[60:63], v240, s[24:27], s6 offen
    v_mfma_f32_16x16x32_bf16 v[148:151], v[220:223], v[224:227], v[148:151]
    s_waitcnt lgkmcnt(2)
    v_mfma_f32_16x16x32_bf16 v[156:159], v[220:223], v[228:231], v[156:159]
    s_waitcnt vmcnt(12)
    s_waitcnt lgkmcnt(0)
    s_barrier
    ds_read_b128 v[224:227], v14 offset:0
    v_mfma_f32_16x16x32_bf16 v[152:155], v[216:219], v[228:231], v[152:155]
    ds_read_b64_tr_b16 v[192:193], v16 offset:32768
    v_mfma_f32_16x16x32_bf16 v[140:143], v[212:215], v[228:231], v[140:143]
    ds_read_b64_tr_b16 v[194:195], v16 offset:34816
    v_mfma_f32_16x16x32_bf16 v[136:139], v[208:211], v[228:231], v[136:139]
    ds_read_b64_tr_b16 v[196:197], v17 offset:32768
    v_mfma_f32_16x16x32_bf16 v[160:163], v[208:211], v[232:235], v[160:163]
    ds_read_b128 v[228:231], v14 offset:2048
    ds_read_b64_tr_b16 v[198:199], v17 offset:34816
    v_mfma_f32_16x16x32_bf16 v[164:167], v[212:215], v[232:235], v[164:167]
    ds_read_b64_tr_b16 v[200:201], v18 offset:32768
    v_mfma_f32_16x16x32_bf16 v[176:179], v[216:219], v[232:235], v[176:179]
    ds_read_b64_tr_b16 v[202:203], v18 offset:34816
    v_mfma_f32_16x16x32_bf16 v[180:183], v[220:223], v[232:235], v[180:183]
    s_add_u32 m0, s60, 114688
    s_add_u32 s58, s62, 3407872
    buffer_load_dwordx4 v24, s[12:15], s58 offen offset:0  lds
    buffer_load_dwordx4 v25, s[12:15], s58 offen offset:1024  lds
    v_mfma_f32_16x16x32_bf16 v[188:191], v[220:223], v[236:239], v[188:191]
    ds_read_b128 v[232:235], v14 offset:4096
    v_mfma_f32_16x16x32_bf16 v[184:187], v[216:219], v[236:239], v[184:187]
    ds_read_b64_tr_b16 v[204:205], v19 offset:32768
    v_mfma_f32_16x16x32_bf16 v[172:175], v[212:215], v[236:239], v[172:175]
    ds_read_b64_tr_b16 v[206:207], v19 offset:34816
    v_mfma_f32_16x16x32_bf16 v[168:171], v[208:211], v[236:239], v[168:171]
    s_waitcnt lgkmcnt(8)
    v_mfma_f32_16x16x32_bf16 v[64:67], v[192:195], v[224:227], v[64:67]
    ds_read_b128 v[236:239], v14 offset:6144
    s_waitcnt lgkmcnt(6)
    v_mfma_f32_16x16x32_bf16 v[68:71], v[196:199], v[224:227], v[68:71]
    s_waitcnt lgkmcnt(4)
    v_mfma_f32_16x16x32_bf16 v[80:83], v[200:203], v[224:227], v[80:83]
    s_waitcnt lgkmcnt(1)
    v_mfma_f32_16x16x32_bf16 v[84:87], v[204:207], v[224:227], v[84:87]
    v_mfma_f32_16x16x32_bf16 v[92:95], v[204:207], v[228:231], v[92:95]
    ds_read_b128 v[224:227], v14 offset:8192
    v_mfma_f32_16x16x32_bf16 v[88:91], v[200:203], v[228:231], v[88:91]
    v_mfma_f32_16x16x32_bf16 v[76:79], v[196:199], v[228:231], v[76:79]
    s_add_u32 m0, s59, 32768
    s_add_u32 s57, s61, 896
    buffer_load_dwordx4 v20, s[8:11], s57 offen offset:0  lds
    buffer_load_dwordx4 v21, s[8:11], s57 offen offset:1024  lds
    v_mfma_f32_16x16x32_bf16 v[72:75], v[192:195], v[228:231], v[72:75]
    v_mfma_f32_16x16x32_bf16 v[96:99], v[192:195], v[232:235], v[96:99]
    ds_read_b128 v[228:231], v14 offset:10240
    v_mfma_f32_16x16x32_bf16 v[100:103], v[196:199], v[232:235], v[100:103]
    v_mfma_f32_16x16x32_bf16 v[112:115], v[200:203], v[232:235], v[112:115]
    v_mfma_f32_16x16x32_bf16 v[116:119], v[204:207], v[232:235], v[116:119]
    s_waitcnt lgkmcnt(2)
    v_mfma_f32_16x16x32_bf16 v[124:127], v[204:207], v[236:239], v[124:127]
    ds_read_b128 v[232:235], v14 offset:12288
    v_mfma_f32_16x16x32_bf16 v[120:123], v[200:203], v[236:239], v[120:123]
    v_mfma_f32_16x16x32_bf16 v[108:111], v[196:199], v[236:239], v[108:111]
    v_mfma_f32_16x16x32_bf16 v[104:107], v[192:195], v[236:239], v[104:107]
    s_waitcnt lgkmcnt(2)
    v_mfma_f32_16x16x32_bf16 v[128:131], v[192:195], v[224:227], v[128:131]
    ds_read_b128 v[236:239], v14 offset:14336
    v_mfma_f32_16x16x32_bf16 v[132:135], v[196:199], v[224:227], v[132:135]
    v_mfma_f32_16x16x32_bf16 v[144:147], v[200:203], v[224:227], v[144:147]
    s_lshl_b32 s6, s2, 3
    s_add_u32 s6, s6, s54
    s_mul_i32 s6, s6, 1280
    buffer_load_dwordx4 v[60:63], v240, s[28:31], s6 offen
    v_mfma_f32_16x16x32_bf16 v[148:151], v[204:207], v[224:227], v[148:151]
    s_waitcnt lgkmcnt(2)
    v_mfma_f32_16x16x32_bf16 v[156:159], v[204:207], v[228:231], v[156:159]
    s_waitcnt vmcnt(15)
    s_waitcnt lgkmcnt(0)
    s_barrier
    ds_read_b128 v[224:227], v15 offset:0
    v_mfma_f32_16x16x32_bf16 v[152:155], v[200:203], v[228:231], v[152:155]
    ds_read_b64_tr_b16 v[208:209], v16 offset:49152
    v_mfma_f32_16x16x32_bf16 v[140:143], v[196:199], v[228:231], v[140:143]
    ds_read_b64_tr_b16 v[210:211], v16 offset:51200
    v_mfma_f32_16x16x32_bf16 v[136:139], v[192:195], v[228:231], v[136:139]
    ds_read_b64_tr_b16 v[212:213], v17 offset:49152
    v_mfma_f32_16x16x32_bf16 v[160:163], v[192:195], v[232:235], v[160:163]
    ds_read_b128 v[228:231], v15 offset:2048
    ds_read_b64_tr_b16 v[214:215], v17 offset:51200
    v_mfma_f32_16x16x32_bf16 v[164:167], v[196:199], v[232:235], v[164:167]
    ds_read_b64_tr_b16 v[216:217], v18 offset:49152
    v_mfma_f32_16x16x32_bf16 v[176:179], v[200:203], v[232:235], v[176:179]
    ds_read_b64_tr_b16 v[218:219], v18 offset:51200
    v_mfma_f32_16x16x32_bf16 v[180:183], v[204:207], v[232:235], v[180:183]
    s_add_u32 m0, s60, 131072
    s_add_u32 s58, s62, 3670016
    buffer_load_dwordx4 v24, s[12:15], s58 offen offset:0  lds
    buffer_load_dwordx4 v25, s[12:15], s58 offen offset:1024  lds
    v_mfma_f32_16x16x32_bf16 v[188:191], v[204:207], v[236:239], v[188:191]
    ds_read_b128 v[232:235], v15 offset:4096
    v_mfma_f32_16x16x32_bf16 v[184:187], v[200:203], v[236:239], v[184:187]
    ds_read_b64_tr_b16 v[220:221], v19 offset:49152
    v_mfma_f32_16x16x32_bf16 v[172:175], v[196:199], v[236:239], v[172:175]
    ds_read_b64_tr_b16 v[222:223], v19 offset:51200
    v_mfma_f32_16x16x32_bf16 v[168:171], v[192:195], v[236:239], v[168:171]
    s_waitcnt lgkmcnt(8)
    v_mfma_f32_16x16x32_bf16 v[64:67], v[208:211], v[224:227], v[64:67]
    ds_read_b128 v[236:239], v15 offset:6144
    s_waitcnt lgkmcnt(6)
    v_mfma_f32_16x16x32_bf16 v[68:71], v[212:215], v[224:227], v[68:71]
    s_waitcnt lgkmcnt(4)
    v_mfma_f32_16x16x32_bf16 v[80:83], v[216:219], v[224:227], v[80:83]
    s_waitcnt lgkmcnt(1)
    v_mfma_f32_16x16x32_bf16 v[84:87], v[220:223], v[224:227], v[84:87]
    v_mfma_f32_16x16x32_bf16 v[92:95], v[220:223], v[228:231], v[92:95]
    ds_read_b128 v[224:227], v15 offset:8192
    v_mfma_f32_16x16x32_bf16 v[88:91], v[216:219], v[228:231], v[88:91]
    v_mfma_f32_16x16x32_bf16 v[76:79], v[212:215], v[228:231], v[76:79]
    s_add_u32 m0, s59, 32768
    s_add_u32 s57, s61, 896
    buffer_load_dwordx4 v22, s[8:11], s57 offen offset:2048  lds
    buffer_load_dwordx4 v23, s[8:11], s57 offen offset:3072  lds
    v_mfma_f32_16x16x32_bf16 v[72:75], v[208:211], v[228:231], v[72:75]
    v_mfma_f32_16x16x32_bf16 v[96:99], v[208:211], v[232:235], v[96:99]
    ds_read_b128 v[228:231], v15 offset:10240
    v_mfma_f32_16x16x32_bf16 v[100:103], v[212:215], v[232:235], v[100:103]
    v_mfma_f32_16x16x32_bf16 v[112:115], v[216:219], v[232:235], v[112:115]
    s_lshl_b32 s6, s2, 3
    s_add_u32 s6, s6, s54
    s_mul_i32 s6, s6, 1280
    s_add_u32 s6, s6, 1024
    buffer_load_dwordx4 v[60:63], v240, s[28:31], s6 offen
    v_mfma_f32_16x16x32_bf16 v[116:119], v[220:223], v[232:235], v[116:119]
    s_waitcnt lgkmcnt(2)
    v_mfma_f32_16x16x32_bf16 v[124:127], v[220:223], v[236:239], v[124:127]
    ds_read_b128 v[232:235], v15 offset:12288
    v_mfma_f32_16x16x32_bf16 v[120:123], v[216:219], v[236:239], v[120:123]
    v_mfma_f32_16x16x32_bf16 v[108:111], v[212:215], v[236:239], v[108:111]
    v_mfma_f32_16x16x32_bf16 v[104:107], v[208:211], v[236:239], v[104:107]
    s_waitcnt lgkmcnt(2)
    v_mfma_f32_16x16x32_bf16 v[128:131], v[208:211], v[224:227], v[128:131]
    ds_read_b128 v[236:239], v15 offset:14336
    v_mfma_f32_16x16x32_bf16 v[132:135], v[212:215], v[224:227], v[132:135]
    v_mfma_f32_16x16x32_bf16 v[144:147], v[216:219], v[224:227], v[144:147]
    s_lshl_b32 s6, s53, 3
    s_add_u32 s6, s6, s54
    s_mul_i32 s6, s6, 24576
    s_lshr_b32 s7, s52, 0
    s_mul_i32 s7, s7, 1024
    s_add_u32 s6, s6, s7
    buffer_load_dwordx4 v[60:63], v240, s[32:35], s6 offen
    v_mfma_f32_16x16x32_bf16 v[148:151], v[220:223], v[224:227], v[148:151]
    s_waitcnt lgkmcnt(2)
    v_mfma_f32_16x16x32_bf16 v[156:159], v[220:223], v[228:231], v[156:159]
    s_waitcnt vmcnt(13)
    s_waitcnt lgkmcnt(0)
    s_barrier
    ds_read_b128 v[224:227], v10 offset:0
    v_mfma_f32_16x16x32_bf16 v[152:155], v[216:219], v[228:231], v[152:155]
    ds_read_b64_tr_b16 v[192:193], v16 offset:0
    v_mfma_f32_16x16x32_bf16 v[140:143], v[212:215], v[228:231], v[140:143]
    ds_read_b64_tr_b16 v[194:195], v16 offset:2048
    v_mfma_f32_16x16x32_bf16 v[136:139], v[208:211], v[228:231], v[136:139]
    ds_read_b64_tr_b16 v[196:197], v17 offset:0
    v_mfma_f32_16x16x32_bf16 v[160:163], v[208:211], v[232:235], v[160:163]
    ds_read_b128 v[228:231], v10 offset:2048
    ds_read_b64_tr_b16 v[198:199], v17 offset:2048
    v_mfma_f32_16x16x32_bf16 v[164:167], v[212:215], v[232:235], v[164:167]
    ds_read_b64_tr_b16 v[200:201], v18 offset:0
    v_mfma_f32_16x16x32_bf16 v[176:179], v[216:219], v[232:235], v[176:179]
    ds_read_b64_tr_b16 v[202:203], v18 offset:2048
    v_mfma_f32_16x16x32_bf16 v[180:183], v[220:223], v[232:235], v[180:183]
    s_add_u32 m0, s60, 147456
    s_add_u32 s58, s62, 3932160
    buffer_load_dwordx4 v24, s[12:15], s58 offen offset:0  lds
    buffer_load_dwordx4 v25, s[12:15], s58 offen offset:1024  lds
    v_mfma_f32_16x16x32_bf16 v[188:191], v[220:223], v[236:239], v[188:191]
    ds_read_b128 v[232:235], v10 offset:4096
    v_mfma_f32_16x16x32_bf16 v[184:187], v[216:219], v[236:239], v[184:187]
    ds_read_b64_tr_b16 v[204:205], v19 offset:0
    v_mfma_f32_16x16x32_bf16 v[172:175], v[212:215], v[236:239], v[172:175]
    ds_read_b64_tr_b16 v[206:207], v19 offset:2048
    v_mfma_f32_16x16x32_bf16 v[168:171], v[208:211], v[236:239], v[168:171]
    s_waitcnt lgkmcnt(8)
    v_mfma_f32_16x16x32_bf16 v[64:67], v[192:195], v[224:227], v[64:67]
    ds_read_b128 v[236:239], v10 offset:6144
    s_waitcnt lgkmcnt(6)
    v_mfma_f32_16x16x32_bf16 v[68:71], v[196:199], v[224:227], v[68:71]
    s_waitcnt lgkmcnt(4)
    v_mfma_f32_16x16x32_bf16 v[80:83], v[200:203], v[224:227], v[80:83]
    s_waitcnt lgkmcnt(1)
    v_mfma_f32_16x16x32_bf16 v[84:87], v[204:207], v[224:227], v[84:87]
    v_mfma_f32_16x16x32_bf16 v[92:95], v[204:207], v[228:231], v[92:95]
    ds_read_b128 v[224:227], v10 offset:8192
    v_mfma_f32_16x16x32_bf16 v[88:91], v[200:203], v[228:231], v[88:91]
    v_mfma_f32_16x16x32_bf16 v[76:79], v[196:199], v[228:231], v[76:79]
    s_add_u32 m0, s60, 65536
    s_add_u32 s57, s4, 0
    buffer_load_dwordx4 v26, s[20:23], s57 offen offset:0  lds
    buffer_load_dwordx4 v27, s[20:23], s57 offen offset:1024  lds
    v_mfma_f32_16x16x32_bf16 v[72:75], v[192:195], v[228:231], v[72:75]
    v_mfma_f32_16x16x32_bf16 v[96:99], v[192:195], v[232:235], v[96:99]
    ds_read_b128 v[228:231], v10 offset:10240
    v_mfma_f32_16x16x32_bf16 v[100:103], v[196:199], v[232:235], v[100:103]
    v_mfma_f32_16x16x32_bf16 v[112:115], v[200:203], v[232:235], v[112:115]
    s_lshl_b32 s6, s53, 3
    s_add_u32 s6, s6, s54
    s_mul_i32 s6, s6, 24576
    s_lshr_b32 s7, s52, 0
    s_mul_i32 s7, s7, 1024
    s_add_u32 s6, s6, s7
    s_add_u32 s6, s6, 8192
    buffer_load_dwordx4 v[60:63], v240, s[32:35], s6 offen
    v_mfma_f32_16x16x32_bf16 v[116:119], v[204:207], v[232:235], v[116:119]
    s_waitcnt lgkmcnt(2)
    v_mfma_f32_16x16x32_bf16 v[124:127], v[204:207], v[236:239], v[124:127]
    ds_read_b128 v[232:235], v10 offset:12288
    v_mfma_f32_16x16x32_bf16 v[120:123], v[200:203], v[236:239], v[120:123]
    v_mfma_f32_16x16x32_bf16 v[108:111], v[196:199], v[236:239], v[108:111]
    v_mfma_f32_16x16x32_bf16 v[104:107], v[192:195], v[236:239], v[104:107]
    s_waitcnt lgkmcnt(2)
    v_mfma_f32_16x16x32_bf16 v[128:131], v[192:195], v[224:227], v[128:131]
    ds_read_b128 v[236:239], v10 offset:14336
    v_mfma_f32_16x16x32_bf16 v[132:135], v[196:199], v[224:227], v[132:135]
    v_mfma_f32_16x16x32_bf16 v[144:147], v[200:203], v[224:227], v[144:147]
    s_lshl_b32 s6, s53, 3
    s_add_u32 s6, s6, s54
    s_mul_i32 s6, s6, 24576
    s_lshr_b32 s7, s52, 0
    s_mul_i32 s7, s7, 1024
    s_add_u32 s6, s6, s7
    s_add_u32 s6, s6, 16384
    buffer_load_dwordx4 v[60:63], v240, s[32:35], s6 offen
    v_mfma_f32_16x16x32_bf16 v[148:151], v[204:207], v[224:227], v[148:151]
    s_waitcnt lgkmcnt(2)
    v_mfma_f32_16x16x32_bf16 v[156:159], v[204:207], v[228:231], v[156:159]
    s_waitcnt vmcnt(15)
    s_waitcnt lgkmcnt(0)
    s_barrier
    ds_read_b128 v[224:227], v11 offset:0
    v_mfma_f32_16x16x32_bf16 v[152:155], v[200:203], v[228:231], v[152:155]
    ds_read_b64_tr_b16 v[208:209], v16 offset:16384
    v_mfma_f32_16x16x32_bf16 v[140:143], v[196:199], v[228:231], v[140:143]
    ds_read_b64_tr_b16 v[210:211], v16 offset:18432
    v_mfma_f32_16x16x32_bf16 v[136:139], v[192:195], v[228:231], v[136:139]
    ds_read_b64_tr_b16 v[212:213], v17 offset:16384
    v_mfma_f32_16x16x32_bf16 v[160:163], v[192:195], v[232:235], v[160:163]
    ds_read_b128 v[228:231], v11 offset:2048
    ds_read_b64_tr_b16 v[214:215], v17 offset:18432
    v_mfma_f32_16x16x32_bf16 v[164:167], v[196:199], v[232:235], v[164:167]
    ds_read_b64_tr_b16 v[216:217], v18 offset:16384
    v_mfma_f32_16x16x32_bf16 v[176:179], v[200:203], v[232:235], v[176:179]
    ds_read_b64_tr_b16 v[218:219], v18 offset:18432
    v_mfma_f32_16x16x32_bf16 v[180:183], v[204:207], v[232:235], v[180:183]
    s_add_u32 m0, s60, 81920
    s_add_u32 s58, s5, 0
    buffer_load_dwordx4 v28, s[24:27], s58 offen offset:0  lds
    buffer_load_dwordx4 v29, s[24:27], s58 offen offset:1024  lds
    v_mfma_f32_16x16x32_bf16 v[188:191], v[204:207], v[236:239], v[188:191]
    ds_read_b128 v[232:235], v11 offset:4096
    v_mfma_f32_16x16x32_bf16 v[184:187], v[200:203], v[236:239], v[184:187]
    ds_read_b64_tr_b16 v[220:221], v19 offset:16384
    v_mfma_f32_16x16x32_bf16 v[172:175], v[196:199], v[236:239], v[172:175]
    ds_read_b64_tr_b16 v[222:223], v19 offset:18432
    v_mfma_f32_16x16x32_bf16 v[168:171], v[192:195], v[236:239], v[168:171]
    s_waitcnt lgkmcnt(8)
    v_mfma_f32_16x16x32_bf16 v[64:67], v[208:211], v[224:227], v[64:67]
    ds_read_b128 v[236:239], v11 offset:6144
    s_waitcnt lgkmcnt(6)
    v_mfma_f32_16x16x32_bf16 v[68:71], v[212:215], v[224:227], v[68:71]
    s_waitcnt lgkmcnt(4)
    v_mfma_f32_16x16x32_bf16 v[80:83], v[216:219], v[224:227], v[80:83]
    s_waitcnt lgkmcnt(1)
    v_mfma_f32_16x16x32_bf16 v[84:87], v[220:223], v[224:227], v[84:87]
    v_mfma_f32_16x16x32_bf16 v[92:95], v[220:223], v[228:231], v[92:95]
    ds_read_b128 v[224:227], v11 offset:8192
    v_mfma_f32_16x16x32_bf16 v[88:91], v[216:219], v[228:231], v[88:91]
    v_mfma_f32_16x16x32_bf16 v[76:79], v[212:215], v[228:231], v[76:79]
    v_mfma_f32_16x16x32_bf16 v[72:75], v[208:211], v[228:231], v[72:75]
    v_mfma_f32_16x16x32_bf16 v[96:99], v[208:211], v[232:235], v[96:99]
    ds_read_b128 v[228:231], v11 offset:10240
    v_mfma_f32_16x16x32_bf16 v[100:103], v[212:215], v[232:235], v[100:103]
    v_mfma_f32_16x16x32_bf16 v[112:115], v[216:219], v[232:235], v[112:115]
    v_mfma_f32_16x16x32_bf16 v[116:119], v[220:223], v[232:235], v[116:119]
    s_waitcnt lgkmcnt(2)
    v_mfma_f32_16x16x32_bf16 v[124:127], v[220:223], v[236:239], v[124:127]
    ds_read_b128 v[232:235], v11 offset:12288
    v_mfma_f32_16x16x32_bf16 v[120:123], v[216:219], v[236:239], v[120:123]
    v_mfma_f32_16x16x32_bf16 v[108:111], v[212:215], v[236:239], v[108:111]
    v_mfma_f32_16x16x32_bf16 v[104:107], v[208:211], v[236:239], v[104:107]
    s_waitcnt lgkmcnt(2)
    v_mfma_f32_16x16x32_bf16 v[128:131], v[208:211], v[224:227], v[128:131]
    ds_read_b128 v[236:239], v11 offset:14336
    v_mfma_f32_16x16x32_bf16 v[132:135], v[212:215], v[224:227], v[132:135]
    v_mfma_f32_16x16x32_bf16 v[144:147], v[216:219], v[224:227], v[144:147]
    v_mfma_f32_16x16x32_bf16 v[148:151], v[220:223], v[224:227], v[148:151]
    s_waitcnt lgkmcnt(2)
    v_mfma_f32_16x16x32_bf16 v[156:159], v[220:223], v[228:231], v[156:159]
    s_waitcnt vmcnt(10)
    s_waitcnt lgkmcnt(0)
    s_barrier
    ds_read_b128 v[224:227], v10 offset:32768
    v_mfma_f32_16x16x32_bf16 v[152:155], v[216:219], v[228:231], v[152:155]
    ds_read_b64_tr_b16 v[192:193], v16 offset:32768
    v_mfma_f32_16x16x32_bf16 v[140:143], v[212:215], v[228:231], v[140:143]
    ds_read_b64_tr_b16 v[194:195], v16 offset:34816
    v_mfma_f32_16x16x32_bf16 v[136:139], v[208:211], v[228:231], v[136:139]
    ds_read_b64_tr_b16 v[196:197], v17 offset:32768
    v_mfma_f32_16x16x32_bf16 v[160:163], v[208:211], v[232:235], v[160:163]
    ds_read_b128 v[228:231], v10 offset:34816
    v_mfma_f32_16x16x32_bf16 v[164:167], v[212:215], v[232:235], v[164:167]
    ds_read_b64_tr_b16 v[198:199], v17 offset:34816
    v_mfma_f32_16x16x32_bf16 v[176:179], v[216:219], v[232:235], v[176:179]
    ds_read_b64_tr_b16 v[200:201], v18 offset:32768
    v_mfma_f32_16x16x32_bf16 v[180:183], v[220:223], v[232:235], v[180:183]
    ds_read_b64_tr_b16 v[202:203], v18 offset:34816
    v_mfma_f32_16x16x32_bf16 v[188:191], v[220:223], v[236:239], v[188:191]
    ds_read_b128 v[232:235], v10 offset:36864
    v_mfma_f32_16x16x32_bf16 v[184:187], v[216:219], v[236:239], v[184:187]
    ds_read_b64_tr_b16 v[204:205], v19 offset:32768
    v_mfma_f32_16x16x32_bf16 v[172:175], v[212:215], v[236:239], v[172:175]
    ds_read_b64_tr_b16 v[206:207], v19 offset:34816
    v_mfma_f32_16x16x32_bf16 v[168:171], v[208:211], v[236:239], v[168:171]
    s_waitcnt lgkmcnt(8)
    v_mfma_f32_16x16x32_bf16 v[64:67], v[192:195], v[224:227], v[64:67]
    ds_read_b128 v[236:239], v10 offset:38912
    s_waitcnt lgkmcnt(6)
    v_mfma_f32_16x16x32_bf16 v[68:71], v[196:199], v[224:227], v[68:71]
    s_waitcnt lgkmcnt(4)
    v_mfma_f32_16x16x32_bf16 v[80:83], v[200:203], v[224:227], v[80:83]
    s_waitcnt lgkmcnt(1)
    v_mfma_f32_16x16x32_bf16 v[84:87], v[204:207], v[224:227], v[84:87]
    v_mfma_f32_16x16x32_bf16 v[92:95], v[204:207], v[228:231], v[92:95]
    ds_read_b128 v[224:227], v10 offset:40960
    v_mfma_f32_16x16x32_bf16 v[88:91], v[200:203], v[228:231], v[88:91]
    v_mfma_f32_16x16x32_bf16 v[76:79], v[196:199], v[228:231], v[76:79]
    s_add_u32 m0, s60, 0
    s_add_u32 s57, s4, 128
    buffer_load_dwordx4 v26, s[20:23], s57 offen offset:0  lds
    buffer_load_dwordx4 v27, s[20:23], s57 offen offset:1024  lds
    v_mfma_f32_16x16x32_bf16 v[72:75], v[192:195], v[228:231], v[72:75]
    v_mfma_f32_16x16x32_bf16 v[96:99], v[192:195], v[232:235], v[96:99]
    ds_read_b128 v[228:231], v10 offset:43008
    v_mfma_f32_16x16x32_bf16 v[100:103], v[196:199], v[232:235], v[100:103]
    v_mfma_f32_16x16x32_bf16 v[112:115], v[200:203], v[232:235], v[112:115]
    v_mfma_f32_16x16x32_bf16 v[116:119], v[204:207], v[232:235], v[116:119]
    s_waitcnt lgkmcnt(2)
    v_mfma_f32_16x16x32_bf16 v[124:127], v[204:207], v[236:239], v[124:127]
    ds_read_b128 v[232:235], v10 offset:45056
    v_mfma_f32_16x16x32_bf16 v[120:123], v[200:203], v[236:239], v[120:123]
    v_mfma_f32_16x16x32_bf16 v[108:111], v[196:199], v[236:239], v[108:111]
    s_add_u32 m0, s60, 16384
    s_add_u32 s58, s5, 245760
    buffer_load_dwordx4 v28, s[24:27], s58 offen offset:0  lds
    buffer_load_dwordx4 v29, s[24:27], s58 offen offset:1024  lds
    v_mfma_f32_16x16x32_bf16 v[104:107], v[192:195], v[236:239], v[104:107]
    s_waitcnt lgkmcnt(2)
    v_mfma_f32_16x16x32_bf16 v[128:131], v[192:195], v[224:227], v[128:131]
    ds_read_b128 v[236:239], v10 offset:47104
    v_mfma_f32_16x16x32_bf16 v[132:135], v[196:199], v[224:227], v[132:135]
    v_mfma_f32_16x16x32_bf16 v[144:147], v[200:203], v[224:227], v[144:147]
    v_mfma_f32_16x16x32_bf16 v[148:151], v[204:207], v[224:227], v[148:151]
    s_waitcnt lgkmcnt(2)
    v_mfma_f32_16x16x32_bf16 v[156:159], v[204:207], v[228:231], v[156:159]
    s_waitcnt vmcnt(10)
    s_waitcnt lgkmcnt(0)
    s_barrier
    ds_read_b128 v[224:227], v11 offset:32768
    v_mfma_f32_16x16x32_bf16 v[152:155], v[200:203], v[228:231], v[152:155]
    ds_read_b64_tr_b16 v[208:209], v16 offset:49152
    v_mfma_f32_16x16x32_bf16 v[140:143], v[196:199], v[228:231], v[140:143]
    ds_read_b64_tr_b16 v[210:211], v16 offset:51200
    v_mfma_f32_16x16x32_bf16 v[136:139], v[192:195], v[228:231], v[136:139]
    ds_read_b64_tr_b16 v[212:213], v17 offset:49152
    v_mfma_f32_16x16x32_bf16 v[160:163], v[192:195], v[232:235], v[160:163]
    ds_read_b128 v[228:231], v11 offset:34816
    ds_read_b64_tr_b16 v[214:215], v17 offset:51200
    v_mfma_f32_16x16x32_bf16 v[164:167], v[196:199], v[232:235], v[164:167]
    ds_read_b64_tr_b16 v[216:217], v18 offset:49152
    v_mfma_f32_16x16x32_bf16 v[176:179], v[200:203], v[232:235], v[176:179]
    ds_read_b64_tr_b16 v[218:219], v18 offset:51200
    v_mfma_f32_16x16x32_bf16 v[180:183], v[204:207], v[232:235], v[180:183]
    s_add_u32 m0, s60, 98304
    s_add_u32 s57, s4, 256
    buffer_load_dwordx4 v26, s[20:23], s57 offen offset:0  lds
    buffer_load_dwordx4 v27, s[20:23], s57 offen offset:1024  lds
    v_mfma_f32_16x16x32_bf16 v[188:191], v[204:207], v[236:239], v[188:191]
    ds_read_b128 v[232:235], v11 offset:36864
    v_mfma_f32_16x16x32_bf16 v[184:187], v[200:203], v[236:239], v[184:187]
    ds_read_b64_tr_b16 v[220:221], v19 offset:49152
    v_mfma_f32_16x16x32_bf16 v[172:175], v[196:199], v[236:239], v[172:175]
    ds_read_b64_tr_b16 v[222:223], v19 offset:51200
    v_mfma_f32_16x16x32_bf16 v[168:171], v[192:195], v[236:239], v[168:171]
    s_waitcnt lgkmcnt(8)
    v_mfma_f32_16x16x32_bf16 v[64:67], v[208:211], v[224:227], v[64:67]
    ds_read_b128 v[236:239], v11 offset:38912
    s_waitcnt lgkmcnt(6)
    v_mfma_f32_16x16x32_bf16 v[68:71], v[212:215], v[224:227], v[68:71]
    s_waitcnt lgkmcnt(4)
    v_mfma_f32_16x16x32_bf16 v[80:83], v[216:219], v[224:227], v[80:83]
    s_waitcnt lgkmcnt(1)
    v_mfma_f32_16x16x32_bf16 v[84:87], v[220:223], v[224:227], v[84:87]
    v_mfma_f32_16x16x32_bf16 v[92:95], v[220:223], v[228:231], v[92:95]
    ds_read_b128 v[224:227], v11 offset:40960
    v_mfma_f32_16x16x32_bf16 v[88:91], v[216:219], v[228:231], v[88:91]
    v_mfma_f32_16x16x32_bf16 v[76:79], v[212:215], v[228:231], v[76:79]
    s_add_u32 m0, s60, 114688
    s_add_u32 s58, s5, 491520
    buffer_load_dwordx4 v28, s[24:27], s58 offen offset:0  lds
    buffer_load_dwordx4 v29, s[24:27], s58 offen offset:1024  lds
    v_mfma_f32_16x16x32_bf16 v[72:75], v[208:211], v[228:231], v[72:75]
    v_mfma_f32_16x16x32_bf16 v[96:99], v[208:211], v[232:235], v[96:99]
    ds_read_b128 v[228:231], v11 offset:43008
    v_mfma_f32_16x16x32_bf16 v[100:103], v[212:215], v[232:235], v[100:103]
    v_mfma_f32_16x16x32_bf16 v[112:115], v[216:219], v[232:235], v[112:115]
    v_mfma_f32_16x16x32_bf16 v[116:119], v[220:223], v[232:235], v[116:119]
    s_waitcnt lgkmcnt(2)
    v_mfma_f32_16x16x32_bf16 v[124:127], v[220:223], v[236:239], v[124:127]
    ds_read_b128 v[232:235], v11 offset:45056
    v_mfma_f32_16x16x32_bf16 v[120:123], v[216:219], v[236:239], v[120:123]
    v_mfma_f32_16x16x32_bf16 v[108:111], v[212:215], v[236:239], v[108:111]
    v_mfma_f32_16x16x32_bf16 v[104:107], v[208:211], v[236:239], v[104:107]
    s_waitcnt lgkmcnt(2)
    v_mfma_f32_16x16x32_bf16 v[128:131], v[208:211], v[224:227], v[128:131]
    ds_read_b128 v[236:239], v11 offset:47104
    v_mfma_f32_16x16x32_bf16 v[132:135], v[212:215], v[224:227], v[132:135]
    v_mfma_f32_16x16x32_bf16 v[144:147], v[216:219], v[224:227], v[144:147]
    v_mfma_f32_16x16x32_bf16 v[148:151], v[220:223], v[224:227], v[148:151]
    s_waitcnt lgkmcnt(2)
    v_mfma_f32_16x16x32_bf16 v[156:159], v[220:223], v[228:231], v[156:159]
    s_waitcnt vmcnt(8)
    s_waitcnt lgkmcnt(0)
    s_barrier
    v_mfma_f32_16x16x32_bf16 v[152:155], v[216:219], v[228:231], v[152:155]
    v_mfma_f32_16x16x32_bf16 v[140:143], v[212:215], v[228:231], v[140:143]
    v_mfma_f32_16x16x32_bf16 v[136:139], v[208:211], v[228:231], v[136:139]
    v_mfma_f32_16x16x32_bf16 v[160:163], v[208:211], v[232:235], v[160:163]
    s_add_u32 m0, s60, 32768
    s_add_u32 s57, s4, 384
    buffer_load_dwordx4 v26, s[20:23], s57 offen offset:0  lds
    buffer_load_dwordx4 v27, s[20:23], s57 offen offset:1024  lds
    s_add_u32 m0, s60, 49152
    s_add_u32 s58, s5, 737280
    buffer_load_dwordx4 v28, s[24:27], s58 offen offset:0  lds
    buffer_load_dwordx4 v29, s[24:27], s58 offen offset:1024  lds
    v_mfma_f32_16x16x32_bf16 v[164:167], v[212:215], v[232:235], v[164:167]
    v_mfma_f32_16x16x32_bf16 v[176:179], v[216:219], v[232:235], v[176:179]
    v_mfma_f32_16x16x32_bf16 v[180:183], v[220:223], v[232:235], v[180:183]
    v_mfma_f32_16x16x32_bf16 v[188:191], v[220:223], v[236:239], v[188:191]
    s_add_u32 m0, s60, 131072
    s_add_u32 s57, s4, 512
    buffer_load_dwordx4 v26, s[20:23], s57 offen offset:0  lds
    buffer_load_dwordx4 v27, s[20:23], s57 offen offset:1024  lds
    s_add_u32 m0, s60, 147456
    s_add_u32 s58, s5, 983040
    buffer_load_dwordx4 v28, s[24:27], s58 offen offset:0  lds
    buffer_load_dwordx4 v29, s[24:27], s58 offen offset:1024  lds
    v_mfma_f32_16x16x32_bf16 v[184:187], v[216:219], v[236:239], v[184:187]
    v_mfma_f32_16x16x32_bf16 v[172:175], v[212:215], v[236:239], v[172:175]
    v_mfma_f32_16x16x32_bf16 v[168:171], v[208:211], v[236:239], v[168:171]
    s_branch L_J
L_V:
    s_waitcnt lgkmcnt(8)
    v_mfma_f32_16x16x32_bf16 v[64:67], v[224:227], v[192:195], 0
    v_add_u32 v14, 0x10000, v10
    v_add_u32 v15, 0x10000, v11
    s_mov_b32 s16, s86
    s_mov_b32 s17, s87
    s_mov_b32 s18, 268435456
    s_waitcnt lgkmcnt(6)
    v_mfma_f32_16x16x32_bf16 v[72:75], v[224:227], v[196:199], 0
    ds_read_b128 v[236:239], v10 offset:6144
    s_waitcnt lgkmcnt(4)
    v_mfma_f32_16x16x32_bf16 v[80:83], v[224:227], v[200:203], 0
    s_add_u32 m0, s60, 131072
    s_add_u32 s58, s62, 524288
    buffer_load_dwordx4 v24, s[12:15], s58 offen offset:0  lds
    buffer_load_dwordx4 v25, s[12:15], s58 offen offset:1024  lds
    s_waitcnt lgkmcnt(1)
    v_mfma_f32_16x16x32_bf16 v[88:91], v[224:227], v[204:207], 0
    s_mov_b32 s19, 0x20000
    s_mov_b32 s20, s76
    s_mov_b32 s21, s77
    s_mov_b32 s22, 2621440
    s_mov_b32 s23, 0x20000
    v_mfma_f32_16x16x32_bf16 v[92:95], v[228:231], v[204:207], 0
    s_mov_b32 s24, s78
    s_mov_b32 s25, s79
    s_mov_b32 s26, 2457600
    s_mov_b32 s27, 0x20000
    s_mov_b32 s28, s64
    v_mfma_f32_16x16x32_bf16 v[84:87], v[228:231], v[200:203], 0
    ds_read_b128 v[224:227], v10 offset:8192
    v_mfma_f32_16x16x32_bf16 v[76:79], v[228:231], v[196:199], 0
    s_mov_b32 s29, s65
    s_mov_b32 s30, 2621440
    s_mov_b32 s31, 0x20000
    s_mov_b32 s32, s68
    s_mov_b32 s33, s69
    v_mfma_f32_16x16x32_bf16 v[68:71], v[228:231], v[192:195], 0
    v_mfma_f32_16x16x32_bf16 v[96:99], v[232:235], v[192:195], 0
    s_mov_b32 s34, 5242880
    s_mov_b32 s35, 0x20000
    s_mov_b32 s36, s74
    s_mov_b32 s37, s75
    s_mov_b32 s38, 5242880
    v_mfma_f32_16x16x32_bf16 v[104:107], v[232:235], v[196:199], 0
    ds_read_b128 v[228:231], v10 offset:10240
    v_mfma_f32_16x16x32_bf16 v[112:115], v[232:235], v[200:203], 0
    s_add_u32 m0, s60, 147456
    s_add_u32 s58, s62, 786432
    buffer_load_dwordx4 v24, s[12:15], s58 offen offset:0  lds
    buffer_load_dwordx4 v25, s[12:15], s58 offen offset:1024  lds
    v_mfma_f32_16x16x32_bf16 v[120:123], v[232:235], v[204:207], 0
    s_mov_b32 s39, 0x20000
    s_mov_b32 s40, s80
    s_mov_b32 s41, s81
    s_mov_b32 s42, 819200
    s_mov_b32 s43, 0x20000
    s_waitcnt lgkmcnt(2)
    v_mfma_f32_16x16x32_bf16 v[124:127], v[236:239], v[204:207], 0
    s_mov_b32 s44, s82
    s_mov_b32 s45, s83
    s_mov_b32 s46, 5242880
    s_mov_b32 s47, 0x20000
    s_mov_b32 s48, s84
    v_mfma_f32_16x16x32_bf16 v[116:119], v[236:239], v[200:203], 0
    ds_read_b128 v[232:235], v10 offset:12288
    v_mfma_f32_16x16x32_bf16 v[108:111], v[236:239], v[196:199], 0
    s_add_u32 m0, s59, 65536
    s_add_u32 s57, s61, 256
    buffer_load_dwordx4 v20, s[8:11], s57 offen offset:0  lds
    buffer_load_dwordx4 v21, s[8:11], s57 offen offset:1024  lds
    v_mfma_f32_16x16x32_bf16 v[100:103], v[236:239], v[192:195], 0
    s_mov_b32 s49, s85
    s_mov_b32 s50, 256
    s_mov_b32 s51, 0x20000
    s_lshl_b32 s55, s2, 3
    s_add_u32 s55, s55, s54
    s_cmp_lg_u32 s55, 4
    s_cbranch_scc1 L_nonon2
    s_memrealtime s[84:85]
    s_waitcnt lgkmcnt(0)
    s_or_b32 s84, s84, 1
    v_mov_b32 v4, s84
    v_mov_b32 v5, s85
    v_mov_b32 v8, 0
    s_mov_b64 exec, 1
    buffer_store_dwordx2 v[4:5], v8, s[48:51], 0 offen sc1
    s_mov_b64 exec, -1
L_nonon2:
    s_min_u32 s55, s53, 29
    s_waitcnt lgkmcnt(2)
    v_mfma_f32_16x16x32_bf16 v[128:131], v[224:227], v[192:195], 0
    s_and_b32 s56, s52, 1
    s_mul_i32 s56, s56, 30
    s_add_u32 s55, s55, s56
    s_lshr_b32 s64, s55, 2
    s_and_b32 s65, s55, 3
    v_mfma_f32_16x16x32_bf16 v[136:139], v[224:227], v[196:199], 0
    ds_read_b128 v[236:239], v10 offset:14336
    v_mfma_f32_16x16x32_bf16 v[144:147], v[224:227], v[200:203], 0
    s_add_u32 m0, s59, 65536
    s_add_u32 s57, s61, 256
    buffer_load_dwordx4 v22, s[8:11], s57 offen offset:2048  lds
    buffer_load_dwordx4 v23, s[8:11], s57 offen offset:3072  lds
    v_mfma_f32_16x16x32_bf16 v[152:155], v[224:227], v[204:207], 0
    s_lshr_b32 s56, s52, 1
    s_lshl_b32 s56, s56, 2
    s_add_u32 s65, s65, s56
    s_lshl_b32 s55, s65, 3
    s_add_u32 s55, s55, s54
    s_waitcnt lgkmcnt(2)
    v_mfma_f32_16x16x32_bf16 v[156:159], v[228:231], v[204:207], 0
    s_waitcnt vmcnt(12)
    s_waitcnt lgkmcnt(0)
    s_barrier
    s_mul_i32 s4, s55, 20480
    s_mul_i32 s5, s54, 30720
    s_lshl_b32 s55, s64, 8
    s_add_u32 s5, s5, s55
    s_and_b32 s56, s54, 1
    v_mfma_f32_16x16x32_bf16 v[148:151], v[228:231], v[200:203], 0
    ds_read_b128 v[224:227], v11 offset:0
    ds_read_b64_tr_b16 v[208:209], v16 offset:16384
    v_mfma_f32_16x16x32_bf16 v[140:143], v[228:231], v[196:199], 0
    ds_read_b64_tr_b16 v[210:211], v16 offset:18432
    ds_read_b64_tr_b16 v[212:213], v17 offset:16384
    v_mfma_f32_16x16x32_bf16 v[132:135], v[228:231], v[192:195], 0
    s_lshl_b32 s55, s65, 1
    s_add_u32 s55, s55, s56
    s_mul_i32 s66, s55, 245760
    s_lshr_b32 s56, s54, 1
    s_lshl_b32 s55, s64, 2
    v_mfma_f32_16x16x32_bf16 v[160:163], v[232:235], v[192:195], 0
    s_add_u32 s55, s55, s56
    s_lshl_b32 s55, s55, 11
    s_add_u32 s66, s66, s55
    s_add_u32 s66, s66, 50331648
    s_lshl_b32 s95, s65, 7
    ds_read_b128 v[228:231], v11 offset:2048
    v_mfma_f32_16x16x32_bf16 v[168:171], v[232:235], v[196:199], 0
    ds_read_b64_tr_b16 v[214:215], v17 offset:18432
    ds_read_b64_tr_b16 v[216:217], v18 offset:16384
    v_mfma_f32_16x16x32_bf16 v[176:179], v[232:235], v[200:203], 0
    ds_read_b64_tr_b16 v[218:219], v18 offset:18432
    s_add_u32 m0, s60, 98304
    s_add_u32 s58, s62, 1048576
    buffer_load_dwordx4 v24, s[12:15], s58 offen offset:0  lds
    buffer_load_dwordx4 v25, s[12:15], s58 offen offset:1024  lds
    v_mfma_f32_16x16x32_bf16 v[184:187], v[232:235], v[204:207], 0
    s_lshl_b32 s55, s64, 3
    s_add_u32 s95, s95, s55
    s_add_u32 s95, s95, 73404416
    s_lshl_b32 s94, s3, 6
    s_lshr_b32 s56, s89, 1
    v_mfma_f32_16x16x32_bf16 v[188:191], v[236:239], v[204:207], 0
    s_lshl_b32 s56, s56, 3
    s_add_u32 s56, s56, s88
    s_lshl_b32 s56, s56, 3
    s_add_u32 s94, s94, s56
    s_add_u32 s94, s94, 73400320
    ds_read_b128 v[232:235], v11 offset:4096
    v_mfma_f32_16x16x32_bf16 v[180:183], v[236:239], v[200:203], 0
    ds_read_b64_tr_b16 v[220:221], v19 offset:16384
    v_mfma_f32_16x16x32_bf16 v[172:175], v[236:239], v[196:199], 0
    ds_read_b64_tr_b16 v[222:223], v19 offset:18432
    v_mfma_f32_16x16x32_bf16 v[164:167], v[236:239], v[192:195], 0
    s_lshr_b32 s56, s54, 2
    s_add_u32 s55, s3, s56
    s_lshl_b32 s63, s55, 19
    s_lshl_b32 s55, s88, 16
    s_add_u32 s63, s63, s55
    s_waitcnt lgkmcnt(8)
    v_mfma_f32_16x16x32_bf16 v[64:67], v[224:227], v[208:211], v[64:67]
    s_and_b32 s55, s54, 1
    s_lshl_b32 s55, s55, 15
    s_add_u32 s63, s63, s55
    s_and_b32 s55, s54, 2
    s_lshl_b32 s55, s55, 11
    s_waitcnt lgkmcnt(5)
    v_mfma_f32_16x16x32_bf16 v[72:75], v[224:227], v[212:215], v[72:75]
    ds_read_b128 v[236:239], v11 offset:6144
    s_waitcnt lgkmcnt(4)
    v_mfma_f32_16x16x32_bf16 v[80:83], v[224:227], v[216:219], v[80:83]
    s_add_u32 s63, s63, s55
    s_lshr_b32 s55, s89, 1
    s_lshl_b32 s55, s55, 24
    s_add_u32 s63, s63, s55
    s_and_b32 s70, s53, 3
    s_waitcnt lgkmcnt(1)
    v_mfma_f32_16x16x32_bf16 v[88:91], v[224:227], v[220:223], v[88:91]
    v_mfma_f32_16x16x32_bf16 v[92:95], v[228:231], v[220:223], v[92:95]
    s_lshl_b32 s55, s52, 2
    s_add_u32 s70, s70, s55
    s_lshr_b32 s71, s53, 2
    s_lshl_b32 s55, s71, 2
    s_add_u32 s55, s55, s54
    v_mfma_f32_16x16x32_bf16 v[84:87], v[228:231], v[216:219], v[84:87]
    ds_read_b128 v[224:227], v11 offset:8192
    v_mfma_f32_16x16x32_bf16 v[76:79], v[228:231], v[212:215], v[76:79]
    s_sub_u32 s56, 63, s55
    s_sub_u32 s55, s55, 4
    s_cmp_lt_u32 s54, 4
    s_cselect_b32 s73, s56, s55
    s_lshl_b32 s72, s73, 5
    s_mul_i32 s68, s72, 1280
    v_mfma_f32_16x16x32_bf16 v[68:71], v[228:231], v[208:211], v[68:71]
    v_mfma_f32_16x16x32_bf16 v[96:99], v[232:235], v[208:211], v[96:99]
    s_mul_i32 s99, s55, 40960
    s_add_u32 s99, s99, 163840
    s_lshl_b32 s69, s70, 8
    s_lshl_b32 s55, s54, 16
    s_add_u32 s69, s69, s55
    v_mfma_f32_16x16x32_bf16 v[104:107], v[232:235], v[212:215], v[104:107]
    ds_read_b128 v[228:231], v11 offset:10240
    v_mfma_f32_16x16x32_bf16 v[112:115], v[232:235], v[216:219], v[112:115]
    s_getpc_b64 s[90:91]
L_pc2:
    s_and_b32 s90, s90, 0xffffff80
    s_lshl_b32 s6, s53, 3
    s_add_u32 s6, s6, s54
    s_lshl_b32 s6, s6, 10
    s_min_u32 s6, s6, (L_end-L_pc2-1024)&0xffffff80
    s_add_u32 s90, s90, s6
    s_addc_u32 s91, s91, 0
    v_mov_b32 v9, s91
    v_add_co_u32 v8, vcc, s90, v240
    s_nop 1
    v_addc_co_u32 v9, vcc, 0, v9, vcc
    global_load_dwordx4 v[60:63], v[8:9], off
    v_mfma_f32_16x16x32_bf16 v[120:123], v[232:235], v[220:223], v[120:123]
    v_bfe_u32 v242, v241, 4, 2
    v_bfe_u32 v243, v241, 0, 3
    v_xor_b32 v242, v242, v243
    v_lshlrev_b32 v242, 4, v242
    v_bfe_u32 v243, v241, 3, 3
    s_waitcnt lgkmcnt(2)
    v_mfma_f32_16x16x32_bf16 v[124:127], v[236:239], v[220:223], v[124:127]
    v_mul_u32_u24 v243, 1280, v243
    v_add_u32 v242, v242, v243
    v_add_u32 v26, 0, v242
    v_bfe_u32 v242, v241, 4, 2
    v_xor_b32 v242, 4, v242
    v_mfma_f32_16x16x32_bf16 v[116:119], v[236:239], v[216:219], v[116:119]
    ds_read_b128 v[232:235], v11 offset:12288
    v_mfma_f32_16x16x32_bf16 v[108:111], v[236:239], v[212:215], v[108:111]
    v_bfe_u32 v243, v241, 0, 3
    v_xor_b32 v242, v242, v243
    v_lshlrev_b32 v242, 4, v242
    v_bfe_u32 v243, v241, 3, 3
    v_mul_u32_u24 v243, 1280, v243
    v_mfma_f32_16x16x32_bf16 v[100:103], v[236:239], v[208:211], v[100:103]
    s_waitcnt lgkmcnt(2)
    v_mfma_f32_16x16x32_bf16 v[128:131], v[224:227], v[208:211], v[128:131]
    v_add_u32 v242, v242, v243
    v_add_u32 v27, 9216, v242
    v_bfe_u32 v242, v241, 4, 2
    v_bfe_u32 v243, v241, 2, 2
    v_xor_b32 v243, v243, v242
    v_mfma_f32_16x16x32_bf16 v[136:139], v[224:227], v[212:215], v[136:139]
    ds_read_b128 v[236:239], v11 offset:14336
    v_mfma_f32_16x16x32_bf16 v[144:147], v[224:227], v[216:219], v[144:147]
    v_lshlrev_b32 v243, 6, v243
    v_bfe_u32 v244, v241, 0, 2
    v_lshl_add_u32 v243, v244, 4, v243
    v_mul_u32_u24 v242, 3840, v242
    v_add_u32 v243, v243, v242
    v_mfma_f32_16x16x32_bf16 v[152:155], v[224:227], v[220:223], v[152:155]
    s_waitcnt lgkmcnt(2)
    v_mfma_f32_16x16x32_bf16 v[156:159], v[228:231], v[220:223], v[156:159]
    s_waitcnt vmcnt(9)
    s_waitcnt lgkmcnt(0)
    s_barrier
    v_add_u32 v28, 0, v243
    v_bfe_u32 v242, v241, 4, 2
    v_bfe_u32 v243, v241, 2, 2
    v_xor_b32 v243, v243, v242
    v_lshlrev_b32 v243, 6, v243
    v_mfma_f32_16x16x32_bf16 v[148:151], v[228:231], v[216:219], v[148:151]
    ds_read_b128 v[224:227], v10 offset:32768
    ds_read_b64_tr_b16 v[192:193], v16 offset:32768
    v_mfma_f32_16x16x32_bf16 v[140:143], v[228:231], v[212:215], v[140:143]
    ds_read_b64_tr_b16 v[194:195], v16 offset:34816
    ds_read_b64_tr_b16 v[196:197], v17 offset:32768
    v_mfma_f32_16x16x32_bf16 v[132:135], v[228:231], v[208:211], v[132:135]
    v_bfe_u32 v244, v241, 0, 2
    v_lshl_add_u32 v243, v244, 4, v243
    v_mul_u32_u24 v242, 3840, v242
    v_add_u32 v243, v243, v242
    v_add_u32 v29, 14336, v243
    v_mfma_f32_16x16x32_bf16 v[160:163], v[232:235], v[208:211], v[160:163]
    s_and_b32 s55, s54, 1
    s_lshl_b32 s55, s55, 13
    v_bfe_u32 v242, v241, 5, 1
    v_add_u32 v242, 0, v242
    v_bfe_u32 v243, v241, 1, 3
    ds_read_b128 v[228:231], v10 offset:34816
    v_mfma_f32_16x16x32_bf16 v[168:171], v[232:235], v[212:215], v[168:171]
    ds_read_b64_tr_b16 v[198:199], v17 offset:34816
    ds_read_b64_tr_b16 v[200:201], v18 offset:32768
    v_mfma_f32_16x16x32_bf16 v[176:179], v[232:235], v[216:219], v[176:179]
    ds_read_b64_tr_b16 v[202:203], v18 offset:34816
    s_add_u32 m0, s60, 114688
    s_add_u32 s58, s62, 1310720
    buffer_load_dwordx4 v24, s[12:15], s58 offen offset:0  lds
    buffer_load_dwordx4 v25, s[12:15], s58 offen offset:1024  lds
    v_mfma_f32_16x16x32_bf16 v[184:187], v[232:235], v[220:223], v[184:187]
    v_xor_b32 v242, v242, v243
    v_lshlrev_b32 v242, 4, v242
    v_bfe_u32 v243, v241, 0, 5
    v_lshl_add_u32 v242, v243, 7, v242
    v_add_u32 v32, s55, v242
    v_mfma_f32_16x16x32_bf16 v[188:191], v[236:239], v[220:223], v[188:191]
    v_bfe_u32 v242, v241, 5, 1
    v_add_u32 v242, 2, v242
    v_bfe_u32 v243, v241, 1, 3
    v_xor_b32 v242, v242, v243
    v_lshlrev_b32 v242, 4, v242
    ds_read_b128 v[232:235], v10 offset:36864
    v_mfma_f32_16x16x32_bf16 v[180:183], v[236:239], v[216:219], v[180:183]
    ds_read_b64_tr_b16 v[204:205], v19 offset:32768
    v_mfma_f32_16x16x32_bf16 v[172:175], v[236:239], v[212:215], v[172:175]
    ds_read_b64_tr_b16 v[206:207], v19 offset:34816
    v_mfma_f32_16x16x32_bf16 v[164:167], v[236:239], v[208:211], v[164:167]
    v_bfe_u32 v243, v241, 0, 5
    v_lshl_add_u32 v242, v243, 7, v242
    v_add_u32 v33, s55, v242
    v_bfe_u32 v242, v241, 5, 1
    v_add_u32 v242, 4, v242
    s_waitcnt lgkmcnt(8)
    v_mfma_f32_16x16x32_bf16 v[64:67], v[224:227], v[192:195], v[64:67]
    v_bfe_u32 v243, v241, 1, 3
    v_xor_b32 v242, v242, v243
    v_lshlrev_b32 v242, 4, v242
    v_bfe_u32 v243, v241, 0, 5
    v_lshl_add_u32 v242, v243, 7, v242
    s_waitcnt lgkmcnt(5)
    v_mfma_f32_16x16x32_bf16 v[72:75], v[224:227], v[196:199], v[72:75]
    ds_read_b128 v[236:239], v10 offset:38912
    s_waitcnt lgkmcnt(4)
    v_mfma_f32_16x16x32_bf16 v[80:83], v[224:227], v[200:203], v[80:83]
    v_add_u32 v34, s55, v242
    v_bfe_u32 v242, v241, 5, 1
    v_add_u32 v242, 6, v242
    v_bfe_u32 v243, v241, 1, 3
    v_xor_b32 v242, v242, v243
    s_waitcnt lgkmcnt(1)
    v_mfma_f32_16x16x32_bf16 v[88:91], v[224:227], v[204:207], v[88:91]
    v_mfma_f32_16x16x32_bf16 v[92:95], v[228:231], v[204:207], v[92:95]
    v_lshlrev_b32 v242, 4, v242
    v_bfe_u32 v243, v241, 0, 5
    v_lshl_add_u32 v242, v243, 7, v242
    v_add_u32 v35, s55, v242
    s_lshr_b32 s56, s54, 1
    v_mfma_f32_16x16x32_bf16 v[84:87], v[228:231], v[200:203], v[84:87]
    ds_read_b128 v[224:227], v10 offset:40960
    v_mfma_f32_16x16x32_bf16 v[76:79], v[228:231], v[196:199], v[76:79]
    s_add_u32 m0, s59, 0
    s_add_u32 s57, s61, 384
    buffer_load_dwordx4 v20, s[8:11], s57 offen offset:0  lds
    buffer_load_dwordx4 v21, s[8:11], s57 offen offset:1024  lds
    v_mfma_f32_16x16x32_bf16 v[68:71], v[228:231], v[192:195], v[68:71]
    v_bfe_u32 v242, v241, 2, 2
    v_xor_b32 v243, s56, v242
    v_lshlrev_b32 v243, 6, v243
    v_bfe_u32 v244, v241, 5, 1
    v_lshl_add_u32 v242, v244, 3, v242
    v_mfma_f32_16x16x32_bf16 v[96:99], v[232:235], v[192:195], v[96:99]
    v_lshl_add_u32 v243, v242, 8, v243
    v_bfe_u32 v242, v241, 4, 1
    v_lshl_add_u32 v243, v242, 5, v243
    v_bfe_u32 v242, v241, 0, 2
    v_lshl_add_u32 v243, v242, 3, v243
    v_mfma_f32_16x16x32_bf16 v[104:107], v[232:235], v[196:199], v[104:107]
    ds_read_b128 v[228:231], v10 offset:43008
    v_mfma_f32_16x16x32_bf16 v[112:115], v[232:235], v[200:203], v[112:115]
    v_add_u32 v36, 16384, v243
    v_mfma_f32_16x16x32_bf16 v[120:123], v[232:235], v[204:207], v[120:123]
    s_waitcnt lgkmcnt(2)
    v_mfma_f32_16x16x32_bf16 v[124:127], v[236:239], v[204:207], v[124:127]
    v_mfma_f32_16x16x32_bf16 v[116:119], v[236:239], v[200:203], v[116:119]
    ds_read_b128 v[232:235], v10 offset:45056
    v_mfma_f32_16x16x32_bf16 v[108:111], v[236:239], v[196:199], v[108:111]
    v_mfma_f32_16x16x32_bf16 v[100:103], v[236:239], v[192:195], v[100:103]
    s_waitcnt lgkmcnt(2)
    v_mfma_f32_16x16x32_bf16 v[128:131], v[224:227], v[192:195], v[128:131]
    v_mfma_f32_16x16x32_bf16 v[136:139], v[224:227], v[196:199], v[136:139]
    ds_read_b128 v[236:239], v10 offset:47104
    v_mfma_f32_16x16x32_bf16 v[144:147], v[224:227], v[200:203], v[144:147]
    v_mfma_f32_16x16x32_bf16 v[152:155], v[224:227], v[204:207], v[152:155]
    s_waitcnt lgkmcnt(2)
    v_mfma_f32_16x16x32_bf16 v[156:159], v[228:231], v[204:207], v[156:159]
    s_waitcnt vmcnt(11)
    s_waitcnt lgkmcnt(0)
    s_barrier
    v_mfma_f32_16x16x32_bf16 v[148:151], v[228:231], v[200:203], v[148:151]
    ds_read_b128 v[224:227], v11 offset:32768
    ds_read_b64_tr_b16 v[208:209], v16 offset:49152
    v_mfma_f32_16x16x32_bf16 v[140:143], v[228:231], v[196:199], v[140:143]
    ds_read_b64_tr_b16 v[210:211], v16 offset:51200
    ds_read_b64_tr_b16 v[212:213], v17 offset:49152
    v_mfma_f32_16x16x32_bf16 v[132:135], v[228:231], v[192:195], v[132:135]
    v_mfma_f32_16x16x32_bf16 v[160:163], v[232:235], v[192:195], v[160:163]
    ds_read_b128 v[228:231], v11 offset:34816
    v_mfma_f32_16x16x32_bf16 v[168:171], v[232:235], v[196:199], v[168:171]
    ds_read_b64_tr_b16 v[214:215], v17 offset:51200
    ds_read_b64_tr_b16 v[216:217], v18 offset:49152
    v_mfma_f32_16x16x32_bf16 v[176:179], v[232:235], v[200:203], v[176:179]
    ds_read_b64_tr_b16 v[218:219], v18 offset:51200
    s_add_u32 m0, s60, 131072
    s_add_u32 s58, s62, 1572864
    buffer_load_dwordx4 v24, s[12:15], s58 offen offset:0  lds
    buffer_load_dwordx4 v25, s[12:15], s58 offen offset:1024  lds
    v_mfma_f32_16x16x32_bf16 v[184:187], v[232:235], v[204:207], v[184:187]
    v_mfma_f32_16x16x32_bf16 v[188:191], v[236:239], v[204:207], v[188:191]
    ds_read_b128 v[232:235], v11 offset:36864
    v_mfma_f32_16x16x32_bf16 v[180:183], v[236:239], v[200:203], v[180:183]
    ds_read_b64_tr_b16 v[220:221], v19 offset:49152
    v_mfma_f32_16x16x32_bf16 v[172:175], v[236:239], v[196:199], v[172:175]
    ds_read_b64_tr_b16 v[222:223], v19 offset:51200
    v_mfma_f32_16x16x32_bf16 v[164:167], v[236:239], v[192:195], v[164:167]
    s_waitcnt lgkmcnt(8)
    v_mfma_f32_16x16x32_bf16 v[64:67], v[224:227], v[208:211], v[64:67]
    ds_read_b128 v[236:239], v11 offset:38912
    s_waitcnt lgkmcnt(6)
    v_mfma_f32_16x16x32_bf16 v[72:75], v[224:227], v[212:215], v[72:75]
    s_waitcnt lgkmcnt(4)
    v_mfma_f32_16x16x32_bf16 v[80:83], v[224:227], v[216:219], v[80:83]
    s_waitcnt lgkmcnt(1)
    v_mfma_f32_16x16x32_bf16 v[88:91], v[224:227], v[220:223], v[88:91]
    v_mfma_f32_16x16x32_bf16 v[92:95], v[228:231], v[220:223], v[92:95]
    ds_read_b128 v[224:227], v11 offset:40960
    v_mfma_f32_16x16x32_bf16 v[84:87], v[228:231], v[216:219], v[84:87]
    v_mfma_f32_16x16x32_bf16 v[76:79], v[228:231], v[212:215], v[76:79]
    s_add_u32 m0, s59, 0
    s_add_u32 s57, s61, 384
    buffer_load_dwordx4 v22, s[8:11], s57 offen offset:2048  lds
    buffer_load_dwordx4 v23, s[8:11], s57 offen offset:3072  lds
    v_mfma_f32_16x16x32_bf16 v[68:71], v[228:231], v[208:211], v[68:71]
    v_mfma_f32_16x16x32_bf16 v[96:99], v[232:235], v[208:211], v[96:99]
    ds_read_b128 v[228:231], v11 offset:43008
    v_mfma_f32_16x16x32_bf16 v[104:107], v[232:235], v[212:215], v[104:107]
    v_mfma_f32_16x16x32_bf16 v[112:115], v[232:235], v[216:219], v[112:115]
    v_mfma_f32_16x16x32_bf16 v[120:123], v[232:235], v[220:223], v[120:123]
    s_waitcnt lgkmcnt(2)
    v_mfma_f32_16x16x32_bf16 v[124:127], v[236:239], v[220:223], v[124:127]
    ds_read_b128 v[232:235], v11 offset:45056
    v_mfma_f32_16x16x32_bf16 v[116:119], v[236:239], v[216:219], v[116:119]
    v_mfma_f32_16x16x32_bf16 v[108:111], v[236:239], v[212:215], v[108:111]
    v_mfma_f32_16x16x32_bf16 v[100:103], v[236:239], v[208:211], v[100:103]
    s_waitcnt lgkmcnt(2)
    v_mfma_f32_16x16x32_bf16 v[128:131], v[224:227], v[208:211], v[128:131]
    ds_read_b128 v[236:239], v11 offset:47104
    v_mfma_f32_16x16x32_bf16 v[136:139], v[224:227], v[212:215], v[136:139]
    v_mfma_f32_16x16x32_bf16 v[144:147], v[224:227], v[216:219], v[144:147]
    v_mfma_f32_16x16x32_bf16 v[152:155], v[224:227], v[220:223], v[152:155]
    s_waitcnt lgkmcnt(2)
    v_mfma_f32_16x16x32_bf16 v[156:159], v[228:231], v[220:223], v[156:159]
    s_waitcnt vmcnt(9)
    s_waitcnt lgkmcnt(0)
    s_barrier
    ds_read_b128 v[224:227], v14 offset:0
    v_mfma_f32_16x16x32_bf16 v[148:151], v[228:231], v[216:219], v[148:151]
    ds_read_b64_tr_b16 v[192:193], v16 offset:0
    v_mfma_f32_16x16x32_bf16 v[140:143], v[228:231], v[212:215], v[140:143]
    ds_read_b64_tr_b16 v[194:195], v16 offset:2048
    v_mfma_f32_16x16x32_bf16 v[132:135], v[228:231], v[208:211], v[132:135]
    ds_read_b64_tr_b16 v[196:197], v17 offset:0
    v_mfma_f32_16x16x32_bf16 v[160:163], v[232:235], v[208:211], v[160:163]
    ds_read_b128 v[228:231], v14 offset:2048
    ds_read_b64_tr_b16 v[198:199], v17 offset:2048
    v_mfma_f32_16x16x32_bf16 v[168:171], v[232:235], v[212:215], v[168:171]
    ds_read_b64_tr_b16 v[200:201], v18 offset:0
    v_mfma_f32_16x16x32_bf16 v[176:179], v[232:235], v[216:219], v[176:179]
    ds_read_b64_tr_b16 v[202:203], v18 offset:2048
    v_mfma_f32_16x16x32_bf16 v[184:187], v[232:235], v[220:223], v[184:187]
    s_add_u32 m0, s60, 147456
    s_add_u32 s58, s62, 1835008
    buffer_load_dwordx4 v24, s[12:15], s58 offen offset:0  lds
    buffer_load_dwordx4 v25, s[12:15], s58 offen offset:1024  lds
    v_mfma_f32_16x16x32_bf16 v[188:191], v[236:239], v[220:223], v[188:191]
    ds_read_b128 v[232:235], v14 offset:4096
    v_mfma_f32_16x16x32_bf16 v[180:183], v[236:239], v[216:219], v[180:183]
    ds_read_b64_tr_b16 v[204:205], v19 offset:0
    v_mfma_f32_16x16x32_bf16 v[172:175], v[236:239], v[212:215], v[172:175]
    ds_read_b64_tr_b16 v[206:207], v19 offset:2048
    v_mfma_f32_16x16x32_bf16 v[164:167], v[236:239], v[208:211], v[164:167]
    s_waitcnt lgkmcnt(8)
    v_mfma_f32_16x16x32_bf16 v[64:67], v[224:227], v[192:195], v[64:67]
    ds_read_b128 v[236:239], v14 offset:6144
    s_waitcnt lgkmcnt(6)
    v_mfma_f32_16x16x32_bf16 v[72:75], v[224:227], v[196:199], v[72:75]
    s_waitcnt lgkmcnt(4)
    v_mfma_f32_16x16x32_bf16 v[80:83], v[224:227], v[200:203], v[80:83]
    s_waitcnt lgkmcnt(1)
    v_mfma_f32_16x16x32_bf16 v[88:91], v[224:227], v[204:207], v[88:91]
    v_mfma_f32_16x16x32_bf16 v[92:95], v[228:231], v[204:207], v[92:95]
    ds_read_b128 v[224:227], v14 offset:8192
    v_mfma_f32_16x16x32_bf16 v[84:87], v[228:231], v[200:203], v[84:87]
    v_mfma_f32_16x16x32_bf16 v[76:79], v[228:231], v[196:199], v[76:79]
    s_add_u32 m0, s59, 32768
    s_add_u32 s57, s61, 512
    buffer_load_dwordx4 v20, s[8:11], s57 offen offset:0  lds
    buffer_load_dwordx4 v21, s[8:11], s57 offen offset:1024  lds
    v_mfma_f32_16x16x32_bf16 v[68:71], v[228:231], v[192:195], v[68:71]
    v_mfma_f32_16x16x32_bf16 v[96:99], v[232:235], v[192:195], v[96:99]
    ds_read_b128 v[228:231], v14 offset:10240
    v_mfma_f32_16x16x32_bf16 v[104:107], v[232:235], v[196:199], v[104:107]
    v_mfma_f32_16x16x32_bf16 v[112:115], v[232:235], v[200:203], v[112:115]
    v_mfma_f32_16x16x32_bf16 v[120:123], v[232:235], v[204:207], v[120:123]
    s_waitcnt lgkmcnt(2)
    v_mfma_f32_16x16x32_bf16 v[124:127], v[236:239], v[204:207], v[124:127]
    ds_read_b128 v[232:235], v14 offset:12288
    v_mfma_f32_16x16x32_bf16 v[116:119], v[236:239], v[200:203], v[116:119]
    v_mfma_f32_16x16x32_bf16 v[108:111], v[236:239], v[196:199], v[108:111]
    v_mfma_f32_16x16x32_bf16 v[100:103], v[236:239], v[192:195], v[100:103]
    s_waitcnt lgkmcnt(2)
    v_mfma_f32_16x16x32_bf16 v[128:131], v[224:227], v[192:195], v[128:131]
    ds_read_b128 v[236:239], v14 offset:14336
    v_mfma_f32_16x16x32_bf16 v[136:139], v[224:227], v[196:199], v[136:139]
    v_mfma_f32_16x16x32_bf16 v[144:147], v[224:227], v[200:203], v[144:147]
    v_mfma_f32_16x16x32_bf16 v[152:155], v[224:227], v[204:207], v[152:155]
    s_waitcnt lgkmcnt(2)
    v_mfma_f32_16x16x32_bf16 v[156:159], v[228:231], v[204:207], v[156:159]
    s_waitcnt vmcnt(10)
    s_waitcnt lgkmcnt(0)
    s_barrier
    ds_read_b128 v[224:227], v15 offset:0
    v_mfma_f32_16x16x32_bf16 v[148:151], v[228:231], v[200:203], v[148:151]
    ds_read_b64_tr_b16 v[208:209], v16 offset:16384
    v_mfma_f32_16x16x32_bf16 v[140:143], v[228:231], v[196:199], v[140:143]
    ds_read_b64_tr_b16 v[210:211], v16 offset:18432
    v_mfma_f32_16x16x32_bf16 v[132:135], v[228:231], v[192:195], v[132:135]
    ds_read_b64_tr_b16 v[212:213], v17 offset:16384
    v_mfma_f32_16x16x32_bf16 v[160:163], v[232:235], v[192:195], v[160:163]
    ds_read_b128 v[228:231], v15 offset:2048
    ds_read_b64_tr_b16 v[214:215], v17 offset:18432
    v_mfma_f32_16x16x32_bf16 v[168:171], v[232:235], v[196:199], v[168:171]
    ds_read_b64_tr_b16 v[216:217], v18 offset:16384
    v_mfma_f32_16x16x32_bf16 v[176:179], v[232:235], v[200:203], v[176:179]
    ds_read_b64_tr_b16 v[218:219], v18 offset:18432
    v_mfma_f32_16x16x32_bf16 v[184:187], v[232:235], v[204:207], v[184:187]
    s_add_u32 m0, s60, 98304
    s_add_u32 s58, s62, 2097152
    buffer_load_dwordx4 v24, s[12:15], s58 offen offset:0  lds
    buffer_load_dwordx4 v25, s[12:15], s58 offen offset:1024  lds
    v_mfma_f32_16x16x32_bf16 v[188:191], v[236:239], v[204:207], v[188:191]
    ds_read_b128 v[232:235], v15 offset:4096
    v_mfma_f32_16x16x32_bf16 v[180:183], v[236:239], v[200:203], v[180:183]
    ds_read_b64_tr_b16 v[220:221], v19 offset:16384
    v_mfma_f32_16x16x32_bf16 v[172:175], v[236:239], v[196:199], v[172:175]
    ds_read_b64_tr_b16 v[222:223], v19 offset:18432
    v_mfma_f32_16x16x32_bf16 v[164:167], v[236:239], v[192:195], v[164:167]
    s_waitcnt lgkmcnt(8)
    v_mfma_f32_16x16x32_bf16 v[64:67], v[224:227], v[208:211], v[64:67]
    ds_read_b128 v[236:239], v15 offset:6144
    s_waitcnt lgkmcnt(6)
    v_mfma_f32_16x16x32_bf16 v[72:75], v[224:227], v[212:215], v[72:75]
    s_waitcnt lgkmcnt(4)
    v_mfma_f32_16x16x32_bf16 v[80:83], v[224:227], v[216:219], v[80:83]
    s_waitcnt lgkmcnt(1)
    v_mfma_f32_16x16x32_bf16 v[88:91], v[224:227], v[220:223], v[88:91]
    v_mfma_f32_16x16x32_bf16 v[92:95], v[228:231], v[220:223], v[92:95]
    ds_read_b128 v[224:227], v15 offset:8192
    v_mfma_f32_16x16x32_bf16 v[84:87], v[228:231], v[216:219], v[84:87]
    v_mfma_f32_16x16x32_bf16 v[76:79], v[228:231], v[212:215], v[76:79]
    s_add_u32 m0, s59, 32768
    s_add_u32 s57, s61, 512
    buffer_load_dwordx4 v22, s[8:11], s57 offen offset:2048  lds
    buffer_load_dwordx4 v23, s[8:11], s57 offen offset:3072  lds
    v_mfma_f32_16x16x32_bf16 v[68:71], v[228:231], v[208:211], v[68:71]
    v_mfma_f32_16x16x32_bf16 v[96:99], v[232:235], v[208:211], v[96:99]
    ds_read_b128 v[228:231], v15 offset:10240
    v_mfma_f32_16x16x32_bf16 v[104:107], v[232:235], v[212:215], v[104:107]
    v_mfma_f32_16x16x32_bf16 v[112:115], v[232:235], v[216:219], v[112:115]
    v_mfma_f32_16x16x32_bf16 v[120:123], v[232:235], v[220:223], v[120:123]
    s_waitcnt lgkmcnt(2)
    v_mfma_f32_16x16x32_bf16 v[124:127], v[236:239], v[220:223], v[124:127]
    ds_read_b128 v[232:235], v15 offset:12288
    v_mfma_f32_16x16x32_bf16 v[116:119], v[236:239], v[216:219], v[116:119]
    v_mfma_f32_16x16x32_bf16 v[108:111], v[236:239], v[212:215], v[108:111]
    v_mfma_f32_16x16x32_bf16 v[100:103], v[236:239], v[208:211], v[100:103]
    s_waitcnt lgkmcnt(2)
    v_mfma_f32_16x16x32_bf16 v[128:131], v[224:227], v[208:211], v[128:131]
    ds_read_b128 v[236:239], v15 offset:14336
    v_mfma_f32_16x16x32_bf16 v[136:139], v[224:227], v[212:215], v[136:139]
    v_mfma_f32_16x16x32_bf16 v[144:147], v[224:227], v[216:219], v[144:147]
    v_mfma_f32_16x16x32_bf16 v[152:155], v[224:227], v[220:223], v[152:155]
    s_waitcnt lgkmcnt(2)
    v_mfma_f32_16x16x32_bf16 v[156:159], v[228:231], v[220:223], v[156:159]
    s_waitcnt vmcnt(8)
    s_waitcnt lgkmcnt(0)
    s_barrier
    ds_read_b128 v[224:227], v10 offset:0
    v_mfma_f32_16x16x32_bf16 v[148:151], v[228:231], v[216:219], v[148:151]
    ds_read_b64_tr_b16 v[192:193], v16 offset:32768
    v_mfma_f32_16x16x32_bf16 v[140:143], v[228:231], v[212:215], v[140:143]
    ds_read_b64_tr_b16 v[194:195], v16 offset:34816
    v_mfma_f32_16x16x32_bf16 v[132:135], v[228:231], v[208:211], v[132:135]
    ds_read_b64_tr_b16 v[196:197], v17 offset:32768
    v_mfma_f32_16x16x32_bf16 v[160:163], v[232:235], v[208:211], v[160:163]
    ds_read_b128 v[228:231], v10 offset:2048
    ds_read_b64_tr_b16 v[198:199], v17 offset:34816
    v_mfma_f32_16x16x32_bf16 v[168:171], v[232:235], v[212:215], v[168:171]
    ds_read_b64_tr_b16 v[200:201], v18 offset:32768
    v_mfma_f32_16x16x32_bf16 v[176:179], v[232:235], v[216:219], v[176:179]
    ds_read_b64_tr_b16 v[202:203], v18 offset:34816
    v_mfma_f32_16x16x32_bf16 v[184:187], v[232:235], v[220:223], v[184:187]
    s_add_u32 m0, s60, 114688
    s_add_u32 s58, s62, 2359296
    buffer_load_dwordx4 v24, s[12:15], s58 offen offset:0  lds
    buffer_load_dwordx4 v25, s[12:15], s58 offen offset:1024  lds
    v_mfma_f32_16x16x32_bf16 v[188:191], v[236:239], v[220:223], v[188:191]
    ds_read_b128 v[232:235], v10 offset:4096
    v_mfma_f32_16x16x32_bf16 v[180:183], v[236:239], v[216:219], v[180:183]
    ds_read_b64_tr_b16 v[204:205], v19 offset:32768
    v_mfma_f32_16x16x32_bf16 v[172:175], v[236:239], v[212:215], v[172:175]
    ds_read_b64_tr_b16 v[206:207], v19 offset:34816
    v_mfma_f32_16x16x32_bf16 v[164:167], v[236:239], v[208:211], v[164:167]
    s_waitcnt lgkmcnt(8)
    v_mfma_f32_16x16x32_bf16 v[64:67], v[224:227], v[192:195], v[64:67]
    ds_read_b128 v[236:239], v10 offset:6144
    s_waitcnt lgkmcnt(6)
    v_mfma_f32_16x16x32_bf16 v[72:75], v[224:227], v[196:199], v[72:75]
    s_waitcnt lgkmcnt(4)
    v_mfma_f32_16x16x32_bf16 v[80:83], v[224:227], v[200:203], v[80:83]
    s_waitcnt lgkmcnt(1)
    v_mfma_f32_16x16x32_bf16 v[88:91], v[224:227], v[204:207], v[88:91]
    v_mfma_f32_16x16x32_bf16 v[92:95], v[228:231], v[204:207], v[92:95]
    ds_read_b128 v[224:227], v10 offset:8192
    v_mfma_f32_16x16x32_bf16 v[84:87], v[228:231], v[200:203], v[84:87]
    v_mfma_f32_16x16x32_bf16 v[76:79], v[228:231], v[196:199], v[76:79]
    s_add_u32 m0, s59, 65536
    s_add_u32 s57, s61, 640
    buffer_load_dwordx4 v20, s[8:11], s57 offen offset:0  lds
    buffer_load_dwordx4 v21, s[8:11], s57 offen offset:1024  lds
    v_mfma_f32_16x16x32_bf16 v[68:71], v[228:231], v[192:195], v[68:71]
    v_mfma_f32_16x16x32_bf16 v[96:99], v[232:235], v[192:195], v[96:99]
    ds_read_b128 v[228:231], v10 offset:10240
    v_mfma_f32_16x16x32_bf16 v[104:107], v[232:235], v[196:199], v[104:107]
    v_mfma_f32_16x16x32_bf16 v[112:115], v[232:235], v[200:203], v[112:115]
    v_mfma_f32_16x16x32_bf16 v[120:123], v[232:235], v[204:207], v[120:123]
    s_waitcnt lgkmcnt(2)
    v_mfma_f32_16x16x32_bf16 v[124:127], v[236:239], v[204:207], v[124:127]
    ds_read_b128 v[232:235], v10 offset:12288
    v_mfma_f32_16x16x32_bf16 v[116:119], v[236:239], v[200:203], v[116:119]
    v_mfma_f32_16x16x32_bf16 v[108:111], v[236:239], v[196:199], v[108:111]
    v_mfma_f32_16x16x32_bf16 v[100:103], v[236:239], v[192:195], v[100:103]
    s_waitcnt lgkmcnt(2)
    v_mfma_f32_16x16x32_bf16 v[128:131], v[224:227], v[192:195], v[128:131]
    ds_read_b128 v[236:239], v10 offset:14336
    v_mfma_f32_16x16x32_bf16 v[136:139], v[224:227], v[196:199], v[136:139]
    v_mfma_f32_16x16x32_bf16 v[144:147], v[224:227], v[200:203], v[144:147]
    v_mfma_f32_16x16x32_bf16 v[152:155], v[224:227], v[204:207], v[152:155]
    s_waitcnt lgkmcnt(2)
    v_mfma_f32_16x16x32_bf16 v[156:159], v[228:231], v[204:207], v[156:159]
    s_waitcnt vmcnt(10)
    s_waitcnt lgkmcnt(0)
    s_barrier
    ds_read_b128 v[224:227], v11 offset:0
    v_mfma_f32_16x16x32_bf16 v[148:151], v[228:231], v[200:203], v[148:151]
    ds_read_b64_tr_b16 v[208:209], v16 offset:49152
    v_mfma_f32_16x16x32_bf16 v[140:143], v[228:231], v[196:199], v[140:143]
    ds_read_b64_tr_b16 v[210:211], v16 offset:51200
    v_mfma_f32_16x16x32_bf16 v[132:135], v[228:231], v[192:195], v[132:135]
    ds_read_b64_tr_b16 v[212:213], v17 offset:49152
    v_mfma_f32_16x16x32_bf16 v[160:163], v[232:235], v[192:195], v[160:163]
    ds_read_b128 v[228:231], v11 offset:2048
    ds_read_b64_tr_b16 v[214:215], v17 offset:51200
    v_mfma_f32_16x16x32_bf16 v[168:171], v[232:235], v[196:199], v[168:171]
    ds_read_b64_tr_b16 v[216:217], v18 offset:49152
    v_mfma_f32_16x16x32_bf16 v[176:179], v[232:235], v[200:203], v[176:179]
    ds_read_b64_tr_b16 v[218:219], v18 offset:51200
    v_mfma_f32_16x16x32_bf16 v[184:187], v[232:235], v[204:207], v[184:187]
    s_add_u32 m0, s60, 131072
    s_add_u32 s58, s62, 2621440
    buffer_load_dwordx4 v24, s[12:15], s58 offen offset:0  lds
    buffer_load_dwordx4 v25, s[12:15], s58 offen offset:1024  lds
    v_mfma_f32_16x16x32_bf16 v[188:191], v[236:239], v[204:207], v[188:191]
    ds_read_b128 v[232:235], v11 offset:4096
    v_mfma_f32_16x16x32_bf16 v[180:183], v[236:239], v[200:203], v[180:183]
    ds_read_b64_tr_b16 v[220:221], v19 offset:49152
    v_mfma_f32_16x16x32_bf16 v[172:175], v[236:239], v[196:199], v[172:175]
    ds_read_b64_tr_b16 v[222:223], v19 offset:51200
    v_mfma_f32_16x16x32_bf16 v[164:167], v[236:239], v[192:195], v[164:167]
    s_waitcnt lgkmcnt(8)
    v_mfma_f32_16x16x32_bf16 v[64:67], v[224:227], v[208:211], v[64:67]
    ds_read_b128 v[236:239], v11 offset:6144
    s_waitcnt lgkmcnt(6)
    v_mfma_f32_16x16x32_bf16 v[72:75], v[224:227], v[212:215], v[72:75]
    s_waitcnt lgkmcnt(4)
    v_mfma_f32_16x16x32_bf16 v[80:83], v[224:227], v[216:219], v[80:83]
    s_waitcnt lgkmcnt(1)
    v_mfma_f32_16x16x32_bf16 v[88:91], v[224:227], v[220:223], v[88:91]
    v_mfma_f32_16x16x32_bf16 v[92:95], v[228:231], v[220:223], v[92:95]
    ds_read_b128 v[224:227], v11 offset:8192
    v_mfma_f32_16x16x32_bf16 v[84:87], v[228:231], v[216:219], v[84:87]
    v_mfma_f32_16x16x32_bf16 v[76:79], v[228:231], v[212:215], v[76:79]
    s_add_u32 m0, s59, 65536
    s_add_u32 s57, s61, 640
    buffer_load_dwordx4 v22, s[8:11], s57 offen offset:2048  lds
    buffer_load_dwordx4 v23, s[8:11], s57 offen offset:3072  lds
    v_mfma_f32_16x16x32_bf16 v[68:71], v[228:231], v[208:211], v[68:71]
    v_mfma_f32_16x16x32_bf16 v[96:99], v[232:235], v[208:211], v[96:99]
    ds_read_b128 v[228:231], v11 offset:10240
    v_mfma_f32_16x16x32_bf16 v[104:107], v[232:235], v[212:215], v[104:107]
    v_mfma_f32_16x16x32_bf16 v[112:115], v[232:235], v[216:219], v[112:115]
    v_mfma_f32_16x16x32_bf16 v[120:123], v[232:235], v[220:223], v[120:123]
    s_waitcnt lgkmcnt(2)
    v_mfma_f32_16x16x32_bf16 v[124:127], v[236:239], v[220:223], v[124:127]
    ds_read_b128 v[232:235], v11 offset:12288
    v_mfma_f32_16x16x32_bf16 v[116:119], v[236:239], v[216:219], v[116:119]
    v_mfma_f32_16x16x32_bf16 v[108:111], v[236:239], v[212:215], v[108:111]
    v_mfma_f32_16x16x32_bf16 v[100:103], v[236:239], v[208:211], v[100:103]
    s_waitcnt lgkmcnt(2)
    v_mfma_f32_16x16x32_bf16 v[128:131], v[224:227], v[208:211], v[128:131]
    ds_read_b128 v[236:239], v11 offset:14336
    v_mfma_f32_16x16x32_bf16 v[136:139], v[224:227], v[212:215], v[136:139]
    v_mfma_f32_16x16x32_bf16 v[144:147], v[224:227], v[216:219], v[144:147]
    v_mfma_f32_16x16x32_bf16 v[152:155], v[224:227], v[220:223], v[152:155]
    s_waitcnt lgkmcnt(2)
    v_mfma_f32_16x16x32_bf16 v[156:159], v[228:231], v[220:223], v[156:159]
    s_waitcnt vmcnt(8)
    s_waitcnt lgkmcnt(0)
    s_barrier
    ds_read_b128 v[224:227], v10 offset:32768
    v_mfma_f32_16x16x32_bf16 v[148:151], v[228:231], v[216:219], v[148:151]
    ds_read_b64_tr_b16 v[192:193], v16 offset:0
    v_mfma_f32_16x16x32_bf16 v[140:143], v[228:231], v[212:215], v[140:143]
    ds_read_b64_tr_b16 v[194:195], v16 offset:2048
    v_mfma_f32_16x16x32_bf16 v[132:135], v[228:231], v[208:211], v[132:135]
    ds_read_b64_tr_b16 v[196:197], v17 offset:0
    v_mfma_f32_16x16x32_bf16 v[160:163], v[232:235], v[208:211], v[160:163]
    ds_read_b128 v[228:231], v10 offset:34816
    ds_read_b64_tr_b16 v[198:199], v17 offset:2048
    v_mfma_f32_16x16x32_bf16 v[168:171], v[232:235], v[212:215], v[168:171]
    ds_read_b64_tr_b16 v[200:201], v18 offset:0
    v_mfma_f32_16x16x32_bf16 v[176:179], v[232:235], v[216:219], v[176:179]
    ds_read_b64_tr_b16 v[202:203], v18 offset:2048
    v_mfma_f32_16x16x32_bf16 v[184:187], v[232:235], v[220:223], v[184:187]
    s_add_u32 m0, s60, 147456
    s_add_u32 s58, s62, 2883584
    buffer_load_dwordx4 v24, s[12:15], s58 offen offset:0  lds
    buffer_load_dwordx4 v25, s[12:15], s58 offen offset:1024  lds
    v_mfma_f32_16x16x32_bf16 v[188:191], v[236:239], v[220:223], v[188:191]
    ds_read_b128 v[232:235], v10 offset:36864
    v_mfma_f32_16x16x32_bf16 v[180:183], v[236:239], v[216:219], v[180:183]
    ds_read_b64_tr_b16 v[204:205], v19 offset:0
    v_mfma_f32_16x16x32_bf16 v[172:175], v[236:239], v[212:215], v[172:175]
    ds_read_b64_tr_b16 v[206:207], v19 offset:2048
    v_mfma_f32_16x16x32_bf16 v[164:167], v[236:239], v[208:211], v[164:167]
    s_waitcnt lgkmcnt(8)
    v_mfma_f32_16x16x32_bf16 v[64:67], v[224:227], v[192:195], v[64:67]
    ds_read_b128 v[236:239], v10 offset:38912
    s_waitcnt lgkmcnt(6)
    v_mfma_f32_16x16x32_bf16 v[72:75], v[224:227], v[196:199], v[72:75]
    s_waitcnt lgkmcnt(4)
    v_mfma_f32_16x16x32_bf16 v[80:83], v[224:227], v[200:203], v[80:83]
    s_waitcnt lgkmcnt(1)
    v_mfma_f32_16x16x32_bf16 v[88:91], v[224:227], v[204:207], v[88:91]
    v_mfma_f32_16x16x32_bf16 v[92:95], v[228:231], v[204:207], v[92:95]
    ds_read_b128 v[224:227], v10 offset:40960
    v_mfma_f32_16x16x32_bf16 v[84:87], v[228:231], v[200:203], v[84:87]
    v_mfma_f32_16x16x32_bf16 v[76:79], v[228:231], v[196:199], v[76:79]
    s_add_u32 m0, s59, 0
    s_add_u32 s57, s61, 768
    buffer_load_dwordx4 v20, s[8:11], s57 offen offset:0  lds
    buffer_load_dwordx4 v21, s[8:11], s57 offen offset:1024  lds
    v_mfma_f32_16x16x32_bf16 v[68:71], v[228:231], v[192:195], v[68:71]
    v_mfma_f32_16x16x32_bf16 v[96:99], v[232:235], v[192:195], v[96:99]
    ds_read_b128 v[228:231], v10 offset:43008
    v_mfma_f32_16x16x32_bf16 v[104:107], v[232:235], v[196:199], v[104:107]
    v_mfma_f32_16x16x32_bf16 v[112:115], v[232:235], v[200:203], v[112:115]
    s_lshl_b32 s6, s2, 3
    s_add_u32 s6, s6, s54
    s_mul_i32 s6, s6, 1280
    buffer_load_dwordx4 v[60:63], v240, s[20:23], s6 offen
    v_mfma_f32_16x16x32_bf16 v[120:123], v[232:235], v[204:207], v[120:123]
    s_waitcnt lgkmcnt(2)
    v_mfma_f32_16x16x32_bf16 v[124:127], v[236:239], v[204:207], v[124:127]
    ds_read_b128 v[232:235], v10 offset:45056
    v_mfma_f32_16x16x32_bf16 v[116:119], v[236:239], v[200:203], v[116:119]
    v_mfma_f32_16x16x32_bf16 v[108:111], v[236:239], v[196:199], v[108:111]
    v_mfma_f32_16x16x32_bf16 v[100:103], v[236:239], v[192:195], v[100:103]
    s_waitcnt lgkmcnt(2)
    v_mfma_f32_16x16x32_bf16 v[128:131], v[224:227], v[192:195], v[128:131]
    ds_read_b128 v[236:239], v10 offset:47104
    v_mfma_f32_16x16x32_bf16 v[136:139], v[224:227], v[196:199], v[136:139]
    v_mfma_f32_16x16x32_bf16 v[144:147], v[224:227], v[200:203], v[144:147]
    s_lshl_b32 s6, s2, 3
    s_add_u32 s6, s6, s54
    s_mul_i32 s6, s6, 1280
    s_add_u32 s6, s6, 1024
    buffer_load_dwordx4 v[60:63], v240, s[20:23], s6 offen
    v_mfma_f32_16x16x32_bf16 v[152:155], v[224:227], v[204:207], v[152:155]
    s_waitcnt lgkmcnt(2)
    v_mfma_f32_16x16x32_bf16 v[156:159], v[228:231], v[204:207], v[156:159]
    s_waitcnt vmcnt(12)
    s_waitcnt lgkmcnt(0)
    s_barrier
    ds_read_b128 v[224:227], v11 offset:32768
    v_mfma_f32_16x16x32_bf16 v[148:151], v[228:231], v[200:203], v[148:151]
    ds_read_b64_tr_b16 v[208:209], v16 offset:16384
    v_mfma_f32_16x16x32_bf16 v[140:143], v[228:231], v[196:199], v[140:143]
    ds_read_b64_tr_b16 v[210:211], v16 offset:18432
    v_mfma_f32_16x16x32_bf16 v[132:135], v[228:231], v[192:195], v[132:135]
    ds_read_b64_tr_b16 v[212:213], v17 offset:16384
    v_mfma_f32_16x16x32_bf16 v[160:163], v[232:235], v[192:195], v[160:163]
    ds_read_b128 v[228:231], v11 offset:34816
    ds_read_b64_tr_b16 v[214:215], v17 offset:18432
    v_mfma_f32_16x16x32_bf16 v[168:171], v[232:235], v[196:199], v[168:171]
    ds_read_b64_tr_b16 v[216:217], v18 offset:16384
    v_mfma_f32_16x16x32_bf16 v[176:179], v[232:235], v[200:203], v[176:179]
    ds_read_b64_tr_b16 v[218:219], v18 offset:18432
    v_mfma_f32_16x16x32_bf16 v[184:187], v[232:235], v[204:207], v[184:187]
    s_add_u32 m0, s60, 98304
    s_add_u32 s58, s62, 3145728
    buffer_load_dwordx4 v24, s[12:15], s58 offen offset:0  lds
    buffer_load_dwordx4 v25, s[12:15], s58 offen offset:1024  lds
    v_mfma_f32_16x16x32_bf16 v[188:191], v[236:239], v[204:207], v[188:191]
    ds_read_b128 v[232:235], v11 offset:36864
    v_mfma_f32_16x16x32_bf16 v[180:183], v[236:239], v[200:203], v[180:183]
    ds_read_b64_tr_b16 v[220:221], v19 offset:16384
    v_mfma_f32_16x16x32_bf16 v[172:175], v[236:239], v[196:199], v[172:175]
    ds_read_b64_tr_b16 v[222:223], v19 offset:18432
    v_mfma_f32_16x16x32_bf16 v[164:167], v[236:239], v[192:195], v[164:167]
    s_waitcnt lgkmcnt(8)
    v_mfma_f32_16x16x32_bf16 v[64:67], v[224:227], v[208:211], v[64:67]
    ds_read_b128 v[236:239], v11 offset:38912
    s_waitcnt lgkmcnt(6)
    v_mfma_f32_16x16x32_bf16 v[72:75], v[224:227], v[212:215], v[72:75]
    s_waitcnt lgkmcnt(4)
    v_mfma_f32_16x16x32_bf16 v[80:83], v[224:227], v[216:219], v[80:83]
    s_waitcnt lgkmcnt(1)
    v_mfma_f32_16x16x32_bf16 v[88:91], v[224:227], v[220:223], v[88:91]
    v_mfma_f32_16x16x32_bf16 v[92:95], v[228:231], v[220:223], v[92:95]
    ds_read_b128 v[224:227], v11 offset:40960
    v_mfma_f32_16x16x32_bf16 v[84:87], v[228:231], v[216:219], v[84:87]
    v_mfma_f32_16x16x32_bf16 v[76:79], v[228:231], v[212:215], v[76:79]
    s_add_u32 m0, s59, 0
    s_add_u32 s57, s61, 768
    buffer_load_dwordx4 v22, s[8:11], s57 offen offset:2048  lds
    buffer_load_dwordx4 v23, s[8:11], s57 offen offset:3072  lds
    v_mfma_f32_16x16x32_bf16 v[68:71], v[228:231], v[208:211], v[68:71]
    v_mfma_f32_16x16x32_bf16 v[96:99], v[232:235], v[208:211], v[96:99]
    ds_read_b128 v[228:231], v11 offset:43008
    v_mfma_f32_16x16x32_bf16 v[104:107], v[232:235], v[212:215], v[104:107]
    v_mfma_f32_16x16x32_bf16 v[112:115], v[232:235], v[216:219], v[112:115]
    s_lshl_b32 s6, s2, 3
    s_add_u32 s6, s6, s54
    s_mul_i32 s6, s6, 1200
    buffer_load_dwordx4 v[60:63], v240, s[24:27], s6 offen
    v_mfma_f32_16x16x32_bf16 v[120:123], v[232:235], v[220:223], v[120:123]
    s_waitcnt lgkmcnt(2)
    v_mfma_f32_16x16x32_bf16 v[124:127], v[236:239], v[220:223], v[124:127]
    ds_read_b128 v[232:235], v11 offset:45056
    v_mfma_f32_16x16x32_bf16 v[116:119], v[236:239], v[216:219], v[116:119]
    v_mfma_f32_16x16x32_bf16 v[108:111], v[236:239], v[212:215], v[108:111]
    v_mfma_f32_16x16x32_bf16 v[100:103], v[236:239], v[208:211], v[100:103]
    s_waitcnt lgkmcnt(2)
    v_mfma_f32_16x16x32_bf16 v[128:131], v[224:227], v[208:211], v[128:131]
    ds_read_b128 v[236:239], v11 offset:47104
    v_mfma_f32_16x16x32_bf16 v[136:139], v[224:227], v[212:215], v[136:139]
    v_mfma_f32_16x16x32_bf16 v[144:147], v[224:227], v[216:219], v[144:147]
    s_lshl_b32 s6, s2, 3
    s_add_u32 s6, s6, s54
    s_mul_i32 s6, s6, 1200
    s_add_u32 s6, s6, 1024
    buffer_load_dwordx4 v[60:63], v240, s[24:27], s6 offen
    v_mfma_f32_16x16x32_bf16 v[152:155], v[224:227], v[220:223], v[152:155]
    s_waitcnt lgkmcnt(2)
    v_mfma_f32_16x16x32_bf16 v[156:159], v[228:231], v[220:223], v[156:159]
    s_waitcnt vmcnt(12)
    s_waitcnt lgkmcnt(0)
    s_barrier
    ds_read_b128 v[224:227], v14 offset:0
    v_mfma_f32_16x16x32_bf16 v[148:151], v[228:231], v[216:219], v[148:151]
    ds_read_b64_tr_b16 v[192:193], v16 offset:32768
    v_mfma_f32_16x16x32_bf16 v[140:143], v[228:231], v[212:215], v[140:143]
    ds_read_b64_tr_b16 v[194:195], v16 offset:34816
    v_mfma_f32_16x16x32_bf16 v[132:135], v[228:231], v[208:211], v[132:135]
    ds_read_b64_tr_b16 v[196:197], v17 offset:32768
    v_mfma_f32_16x16x32_bf16 v[160:163], v[232:235], v[208:211], v[160:163]
    ds_read_b128 v[228:231], v14 offset:2048
    ds_read_b64_tr_b16 v[198:199], v17 offset:34816
    v_mfma_f32_16x16x32_bf16 v[168:171], v[232:235], v[212:215], v[168:171]
    ds_read_b64_tr_b16 v[200:201], v18 offset:32768
    v_mfma_f32_16x16x32_bf16 v[176:179], v[232:235], v[216:219], v[176:179]
    ds_read_b64_tr_b16 v[202:203], v18 offset:34816
    v_mfma_f32_16x16x32_bf16 v[184:187], v[232:235], v[220:223], v[184:187]
    s_add_u32 m0, s60, 114688
    s_add_u32 s58, s62, 3407872
    buffer_load_dwordx4 v24, s[12:15], s58 offen offset:0  lds
    buffer_load_dwordx4 v25, s[12:15], s58 offen offset:1024  lds
    v_mfma_f32_16x16x32_bf16 v[188:191], v[236:239], v[220:223], v[188:191]
    ds_read_b128 v[232:235], v14 offset:4096
    v_mfma_f32_16x16x32_bf16 v[180:183], v[236:239], v[216:219], v[180:183]
    ds_read_b64_tr_b16 v[204:205], v19 offset:32768
    v_mfma_f32_16x16x32_bf16 v[172:175], v[236:239], v[212:215], v[172:175]
    ds_read_b64_tr_b16 v[206:207], v19 offset:34816
    v_mfma_f32_16x16x32_bf16 v[164:167], v[236:239], v[208:211], v[164:167]
    s_waitcnt lgkmcnt(8)
    v_mfma_f32_16x16x32_bf16 v[64:67], v[224:227], v[192:195], v[64:67]
    ds_read_b128 v[236:239], v14 offset:6144
    s_waitcnt lgkmcnt(6)
    v_mfma_f32_16x16x32_bf16 v[72:75], v[224:227], v[196:199], v[72:75]
    s_waitcnt lgkmcnt(4)
    v_mfma_f32_16x16x32_bf16 v[80:83], v[224:227], v[200:203], v[80:83]
    s_waitcnt lgkmcnt(1)
    v_mfma_f32_16x16x32_bf16 v[88:91], v[224:227], v[204:207], v[88:91]
    v_mfma_f32_16x16x32_bf16 v[92:95], v[228:231], v[204:207], v[92:95]
    ds_read_b128 v[224:227], v14 offset:8192
    v_mfma_f32_16x16x32_bf16 v[84:87], v[228:231], v[200:203], v[84:87]
    v_mfma_f32_16x16x32_bf16 v[76:79], v[228:231], v[196:199], v[76:79]
    s_add_u32 m0, s59, 32768
    s_add_u32 s57, s61, 896
    buffer_load_dwordx4 v20, s[8:11], s57 offen offset:0  lds
    buffer_load_dwordx4 v21, s[8:11], s57 offen offset:1024  lds
    v_mfma_f32_16x16x32_bf16 v[68:71], v[228:231], v[192:195], v[68:71]
    v_mfma_f32_16x16x32_bf16 v[96:99], v[232:235], v[192:195], v[96:99]
    ds_read_b128 v[228:231], v14 offset:10240
    v_mfma_f32_16x16x32_bf16 v[104:107], v[232:235], v[196:199], v[104:107]
    v_mfma_f32_16x16x32_bf16 v[112:115], v[232:235], v[200:203], v[112:115]
    v_mfma_f32_16x16x32_bf16 v[120:123], v[232:235], v[204:207], v[120:123]
    s_waitcnt lgkmcnt(2)
    v_mfma_f32_16x16x32_bf16 v[124:127], v[236:239], v[204:207], v[124:127]
    ds_read_b128 v[232:235], v14 offset:12288
    v_mfma_f32_16x16x32_bf16 v[116:119], v[236:239], v[200:203], v[116:119]
    v_mfma_f32_16x16x32_bf16 v[108:111], v[236:239], v[196:199], v[108:111]
    v_mfma_f32_16x16x32_bf16 v[100:103], v[236:239], v[192:195], v[100:103]
    s_waitcnt lgkmcnt(2)
    v_mfma_f32_16x16x32_bf16 v[128:131], v[224:227], v[192:195], v[128:131]
    ds_read_b128 v[236:239], v14 offset:14336
    v_mfma_f32_16x16x32_bf16 v[136:139], v[224:227], v[196:199], v[136:139]
    v_mfma_f32_16x16x32_bf16 v[144:147], v[224:227], v[200:203], v[144:147]
    s_lshl_b32 s6, s2, 3
    s_add_u32 s6, s6, s54
    s_mul_i32 s6, s6, 1280
    buffer_load_dwordx4 v[60:63], v240, s[28:31], s6 offen
    v_mfma_f32_16x16x32_bf16 v[152:155], v[224:227], v[204:207], v[152:155]
    s_waitcnt lgkmcnt(2)
    v_mfma_f32_16x16x32_bf16 v[156:159], v[228:231], v[204:207], v[156:159]
    s_waitcnt vmcnt(15)
    s_waitcnt lgkmcnt(0)
    s_barrier
    ds_read_b128 v[224:227], v15 offset:0
    v_mfma_f32_16x16x32_bf16 v[148:151], v[228:231], v[200:203], v[148:151]
    ds_read_b64_tr_b16 v[208:209], v16 offset:49152
    v_mfma_f32_16x16x32_bf16 v[140:143], v[228:231], v[196:199], v[140:143]
    ds_read_b64_tr_b16 v[210:211], v16 offset:51200
    v_mfma_f32_16x16x32_bf16 v[132:135], v[228:231], v[192:195], v[132:135]
    ds_read_b64_tr_b16 v[212:213], v17 offset:49152
    v_mfma_f32_16x16x32_bf16 v[160:163], v[232:235], v[192:195], v[160:163]
    ds_read_b128 v[228:231], v15 offset:2048
    ds_read_b64_tr_b16 v[214:215], v17 offset:51200
    v_mfma_f32_16x16x32_bf16 v[168:171], v[232:235], v[196:199], v[168:171]
    ds_read_b64_tr_b16 v[216:217], v18 offset:49152
    v_mfma_f32_16x16x32_bf16 v[176:179], v[232:235], v[200:203], v[176:179]
    ds_read_b64_tr_b16 v[218:219], v18 offset:51200
    v_mfma_f32_16x16x32_bf16 v[184:187], v[232:235], v[204:207], v[184:187]
    s_add_u32 m0, s60, 131072
    s_add_u32 s58, s62, 3670016
    buffer_load_dwordx4 v24, s[12:15], s58 offen offset:0  lds
    buffer_load_dwordx4 v25, s[12:15], s58 offen offset:1024  lds
    v_mfma_f32_16x16x32_bf16 v[188:191], v[236:239], v[204:207], v[188:191]
    ds_read_b128 v[232:235], v15 offset:4096
    v_mfma_f32_16x16x32_bf16 v[180:183], v[236:239], v[200:203], v[180:183]
    ds_read_b64_tr_b16 v[220:221], v19 offset:49152
    v_mfma_f32_16x16x32_bf16 v[172:175], v[236:239], v[196:199], v[172:175]
    ds_read_b64_tr_b16 v[222:223], v19 offset:51200
    v_mfma_f32_16x16x32_bf16 v[164:167], v[236:239], v[192:195], v[164:167]
    s_waitcnt lgkmcnt(8)
    v_mfma_f32_16x16x32_bf16 v[64:67], v[224:227], v[208:211], v[64:67]
    ds_read_b128 v[236:239], v15 offset:6144
    s_waitcnt lgkmcnt(6)
    v_mfma_f32_16x16x32_bf16 v[72:75], v[224:227], v[212:215], v[72:75]
    s_waitcnt lgkmcnt(4)
    v_mfma_f32_16x16x32_bf16 v[80:83], v[224:227], v[216:219], v[80:83]
    s_waitcnt lgkmcnt(1)
    v_mfma_f32_16x16x32_bf16 v[88:91], v[224:227], v[220:223], v[88:91]
    v_mfma_f32_16x16x32_bf16 v[92:95], v[228:231], v[220:223], v[92:95]
    ds_read_b128 v[224:227], v15 offset:8192
    v_mfma_f32_16x16x32_bf16 v[84:87], v[228:231], v[216:219], v[84:87]
    v_mfma_f32_16x16x32_bf16 v[76:79], v[228:231], v[212:215], v[76:79]
    s_add_u32 m0, s59, 32768
    s_add_u32 s57, s61, 896
    buffer_load_dwordx4 v22, s[8:11], s57 offen offset:2048  lds
    buffer_load_dwordx4 v23, s[8:11], s57 offen offset:3072  lds
    v_mfma_f32_16x16x32_bf16 v[68:71], v[228:231], v[208:211], v[68:71]
    v_mfma_f32_16x16x32_bf16 v[96:99], v[232:235], v[208:211], v[96:99]
    ds_read_b128 v[228:231], v15 offset:10240
    v_mfma_f32_16x16x32_bf16 v[104:107], v[232:235], v[212:215], v[104:107]
    v_mfma_f32_16x16x32_bf16 v[112:115], v[232:235], v[216:219], v[112:115]
    s_lshl_b32 s6, s2, 3
    s_add_u32 s6, s6, s54
    s_mul_i32 s6, s6, 1280
    s_add_u32 s6, s6, 1024
    buffer_load_dwordx4 v[60:63], v240, s[28:31], s6 offen
    v_mfma_f32_16x16x32_bf16 v[120:123], v[232:235], v[220:223], v[120:123]
    s_waitcnt lgkmcnt(2)
    v_mfma_f32_16x16x32_bf16 v[124:127], v[236:239], v[220:223], v[124:127]
    ds_read_b128 v[232:235], v15 offset:12288
    v_mfma_f32_16x16x32_bf16 v[116:119], v[236:239], v[216:219], v[116:119]
    v_mfma_f32_16x16x32_bf16 v[108:111], v[236:239], v[212:215], v[108:111]
    v_mfma_f32_16x16x32_bf16 v[100:103], v[236:239], v[208:211], v[100:103]
    s_waitcnt lgkmcnt(2)
    v_mfma_f32_16x16x32_bf16 v[128:131], v[224:227], v[208:211], v[128:131]
    ds_read_b128 v[236:239], v15 offset:14336
    v_mfma_f32_16x16x32_bf16 v[136:139], v[224:227], v[212:215], v[136:139]
    v_mfma_f32_16x16x32_bf16 v[144:147], v[224:227], v[216:219], v[144:147]
    s_lshl_b32 s6, s53, 3
    s_add_u32 s6, s6, s54
    s_mul_i32 s6, s6, 24576
    s_lshr_b32 s7, s52, 0
    s_mul_i32 s7, s7, 1024
    s_add_u32 s6, s6, s7
    buffer_load_dwordx4 v[60:63], v240, s[32:35], s6 offen
    v_mfma_f32_16x16x32_bf16 v[152:155], v[224:227], v[220:223], v[152:155]
    s_waitcnt lgkmcnt(2)
    v_mfma_f32_16x16x32_bf16 v[156:159], v[228:231], v[220:223], v[156:159]
    s_waitcnt vmcnt(13)
    s_waitcnt lgkmcnt(0)
    s_barrier
    ds_read_b128 v[224:227], v10 offset:0
    v_mfma_f32_16x16x32_bf16 v[148:151], v[228:231], v[216:219], v[148:151]
    ds_read_b64_tr_b16 v[192:193], v16 offset:0
    v_mfma_f32_16x16x32_bf16 v[140:143], v[228:231], v[212:215], v[140:143]
    ds_read_b64_tr_b16 v[194:195], v16 offset:2048
    v_mfma_f32_16x16x32_bf16 v[132:135], v[228:231], v[208:211], v[132:135]
    ds_read_b64_tr_b16 v[196:197], v17 offset:0
    v_mfma_f32_16x16x32_bf16 v[160:163], v[232:235], v[208:211], v[160:163]
    ds_read_b128 v[228:231], v10 offset:2048
    ds_read_b64_tr_b16 v[198:199], v17 offset:2048
    v_mfma_f32_16x16x32_bf16 v[168:171], v[232:235], v[212:215], v[168:171]
    ds_read_b64_tr_b16 v[200:201], v18 offset:0
    v_mfma_f32_16x16x32_bf16 v[176:179], v[232:235], v[216:219], v[176:179]
    ds_read_b64_tr_b16 v[202:203], v18 offset:2048
    v_mfma_f32_16x16x32_bf16 v[184:187], v[232:235], v[220:223], v[184:187]
    s_add_u32 m0, s60, 147456
    s_add_u32 s58, s62, 3932160
    buffer_load_dwordx4 v24, s[12:15], s58 offen offset:0  lds
    buffer_load_dwordx4 v25, s[12:15], s58 offen offset:1024  lds
    v_mfma_f32_16x16x32_bf16 v[188:191], v[236:239], v[220:223], v[188:191]
    ds_read_b128 v[232:235], v10 offset:4096
    v_mfma_f32_16x16x32_bf16 v[180:183], v[236:239], v[216:219], v[180:183]
    ds_read_b64_tr_b16 v[204:205], v19 offset:0
    v_mfma_f32_16x16x32_bf16 v[172:175], v[236:239], v[212:215], v[172:175]
    ds_read_b64_tr_b16 v[206:207], v19 offset:2048
    v_mfma_f32_16x16x32_bf16 v[164:167], v[236:239], v[208:211], v[164:167]
    s_waitcnt lgkmcnt(8)
    v_mfma_f32_16x16x32_bf16 v[64:67], v[224:227], v[192:195], v[64:67]
    ds_read_b128 v[236:239], v10 offset:6144
    s_waitcnt lgkmcnt(6)
    v_mfma_f32_16x16x32_bf16 v[72:75], v[224:227], v[196:199], v[72:75]
    s_waitcnt lgkmcnt(4)
    v_mfma_f32_16x16x32_bf16 v[80:83], v[224:227], v[200:203], v[80:83]
    s_waitcnt lgkmcnt(1)
    v_mfma_f32_16x16x32_bf16 v[88:91], v[224:227], v[204:207], v[88:91]
    v_mfma_f32_16x16x32_bf16 v[92:95], v[228:231], v[204:207], v[92:95]
    ds_read_b128 v[224:227], v10 offset:8192
    v_mfma_f32_16x16x32_bf16 v[84:87], v[228:231], v[200:203], v[84:87]
    v_mfma_f32_16x16x32_bf16 v[76:79], v[228:231], v[196:199], v[76:79]
    s_add_u32 m0, s60, 65536
    s_add_u32 s57, s4, 0
    buffer_load_dwordx4 v26, s[20:23], s57 offen offset:0  lds
    buffer_load_dwordx4 v27, s[20:23], s57 offen offset:1024  lds
    v_mfma_f32_16x16x32_bf16 v[68:71], v[228:231], v[192:195], v[68:71]
    v_mfma_f32_16x16x32_bf16 v[96:99], v[232:235], v[192:195], v[96:99]
    ds_read_b128 v[228:231], v10 offset:10240
    v_mfma_f32_16x16x32_bf16 v[104:107], v[232:235], v[196:199], v[104:107]
    v_mfma_f32_16x16x32_bf16 v[112:115], v[232:235], v[200:203], v[112:115]
    s_lshl_b32 s6, s53, 3
    s_add_u32 s6, s6, s54
    s_mul_i32 s6, s6, 24576
    s_lshr_b32 s7, s52, 0
    s_mul_i32 s7, s7, 1024
    s_add_u32 s6, s6, s7
    s_add_u32 s6, s6, 8192
    buffer_load_dwordx4 v[60:63], v240, s[32:35], s6 offen
    v_mfma_f32_16x16x32_bf16 v[120:123], v[232:235], v[204:207], v[120:123]
    s_waitcnt lgkmcnt(2)
    v_mfma_f32_16x16x32_bf16 v[124:127], v[236:239], v[204:207], v[124:127]
    ds_read_b128 v[232:235], v10 offset:12288
    v_mfma_f32_16x16x32_bf16 v[116:119], v[236:239], v[200:203], v[116:119]
    v_mfma_f32_16x16x32_bf16 v[108:111], v[236:239], v[196:199], v[108:111]
    v_mfma_f32_16x16x32_bf16 v[100:103], v[236:239], v[192:195], v[100:103]
    s_waitcnt lgkmcnt(2)
    v_mfma_f32_16x16x32_bf16 v[128:131], v[224:227], v[192:195], v[128:131]
    ds_read_b128 v[236:239], v10 offset:14336
    v_mfma_f32_16x16x32_bf16 v[136:139], v[224:227], v[196:199], v[136:139]
    v_mfma_f32_16x16x32_bf16 v[144:147], v[224:227], v[200:203], v[144:147]
    s_lshl_b32 s6, s53, 3
    s_add_u32 s6, s6, s54
    s_mul_i32 s6, s6, 24576
    s_lshr_b32 s7, s52, 0
    s_mul_i32 s7, s7, 1024
    s_add_u32 s6, s6, s7
    s_add_u32 s6, s6, 16384
    buffer_load_dwordx4 v[60:63], v240, s[32:35], s6 offen
    v_mfma_f32_16x16x32_bf16 v[152:155], v[224:227], v[204:207], v[152:155]
    s_waitcnt lgkmcnt(2)
    v_mfma_f32_16x16x32_bf16 v[156:159], v[228:231], v[204:207], v[156:159]
    s_waitcnt vmcnt(15)
    s_waitcnt lgkmcnt(0)
    s_barrier
    ds_read_b128 v[224:227], v11 offset:0
    v_mfma_f32_16x16x32_bf16 v[148:151], v[228:231], v[200:203], v[148:151]
    ds_read_b64_tr_b16 v[208:209], v16 offset:16384
    v_mfma_f32_16x16x32_bf16 v[140:143], v[228:231], v[196:199], v[140:143]
    ds_read_b64_tr_b16 v[210:211], v16 offset:18432
    v_mfma_f32_16x16x32_bf16 v[132:135], v[228:231], v[192:195], v[132:135]
    ds_read_b64_tr_b16 v[212:213], v17 offset:16384
    v_mfma_f32_16x16x32_bf16 v[160:163], v[232:235], v[192:195], v[160:163]
    ds_read_b128 v[228:231], v11 offset:2048
    ds_read_b64_tr_b16 v[214:215], v17 offset:18432
    v_mfma_f32_16x16x32_bf16 v[168:171], v[232:235], v[196:199], v[168:171]
    ds_read_b64_tr_b16 v[216:217], v18 offset:16384
    v_mfma_f32_16x16x32_bf16 v[176:179], v[232:235], v[200:203], v[176:179]
    ds_read_b64_tr_b16 v[218:219], v18 offset:18432
    v_mfma_f32_16x16x32_bf16 v[184:187], v[232:235], v[204:207], v[184:187]
    s_add_u32 m0, s60, 81920
    s_add_u32 s58, s5, 0
    buffer_load_dwordx4 v28, s[24:27], s58 offen offset:0  lds
    buffer_load_dwordx4 v29, s[24:27], s58 offen offset:1024  lds
    v_mfma_f32_16x16x32_bf16 v[188:191], v[236:239], v[204:207], v[188:191]
    ds_read_b128 v[232:235], v11 offset:4096
    v_mfma_f32_16x16x32_bf16 v[180:183], v[236:239], v[200:203], v[180:183]
    ds_read_b64_tr_b16 v[220:221], v19 offset:16384
    v_mfma_f32_16x16x32_bf16 v[172:175], v[236:239], v[196:199], v[172:175]
    ds_read_b64_tr_b16 v[222:223], v19 offset:18432
    v_mfma_f32_16x16x32_bf16 v[164:167], v[236:239], v[192:195], v[164:167]
    s_waitcnt lgkmcnt(8)
    v_mfma_f32_16x16x32_bf16 v[64:67], v[224:227], v[208:211], v[64:67]
    ds_read_b128 v[236:239], v11 offset:6144
    s_waitcnt lgkmcnt(6)
    v_mfma_f32_16x16x32_bf16 v[72:75], v[224:227], v[212:215], v[72:75]
    s_waitcnt lgkmcnt(4)
    v_mfma_f32_16x16x32_bf16 v[80:83], v[224:227], v[216:219], v[80:83]
    s_waitcnt lgkmcnt(1)
    v_mfma_f32_16x16x32_bf16 v[88:91], v[224:227], v[220:223], v[88:91]
    v_mfma_f32_16x16x32_bf16 v[92:95], v[228:231], v[220:223], v[92:95]
    ds_read_b128 v[224:227], v11 offset:8192
    v_mfma_f32_16x16x32_bf16 v[84:87], v[228:231], v[216:219], v[84:87]
    v_mfma_f32_16x16x32_bf16 v[76:79], v[228:231], v[212:215], v[76:79]
    v_mfma_f32_16x16x32_bf16 v[68:71], v[228:231], v[208:211], v[68:71]
    v_mfma_f32_16x16x32_bf16 v[96:99], v[232:235], v[208:211], v[96:99]
    ds_read_b128 v[228:231], v11 offset:10240
    v_mfma_f32_16x16x32_bf16 v[104:107], v[232:235], v[212:215], v[104:107]
    v_mfma_f32_16x16x32_bf16 v[112:115], v[232:235], v[216:219], v[112:115]
    v_mfma_f32_16x16x32_bf16 v[120:123], v[232:235], v[220:223], v[120:123]
    s_waitcnt lgkmcnt(2)
    v_mfma_f32_16x16x32_bf16 v[124:127], v[236:239], v[220:223], v[124:127]
    ds_read_b128 v[232:235], v11 offset:12288
    v_mfma_f32_16x16x32_bf16 v[116:119], v[236:239], v[216:219], v[116:119]
    v_mfma_f32_16x16x32_bf16 v[108:111], v[236:239], v[212:215], v[108:111]
    v_mfma_f32_16x16x32_bf16 v[100:103], v[236:239], v[208:211], v[100:103]
    s_waitcnt lgkmcnt(2)
    v_mfma_f32_16x16x32_bf16 v[128:131], v[224:227], v[208:211], v[128:131]
    ds_read_b128 v[236:239], v11 offset:14336
    v_mfma_f32_16x16x32_bf16 v[136:139], v[224:227], v[212:215], v[136:139]
    v_mfma_f32_16x16x32_bf16 v[144:147], v[224:227], v[216:219], v[144:147]
    v_mfma_f32_16x16x32_bf16 v[152:155], v[224:227], v[220:223], v[152:155]
    s_waitcnt lgkmcnt(2)
    v_mfma_f32_16x16x32_bf16 v[156:159], v[228:231], v[220:223], v[156:159]
    s_waitcnt vmcnt(10)
    s_waitcnt lgkmcnt(0)
    s_barrier
    ds_read_b128 v[224:227], v10 offset:32768
    v_mfma_f32_16x16x32_bf16 v[148:151], v[228:231], v[216:219], v[148:151]
    ds_read_b64_tr_b16 v[192:193], v16 offset:32768
    v_mfma_f32_16x16x32_bf16 v[140:143], v[228:231], v[212:215], v[140:143]
    ds_read_b64_tr_b16 v[194:195], v16 offset:34816
    v_mfma_f32_16x16x32_bf16 v[132:135], v[228:231], v[208:211], v[132:135]
    ds_read_b64_tr_b16 v[196:197], v17 offset:32768
    v_mfma_f32_16x16x32_bf16 v[160:163], v[232:235], v[208:211], v[160:163]
    ds_read_b128 v[228:231], v10 offset:34816
    v_mfma_f32_16x16x32_bf16 v[168:171], v[232:235], v[212:215], v[168:171]
    ds_read_b64_tr_b16 v[198:199], v17 offset:34816
    v_mfma_f32_16x16x32_bf16 v[176:179], v[232:235], v[216:219], v[176:179]
    ds_read_b64_tr_b16 v[200:201], v18 offset:32768
    v_mfma_f32_16x16x32_bf16 v[184:187], v[232:235], v[220:223], v[184:187]
    ds_read_b64_tr_b16 v[202:203], v18 offset:34816
    v_mfma_f32_16x16x32_bf16 v[188:191], v[236:239], v[220:223], v[188:191]
    ds_read_b128 v[232:235], v10 offset:36864
    v_mfma_f32_16x16x32_bf16 v[180:183], v[236:239], v[216:219], v[180:183]
    ds_read_b64_tr_b16 v[204:205], v19 offset:32768
    v_mfma_f32_16x16x32_bf16 v[172:175], v[236:239], v[212:215], v[172:175]
    ds_read_b64_tr_b16 v[206:207], v19 offset:34816
    v_mfma_f32_16x16x32_bf16 v[164:167], v[236:239], v[208:211], v[164:167]
    s_waitcnt lgkmcnt(8)
    v_mfma_f32_16x16x32_bf16 v[64:67], v[224:227], v[192:195], v[64:67]
    ds_read_b128 v[236:239], v10 offset:38912
    s_waitcnt lgkmcnt(6)
    v_mfma_f32_16x16x32_bf16 v[72:75], v[224:227], v[196:199], v[72:75]
    s_waitcnt lgkmcnt(4)
    v_mfma_f32_16x16x32_bf16 v[80:83], v[224:227], v[200:203], v[80:83]
    s_waitcnt lgkmcnt(1)
    v_mfma_f32_16x16x32_bf16 v[88:91], v[224:227], v[204:207], v[88:91]
    v_mfma_f32_16x16x32_bf16 v[92:95], v[228:231], v[204:207], v[92:95]
    ds_read_b128 v[224:227], v10 offset:40960
    v_mfma_f32_16x16x32_bf16 v[84:87], v[228:231], v[200:203], v[84:87]
    v_mfma_f32_16x16x32_bf16 v[76:79], v[228:231], v[196:199], v[76:79]
    s_add_u32 m0, s60, 0
    s_add_u32 s57, s4, 128
    buffer_load_dwordx4 v26, s[20:23], s57 offen offset:0  lds
    buffer_load_dwordx4 v27, s[20:23], s57 offen offset:1024  lds
    v_mfma_f32_16x16x32_bf16 v[68:71], v[228:231], v[192:195], v[68:71]
    v_mfma_f32_16x16x32_bf16 v[96:99], v[232:235], v[192:195], v[96:99]
    ds_read_b128 v[228:231], v10 offset:43008
    v_mfma_f32_16x16x32_bf16 v[104:107], v[232:235], v[196:199], v[104:107]
    v_mfma_f32_16x16x32_bf16 v[112:115], v[232:235], v[200:203], v[112:115]
    v_mfma_f32_16x16x32_bf16 v[120:123], v[232:235], v[204:207], v[120:123]
    s_waitcnt lgkmcnt(2)
    v_mfma_f32_16x16x32_bf16 v[124:127], v[236:239], v[204:207], v[124:127]
    ds_read_b128 v[232:235], v10 offset:45056
    v_mfma_f32_16x16x32_bf16 v[116:119], v[236:239], v[200:203], v[116:119]
    v_mfma_f32_16x16x32_bf16 v[108:111], v[236:239], v[196:199], v[108:111]
    s_add_u32 m0, s60, 16384
    s_add_u32 s58, s5, 245760
    buffer_load_dwordx4 v28, s[24:27], s58 offen offset:0  lds
    buffer_load_dwordx4 v29, s[24:27], s58 offen offset:1024  lds
    v_mfma_f32_16x16x32_bf16 v[100:103], v[236:239], v[192:195], v[100:103]
    s_waitcnt lgkmcnt(2)
    v_mfma_f32_16x16x32_bf16 v[128:131], v[224:227], v[192:195], v[128:131]
    ds_read_b128 v[236:239], v10 offset:47104
    v_mfma_f32_16x16x32_bf16 v[136:139], v[224:227], v[196:199], v[136:139]
    v_mfma_f32_16x16x32_bf16 v[144:147], v[224:227], v[200:203], v[144:147]
    v_mfma_f32_16x16x32_bf16 v[152:155], v[224:227], v[204:207], v[152:155]
    s_waitcnt lgkmcnt(2)
    v_mfma_f32_16x16x32_bf16 v[156:159], v[228:231], v[204:207], v[156:159]
    s_waitcnt vmcnt(10)
    s_waitcnt lgkmcnt(0)
    s_barrier
    ds_read_b128 v[224:227], v11 offset:32768
    v_mfma_f32_16x16x32_bf16 v[148:151], v[228:231], v[200:203], v[148:151]
    ds_read_b64_tr_b16 v[208:209], v16 offset:49152
    v_mfma_f32_16x16x32_bf16 v[140:143], v[228:231], v[196:199], v[140:143]
    ds_read_b64_tr_b16 v[210:211], v16 offset:51200
    v_mfma_f32_16x16x32_bf16 v[132:135], v[228:231], v[192:195], v[132:135]
    ds_read_b64_tr_b16 v[212:213], v17 offset:49152
    v_mfma_f32_16x16x32_bf16 v[160:163], v[232:235], v[192:195], v[160:163]
    ds_read_b128 v[228:231], v11 offset:34816
    ds_read_b64_tr_b16 v[214:215], v17 offset:51200
    v_mfma_f32_16x16x32_bf16 v[168:171], v[232:235], v[196:199], v[168:171]
    ds_read_b64_tr_b16 v[216:217], v18 offset:49152
    v_mfma_f32_16x16x32_bf16 v[176:179], v[232:235], v[200:203], v[176:179]
    ds_read_b64_tr_b16 v[218:219], v18 offset:51200
    v_mfma_f32_16x16x32_bf16 v[184:187], v[232:235], v[204:207], v[184:187]
    s_add_u32 m0, s60, 98304
    s_add_u32 s57, s4, 256
    buffer_load_dwordx4 v26, s[20:23], s57 offen offset:0  lds
    buffer_load_dwordx4 v27, s[20:23], s57 offen offset:1024  lds
    v_mfma_f32_16x16x32_bf16 v[188:191], v[236:239], v[204:207], v[188:191]
    ds_read_b128 v[232:235], v11 offset:36864
    v_mfma_f32_16x16x32_bf16 v[180:183], v[236:239], v[200:203], v[180:183]
    ds_read_b64_tr_b16 v[220:221], v19 offset:49152
    v_mfma_f32_16x16x32_bf16 v[172:175], v[236:239], v[196:199], v[172:175]
    ds_read_b64_tr_b16 v[222:223], v19 offset:51200
    v_mfma_f32_16x16x32_bf16 v[164:167], v[236:239], v[192:195], v[164:167]
    s_waitcnt lgkmcnt(8)
    v_mfma_f32_16x16x32_bf16 v[64:67], v[224:227], v[208:211], v[64:67]
    ds_read_b128 v[236:239], v11 offset:38912
    s_waitcnt lgkmcnt(6)
    v_mfma_f32_16x16x32_bf16 v[72:75], v[224:227], v[212:215], v[72:75]
    s_waitcnt lgkmcnt(4)
    v_mfma_f32_16x16x32_bf16 v[80:83], v[224:227], v[216:219], v[80:83]
    s_waitcnt lgkmcnt(1)
    v_mfma_f32_16x16x32_bf16 v[88:91], v[224:227], v[220:223], v[88:91]
    v_mfma_f32_16x16x32_bf16 v[92:95], v[228:231], v[220:223], v[92:95]
    ds_read_b128 v[224:227], v11 offset:40960
    v_mfma_f32_16x16x32_bf16 v[84:87], v[228:231], v[216:219], v[84:87]
    v_mfma_f32_16x16x32_bf16 v[76:79], v[228:231], v[212:215], v[76:79]
    s_add_u32 m0, s60, 114688
    s_add_u32 s58, s5, 491520
    buffer_load_dwordx4 v28, s[24:27], s58 offen offset:0  lds
    buffer_load_dwordx4 v29, s[24:27], s58 offen offset:1024  lds
    v_mfma_f32_16x16x32_bf16 v[68:71], v[228:231], v[208:211], v[68:71]
    v_mfma_f32_16x16x32_bf16 v[96:99], v[232:235], v[208:211], v[96:99]
    ds_read_b128 v[228:231], v11 offset:43008
    v_mfma_f32_16x16x32_bf16 v[104:107], v[232:235], v[212:215], v[104:107]
    v_mfma_f32_16x16x32_bf16 v[112:115], v[232:235], v[216:219], v[112:115]
    v_mfma_f32_16x16x32_bf16 v[120:123], v[232:235], v[220:223], v[120:123]
    s_waitcnt lgkmcnt(2)
    v_mfma_f32_16x16x32_bf16 v[124:127], v[236:239], v[220:223], v[124:127]
    ds_read_b128 v[232:235], v11 offset:45056
    v_mfma_f32_16x16x32_bf16 v[116:119], v[236:239], v[216:219], v[116:119]
    v_mfma_f32_16x16x32_bf16 v[108:111], v[236:239], v[212:215], v[108:111]
    v_mfma_f32_16x16x32_bf16 v[100:103], v[236:239], v[208:211], v[100:103]
    s_waitcnt lgkmcnt(2)
    v_mfma_f32_16x16x32_bf16 v[128:131], v[224:227], v[208:211], v[128:131]
    ds_read_b128 v[236:239], v11 offset:47104
    v_mfma_f32_16x16x32_bf16 v[136:139], v[224:227], v[212:215], v[136:139]
    v_mfma_f32_16x16x32_bf16 v[144:147], v[224:227], v[216:219], v[144:147]
    v_mfma_f32_16x16x32_bf16 v[152:155], v[224:227], v[220:223], v[152:155]
    s_waitcnt lgkmcnt(2)
    v_mfma_f32_16x16x32_bf16 v[156:159], v[228:231], v[220:223], v[156:159]
    s_waitcnt vmcnt(8)
    s_waitcnt lgkmcnt(0)
    s_barrier
    v_mfma_f32_16x16x32_bf16 v[148:151], v[228:231], v[216:219], v[148:151]
    v_mfma_f32_16x16x32_bf16 v[140:143], v[228:231], v[212:215], v[140:143]
    v_mfma_f32_16x16x32_bf16 v[132:135], v[228:231], v[208:211], v[132:135]
    v_mfma_f32_16x16x32_bf16 v[160:163], v[232:235], v[208:211], v[160:163]
    s_add_u32 m0, s60, 32768
    s_add_u32 s57, s4, 384
    buffer_load_dwordx4 v26, s[20:23], s57 offen offset:0  lds
    buffer_load_dwordx4 v27, s[20:23], s57 offen offset:1024  lds
    s_add_u32 m0, s60, 49152
    s_add_u32 s58, s5, 737280
    buffer_load_dwordx4 v28, s[24:27], s58 offen offset:0  lds
    buffer_load_dwordx4 v29, s[24:27], s58 offen offset:1024  lds
    v_mfma_f32_16x16x32_bf16 v[168:171], v[232:235], v[212:215], v[168:171]
    v_mfma_f32_16x16x32_bf16 v[176:179], v[232:235], v[216:219], v[176:179]
    v_mfma_f32_16x16x32_bf16 v[184:187], v[232:235], v[220:223], v[184:187]
    v_mfma_f32_16x16x32_bf16 v[188:191], v[236:239], v[220:223], v[188:191]
    s_add_u32 m0, s60, 131072
    s_add_u32 s57, s4, 512
    buffer_load_dwordx4 v26, s[20:23], s57 offen offset:0  lds
    buffer_load_dwordx4 v27, s[20:23], s57 offen offset:1024  lds
    s_add_u32 m0, s60, 147456
    s_add_u32 s58, s5, 983040
    buffer_load_dwordx4 v28, s[24:27], s58 offen offset:0  lds
    buffer_load_dwordx4 v29, s[24:27], s58 offen offset:1024  lds
    v_mfma_f32_16x16x32_bf16 v[180:183], v[236:239], v[216:219], v[180:183]
    v_mfma_f32_16x16x32_bf16 v[172:175], v[236:239], v[212:215], v[172:175]
    v_mfma_f32_16x16x32_bf16 v[164:167], v[236:239], v[208:211], v[164:167]
L_J:
    v_add_u32 v37, 65536, v32
    v_add_u32 v38, 65536, v33
    v_add_u32 v39, 65536, v34
    v_add_u32 v40, 65536, v35
    v_add_u32 v41, 65536, v36
    ds_read_b64_tr_b16 v[200:201], v41 offset:0
    ds_read_b64_tr_b16 v[202:203], v41 offset:1024
    ds_read_b128 v[192:195], v37 offset:0
    ds_read_b128 v[196:199], v37 offset:4096
    ds_read_b64_tr_b16 v[212:213], v41 offset:4096
    ds_read_b64_tr_b16 v[214:215], v41 offset:5120
    ds_read_b128 v[204:207], v38 offset:0
    ds_read_b128 v[208:211], v38 offset:4096
    v_cvt_pk_bf16_f32 v44, v160, v161
    v_cvt_pk_bf16_f32 v45, v162, v163
    v_cvt_pk_bf16_f32 v46, v164, v165
    v_cvt_pk_bf16_f32 v47, v166, v167
    v_cvt_pk_bf16_f32 v48, v168, v169
    v_cvt_pk_bf16_f32 v49, v170, v171
    v_cvt_pk_bf16_f32 v50, v172, v173
    v_cvt_pk_bf16_f32 v51, v174, v175
    v_cvt_pk_bf16_f32 v52, v176, v177
    v_cvt_pk_bf16_f32 v53, v178, v179
    v_cvt_pk_bf16_f32 v54, v180, v181
    v_cvt_pk_bf16_f32 v55, v182, v183
    v_cvt_pk_bf16_f32 v56, v184, v185
    v_cvt_pk_bf16_f32 v57, v186, v187
    v_cvt_pk_bf16_f32 v58, v188, v189
    v_cvt_pk_bf16_f32 v59, v190, v191
    s_waitcnt lgkmcnt(5)
    v_mfma_f32_32x32x16_bf16 v[160:175], v[200:203], v[192:195], 0
    ds_read_b64_tr_b16 v[224:225], v41 offset:8192
    v_cvt_pk_bf16_f32 v128, v128, v129
    v_cvt_pk_bf16_f32 v129, v130, v131
    v_bfe_u32 v242, v241, 4, 2
    v_bfe_u32 v243, v241, 0, 3
    v_xor_b32 v242, v242, v243
    v_lshlrev_b32 v242, 4, v242
    v_cvt_pk_bf16_f32 v130, v132, v133
    s_waitcnt lgkmcnt(5)
    v_mfma_f32_32x32x16_bf16 v[176:191], v[200:203], v[196:199], 0
    ds_read_b64_tr_b16 v[226:227], v41 offset:9216
    ds_read_b128 v[216:219], v39 offset:0
    ds_read_b128 v[220:223], v39 offset:4096
    v_bfe_u32 v243, v241, 3, 3
    v_mul_u32_u24 v243, 1280, v243
    v_add_u32 v242, v242, v243
    v_add_u32 v10, 0, v242
    s_add_u32 s67, s63, 24576
    buffer_store_dwordx4 v[44:47], v240, s[16:19], s67 offen offset:0 sc1
    s_waitcnt lgkmcnt(5)
    v_mfma_f32_32x32x16_bf16 v[160:175], v[212:215], v[204:207], v[160:175]
    ds_read_b64_tr_b16 v[236:237], v41 offset:12288
    v_cvt_pk_bf16_f32 v131, v134, v135
    v_cvt_pk_bf16_f32 v132, v136, v137
    v_bfe_u32 v242, v241, 4, 2
    v_xor_b32 v242, 4, v242
    v_bfe_u32 v243, v241, 0, 3
    v_xor_b32 v242, v242, v243
    v_cvt_pk_bf16_f32 v133, v138, v139
    s_waitcnt lgkmcnt(5)
    v_mfma_f32_32x32x16_bf16 v[176:191], v[212:215], v[208:211], v[176:191]
    ds_read_b64_tr_b16 v[238:239], v41 offset:13312
    ds_read_b128 v[228:231], v40 offset:0
    ds_read_b128 v[232:235], v40 offset:4096
    v_lshlrev_b32 v242, 4, v242
    v_bfe_u32 v243, v241, 3, 3
    v_mul_u32_u24 v243, 1280, v243
    v_add_u32 v242, v242, v243
    s_waitcnt lgkmcnt(5)
    v_mfma_f32_32x32x16_bf16 v[160:175], v[224:227], v[216:219], v[160:175]
    s_waitcnt vmcnt(13)
    s_waitcnt lgkmcnt(0)
    s_barrier
    v_add_u32 v37, 0, v32
    v_add_u32 v38, 0, v33
    v_add_u32 v39, 0, v34
    v_add_u32 v40, 0, v35
    v_add_u32 v41, 0, v36
    v_cvt_pk_bf16_f32 v134, v140, v141
    v_cvt_pk_bf16_f32 v135, v142, v143
    v_cvt_pk_bf16_f32 v144, v144, v145
    v_add_u32 v11, 9216, v242
    v_bfe_u32 v242, v241, 4, 2
    v_bfe_u32 v243, v241, 0, 3
    v_xor_b32 v242, v242, v243
    ds_read_b64_tr_b16 v[200:201], v41 offset:0
    v_mfma_f32_32x32x16_bf16 v[176:191], v[224:227], v[220:223], v[176:191]
    ds_read_b64_tr_b16 v[202:203], v41 offset:1024
    ds_read_b128 v[192:195], v37 offset:0
    ds_read_b128 v[196:199], v37 offset:4096
    v_lshlrev_b32 v242, 4, v242
    v_bfe_u32 v243, v241, 3, 3
    v_mul_u32_u24 v243, 1280, v243
    v_add_u32 v242, v242, v243
    s_add_u32 m0, s60, 65536
    s_add_u32 s57, s4, 640
    buffer_load_dwordx4 v26, s[20:23], s57 offen offset:0  lds
    buffer_load_dwordx4 v27, s[20:23], s57 offen offset:1024  lds
    v_mfma_f32_32x32x16_bf16 v[160:175], v[236:239], v[228:231], v[160:175]
    ds_read_b64_tr_b16 v[212:213], v41 offset:4096
    v_cvt_pk_bf16_f32 v145, v146, v147
    v_cvt_pk_bf16_f32 v146, v148, v149
    v_add_u32 v12, 18432, v242
    v_bfe_u32 v242, v241, 4, 2
    v_xor_b32 v242, 4, v242
    v_bfe_u32 v243, v241, 0, 3
    v_cvt_pk_bf16_f32 v147, v150, v151
    v_mfma_f32_32x32x16_bf16 v[176:191], v[236:239], v[232:235], v[176:191]
    ds_read_b64_tr_b16 v[214:215], v41 offset:5120
    ds_read_b128 v[204:207], v38 offset:0
    ds_read_b128 v[208:211], v38 offset:4096
    v_xor_b32 v242, v242, v243
    v_lshlrev_b32 v242, 4, v242
    v_bfe_u32 v243, v241, 3, 3
    v_mul_u32_u24 v243, 1280, v243
    s_add_u32 m0, s60, 81920
    s_add_u32 s58, s5, 1228800
    buffer_load_dwordx4 v28, s[24:27], s58 offen offset:0  lds
    buffer_load_dwordx4 v29, s[24:27], s58 offen offset:1024  lds
    s_waitcnt lgkmcnt(5)
    v_mfma_f32_32x32x16_bf16 v[160:175], v[200:203], v[192:195], v[160:175]
    ds_read_b64_tr_b16 v[224:225], v41 offset:8192
    v_cvt_pk_bf16_f32 v148, v152, v153
    v_cvt_pk_bf16_f32 v149, v154, v155
    v_add_u32 v242, v242, v243
    v_add_u32 v13, 27648, v242
    s_and_b32 s55, s54, 1
    s_lshl_b32 s55, s55, 1
    v_cvt_pk_bf16_f32 v150, v156, v157
    s_waitcnt lgkmcnt(5)
    v_mfma_f32_32x32x16_bf16 v[176:191], v[200:203], v[196:199], v[176:191]
    ds_read_b64_tr_b16 v[226:227], v41 offset:9216
    ds_read_b128 v[216:219], v39 offset:0
    ds_read_b128 v[220:223], v39 offset:4096
    v_bfe_u32 v242, v241, 4, 2
    v_lshl_add_u32 v243, v242, 2, s55
    v_bfe_u32 v244, v241, 0, 4
    v_xor_b32 v243, v243, v244
    s_add_u32 s67, s63, 24576
    buffer_store_dwordx4 v[48:51], v240, s[16:19], s67 offen offset:1024 sc1
    s_waitcnt lgkmcnt(5)
    v_mfma_f32_32x32x16_bf16 v[160:175], v[212:215], v[204:207], v[160:175]
    ds_read_b64_tr_b16 v[236:237], v41 offset:12288
    v_cvt_pk_bf16_f32 v151, v158, v159
    v_cvt_pk_bf16_f32 v64, v64, v65
    v_lshlrev_b32 v243, 4, v243
    v_mul_u32_u24 v242, 8192, v242
    v_add_u32 v243, v243, v242
    v_add_u32 v14, 0, v243
    v_cvt_pk_bf16_f32 v65, v66, v67
    s_waitcnt lgkmcnt(5)
    v_mfma_f32_32x32x16_bf16 v[176:191], v[212:215], v[208:211], v[176:191]
    ds_read_b64_tr_b16 v[238:239], v41 offset:13312
    ds_read_b128 v[228:231], v40 offset:0
    ds_read_b128 v[232:235], v40 offset:4096
    v_bfe_u32 v242, v241, 4, 2
    v_lshl_add_u32 v243, v242, 2, s55
    v_bfe_u32 v244, v241, 0, 4
    v_xor_b32 v243, v243, v244
    v_mov_b32 v245, 0
    buffer_load_dwordx2 v[8:9], v245, s[48:51], 0 offen sc1
    s_waitcnt lgkmcnt(5)
    v_mfma_f32_32x32x16_bf16 v[160:175], v[224:227], v[216:219], v[160:175]
    s_waitcnt vmcnt(15)
    s_waitcnt lgkmcnt(0)
    s_barrier
    v_add_u32 v37, 98304, v32
    v_add_u32 v38, 98304, v33
    v_add_u32 v39, 98304, v34
    v_add_u32 v40, 98304, v35
    v_add_u32 v41, 98304, v36
    v_cvt_pk_bf16_f32 v66, v68, v69
    v_cvt_pk_bf16_f32 v67, v70, v71
    v_cvt_pk_bf16_f32 v68, v72, v73
    v_lshlrev_b32 v243, 4, v243
    v_mul_u32_u24 v242, 8192, v242
    v_add_u32 v243, v243, v242
    v_add_u32 v15, 31744, v243
    ds_read_b64_tr_b16 v[200:201], v41 offset:0
    v_mfma_f32_32x32x16_bf16 v[176:191], v[224:227], v[220:223], v[176:191]
    ds_read_b64_tr_b16 v[202:203], v41 offset:1024
    ds_read_b128 v[192:195], v37 offset:0
    ds_read_b128 v[196:199], v37 offset:4096
    s_and_b32 s55, s54, 4
    s_add_u32 s56, s55, 0
    v_bfe_u32 v242, v241, 2, 2
    v_bfe_u32 v244, v241, 4, 1
    s_add_u32 m0, s60, 0
    s_add_u32 s57, s4, 768
    buffer_load_dwordx4 v26, s[20:23], s57 offen offset:0  lds
    buffer_load_dwordx4 v27, s[20:23], s57 offen offset:1024  lds
    v_mfma_f32_32x32x16_bf16 v[160:175], v[236:239], v[228:231], v[160:175]
    ds_read_b64_tr_b16 v[212:213], v41 offset:4096
    v_cvt_pk_bf16_f32 v69, v74, v75
    v_cvt_pk_bf16_f32 v70, v76, v77
    v_lshl_add_u32 v243, v242, 1, v244
    v_xor_b32 v243, s56, v243
    v_lshlrev_b32 v243, 5, v243
    v_bfe_u32 v244, v241, 4, 2
    v_cvt_pk_bf16_f32 v71, v78, v79
    v_mfma_f32_32x32x16_bf16 v[176:191], v[236:239], v[232:235], v[176:191]
    ds_read_b64_tr_b16 v[214:215], v41 offset:5120
    ds_read_b128 v[204:207], v38 offset:0
    ds_read_b128 v[208:211], v38 offset:4096
    v_lshl_add_u32 v242, v244, 3, v242
    v_lshl_add_u32 v243, v242, 8, v243
    v_bfe_u32 v242, v241, 0, 2
    v_lshl_add_u32 v243, v242, 3, v243
    s_add_u32 m0, s60, 16384
    s_add_u32 s58, s5, 1474560
    buffer_load_dwordx4 v28, s[24:27], s58 offen offset:0  lds
    buffer_load_dwordx4 v29, s[24:27], s58 offen offset:1024  lds
    s_waitcnt lgkmcnt(5)
    v_mfma_f32_32x32x16_bf16 v[160:175], v[200:203], v[192:195], v[160:175]
    ds_read_b64_tr_b16 v[224:225], v41 offset:8192
    v_cvt_pk_bf16_f32 v80, v80, v81
    v_cvt_pk_bf16_f32 v81, v82, v83
    v_add_u32 v20, 98304, v243
    s_add_u32 s56, s55, 1
    v_bfe_u32 v242, v241, 2, 2
    v_bfe_u32 v244, v241, 4, 1
    v_cvt_pk_bf16_f32 v82, v84, v85
    s_waitcnt lgkmcnt(5)
    v_mfma_f32_32x32x16_bf16 v[176:191], v[200:203], v[196:199], v[176:191]
    ds_read_b64_tr_b16 v[226:227], v41 offset:9216
    ds_read_b128 v[216:219], v39 offset:0
    ds_read_b128 v[220:223], v39 offset:4096
    v_lshl_add_u32 v243, v242, 1, v244
    v_xor_b32 v243, s56, v243
    v_lshlrev_b32 v243, 5, v243
    v_bfe_u32 v244, v241, 4, 2
    s_add_u32 s67, s63, 24576
    buffer_store_dwordx4 v[52:55], v240, s[16:19], s67 offen offset:2048 sc1
    s_waitcnt lgkmcnt(5)
    v_mfma_f32_32x32x16_bf16 v[160:175], v[212:215], v[204:207], v[160:175]
    ds_read_b64_tr_b16 v[236:237], v41 offset:12288
    v_cvt_pk_bf16_f32 v83, v86, v87
    v_cvt_pk_bf16_f32 v84, v88, v89
    v_lshl_add_u32 v242, v244, 3, v242
    v_lshl_add_u32 v243, v242, 8, v243
    v_bfe_u32 v242, v241, 0, 2
    v_lshl_add_u32 v243, v242, 3, v243
    v_cvt_pk_bf16_f32 v85, v90, v91
    s_waitcnt lgkmcnt(5)
    v_mfma_f32_32x32x16_bf16 v[176:191], v[212:215], v[208:211], v[176:191]
    ds_read_b64_tr_b16 v[238:239], v41 offset:13312
    ds_read_b128 v[228:231], v40 offset:0
    ds_read_b128 v[232:235], v40 offset:4096
    v_add_u32 v21, 98304, v243
    s_add_u32 s56, s55, 2
    v_bfe_u32 v242, v241, 2, 2
    v_bfe_u32 v244, v241, 4, 1
    s_waitcnt lgkmcnt(5)
    v_mfma_f32_32x32x16_bf16 v[160:175], v[224:227], v[216:219], v[160:175]
    s_waitcnt vmcnt(16)
    s_waitcnt lgkmcnt(0)
    s_barrier
    v_add_u32 v37, 32768, v32
    v_add_u32 v38, 32768, v33
    v_add_u32 v39, 32768, v34
    v_add_u32 v40, 32768, v35
    v_add_u32 v41, 32768, v36
    v_cvt_pk_bf16_f32 v86, v92, v93
    v_cvt_pk_bf16_f32 v87, v94, v95
    v_cvt_pk_bf16_f32 v96, v96, v97
    v_lshl_add_u32 v243, v242, 1, v244
    v_xor_b32 v243, s56, v243
    v_lshlrev_b32 v243, 5, v243
    v_bfe_u32 v244, v241, 4, 2
    ds_read_b64_tr_b16 v[200:201], v41 offset:0
    v_mfma_f32_32x32x16_bf16 v[176:191], v[224:227], v[220:223], v[176:191]
    ds_read_b64_tr_b16 v[202:203], v41 offset:1024
    ds_read_b128 v[192:195], v37 offset:0
    ds_read_b128 v[196:199], v37 offset:4096
    v_lshl_add_u32 v242, v244, 3, v242
    v_lshl_add_u32 v243, v242, 8, v243
    v_bfe_u32 v242, v241, 0, 2
    v_lshl_add_u32 v243, v242, 3, v243
    s_add_u32 m0, s60, 98304
    s_add_u32 s57, s4, 896
    buffer_load_dwordx4 v26, s[20:23], s57 offen offset:0  lds
    buffer_load_dwordx4 v27, s[20:23], s57 offen offset:1024  lds
    v_mfma_f32_32x32x16_bf16 v[160:175], v[236:239], v[228:231], v[160:175]
    ds_read_b64_tr_b16 v[212:213], v41 offset:4096
    v_cvt_pk_bf16_f32 v97, v98, v99
    v_cvt_pk_bf16_f32 v98, v100, v101
    v_add_u32 v22, 98304, v243
    s_add_u32 s56, s55, 3
    v_bfe_u32 v242, v241, 2, 2
    v_bfe_u32 v244, v241, 4, 1
    v_cvt_pk_bf16_f32 v99, v102, v103
    v_mfma_f32_32x32x16_bf16 v[176:191], v[236:239], v[232:235], v[176:191]
    ds_read_b64_tr_b16 v[214:215], v41 offset:5120
    ds_read_b128 v[204:207], v38 offset:0
    ds_read_b128 v[208:211], v38 offset:4096
    v_lshl_add_u32 v243, v242, 1, v244
    v_xor_b32 v243, s56, v243
    v_lshlrev_b32 v243, 5, v243
    v_bfe_u32 v244, v241, 4, 2
    s_add_u32 m0, s60, 114688
    s_add_u32 s58, s5, 1720320
    buffer_load_dwordx4 v28, s[24:27], s58 offen offset:0  lds
    buffer_load_dwordx4 v29, s[24:27], s58 offen offset:1024  lds
    s_waitcnt lgkmcnt(5)
    v_mfma_f32_32x32x16_bf16 v[160:175], v[200:203], v[192:195], v[160:175]
    ds_read_b64_tr_b16 v[224:225], v41 offset:8192
    v_cvt_pk_bf16_f32 v100, v104, v105
    v_cvt_pk_bf16_f32 v101, v106, v107
    v_lshl_add_u32 v242, v244, 3, v242
    v_lshl_add_u32 v243, v242, 8, v243
    v_bfe_u32 v242, v241, 0, 2
    v_lshl_add_u32 v243, v242, 3, v243
    v_cvt_pk_bf16_f32 v102, v108, v109
    s_waitcnt lgkmcnt(5)
    v_mfma_f32_32x32x16_bf16 v[176:191], v[200:203], v[196:199], v[176:191]
    ds_read_b64_tr_b16 v[226:227], v41 offset:9216
    ds_read_b128 v[216:219], v39 offset:0
    ds_read_b128 v[220:223], v39 offset:4096
    v_add_u32 v23, 98304, v243
    s_xor_b32 s55, s59, 0x4000
    v_bfe_u32 v242, v241, 4, 2
    v_add_u32 v242, 0, v242
    s_add_u32 s67, s63, 24576
    buffer_store_dwordx4 v[56:59], v240, s[16:19], s67 offen offset:3072 sc1
    s_waitcnt lgkmcnt(5)
    v_mfma_f32_32x32x16_bf16 v[160:175], v[212:215], v[204:207], v[160:175]
    ds_read_b64_tr_b16 v[236:237], v41 offset:12288
    v_cvt_pk_bf16_f32 v103, v110, v111
    v_cvt_pk_bf16_f32 v112, v112, v113
    v_bfe_u32 v243, v241, 1, 3
    v_xor_b32 v242, v242, v243
    v_lshlrev_b32 v242, 4, v242
    v_bfe_u32 v243, v241, 0, 4
    v_cvt_pk_bf16_f32 v113, v114, v115
    s_waitcnt lgkmcnt(5)
    v_mfma_f32_32x32x16_bf16 v[176:191], v[212:215], v[208:211], v[176:191]
    ds_read_b64_tr_b16 v[238:239], v41 offset:13312
    ds_read_b128 v[228:231], v40 offset:0
    ds_read_b128 v[232:235], v40 offset:4096
    v_lshl_add_u32 v242, v243, 7, v242
    v_add_u32 v16, s59, v242
    v_add_u32 v18, s55, v242
    v_bfe_u32 v242, v241, 4, 2
    s_waitcnt lgkmcnt(5)
    v_mfma_f32_32x32x16_bf16 v[160:175], v[224:227], v[216:219], v[160:175]
    s_waitcnt vmcnt(17)
    s_waitcnt lgkmcnt(0)
    s_barrier
    v_add_u32 v37, 131072, v32
    v_add_u32 v38, 131072, v33
    v_add_u32 v39, 131072, v34
    v_add_u32 v40, 131072, v35
    v_add_u32 v41, 131072, v36
    v_cvt_pk_bf16_f32 v114, v116, v117
    v_cvt_pk_bf16_f32 v115, v118, v119
    v_cvt_pk_bf16_f32 v116, v120, v121
    v_add_u32 v242, 4, v242
    v_bfe_u32 v243, v241, 1, 3
    v_xor_b32 v242, v242, v243
    v_lshlrev_b32 v242, 4, v242
    ds_read_b64_tr_b16 v[200:201], v41 offset:0
    v_mfma_f32_32x32x16_bf16 v[176:191], v[224:227], v[220:223], v[176:191]
    ds_read_b64_tr_b16 v[202:203], v41 offset:1024
    ds_read_b128 v[192:195], v37 offset:0
    ds_read_b128 v[196:199], v37 offset:4096
    v_bfe_u32 v243, v241, 0, 4
    v_lshl_add_u32 v242, v243, 7, v242
    v_add_u32 v17, s59, v242
    v_add_u32 v19, s55, v242
    s_add_u32 m0, s60, 32768
    s_add_u32 s57, s4, 1024
    buffer_load_dwordx4 v26, s[20:23], s57 offen offset:0  lds
    buffer_load_dwordx4 v27, s[20:23], s57 offen offset:1024  lds
    v_mfma_f32_32x32x16_bf16 v[160:175], v[236:239], v[228:231], v[160:175]
    ds_read_b64_tr_b16 v[212:213], v41 offset:4096
    v_cvt_pk_bf16_f32 v117, v122, v123
    v_cvt_pk_bf16_f32 v118, v124, v125
    v_cvt_pk_bf16_f32 v119, v126, v127
    v_mfma_f32_32x32x16_bf16 v[176:191], v[236:239], v[232:235], v[176:191]
    ds_read_b64_tr_b16 v[214:215], v41 offset:5120
    ds_read_b128 v[204:207], v38 offset:0
    ds_read_b128 v[208:211], v38 offset:4096
    s_add_u32 m0, s60, 49152
    s_add_u32 s58, s5, 1966080
    buffer_load_dwordx4 v28, s[24:27], s58 offen offset:0  lds
    buffer_load_dwordx4 v29, s[24:27], s58 offen offset:1024  lds
    s_waitcnt lgkmcnt(5)
    v_mfma_f32_32x32x16_bf16 v[160:175], v[200:203], v[192:195], v[160:175]
    ds_read_b64_tr_b16 v[224:225], v41 offset:8192
    ds_read_b64_tr_b16 v[226:227], v41 offset:9216
    ds_read_b128 v[216:219], v39 offset:0
    s_waitcnt lgkmcnt(7)
    v_mfma_f32_32x32x16_bf16 v[176:191], v[200:203], v[196:199], v[176:191]
    ds_read_b128 v[220:223], v39 offset:4096
    s_add_u32 s67, s63, 16384
    buffer_store_dwordx4 v[128:131], v240, s[16:19], s67 offen offset:0 sc1
    s_waitcnt lgkmcnt(5)
    v_mfma_f32_32x32x16_bf16 v[160:175], v[212:215], v[204:207], v[160:175]
    ds_read_b64_tr_b16 v[236:237], v41 offset:12288
    ds_read_b64_tr_b16 v[238:239], v41 offset:13312
    s_waitcnt lgkmcnt(6)
    v_mfma_f32_32x32x16_bf16 v[176:191], v[212:215], v[208:211], v[176:191]
    ds_read_b128 v[228:231], v40 offset:0
    ds_read_b128 v[232:235], v40 offset:4096
    s_waitcnt lgkmcnt(5)
    v_mfma_f32_32x32x16_bf16 v[160:175], v[224:227], v[216:219], v[160:175]
    s_waitcnt vmcnt(17)
    s_waitcnt lgkmcnt(0)
    s_barrier
    v_add_u32 v37, 65536, v32
    v_add_u32 v38, 65536, v33
    v_add_u32 v39, 65536, v34
    v_add_u32 v40, 65536, v35
    v_add_u32 v41, 65536, v36
    ds_read_b64_tr_b16 v[200:201], v41 offset:0
    ds_read_b64_tr_b16 v[202:203], v41 offset:1024
    v_mfma_f32_32x32x16_bf16 v[176:191], v[224:227], v[220:223], v[176:191]
    ds_read_b128 v[192:195], v37 offset:0
    ds_read_b128 v[196:199], v37 offset:4096
    s_add_u32 m0, s60, 131072
    s_add_u32 s57, s4, 1152
    buffer_load_dwordx4 v26, s[20:23], s57 offen offset:0  lds
    buffer_load_dwordx4 v27, s[20:23], s57 offen offset:1024  lds
    v_mfma_f32_32x32x16_bf16 v[160:175], v[236:239], v[228:231], v[160:175]
    ds_read_b64_tr_b16 v[212:213], v41 offset:4096
    ds_read_b64_tr_b16 v[214:215], v41 offset:5120
    ds_read_b128 v[204:207], v38 offset:0
    v_mfma_f32_32x32x16_bf16 v[176:191], v[236:239], v[232:235], v[176:191]
    ds_read_b128 v[208:211], v38 offset:4096
    s_add_u32 m0, s60, 147456
    s_add_u32 s58, s5, 2211840
    buffer_load_dwordx4 v28, s[24:27], s58 offen offset:0  lds
    buffer_load_dwordx4 v29, s[24:27], s58 offen offset:1024  lds
    s_waitcnt lgkmcnt(5)
    v_mfma_f32_32x32x16_bf16 v[160:175], v[200:203], v[192:195], v[160:175]
    ds_read_b64_tr_b16 v[224:225], v41 offset:8192
    ds_read_b64_tr_b16 v[226:227], v41 offset:9216
    ds_read_b128 v[216:219], v39 offset:0
    s_waitcnt lgkmcnt(7)
    v_mfma_f32_32x32x16_bf16 v[176:191], v[200:203], v[196:199], v[176:191]
    ds_read_b128 v[220:223], v39 offset:4096
    s_add_u32 s67, s63, 16384
    buffer_store_dwordx4 v[132:135], v240, s[16:19], s67 offen offset:1024 sc1
    s_waitcnt lgkmcnt(5)
    v_mfma_f32_32x32x16_bf16 v[160:175], v[212:215], v[204:207], v[160:175]
    ds_read_b64_tr_b16 v[236:237], v41 offset:12288
    ds_read_b64_tr_b16 v[238:239], v41 offset:13312
    s_waitcnt lgkmcnt(6)
    v_mfma_f32_32x32x16_bf16 v[176:191], v[212:215], v[208:211], v[176:191]
    ds_read_b128 v[228:231], v40 offset:0
    ds_read_b128 v[232:235], v40 offset:4096
    s_waitcnt lgkmcnt(5)
    v_mfma_f32_32x32x16_bf16 v[160:175], v[224:227], v[216:219], v[160:175]
    s_waitcnt vmcnt(16)
    s_waitcnt lgkmcnt(0)
    s_barrier
    v_add_u32 v37, 0, v32
    v_add_u32 v38, 0, v33
    v_add_u32 v39, 0, v34
    v_add_u32 v40, 0, v35
    v_add_u32 v41, 0, v36
    ds_read_b64_tr_b16 v[200:201], v41 offset:0
    ds_read_b64_tr_b16 v[202:203], v41 offset:1024
    v_mfma_f32_32x32x16_bf16 v[176:191], v[224:227], v[220:223], v[176:191]
    ds_read_b128 v[192:195], v37 offset:0
    ds_read_b128 v[196:199], v37 offset:4096
    s_add_u32 m0, s59, 65536
    s_add_u32 s57, s68, 0
    buffer_load_dwordx4 v10, s[28:31], s57 offen offset:0  lds
    buffer_load_dwordx4 v11, s[28:31], s57 offen offset:1024  lds
    v_mfma_f32_32x32x16_bf16 v[160:175], v[236:239], v[228:231], v[160:175]
    ds_read_b64_tr_b16 v[212:213], v41 offset:4096
    ds_read_b64_tr_b16 v[214:215], v41 offset:5120
    ds_read_b128 v[204:207], v38 offset:0
    v_mfma_f32_32x32x16_bf16 v[176:191], v[236:239], v[232:235], v[176:191]
    ds_read_b128 v[208:211], v38 offset:4096
    s_add_u32 m0, s59, 65536
    s_add_u32 s57, s68, 0
    buffer_load_dwordx4 v12, s[28:31], s57 offen offset:2048  lds
    buffer_load_dwordx4 v13, s[28:31], s57 offen offset:3072  lds
    s_waitcnt lgkmcnt(5)
    v_mfma_f32_32x32x16_bf16 v[160:175], v[200:203], v[192:195], v[160:175]
    ds_read_b64_tr_b16 v[224:225], v41 offset:8192
    ds_read_b64_tr_b16 v[226:227], v41 offset:9216
    ds_read_b128 v[216:219], v39 offset:0
    s_waitcnt lgkmcnt(7)
    v_mfma_f32_32x32x16_bf16 v[176:191], v[200:203], v[196:199], v[176:191]
    ds_read_b128 v[220:223], v39 offset:4096
    s_add_u32 s67, s63, 16384
    buffer_store_dwordx4 v[144:147], v240, s[16:19], s67 offen offset:2048 sc1
    s_waitcnt lgkmcnt(5)
    v_mfma_f32_32x32x16_bf16 v[160:175], v[212:215], v[204:207], v[160:175]
    ds_read_b64_tr_b16 v[236:237], v41 offset:12288
    ds_read_b64_tr_b16 v[238:239], v41 offset:13312
    s_waitcnt lgkmcnt(6)
    v_mfma_f32_32x32x16_bf16 v[176:191], v[212:215], v[208:211], v[176:191]
    ds_read_b128 v[228:231], v40 offset:0
    ds_read_b128 v[232:235], v40 offset:4096
    s_waitcnt lgkmcnt(5)
    v_mfma_f32_32x32x16_bf16 v[160:175], v[224:227], v[216:219], v[160:175]
    s_waitcnt vmcnt(16)
    s_waitcnt lgkmcnt(0)
    s_barrier
    v_add_u32 v37, 98304, v32
    v_add_u32 v38, 98304, v33
    v_add_u32 v39, 98304, v34
    v_add_u32 v40, 98304, v35
    v_add_u32 v41, 98304, v36
    ds_read_b64_tr_b16 v[200:201], v41 offset:0
    ds_read_b64_tr_b16 v[202:203], v41 offset:1024
    v_mfma_f32_32x32x16_bf16 v[176:191], v[224:227], v[220:223], v[176:191]
    ds_read_b128 v[192:195], v37 offset:0
    ds_read_b128 v[196:199], v37 offset:4096
    s_add_u32 m0, s59, 0
    s_add_u32 s57, s68, 128
    buffer_load_dwordx4 v10, s[28:31], s57 offen offset:0  lds
    buffer_load_dwordx4 v11, s[28:31], s57 offen offset:1024  lds
    v_mfma_f32_32x32x16_bf16 v[160:175], v[236:239], v[228:231], v[160:175]
    ds_read_b64_tr_b16 v[212:213], v41 offset:4096
    ds_read_b64_tr_b16 v[214:215], v41 offset:5120
    ds_read_b128 v[204:207], v38 offset:0
    v_mfma_f32_32x32x16_bf16 v[176:191], v[236:239], v[232:235], v[176:191]
    ds_read_b128 v[208:211], v38 offset:4096
    s_add_u32 m0, s59, 0
    s_add_u32 s57, s68, 128
    buffer_load_dwordx4 v12, s[28:31], s57 offen offset:2048  lds
    buffer_load_dwordx4 v13, s[28:31], s57 offen offset:3072  lds
    s_waitcnt lgkmcnt(5)
    v_mfma_f32_32x32x16_bf16 v[160:175], v[200:203], v[192:195], v[160:175]
    ds_read_b64_tr_b16 v[224:225], v41 offset:8192
    ds_read_b64_tr_b16 v[226:227], v41 offset:9216
    ds_read_b128 v[216:219], v39 offset:0
    s_waitcnt lgkmcnt(7)
    v_mfma_f32_32x32x16_bf16 v[176:191], v[200:203], v[196:199], v[176:191]
    ds_read_b128 v[220:223], v39 offset:4096
    s_add_u32 s67, s63, 16384
    buffer_store_dwordx4 v[148:151], v240, s[16:19], s67 offen offset:3072 sc1
    s_waitcnt lgkmcnt(5)
    v_mfma_f32_32x32x16_bf16 v[160:175], v[212:215], v[204:207], v[160:175]
    ds_read_b64_tr_b16 v[236:237], v41 offset:12288
    ds_read_b64_tr_b16 v[238:239], v41 offset:13312
    ds_read_b128 v[228:231], v40 offset:0
    s_waitcnt lgkmcnt(7)
    v_mfma_f32_32x32x16_bf16 v[176:191], v[212:215], v[208:211], v[176:191]
    ds_read_b128 v[232:235], v40 offset:4096
    v_readfirstlane_b32 s84, v8
    v_readfirstlane_b32 s85, v9
    s_cmp_lg_u32 s84, 0
    s_cbranch_scc1 L_nget3_ok
    s_mov_b32 s56, 1048576
L_nget3:
    buffer_load_dwordx2 v[8:9], v245, s[48:51], 0 offen sc1
    s_waitcnt vmcnt(0)
    v_readfirstlane_b32 s84, v8
    v_readfirstlane_b32 s85, v9
    s_sub_u32 s56, s56, 1
    s_cbranch_scc1 L_nget3_ok
    s_cmp_eq_u32 s84, 0
    s_cbranch_scc1 L_nget3
L_nget3_ok:
    s_waitcnt lgkmcnt(5)
    v_mfma_f32_32x32x16_bf16 v[160:175], v[224:227], v[216:219], v[160:175]
    s_waitcnt vmcnt(16)
    s_waitcnt lgkmcnt(0)
    s_barrier
    v_add_u32 v37, 32768, v32
    v_add_u32 v38, 32768, v33
    v_add_u32 v39, 32768, v34
    v_add_u32 v40, 32768, v35
    v_add_u32 v41, 32768, v36
    ds_read_b64_tr_b16 v[200:201], v41 offset:0
    ds_read_b64_tr_b16 v[202:203], v41 offset:1024
    v_mfma_f32_32x32x16_bf16 v[176:191], v[224:227], v[220:223], v[176:191]
    ds_read_b128 v[192:195], v37 offset:0
    ds_read_b128 v[196:199], v37 offset:4096
    s_add_u32 m0, s60, 98304
    s_add_u32 s58, s69, 0
    buffer_load_dwordx4 v14, s[32:35], s58 offen offset:0  lds
    buffer_load_dwordx4 v15, s[32:35], s58 offen offset:1024  lds
    v_mfma_f32_32x32x16_bf16 v[160:175], v[236:239], v[228:231], v[160:175]
    ds_read_b64_tr_b16 v[212:213], v41 offset:4096
    ds_read_b64_tr_b16 v[214:215], v41 offset:5120
    ds_read_b128 v[204:207], v38 offset:0
    v_mfma_f32_32x32x16_bf16 v[176:191], v[236:239], v[232:235], v[176:191]
    ds_read_b128 v[208:211], v38 offset:4096
    s_add_u32 m0, s60, 114688
    s_add_u32 s58, s69, 524288
    buffer_load_dwordx4 v14, s[32:35], s58 offen offset:0  lds
    buffer_load_dwordx4 v15, s[32:35], s58 offen offset:1024  lds
    s_waitcnt lgkmcnt(5)
    v_mfma_f32_32x32x16_bf16 v[160:175], v[200:203], v[192:195], v[160:175]
    ds_read_b64_tr_b16 v[224:225], v41 offset:8192
    ds_read_b64_tr_b16 v[226:227], v41 offset:9216
    ds_read_b128 v[216:219], v39 offset:0
    s_waitcnt lgkmcnt(7)
    v_mfma_f32_32x32x16_bf16 v[176:191], v[200:203], v[196:199], v[176:191]
    ds_read_b128 v[220:223], v39 offset:4096
    s_add_u32 s67, s63, 0
    buffer_store_dwordx4 v[64:67], v240, s[16:19], s67 offen offset:0 sc1
    s_waitcnt lgkmcnt(5)
    v_mfma_f32_32x32x16_bf16 v[160:175], v[212:215], v[204:207], v[160:175]
    ds_read_b64_tr_b16 v[236:237], v41 offset:12288
    ds_read_b64_tr_b16 v[238:239], v41 offset:13312
    s_waitcnt lgkmcnt(6)
    v_mfma_f32_32x32x16_bf16 v[176:191], v[212:215], v[208:211], v[176:191]
    ds_read_b128 v[228:231], v40 offset:0
    ds_read_b128 v[232:235], v40 offset:4096
    s_waitcnt lgkmcnt(5)
    v_mfma_f32_32x32x16_bf16 v[160:175], v[224:227], v[216:219], v[160:175]
    s_waitcnt vmcnt(16)
    s_waitcnt lgkmcnt(0)
    s_barrier
    v_add_u32 v37, 131072, v32
    v_add_u32 v38, 131072, v33
    v_add_u32 v39, 131072, v34
    v_add_u32 v40, 131072, v35
    v_add_u32 v41, 131072, v36
    ds_read_b64_tr_b16 v[200:201], v41 offset:0
    ds_read_b64_tr_b16 v[202:203], v41 offset:1024
    v_mfma_f32_32x32x16_bf16 v[176:191], v[224:227], v[220:223], v[176:191]
    ds_read_b128 v[192:195], v37 offset:0
    ds_read_b128 v[196:199], v37 offset:4096
    s_add_u32 m0, s59, 32768
    s_add_u32 s57, s68, 256
    buffer_load_dwordx4 v10, s[28:31], s57 offen offset:0  lds
    buffer_load_dwordx4 v11, s[28:31], s57 offen offset:1024  lds
    v_mfma_f32_32x32x16_bf16 v[160:175], v[236:239], v[228:231], v[160:175]
    ds_read_b64_tr_b16 v[212:213], v41 offset:4096
    ds_read_b64_tr_b16 v[214:215], v41 offset:5120
    ds_read_b128 v[204:207], v38 offset:0
    v_mfma_f32_32x32x16_bf16 v[176:191], v[236:239], v[232:235], v[176:191]
    ds_read_b128 v[208:211], v38 offset:4096
    s_add_u32 m0, s59, 32768
    s_add_u32 s57, s68, 256
    buffer_load_dwordx4 v12, s[28:31], s57 offen offset:2048  lds
    buffer_load_dwordx4 v13, s[28:31], s57 offen offset:3072  lds
    s_waitcnt lgkmcnt(5)
    v_mfma_f32_32x32x16_bf16 v[160:175], v[200:203], v[192:195], v[160:175]
    ds_read_b64_tr_b16 v[224:225], v41 offset:8192
    ds_read_b64_tr_b16 v[226:227], v41 offset:9216
    ds_read_b128 v[216:219], v39 offset:0
    s_waitcnt lgkmcnt(7)
    v_mfma_f32_32x32x16_bf16 v[176:191], v[200:203], v[196:199], v[176:191]
    ds_read_b128 v[220:223], v39 offset:4096
    s_add_u32 s67, s63, 0
    buffer_store_dwordx4 v[68:71], v240, s[16:19], s67 offen offset:1024 sc1
    s_waitcnt lgkmcnt(5)
    v_mfma_f32_32x32x16_bf16 v[160:175], v[212:215], v[204:207], v[160:175]
    ds_read_b64_tr_b16 v[236:237], v41 offset:12288
    ds_read_b64_tr_b16 v[238:239], v41 offset:13312
    s_waitcnt lgkmcnt(6)
    v_mfma_f32_32x32x16_bf16 v[176:191], v[212:215], v[208:211], v[176:191]
    ds_read_b128 v[228:231], v40 offset:0
    ds_read_b128 v[232:235], v40 offset:4096
    s_waitcnt lgkmcnt(5)
    v_mfma_f32_32x32x16_bf16 v[160:175], v[224:227], v[216:219], v[160:175]
    s_waitcnt lgkmcnt(0)
    s_barrier
    v_mfma_f32_32x32x16_bf16 v[176:191], v[224:227], v[220:223], v[176:191]
    s_add_u32 m0, s60, 131072
    s_add_u32 s58, s69, 1048576
    buffer_load_dwordx4 v14, s[32:35], s58 offen offset:0  lds
    buffer_load_dwordx4 v15, s[32:35], s58 offen offset:1024  lds
    v_mfma_f32_32x32x16_bf16 v[160:175], v[236:239], v[228:231], v[160:175]
    s_add_u32 m0, s60, 147456
    s_add_u32 s58, s69, 1572864
    buffer_load_dwordx4 v14, s[32:35], s58 offen offset:0  lds
    buffer_load_dwordx4 v15, s[32:35], s58 offen offset:1024  lds
    v_mfma_f32_32x32x16_bf16 v[176:191], v[236:239], v[232:235], v[176:191]
    v_add_u32 v0, 65536, v16
    v_add_u32 v1, 65536, v17
    v_add_u32 v2, 65536, v18
    v_add_u32 v3, 65536, v19
    s_waitcnt vmcnt(12)
    s_barrier
    ds_read_b64_tr_b16 v[192:193], v20 offset:0
    ds_read_b64_tr_b16 v[194:195], v20 offset:1024
    ds_read_b128 v[224:227], v0 offset:0
    ds_read_b64_tr_b16 v[196:197], v21 offset:0
    ds_read_b64_tr_b16 v[198:199], v21 offset:1024
    ds_read_b128 v[228:231], v0 offset:2048
    ds_read_b64_tr_b16 v[200:201], v22 offset:0
    ds_read_b64_tr_b16 v[202:203], v22 offset:1024
    ds_read_b128 v[232:235], v2 offset:0
    ds_read_b64_tr_b16 v[204:205], v23 offset:0
    ds_read_b64_tr_b16 v[206:207], v23 offset:1024
    ds_read_b128 v[236:239], v2 offset:2048
    v_cvt_pk_bf16_f32 v44, v160, v161
    v_cvt_pk_bf16_f32 v45, v162, v163
    v_cvt_pk_bf16_f32 v46, v164, v165
    v_cvt_pk_bf16_f32 v47, v166, v167
    v_cvt_pk_bf16_f32 v48, v168, v169
    v_cvt_pk_bf16_f32 v49, v170, v171
    v_cvt_pk_bf16_f32 v50, v172, v173
    v_cvt_pk_bf16_f32 v51, v174, v175
    v_cvt_pk_bf16_f32 v52, v176, v177
    v_cvt_pk_bf16_f32 v53, v178, v179
    v_cvt_pk_bf16_f32 v54, v180, v181
    v_cvt_pk_bf16_f32 v55, v182, v183
    v_cvt_pk_bf16_f32 v56, v184, v185
    v_cvt_pk_bf16_f32 v57, v186, v187
    v_cvt_pk_bf16_f32 v58, v188, v189
    v_cvt_pk_bf16_f32 v59, v190, v191
    v_permlane32_swap_b32 v44, v46
    v_permlane32_swap_b32 v45, v47
    v_permlane32_swap_b32 v48, v50
    v_permlane32_swap_b32 v49, v51
    v_permlane32_swap_b32 v52, v54
    v_permlane32_swap_b32 v53, v55
    v_permlane32_swap_b32 v56, v58
    v_permlane32_swap_b32 v57, v59
    s_waitcnt lgkmcnt(9)
    v_mfma_f32_16x16x32_bf16 v[128:131], v[192:195], v[224:227], 0
    ds_read_b64_tr_b16 v[208:209], v20 offset:8192
    s_waitcnt lgkmcnt(8)
    v_mfma_f32_16x16x32_bf16 v[132:135], v[196:199], v[224:227], 0
    s_waitcnt lgkmcnt(5)
    v_mfma_f32_16x16x32_bf16 v[136:139], v[200:203], v[224:227], 0
    ds_read_b64_tr_b16 v[210:211], v20 offset:9216
    s_waitcnt lgkmcnt(3)
    v_mfma_f32_16x16x32_bf16 v[140:143], v[204:207], v[224:227], 0
    v_mfma_f32_16x16x32_bf16 v[156:159], v[204:207], v[228:231], 0
    ds_read_b128 v[224:227], v1 offset:0
    v_mfma_f32_16x16x32_bf16 v[152:155], v[200:203], v[228:231], 0
    ds_read_b64_tr_b16 v[212:213], v21 offset:8192
    v_mfma_f32_16x16x32_bf16 v[148:151], v[196:199], v[228:231], 0
    ds_read_b64_tr_b16 v[214:215], v21 offset:9216
    v_mfma_f32_16x16x32_bf16 v[144:147], v[192:195], v[228:231], 0
    v_mfma_f32_16x16x32_bf16 v[160:163], v[192:195], v[232:235], 0
    ds_read_b128 v[228:231], v1 offset:2048
    v_mfma_f32_16x16x32_bf16 v[164:167], v[196:199], v[232:235], 0
    ds_read_b64_tr_b16 v[216:217], v22 offset:8192
    v_mfma_f32_16x16x32_bf16 v[168:171], v[200:203], v[232:235], 0
    s_add_u32 s67, s63, 0
    buffer_store_dwordx4 v[80:83], v240, s[16:19], s67 offen offset:2048 sc1
    v_mfma_f32_16x16x32_bf16 v[172:175], v[204:207], v[232:235], 0
    ds_read_b64_tr_b16 v[218:219], v22 offset:9216
    s_waitcnt lgkmcnt(8)
    v_mfma_f32_16x16x32_bf16 v[188:191], v[204:207], v[236:239], 0
    ds_read_b128 v[232:235], v3 offset:0
    v_mfma_f32_16x16x32_bf16 v[184:187], v[200:203], v[236:239], 0
    s_add_u32 s67, s63, 0
    buffer_store_dwordx4 v[84:87], v240, s[16:19], s67 offen offset:3072 sc1
    v_mfma_f32_16x16x32_bf16 v[180:183], v[196:199], v[236:239], 0
    ds_read_b64_tr_b16 v[220:221], v23 offset:8192
    v_mfma_f32_16x16x32_bf16 v[176:179], v[192:195], v[236:239], 0
    ds_read_b64_tr_b16 v[222:223], v23 offset:9216
    ds_read_b128 v[236:239], v3 offset:2048
    s_waitcnt lgkmcnt(9)
    v_mfma_f32_16x16x32_bf16 v[128:131], v[208:211], v[224:227], v[128:131]
    s_waitcnt vmcnt(12)
    s_waitcnt lgkmcnt(0)
    s_barrier
    v_add_u32 v0, 0, v16
    v_add_u32 v1, 0, v17
    v_add_u32 v2, 0, v18
    v_add_u32 v3, 0, v19
    v_mfma_f32_16x16x32_bf16 v[132:135], v[212:215], v[224:227], v[132:135]
    ds_read_b64_tr_b16 v[192:193], v20 offset:16384
    v_mfma_f32_16x16x32_bf16 v[136:139], v[216:219], v[224:227], v[136:139]
    s_add_u32 m0, s60, 98304
    s_add_u32 s58, s69, 2097152
    buffer_load_dwordx4 v14, s[32:35], s58 offen offset:0  lds
    v_mfma_f32_16x16x32_bf16 v[140:143], v[220:223], v[224:227], v[140:143]
    v_mfma_f32_16x16x32_bf16 v[156:159], v[220:223], v[228:231], v[156:159]
    ds_read_b128 v[224:227], v0 offset:0
    ds_read_b64_tr_b16 v[194:195], v20 offset:17408
    v_mfma_f32_16x16x32_bf16 v[152:155], v[216:219], v[228:231], v[152:155]
    ds_read_b64_tr_b16 v[196:197], v21 offset:16384
    v_mfma_f32_16x16x32_bf16 v[148:151], v[212:215], v[228:231], v[148:151]
    s_add_u32 m0, s60, 98304
    s_add_u32 s58, s69, 2097152
    buffer_load_dwordx4 v15, s[32:35], s58 offen offset:1024  lds
    v_mfma_f32_16x16x32_bf16 v[144:147], v[208:211], v[228:231], v[144:147]
    ds_read_b64_tr_b16 v[198:199], v21 offset:17408
    v_mfma_f32_16x16x32_bf16 v[160:163], v[208:211], v[232:235], v[160:163]
    ds_read_b128 v[228:231], v0 offset:2048
    v_mfma_f32_16x16x32_bf16 v[164:167], v[212:215], v[232:235], v[164:167]
    ds_read_b64_tr_b16 v[200:201], v22 offset:16384
    v_mfma_f32_16x16x32_bf16 v[168:171], v[216:219], v[232:235], v[168:171]
    s_add_u32 m0, s59, 65536
    s_add_u32 s57, s68, 384
    buffer_load_dwordx4 v10, s[28:31], s57 offen offset:0  lds
    v_mfma_f32_16x16x32_bf16 v[172:175], v[220:223], v[232:235], v[172:175]
    ds_read_b64_tr_b16 v[202:203], v22 offset:17408
    v_mfma_f32_16x16x32_bf16 v[188:191], v[220:223], v[236:239], v[188:191]
    ds_read_b128 v[232:235], v2 offset:0
    v_mfma_f32_16x16x32_bf16 v[184:187], v[216:219], v[236:239], v[184:187]
    s_add_u32 m0, s59, 65536
    s_add_u32 s57, s68, 384
    buffer_load_dwordx4 v11, s[28:31], s57 offen offset:1024  lds
    v_mfma_f32_16x16x32_bf16 v[180:183], v[212:215], v[236:239], v[180:183]
    ds_read_b64_tr_b16 v[204:205], v23 offset:16384
    v_mfma_f32_16x16x32_bf16 v[176:179], v[208:211], v[236:239], v[176:179]
    ds_read_b64_tr_b16 v[206:207], v23 offset:17408
    ds_read_b128 v[236:239], v2 offset:2048
    s_waitcnt lgkmcnt(9)
    v_mfma_f32_16x16x32_bf16 v[128:131], v[192:195], v[224:227], v[128:131]
    ds_read_b64_tr_b16 v[208:209], v20 offset:24576
    s_waitcnt lgkmcnt(8)
    v_mfma_f32_16x16x32_bf16 v[132:135], v[196:199], v[224:227], v[132:135]
    s_add_u32 m0, s59, 65536
    s_add_u32 s57, s68, 384
    buffer_load_dwordx4 v12, s[28:31], s57 offen offset:2048  lds
    s_waitcnt lgkmcnt(5)
    v_mfma_f32_16x16x32_bf16 v[136:139], v[200:203], v[224:227], v[136:139]
    ds_read_b64_tr_b16 v[210:211], v20 offset:25600
    s_waitcnt lgkmcnt(3)
    v_mfma_f32_16x16x32_bf16 v[140:143], v[204:207], v[224:227], v[140:143]
    v_mfma_f32_16x16x32_bf16 v[156:159], v[204:207], v[228:231], v[156:159]
    ds_read_b128 v[224:227], v1 offset:0
    v_mfma_f32_16x16x32_bf16 v[152:155], v[200:203], v[228:231], v[152:155]
    ds_read_b64_tr_b16 v[212:213], v21 offset:24576
    v_mfma_f32_16x16x32_bf16 v[148:151], v[196:199], v[228:231], v[148:151]
    s_add_u32 m0, s59, 65536
    s_add_u32 s57, s68, 384
    buffer_load_dwordx4 v13, s[28:31], s57 offen offset:3072  lds
    v_mfma_f32_16x16x32_bf16 v[144:147], v[192:195], v[228:231], v[144:147]
    ds_read_b64_tr_b16 v[214:215], v21 offset:25600
    v_mfma_f32_16x16x32_bf16 v[160:163], v[192:195], v[232:235], v[160:163]
    ds_read_b128 v[228:231], v1 offset:2048
    v_mfma_f32_16x16x32_bf16 v[164:167], v[196:199], v[232:235], v[164:167]
    ds_read_b64_tr_b16 v[216:217], v22 offset:24576
    v_mfma_f32_16x16x32_bf16 v[168:171], v[200:203], v[232:235], v[168:171]
    s_add_u32 s67, s63, 8192
    buffer_store_dwordx4 v[96:99], v240, s[16:19], s67 offen offset:0 sc1
    v_mfma_f32_16x16x32_bf16 v[172:175], v[204:207], v[232:235], v[172:175]
    ds_read_b64_tr_b16 v[218:219], v22 offset:25600
    s_waitcnt lgkmcnt(8)
    v_mfma_f32_16x16x32_bf16 v[188:191], v[204:207], v[236:239], v[188:191]
    ds_read_b128 v[232:235], v3 offset:0
    v_mfma_f32_16x16x32_bf16 v[184:187], v[200:203], v[236:239], v[184:187]
    s_add_u32 s67, s63, 8192
    buffer_store_dwordx4 v[100:103], v240, s[16:19], s67 offen offset:1024 sc1
    v_mfma_f32_16x16x32_bf16 v[180:183], v[196:199], v[236:239], v[180:183]
    ds_read_b64_tr_b16 v[220:221], v23 offset:24576
    v_mfma_f32_16x16x32_bf16 v[176:179], v[192:195], v[236:239], v[176:179]
    ds_read_b64_tr_b16 v[222:223], v23 offset:25600
    ds_read_b128 v[236:239], v3 offset:2048
    s_waitcnt lgkmcnt(9)
    v_mfma_f32_16x16x32_bf16 v[128:131], v[208:211], v[224:227], v[128:131]
    s_waitcnt vmcnt(12)
    s_waitcnt lgkmcnt(0)
    s_barrier
    v_add_u32 v0, 32768, v16
    v_add_u32 v1, 32768, v17
    v_add_u32 v2, 32768, v18
    v_add_u32 v3, 32768, v19
    v_mfma_f32_16x16x32_bf16 v[132:135], v[212:215], v[224:227], v[132:135]
    ds_read_b64_tr_b16 v[192:193], v20 offset:32768
    v_mfma_f32_16x16x32_bf16 v[136:139], v[216:219], v[224:227], v[136:139]
    s_add_u32 m0, s60, 114688
    s_add_u32 s58, s69, 2621440
    buffer_load_dwordx4 v14, s[32:35], s58 offen offset:0  lds
    v_mfma_f32_16x16x32_bf16 v[140:143], v[220:223], v[224:227], v[140:143]
    v_mfma_f32_16x16x32_bf16 v[156:159], v[220:223], v[228:231], v[156:159]
    ds_read_b128 v[224:227], v0 offset:0
    ds_read_b64_tr_b16 v[194:195], v20 offset:33792
    v_mfma_f32_16x16x32_bf16 v[152:155], v[216:219], v[228:231], v[152:155]
    ds_read_b64_tr_b16 v[196:197], v21 offset:32768
    v_mfma_f32_16x16x32_bf16 v[148:151], v[212:215], v[228:231], v[148:151]
    s_add_u32 m0, s60, 114688
    s_add_u32 s58, s69, 2621440
    buffer_load_dwordx4 v15, s[32:35], s58 offen offset:1024  lds
    v_mfma_f32_16x16x32_bf16 v[144:147], v[208:211], v[228:231], v[144:147]
    ds_read_b64_tr_b16 v[198:199], v21 offset:33792
    v_mfma_f32_16x16x32_bf16 v[160:163], v[208:211], v[232:235], v[160:163]
    ds_read_b128 v[228:231], v0 offset:2048
    v_mfma_f32_16x16x32_bf16 v[164:167], v[212:215], v[232:235], v[164:167]
    ds_read_b64_tr_b16 v[200:201], v22 offset:32768
    v_mfma_f32_16x16x32_bf16 v[168:171], v[216:219], v[232:235], v[168:171]
    s_add_u32 m0, s59, 0
    s_add_u32 s57, s68, 512
    buffer_load_dwordx4 v10, s[28:31], s57 offen offset:0  lds
    v_mfma_f32_16x16x32_bf16 v[172:175], v[220:223], v[232:235], v[172:175]
    ds_read_b64_tr_b16 v[202:203], v22 offset:33792
    v_mfma_f32_16x16x32_bf16 v[188:191], v[220:223], v[236:239], v[188:191]
    ds_read_b128 v[232:235], v2 offset:0
    v_mfma_f32_16x16x32_bf16 v[184:187], v[216:219], v[236:239], v[184:187]
    s_add_u32 m0, s59, 0
    s_add_u32 s57, s68, 512
    buffer_load_dwordx4 v11, s[28:31], s57 offen offset:1024  lds
    v_mfma_f32_16x16x32_bf16 v[180:183], v[212:215], v[236:239], v[180:183]
    ds_read_b64_tr_b16 v[204:205], v23 offset:32768
    v_mfma_f32_16x16x32_bf16 v[176:179], v[208:211], v[236:239], v[176:179]
    ds_read_b64_tr_b16 v[206:207], v23 offset:33792
    ds_read_b128 v[236:239], v2 offset:2048
    s_waitcnt lgkmcnt(9)
    v_mfma_f32_16x16x32_bf16 v[128:131], v[192:195], v[224:227], v[128:131]
    ds_read_b64_tr_b16 v[208:209], v20 offset:40960
    s_waitcnt lgkmcnt(8)
    v_mfma_f32_16x16x32_bf16 v[132:135], v[196:199], v[224:227], v[132:135]
    s_add_u32 m0, s59, 0
    s_add_u32 s57, s68, 512
    buffer_load_dwordx4 v12, s[28:31], s57 offen offset:2048  lds
    s_waitcnt lgkmcnt(5)
    v_mfma_f32_16x16x32_bf16 v[136:139], v[200:203], v[224:227], v[136:139]
    ds_read_b64_tr_b16 v[210:211], v20 offset:41984
    s_waitcnt lgkmcnt(3)
    v_mfma_f32_16x16x32_bf16 v[140:143], v[204:207], v[224:227], v[140:143]
    v_mfma_f32_16x16x32_bf16 v[156:159], v[204:207], v[228:231], v[156:159]
    ds_read_b128 v[224:227], v1 offset:0
    v_mfma_f32_16x16x32_bf16 v[152:155], v[200:203], v[228:231], v[152:155]
    ds_read_b64_tr_b16 v[212:213], v21 offset:40960
    v_mfma_f32_16x16x32_bf16 v[148:151], v[196:199], v[228:231], v[148:151]
    s_add_u32 m0, s59, 0
    s_add_u32 s57, s68, 512
    buffer_load_dwordx4 v13, s[28:31], s57 offen offset:3072  lds
    v_mfma_f32_16x16x32_bf16 v[144:147], v[192:195], v[228:231], v[144:147]
    ds_read_b64_tr_b16 v[214:215], v21 offset:41984
    v_mfma_f32_16x16x32_bf16 v[160:163], v[192:195], v[232:235], v[160:163]
    ds_read_b128 v[228:231], v1 offset:2048
    v_mfma_f32_16x16x32_bf16 v[164:167], v[196:199], v[232:235], v[164:167]
    ds_read_b64_tr_b16 v[216:217], v22 offset:40960
    v_mfma_f32_16x16x32_bf16 v[168:171], v[200:203], v[232:235], v[168:171]
    s_add_u32 s67, s63, 8192
    buffer_store_dwordx4 v[112:115], v240, s[16:19], s67 offen offset:2048 sc1
    v_mfma_f32_16x16x32_bf16 v[172:175], v[204:207], v[232:235], v[172:175]
    ds_read_b64_tr_b16 v[218:219], v22 offset:41984
    s_waitcnt lgkmcnt(8)
    v_mfma_f32_16x16x32_bf16 v[188:191], v[204:207], v[236:239], v[188:191]
    ds_read_b128 v[232:235], v3 offset:0
    v_mfma_f32_16x16x32_bf16 v[184:187], v[200:203], v[236:239], v[184:187]
    s_add_u32 s67, s63, 8192
    buffer_store_dwordx4 v[116:119], v240, s[16:19], s67 offen offset:3072 sc1
    v_mfma_f32_16x16x32_bf16 v[180:183], v[196:199], v[236:239], v[180:183]
    ds_read_b64_tr_b16 v[220:221], v23 offset:40960
    v_mfma_f32_16x16x32_bf16 v[176:179], v[192:195], v[236:239], v[176:179]
    ds_read_b64_tr_b16 v[222:223], v23 offset:41984
    ds_read_b128 v[236:239], v3 offset:2048
    s_waitcnt lgkmcnt(9)
    v_mfma_f32_16x16x32_bf16 v[128:131], v[208:211], v[224:227], v[128:131]
    s_waitcnt vmcnt(10)
    s_waitcnt lgkmcnt(0)
    s_barrier
    v_add_u32 v0, 65536, v16
    v_add_u32 v1, 65536, v17
    v_add_u32 v2, 65536, v18
    v_add_u32 v3, 65536, v19
    v_mfma_f32_16x16x32_bf16 v[132:135], v[212:215], v[224:227], v[132:135]
    ds_read_b64_tr_b16 v[192:193], v20 offset:49152
    v_mfma_f32_16x16x32_bf16 v[136:139], v[216:219], v[224:227], v[136:139]
    s_add_u32 m0, s60, 131072
    s_add_u32 s58, s69, 3145728
    buffer_load_dwordx4 v14, s[32:35], s58 offen offset:0  lds
    v_mfma_f32_16x16x32_bf16 v[140:143], v[220:223], v[224:227], v[140:143]
    v_mfma_f32_16x16x32_bf16 v[156:159], v[220:223], v[228:231], v[156:159]
    ds_read_b128 v[224:227], v0 offset:0
    ds_read_b64_tr_b16 v[194:195], v20 offset:50176
    v_mfma_f32_16x16x32_bf16 v[152:155], v[216:219], v[228:231], v[152:155]
    ds_read_b64_tr_b16 v[196:197], v21 offset:49152
    v_mfma_f32_16x16x32_bf16 v[148:151], v[212:215], v[228:231], v[148:151]
    s_add_u32 m0, s60, 131072
    s_add_u32 s58, s69, 3145728
    buffer_load_dwordx4 v15, s[32:35], s58 offen offset:1024  lds
    v_mfma_f32_16x16x32_bf16 v[144:147], v[208:211], v[228:231], v[144:147]
    ds_read_b64_tr_b16 v[198:199], v21 offset:50176
    v_mfma_f32_16x16x32_bf16 v[160:163], v[208:211], v[232:235], v[160:163]
    ds_read_b128 v[228:231], v0 offset:2048
    v_mfma_f32_16x16x32_bf16 v[164:167], v[212:215], v[232:235], v[164:167]
    ds_read_b64_tr_b16 v[200:201], v22 offset:49152
    v_mfma_f32_16x16x32_bf16 v[168:171], v[216:219], v[232:235], v[168:171]
    s_add_u32 m0, s59, 32768
    s_add_u32 s57, s68, 640
    buffer_load_dwordx4 v10, s[28:31], s57 offen offset:0  lds
    v_mfma_f32_16x16x32_bf16 v[172:175], v[220:223], v[232:235], v[172:175]
    ds_read_b64_tr_b16 v[202:203], v22 offset:50176
    v_mfma_f32_16x16x32_bf16 v[188:191], v[220:223], v[236:239], v[188:191]
    ds_read_b128 v[232:235], v2 offset:0
    v_mfma_f32_16x16x32_bf16 v[184:187], v[216:219], v[236:239], v[184:187]
    s_add_u32 m0, s59, 32768
    s_add_u32 s57, s68, 640
    buffer_load_dwordx4 v11, s[28:31], s57 offen offset:1024  lds
    v_mfma_f32_16x16x32_bf16 v[180:183], v[212:215], v[236:239], v[180:183]
    ds_read_b64_tr_b16 v[204:205], v23 offset:49152
    v_mfma_f32_16x16x32_bf16 v[176:179], v[208:211], v[236:239], v[176:179]
    ds_read_b64_tr_b16 v[206:207], v23 offset:50176
    ds_read_b128 v[236:239], v2 offset:2048
    s_waitcnt lgkmcnt(9)
    v_mfma_f32_16x16x32_bf16 v[128:131], v[192:195], v[224:227], v[128:131]
    ds_read_b64_tr_b16 v[208:209], v20 offset:57344
    s_waitcnt lgkmcnt(8)
    v_mfma_f32_16x16x32_bf16 v[132:135], v[196:199], v[224:227], v[132:135]
    s_add_u32 m0, s59, 32768
    s_add_u32 s57, s68, 640
    buffer_load_dwordx4 v12, s[28:31], s57 offen offset:2048  lds
    s_waitcnt lgkmcnt(5)
    v_mfma_f32_16x16x32_bf16 v[136:139], v[200:203], v[224:227], v[136:139]
    ds_read_b64_tr_b16 v[210:211], v20 offset:58368
    s_waitcnt lgkmcnt(3)
    v_mfma_f32_16x16x32_bf16 v[140:143], v[204:207], v[224:227], v[140:143]
    v_mfma_f32_16x16x32_bf16 v[156:159], v[204:207], v[228:231], v[156:159]
    ds_read_b128 v[224:227], v1 offset:0
    v_mfma_f32_16x16x32_bf16 v[152:155], v[200:203], v[228:231], v[152:155]
    ds_read_b64_tr_b16 v[212:213], v21 offset:57344
    v_mfma_f32_16x16x32_bf16 v[148:151], v[196:199], v[228:231], v[148:151]
    s_add_u32 m0, s59, 32768
    s_add_u32 s57, s68, 640
    buffer_load_dwordx4 v13, s[28:31], s57 offen offset:3072  lds
    v_mfma_f32_16x16x32_bf16 v[144:147], v[192:195], v[228:231], v[144:147]
    ds_read_b64_tr_b16 v[214:215], v21 offset:58368
    v_mfma_f32_16x16x32_bf16 v[160:163], v[192:195], v[232:235], v[160:163]
    ds_read_b128 v[228:231], v1 offset:2048
    v_mfma_f32_16x16x32_bf16 v[164:167], v[196:199], v[232:235], v[164:167]
    ds_read_b64_tr_b16 v[216:217], v22 offset:57344
    v_mfma_f32_16x16x32_bf16 v[168:171], v[200:203], v[232:235], v[168:171]
    s_add_u32 s67, s66, 0
    buffer_store_dwordx4 v[44:47], v240, s[16:19], s67 offen offset:0 sc1
    v_mfma_f32_16x16x32_bf16 v[172:175], v[204:207], v[232:235], v[172:175]
    ds_read_b64_tr_b16 v[218:219], v22 offset:58368
    s_waitcnt lgkmcnt(8)
    v_mfma_f32_16x16x32_bf16 v[188:191], v[204:207], v[236:239], v[188:191]
    ds_read_b128 v[232:235], v3 offset:0
    v_mfma_f32_16x16x32_bf16 v[184:187], v[200:203], v[236:239], v[184:187]
    s_add_u32 s67, s66, 0
    buffer_store_dwordx4 v[48:51], v240, s[16:19], s67 offen offset:1024 sc1
    v_mfma_f32_16x16x32_bf16 v[180:183], v[196:199], v[236:239], v[180:183]
    ds_read_b64_tr_b16 v[220:221], v23 offset:57344
    v_mfma_f32_16x16x32_bf16 v[176:179], v[192:195], v[236:239], v[176:179]
    ds_read_b64_tr_b16 v[222:223], v23 offset:58368
    ds_read_b128 v[236:239], v3 offset:2048
    s_waitcnt lgkmcnt(9)
    v_mfma_f32_16x16x32_bf16 v[128:131], v[208:211], v[224:227], v[128:131]
    s_waitcnt vmcnt(10)
    s_waitcnt lgkmcnt(0)
    s_barrier
    v_add_u32 v0, 0, v16
    v_add_u32 v1, 0, v17
    v_add_u32 v2, 0, v18
    v_add_u32 v3, 0, v19
    v_mfma_f32_16x16x32_bf16 v[132:135], v[212:215], v[224:227], v[132:135]
    ds_read_b64_tr_b16 v[192:193], v20 offset:0
    v_mfma_f32_16x16x32_bf16 v[136:139], v[216:219], v[224:227], v[136:139]
    s_add_u32 m0, s60, 147456
    s_add_u32 s58, s69, 3670016
    buffer_load_dwordx4 v14, s[32:35], s58 offen offset:0  lds
    v_mfma_f32_16x16x32_bf16 v[140:143], v[220:223], v[224:227], v[140:143]
    v_mfma_f32_16x16x32_bf16 v[156:159], v[220:223], v[228:231], v[156:159]
    ds_read_b128 v[224:227], v0 offset:0
    ds_read_b64_tr_b16 v[194:195], v20 offset:1024
    v_mfma_f32_16x16x32_bf16 v[152:155], v[216:219], v[228:231], v[152:155]
    ds_read_b64_tr_b16 v[196:197], v21 offset:0
    v_mfma_f32_16x16x32_bf16 v[148:151], v[212:215], v[228:231], v[148:151]
    s_add_u32 m0, s60, 147456
    s_add_u32 s58, s69, 3670016
    buffer_load_dwordx4 v15, s[32:35], s58 offen offset:1024  lds
    v_mfma_f32_16x16x32_bf16 v[144:147], v[208:211], v[228:231], v[144:147]
    ds_read_b64_tr_b16 v[198:199], v21 offset:1024
    v_mfma_f32_16x16x32_bf16 v[160:163], v[208:211], v[232:235], v[160:163]
    ds_read_b128 v[228:231], v0 offset:2048
    v_mfma_f32_16x16x32_bf16 v[164:167], v[212:215], v[232:235], v[164:167]
    ds_read_b64_tr_b16 v[200:201], v22 offset:0
    v_mfma_f32_16x16x32_bf16 v[168:171], v[216:219], v[232:235], v[168:171]
    s_add_u32 m0, s59, 65536
    s_add_u32 s57, s68, 768
    buffer_load_dwordx4 v10, s[28:31], s57 offen offset:0  lds
    v_mfma_f32_16x16x32_bf16 v[172:175], v[220:223], v[232:235], v[172:175]
    ds_read_b64_tr_b16 v[202:203], v22 offset:1024
    v_mfma_f32_16x16x32_bf16 v[188:191], v[220:223], v[236:239], v[188:191]
    ds_read_b128 v[232:235], v2 offset:0
    v_mfma_f32_16x16x32_bf16 v[184:187], v[216:219], v[236:239], v[184:187]
    s_add_u32 m0, s59, 65536
    s_add_u32 s57, s68, 768
    buffer_load_dwordx4 v11, s[28:31], s57 offen offset:1024  lds
    v_mfma_f32_16x16x32_bf16 v[180:183], v[212:215], v[236:239], v[180:183]
    ds_read_b64_tr_b16 v[204:205], v23 offset:0
    v_mfma_f32_16x16x32_bf16 v[176:179], v[208:211], v[236:239], v[176:179]
    ds_read_b64_tr_b16 v[206:207], v23 offset:1024
    ds_read_b128 v[236:239], v2 offset:2048
    s_waitcnt lgkmcnt(9)
    v_mfma_f32_16x16x32_bf16 v[128:131], v[192:195], v[224:227], v[128:131]
    ds_read_b64_tr_b16 v[208:209], v20 offset:8192
    s_waitcnt lgkmcnt(8)
    v_mfma_f32_16x16x32_bf16 v[132:135], v[196:199], v[224:227], v[132:135]
    s_add_u32 m0, s59, 65536
    s_add_u32 s57, s68, 768
    buffer_load_dwordx4 v12, s[28:31], s57 offen offset:2048  lds
    s_waitcnt lgkmcnt(5)
    v_mfma_f32_16x16x32_bf16 v[136:139], v[200:203], v[224:227], v[136:139]
    ds_read_b64_tr_b16 v[210:211], v20 offset:9216
    s_waitcnt lgkmcnt(3)
    v_mfma_f32_16x16x32_bf16 v[140:143], v[204:207], v[224:227], v[140:143]
    v_mfma_f32_16x16x32_bf16 v[156:159], v[204:207], v[228:231], v[156:159]
    ds_read_b128 v[224:227], v1 offset:0
    v_mfma_f32_16x16x32_bf16 v[152:155], v[200:203], v[228:231], v[152:155]
    ds_read_b64_tr_b16 v[212:213], v21 offset:8192
    v_mfma_f32_16x16x32_bf16 v[148:151], v[196:199], v[228:231], v[148:151]
    s_add_u32 m0, s59, 65536
    s_add_u32 s57, s68, 768
    buffer_load_dwordx4 v13, s[28:31], s57 offen offset:3072  lds
    v_mfma_f32_16x16x32_bf16 v[144:147], v[192:195], v[228:231], v[144:147]
    ds_read_b64_tr_b16 v[214:215], v21 offset:9216
    v_mfma_f32_16x16x32_bf16 v[160:163], v[192:195], v[232:235], v[160:163]
    ds_read_b128 v[228:231], v1 offset:2048
    v_mfma_f32_16x16x32_bf16 v[164:167], v[196:199], v[232:235], v[164:167]
    ds_read_b64_tr_b16 v[216:217], v22 offset:8192
    v_mfma_f32_16x16x32_bf16 v[168:171], v[200:203], v[232:235], v[168:171]
    s_add_u32 s67, s66, 122880
    buffer_store_dwordx4 v[52:55], v240, s[16:19], s67 offen offset:0 sc1
    v_mfma_f32_16x16x32_bf16 v[172:175], v[204:207], v[232:235], v[172:175]
    ds_read_b64_tr_b16 v[218:219], v22 offset:9216
    s_waitcnt lgkmcnt(8)
    v_mfma_f32_16x16x32_bf16 v[188:191], v[204:207], v[236:239], v[188:191]
    ds_read_b128 v[232:235], v3 offset:0
    v_mfma_f32_16x16x32_bf16 v[184:187], v[200:203], v[236:239], v[184:187]
    s_add_u32 s67, s66, 122880
    buffer_store_dwordx4 v[56:59], v240, s[16:19], s67 offen offset:1024 sc1
    v_mfma_f32_16x16x32_bf16 v[180:183], v[196:199], v[236:239], v[180:183]
    ds_read_b64_tr_b16 v[220:221], v23 offset:8192
    v_mfma_f32_16x16x32_bf16 v[176:179], v[192:195], v[236:239], v[176:179]
    ds_read_b64_tr_b16 v[222:223], v23 offset:9216
    ds_read_b128 v[236:239], v3 offset:2048
    s_waitcnt lgkmcnt(9)
    v_mfma_f32_16x16x32_bf16 v[128:131], v[208:211], v[224:227], v[128:131]
    s_waitcnt vmcnt(10)
    s_waitcnt lgkmcnt(0)
    s_barrier
    v_add_u32 v0, 32768, v16
    v_add_u32 v1, 32768, v17
    v_add_u32 v2, 32768, v18
    v_add_u32 v3, 32768, v19
    v_mfma_f32_16x16x32_bf16 v[132:135], v[212:215], v[224:227], v[132:135]
    ds_read_b64_tr_b16 v[192:193], v20 offset:16384
    v_mfma_f32_16x16x32_bf16 v[136:139], v[216:219], v[224:227], v[136:139]
    s_add_u32 m0, s60, 98304
    s_add_u32 s58, s69, 4194304
    buffer_load_dwordx4 v14, s[32:35], s58 offen offset:0  lds
    v_mfma_f32_16x16x32_bf16 v[140:143], v[220:223], v[224:227], v[140:143]
    v_mfma_f32_16x16x32_bf16 v[156:159], v[220:223], v[228:231], v[156:159]
    ds_read_b128 v[224:227], v0 offset:0
    ds_read_b64_tr_b16 v[194:195], v20 offset:17408
    v_mfma_f32_16x16x32_bf16 v[152:155], v[216:219], v[228:231], v[152:155]
    ds_read_b64_tr_b16 v[196:197], v21 offset:16384
    v_mfma_f32_16x16x32_bf16 v[148:151], v[212:215], v[228:231], v[148:151]
    s_add_u32 m0, s60, 98304
    s_add_u32 s58, s69, 4194304
    buffer_load_dwordx4 v15, s[32:35], s58 offen offset:1024  lds
    v_mfma_f32_16x16x32_bf16 v[144:147], v[208:211], v[228:231], v[144:147]
    ds_read_b64_tr_b16 v[198:199], v21 offset:17408
    v_mfma_f32_16x16x32_bf16 v[160:163], v[208:211], v[232:235], v[160:163]
    ds_read_b128 v[228:231], v0 offset:2048
    v_mfma_f32_16x16x32_bf16 v[164:167], v[212:215], v[232:235], v[164:167]
    ds_read_b64_tr_b16 v[200:201], v22 offset:16384
    v_mfma_f32_16x16x32_bf16 v[168:171], v[216:219], v[232:235], v[168:171]
    s_add_u32 m0, s59, 0
    s_add_u32 s57, s68, 896
    buffer_load_dwordx4 v10, s[28:31], s57 offen offset:0  lds
    v_mfma_f32_16x16x32_bf16 v[172:175], v[220:223], v[232:235], v[172:175]
    ds_read_b64_tr_b16 v[202:203], v22 offset:17408
    v_mfma_f32_16x16x32_bf16 v[188:191], v[220:223], v[236:239], v[188:191]
    ds_read_b128 v[232:235], v2 offset:0
    v_mfma_f32_16x16x32_bf16 v[184:187], v[216:219], v[236:239], v[184:187]
    s_add_u32 m0, s59, 0
    s_add_u32 s57, s68, 896
    buffer_load_dwordx4 v11, s[28:31], s57 offen offset:1024  lds
    v_mfma_f32_16x16x32_bf16 v[180:183], v[212:215], v[236:239], v[180:183]
    ds_read_b64_tr_b16 v[204:205], v23 offset:16384
    v_mfma_f32_16x16x32_bf16 v[176:179], v[208:211], v[236:239], v[176:179]
    ds_read_b64_tr_b16 v[206:207], v23 offset:17408
    ds_read_b128 v[236:239], v2 offset:2048
    s_waitcnt lgkmcnt(9)
    v_mfma_f32_16x16x32_bf16 v[128:131], v[192:195], v[224:227], v[128:131]
    ds_read_b64_tr_b16 v[208:209], v20 offset:24576
    s_waitcnt lgkmcnt(8)
    v_mfma_f32_16x16x32_bf16 v[132:135], v[196:199], v[224:227], v[132:135]
    s_add_u32 m0, s59, 0
    s_add_u32 s57, s68, 896
    buffer_load_dwordx4 v12, s[28:31], s57 offen offset:2048  lds
    s_waitcnt lgkmcnt(5)
    v_mfma_f32_16x16x32_bf16 v[136:139], v[200:203], v[224:227], v[136:139]
    ds_read_b64_tr_b16 v[210:211], v20 offset:25600
    s_waitcnt lgkmcnt(3)
    v_mfma_f32_16x16x32_bf16 v[140:143], v[204:207], v[224:227], v[140:143]
    v_mfma_f32_16x16x32_bf16 v[156:159], v[204:207], v[228:231], v[156:159]
    ds_read_b128 v[224:227], v1 offset:0
    v_mfma_f32_16x16x32_bf16 v[152:155], v[200:203], v[228:231], v[152:155]
    ds_read_b64_tr_b16 v[212:213], v21 offset:24576
    v_mfma_f32_16x16x32_bf16 v[148:151], v[196:199], v[228:231], v[148:151]
    s_add_u32 m0, s59, 0
    s_add_u32 s57, s68, 896
    buffer_load_dwordx4 v13, s[28:31], s57 offen offset:3072  lds
    v_mfma_f32_16x16x32_bf16 v[144:147], v[192:195], v[228:231], v[144:147]
    ds_read_b64_tr_b16 v[214:215], v21 offset:25600
    v_mfma_f32_16x16x32_bf16 v[160:163], v[192:195], v[232:235], v[160:163]
    ds_read_b128 v[228:231], v1 offset:2048
    v_mfma_f32_16x16x32_bf16 v[164:167], v[196:199], v[232:235], v[164:167]
    ds_read_b64_tr_b16 v[216:217], v22 offset:24576
    v_mfma_f32_16x16x32_bf16 v[168:171], v[200:203], v[232:235], v[168:171]
    ds_read_b64_tr_b16 v[218:219], v22 offset:25600
    v_mfma_f32_16x16x32_bf16 v[172:175], v[204:207], v[232:235], v[172:175]
    s_waitcnt lgkmcnt(8)
    v_mfma_f32_16x16x32_bf16 v[188:191], v[204:207], v[236:239], v[188:191]
    ds_read_b128 v[232:235], v3 offset:0
    v_mfma_f32_16x16x32_bf16 v[184:187], v[200:203], v[236:239], v[184:187]
    ds_read_b64_tr_b16 v[220:221], v23 offset:24576
    v_mfma_f32_16x16x32_bf16 v[180:183], v[196:199], v[236:239], v[180:183]
    ds_read_b64_tr_b16 v[222:223], v23 offset:25600
    v_mfma_f32_16x16x32_bf16 v[176:179], v[192:195], v[236:239], v[176:179]
    ds_read_b128 v[236:239], v3 offset:2048
    s_waitcnt lgkmcnt(9)
    v_mfma_f32_16x16x32_bf16 v[128:131], v[208:211], v[224:227], v[128:131]
    s_waitcnt vmcnt(8)
    s_waitcnt vmcnt(6)
    s_waitcnt lgkmcnt(0)
    s_barrier
    s_cmp_lg_u32 s54, 4
    s_cbranch_scc1 L_pubk
    v_mov_b32 v114, s84
    v_mov_b32 v115, s85
    v_mov_b32 v116, 0
    s_mov_b64 exec, 1
    buffer_store_dwordx2 v[114:115], v116, s[16:19], s94 offen sc1
    buffer_store_dwordx2 v[114:115], v116, s[16:19], s95 offen sc1
    s_mov_b64 exec, -1
L_pubk:
    v_add_u32 v0, 65536, v16
    v_add_u32 v1, 65536, v17
    v_add_u32 v2, 65536, v18
    v_add_u32 v3, 65536, v19
    v_mfma_f32_16x16x32_bf16 v[132:135], v[212:215], v[224:227], v[132:135]
    ds_read_b64_tr_b16 v[192:193], v20 offset:32768
    v_mfma_f32_16x16x32_bf16 v[136:139], v[216:219], v[224:227], v[136:139]
    s_add_u32 m0, s60, 114688
    s_add_u32 s58, s69, 4718592
    buffer_load_dwordx4 v14, s[32:35], s58 offen offset:0  lds
    v_mfma_f32_16x16x32_bf16 v[140:143], v[220:223], v[224:227], v[140:143]
    s_mov_b32 s92, 0x3e0293ee
    s_mov_b32 s93, 0x3e0293ee
    s_add_u32 s55, s59, 131072
    v_add_u32 v9, s55, v240
    s_mov_b32 s6, 0
    v_mfma_f32_16x16x32_bf16 v[156:159], v[220:223], v[228:231], v[156:159]
    ds_read_b128 v[224:227], v0 offset:0
    ds_read_b64_tr_b16 v[194:195], v20 offset:33792
    v_mfma_f32_16x16x32_bf16 v[152:155], v[216:219], v[228:231], v[152:155]
    s_add_u32 m0, s60, 114688
    s_add_u32 s58, s69, 4718592
    buffer_load_dwordx4 v15, s[32:35], s58 offen offset:1024  lds
    v_mfma_f32_16x16x32_bf16 v[148:151], v[212:215], v[228:231], v[148:151]
    ds_read_b64_tr_b16 v[196:197], v21 offset:32768
    ds_read_b64_tr_b16 v[198:199], v21 offset:33792
    v_mfma_f32_16x16x32_bf16 v[144:147], v[208:211], v[228:231], v[144:147]
    s_mov_b32 s94, 0x3f803f80
    v_mov_b32 v32, 0
    v_mov_b32 v33, 0
    v_mov_b32 v34, 0
    v_mov_b32 v35, 0
    v_mfma_f32_16x16x32_bf16 v[160:163], v[208:211], v[232:235], v[160:163]
    ds_read_b128 v[228:231], v0 offset:2048
    ds_read_b64_tr_b16 v[200:201], v22 offset:32768
    v_mfma_f32_16x16x32_bf16 v[164:167], v[212:215], v[232:235], v[164:167]
    s_add_u32 m0, s59, 32768
    s_add_u32 s57, s68, 1024
    buffer_load_dwordx4 v10, s[28:31], s57 offen offset:0  lds
    v_mfma_f32_16x16x32_bf16 v[168:171], v[216:219], v[232:235], v[168:171]
    v_mov_b32 v36, 0
    v_mov_b32 v37, 0
    v_mov_b32 v38, 0
    v_mov_b32 v39, 0
    v_mov_b32 v40, 0
    v_mfma_f32_16x16x32_bf16 v[172:175], v[220:223], v[232:235], v[172:175]
    s_add_u32 m0, s59, 32768
    s_add_u32 s57, s68, 1024
    buffer_load_dwordx4 v11, s[28:31], s57 offen offset:1024  lds
    v_mfma_f32_16x16x32_bf16 v[188:191], v[220:223], v[236:239], v[188:191]
    ds_read_b128 v[232:235], v2 offset:0
    ds_read_b64_tr_b16 v[202:203], v22 offset:33792
    v_mfma_f32_16x16x32_bf16 v[184:187], v[216:219], v[236:239], v[184:187]
    ds_read_b64_tr_b16 v[204:205], v23 offset:32768
    v_mfma_f32_16x16x32_bf16 v[180:183], v[212:215], v[236:239], v[180:183]
    ds_read_b64_tr_b16 v[206:207], v23 offset:33792
    v_mfma_f32_16x16x32_bf16 v[176:179], v[208:211], v[236:239], v[176:179]
    v_mov_b32 v41, 0
    v_mov_b32 v42, 0
    v_mov_b32 v43, 0
    v_mov_b32 v44, 0
    v_mov_b32 v45, 0
    ds_read_b128 v[236:239], v2 offset:2048
    s_waitcnt lgkmcnt(9)
    v_mfma_f32_16x16x32_bf16 v[128:131], v[192:195], v[224:227], v[128:131]
    ds_read_b64_tr_b16 v[208:209], v20 offset:40960
    s_waitcnt lgkmcnt(8)
    v_mfma_f32_16x16x32_bf16 v[132:135], v[196:199], v[224:227], v[132:135]
    s_add_u32 m0, s59, 32768
    s_add_u32 s57, s68, 1024
    buffer_load_dwordx4 v12, s[28:31], s57 offen offset:2048  lds
    s_waitcnt lgkmcnt(4)
    v_mfma_f32_16x16x32_bf16 v[136:139], v[200:203], v[224:227], v[136:139]
    ds_read_b64_tr_b16 v[210:211], v20 offset:41984
    s_waitcnt lgkmcnt(3)
    v_mfma_f32_16x16x32_bf16 v[140:143], v[204:207], v[224:227], v[140:143]
    v_mov_b32 v46, 0
    v_mov_b32 v47, 0
    v_mov_b32 v48, 0
    v_mov_b32 v49, 0
    v_mov_b32 v50, 0
    v_mfma_f32_16x16x32_bf16 v[156:159], v[204:207], v[228:231], v[156:159]
    ds_read_b128 v[224:227], v1 offset:0
    s_add_u32 m0, s59, 32768
    s_add_u32 s57, s68, 1024
    buffer_load_dwordx4 v13, s[28:31], s57 offen offset:3072  lds
    v_mfma_f32_16x16x32_bf16 v[152:155], v[200:203], v[228:231], v[152:155]
    ds_read_b64_tr_b16 v[212:213], v21 offset:40960
    v_mfma_f32_16x16x32_bf16 v[148:151], v[196:199], v[228:231], v[148:151]
    ds_read_b64_tr_b16 v[214:215], v21 offset:41984
    v_mfma_f32_16x16x32_bf16 v[144:147], v[192:195], v[228:231], v[144:147]
    v_mov_b32 v51, 0
    v_mov_b32 v52, 0
    v_mov_b32 v53, 0
    v_mov_b32 v54, 0
    v_mov_b32 v55, 0
    v_mfma_f32_16x16x32_bf16 v[160:163], v[192:195], v[232:235], v[160:163]
    ds_read_b128 v[228:231], v1 offset:2048
    v_mfma_f32_16x16x32_bf16 v[164:167], v[196:199], v[232:235], v[164:167]
    ds_read_b64_tr_b16 v[216:217], v22 offset:40960
    v_mfma_f32_16x16x32_bf16 v[168:171], v[200:203], v[232:235], v[168:171]
    v_mov_b32 v56, 0
    v_mov_b32 v57, 0
    v_mov_b32 v58, 0
    v_mov_b32 v59, 0
    v_mov_b32 v60, 0
    v_mfma_f32_16x16x32_bf16 v[172:175], v[204:207], v[232:235], v[172:175]
    ds_read_b64_tr_b16 v[218:219], v22 offset:41984
    s_waitcnt lgkmcnt(8)
    v_mfma_f32_16x16x32_bf16 v[188:191], v[204:207], v[236:239], v[188:191]
    ds_read_b128 v[232:235], v3 offset:0
    v_mfma_f32_16x16x32_bf16 v[184:187], v[200:203], v[236:239], v[184:187]
    ds_read_b64_tr_b16 v[220:221], v23 offset:40960
    v_mfma_f32_16x16x32_bf16 v[180:183], v[196:199], v[236:239], v[180:183]
    ds_read_b64_tr_b16 v[222:223], v23 offset:41984
    v_mfma_f32_16x16x32_bf16 v[176:179], v[192:195], v[236:239], v[176:179]
    v_mov_b32 v61, 0
    v_mov_b32 v62, 0
    v_mov_b32 v63, 0
    v_mov_b32 v64, 0
    v_mov_b32 v65, 0
    ds_read_b128 v[236:239], v3 offset:2048
    s_waitcnt lgkmcnt(9)
    v_mfma_f32_16x16x32_bf16 v[128:131], v[208:211], v[224:227], v[128:131]
    s_waitcnt vmcnt(6)
    s_waitcnt lgkmcnt(0)
    s_barrier
    v_add_u32 v0, 0, v16
    v_add_u32 v1, 0, v17
    v_add_u32 v2, 0, v18
    v_add_u32 v3, 0, v19
    v_mfma_f32_16x16x32_bf16 v[132:135], v[212:215], v[224:227], v[132:135]
    ds_read_b64_tr_b16 v[192:193], v20 offset:49152
    v_mfma_f32_16x16x32_bf16 v[136:139], v[216:219], v[224:227], v[136:139]
    v_mov_b32 v66, 0
    v_mov_b32 v67, 0
    v_mov_b32 v68, 0
    v_mov_b32 v69, 0
    v_mov_b32 v70, 0
    v_mfma_f32_16x16x32_bf16 v[140:143], v[220:223], v[224:227], v[140:143]
    v_mfma_f32_16x16x32_bf16 v[156:159], v[220:223], v[228:231], v[156:159]
    ds_read_b128 v[224:227], v0 offset:0
    ds_read_b64_tr_b16 v[194:195], v20 offset:50176
    v_mfma_f32_16x16x32_bf16 v[152:155], v[216:219], v[228:231], v[152:155]
    ds_read_b64_tr_b16 v[196:197], v21 offset:49152
    v_mfma_f32_16x16x32_bf16 v[148:151], v[212:215], v[228:231], v[148:151]
    ds_read_b64_tr_b16 v[198:199], v21 offset:50176
    v_mfma_f32_16x16x32_bf16 v[144:147], v[208:211], v[228:231], v[144:147]
    v_mov_b32 v71, 0
    v_mov_b32 v72, 0
    v_mov_b32 v73, 0
    v_mov_b32 v74, 0
    v_mov_b32 v75, 0
    v_mfma_f32_16x16x32_bf16 v[160:163], v[208:211], v[232:235], v[160:163]
    ds_read_b128 v[228:231], v0 offset:2048
    ds_read_b64_tr_b16 v[200:201], v22 offset:49152
    v_mfma_f32_16x16x32_bf16 v[164:167], v[212:215], v[232:235], v[164:167]
    s_add_u32 m0, s59, 65536
    s_add_u32 s57, s68, 1152
    buffer_load_dwordx4 v10, s[28:31], s57 offen offset:0  lds
    v_mfma_f32_16x16x32_bf16 v[168:171], v[216:219], v[232:235], v[168:171]
    v_mov_b32 v76, 0
    v_mov_b32 v77, 0
    v_mov_b32 v78, 0
    v_mov_b32 v79, 0
    v_mov_b32 v80, 0
    v_mfma_f32_16x16x32_bf16 v[172:175], v[220:223], v[232:235], v[172:175]
    s_add_u32 m0, s59, 65536
    s_add_u32 s57, s68, 1152
    buffer_load_dwordx4 v11, s[28:31], s57 offen offset:1024  lds
    v_mfma_f32_16x16x32_bf16 v[188:191], v[220:223], v[236:239], v[188:191]
    ds_read_b128 v[232:235], v2 offset:0
    ds_read_b64_tr_b16 v[202:203], v22 offset:50176
    v_mfma_f32_16x16x32_bf16 v[184:187], v[216:219], v[236:239], v[184:187]
    ds_read_b64_tr_b16 v[204:205], v23 offset:49152
    v_mfma_f32_16x16x32_bf16 v[180:183], v[212:215], v[236:239], v[180:183]
    ds_read_b64_tr_b16 v[206:207], v23 offset:50176
    v_mfma_f32_16x16x32_bf16 v[176:179], v[208:211], v[236:239], v[176:179]
    v_mov_b32 v81, 0
    v_mov_b32 v82, 0
    v_mov_b32 v83, 0
    v_mov_b32 v84, 0
    v_mov_b32 v85, 0
    ds_read_b128 v[236:239], v2 offset:2048
    s_waitcnt lgkmcnt(9)
    v_mfma_f32_16x16x32_bf16 v[128:131], v[192:195], v[224:227], v[128:131]
    ds_read_b64_tr_b16 v[208:209], v20 offset:57344
    s_waitcnt lgkmcnt(8)
    v_mfma_f32_16x16x32_bf16 v[132:135], v[196:199], v[224:227], v[132:135]
    s_add_u32 m0, s59, 65536
    s_add_u32 s57, s68, 1152
    buffer_load_dwordx4 v12, s[28:31], s57 offen offset:2048  lds
    s_waitcnt lgkmcnt(4)
    v_mfma_f32_16x16x32_bf16 v[136:139], v[200:203], v[224:227], v[136:139]
    ds_read_b64_tr_b16 v[210:211], v20 offset:58368
    s_waitcnt lgkmcnt(3)
    v_mfma_f32_16x16x32_bf16 v[140:143], v[204:207], v[224:227], v[140:143]
    v_mov_b32 v86, 0
    v_mov_b32 v87, 0
    v_mov_b32 v88, 0
    v_mov_b32 v89, 0
    v_mov_b32 v90, 0
    v_mfma_f32_16x16x32_bf16 v[156:159], v[204:207], v[228:231], v[156:159]
    ds_read_b128 v[224:227], v1 offset:0
    s_add_u32 m0, s59, 65536
    s_add_u32 s57, s68, 1152
    buffer_load_dwordx4 v13, s[28:31], s57 offen offset:3072  lds
    v_mfma_f32_16x16x32_bf16 v[152:155], v[200:203], v[228:231], v[152:155]
    ds_read_b64_tr_b16 v[212:213], v21 offset:57344
    v_mfma_f32_16x16x32_bf16 v[148:151], v[196:199], v[228:231], v[148:151]
    ds_read_b64_tr_b16 v[214:215], v21 offset:58368
    v_mfma_f32_16x16x32_bf16 v[144:147], v[192:195], v[228:231], v[144:147]
    v_mov_b32 v91, 0
    v_mov_b32 v92, 0
    v_mov_b32 v93, 0
    v_mov_b32 v94, 0
    v_mov_b32 v95, 0
    v_mfma_f32_16x16x32_bf16 v[160:163], v[192:195], v[232:235], v[160:163]
    ds_read_b128 v[228:231], v1 offset:2048
    v_mfma_f32_16x16x32_bf16 v[164:167], v[196:199], v[232:235], v[164:167]
    ds_read_b64_tr_b16 v[216:217], v22 offset:57344
    v_mfma_f32_16x16x32_bf16 v[168:171], v[200:203], v[232:235], v[168:171]
    v_lshrrev_b32 v242, 2, v240
    v_add_u32 v242, 160768, v242
    v_bfe_u32 v243, v241, 0, 2
    v_lshl_add_u32 v248, v243, 8, v242
    v_bfe_u32 v243, v241, 0, 3
    v_mfma_f32_16x16x32_bf16 v[172:175], v[204:207], v[232:235], v[172:175]
    ds_read_b64_tr_b16 v[218:219], v22 offset:58368
    s_waitcnt lgkmcnt(8)
    v_mfma_f32_16x16x32_bf16 v[188:191], v[204:207], v[236:239], v[188:191]
    ds_read_b128 v[232:235], v3 offset:0
    v_mfma_f32_16x16x32_bf16 v[184:187], v[200:203], v[236:239], v[184:187]
    ds_read_b64_tr_b16 v[220:221], v23 offset:57344
    v_mfma_f32_16x16x32_bf16 v[180:183], v[196:199], v[236:239], v[180:183]
    ds_read_b64_tr_b16 v[222:223], v23 offset:58368
    v_mfma_f32_16x16x32_bf16 v[176:179], v[192:195], v[236:239], v[176:179]
    v_lshl_add_u32 v250, v243, 8, v242
    v_add_u32 v250, 1024, v250
    s_lshl_b32 s55, s54, 8
    v_add_u32 v251, s55, v242
    v_add_u32 v249, 1024, v251
    ds_read_b128 v[236:239], v3 offset:2048
    s_waitcnt lgkmcnt(9)
    v_mfma_f32_16x16x32_bf16 v[128:131], v[208:211], v[224:227], v[128:131]
    s_waitcnt vmcnt(4)
    s_waitcnt lgkmcnt(0)
    s_barrier
    v_add_u32 v0, 32768, v16
    v_add_u32 v1, 32768, v17
    v_add_u32 v2, 32768, v18
    v_add_u32 v3, 32768, v19
    v_mfma_f32_16x16x32_bf16 v[132:135], v[212:215], v[224:227], v[132:135]
    ds_read_b64_tr_b16 v[192:193], v20 offset:0
    v_mfma_f32_16x16x32_bf16 v[136:139], v[216:219], v[224:227], v[136:139]
    s_lshl_b32 s55, s71, 2
    s_sub_u32 s79, 63, s55
    s_cmp_lt_u32 s54, 4
    s_cbranch_scc1 L_er
    s_lshr_b32 s55, s70, 1
    s_lshl_b32 s55, s55, 7
    s_add_u32 s55, s55, 73400320
    v_lshrrev_b32 v245, 1, v240
    v_and_b32 v245, 0x78, v245
    buffer_load_dwordx2 v[112:113], v245, s[16:19], s55 offen sc1
    s_lshl_b32 s80, s70, 19
    s_sub_u32 s55, s54, 4
    s_lshl_b32 s82, s55, 13
    s_and_b32 s78, s55, 1
    s_add_u32 s78, s78, 1
    s_cmp_ge_u32 s55, 2
    s_cselect_b32 s56, 2, 0
    s_sub_u32 s78, s78, s56
    s_cmp_ge_u32 s55, 2
    s_cselect_b32 s56, 16777216, 0
    s_mov_b32 s86, s80
    s_add_u32 s80, s80, s56
    s_mov_b32 s76, 0
    s_mov_b32 s62, 0
L_er:
    v_mfma_f32_16x16x32_bf16 v[140:143], v[220:223], v[224:227], v[140:143]
    v_subrev_u32 v251, 1024, v251
    v_mov_b32 v252, 0
    v_mov_b32 v254, 1
    s_mov_b32 s81, 0x53800000
    s_mov_b32 s61, 2
    v_mfma_f32_16x16x32_bf16 v[156:159], v[220:223], v[228:231], v[156:159]
    ds_read_b128 v[224:227], v0 offset:0
    ds_read_b64_tr_b16 v[194:195], v20 offset:1024
    v_mfma_f32_16x16x32_bf16 v[152:155], v[216:219], v[228:231], v[152:155]
    ds_read_b64_tr_b16 v[196:197], v21 offset:0
    v_mfma_f32_16x16x32_bf16 v[148:151], v[212:215], v[228:231], v[148:151]
    ds_read_b64_tr_b16 v[198:199], v21 offset:1024
    v_mfma_f32_16x16x32_bf16 v[144:147], v[208:211], v[228:231], v[144:147]
    s_max_u32 s74, s73, 1
    s_sub_u32 s74, s74, 1
    s_cmp_eq_u32 s73, 0
    s_cselect_b32 s75, 1, 0
    v_mfma_f32_16x16x32_bf16 v[160:163], v[208:211], v[232:235], v[160:163]
    ds_read_b128 v[228:231], v0 offset:2048
    v_mfma_f32_16x16x32_bf16 v[164:167], v[212:215], v[232:235], v[164:167]
    ds_read_b64_tr_b16 v[200:201], v22 offset:0
    v_mfma_f32_16x16x32_bf16 v[168:171], v[216:219], v[232:235], v[168:171]
    v_mfma_f32_16x16x32_bf16 v[172:175], v[220:223], v[232:235], v[172:175]
    ds_read_b64_tr_b16 v[202:203], v22 offset:1024
    v_mfma_f32_16x16x32_bf16 v[188:191], v[220:223], v[236:239], v[188:191]
    ds_read_b128 v[232:235], v2 offset:0
    v_mfma_f32_16x16x32_bf16 v[184:187], v[216:219], v[236:239], v[184:187]
    ds_read_b64_tr_b16 v[204:205], v23 offset:0
    v_mfma_f32_16x16x32_bf16 v[180:183], v[212:215], v[236:239], v[180:183]
    ds_read_b64_tr_b16 v[206:207], v23 offset:1024
    v_mfma_f32_16x16x32_bf16 v[176:179], v[208:211], v[236:239], v[176:179]
    ds_read_b128 v[236:239], v2 offset:2048
    s_waitcnt lgkmcnt(9)
    v_mfma_f32_16x16x32_bf16 v[128:131], v[192:195], v[224:227], v[128:131]
    ds_read_b64_tr_b16 v[208:209], v20 offset:8192
    s_waitcnt lgkmcnt(8)
    v_mfma_f32_16x16x32_bf16 v[132:135], v[196:199], v[224:227], v[132:135]
    ds_read_b64_tr_b16 v[210:211], v20 offset:9216
    s_waitcnt lgkmcnt(6)
    v_mfma_f32_16x16x32_bf16 v[136:139], v[200:203], v[224:227], v[136:139]
    s_waitcnt lgkmcnt(3)
    v_mfma_f32_16x16x32_bf16 v[140:143], v[204:207], v[224:227], v[140:143]
    v_mfma_f32_16x16x32_bf16 v[156:159], v[204:207], v[228:231], v[156:159]
    ds_read_b128 v[224:227], v1 offset:0
    v_mfma_f32_16x16x32_bf16 v[152:155], v[200:203], v[228:231], v[152:155]
    ds_read_b64_tr_b16 v[212:213], v21 offset:8192
    v_mfma_f32_16x16x32_bf16 v[148:151], v[196:199], v[228:231], v[148:151]
    ds_read_b64_tr_b16 v[214:215], v21 offset:9216
    v_mfma_f32_16x16x32_bf16 v[144:147], v[192:195], v[228:231], v[144:147]
    v_mfma_f32_16x16x32_bf16 v[160:163], v[192:195], v[232:235], v[160:163]
    ds_read_b128 v[228:231], v1 offset:2048
    v_mfma_f32_16x16x32_bf16 v[164:167], v[196:199], v[232:235], v[164:167]
    ds_read_b64_tr_b16 v[216:217], v22 offset:8192
    v_mfma_f32_16x16x32_bf16 v[168:171], v[200:203], v[232:235], v[168:171]
    v_mfma_f32_16x16x32_bf16 v[172:175], v[204:207], v[232:235], v[172:175]
    ds_read_b64_tr_b16 v[218:219], v22 offset:9216
    s_waitcnt lgkmcnt(8)
    v_mfma_f32_16x16x32_bf16 v[188:191], v[204:207], v[236:239], v[188:191]
    ds_read_b128 v[232:235], v3 offset:0
    v_mfma_f32_16x16x32_bf16 v[184:187], v[200:203], v[236:239], v[184:187]
    ds_read_b64_tr_b16 v[220:221], v23 offset:8192
    v_mfma_f32_16x16x32_bf16 v[180:183], v[196:199], v[236:239], v[180:183]
    ds_read_b64_tr_b16 v[222:223], v23 offset:9216
    v_mfma_f32_16x16x32_bf16 v[176:179], v[192:195], v[236:239], v[176:179]
    ds_read_b128 v[236:239], v3 offset:2048
    s_waitcnt lgkmcnt(9)
    v_mfma_f32_16x16x32_bf16 v[128:131], v[208:211], v[224:227], v[128:131]
    s_waitcnt vmcnt(0)
    s_waitcnt lgkmcnt(0)
    s_barrier
    v_add_u32 v0, 65536, v16
    v_add_u32 v1, 65536, v17
    v_add_u32 v2, 65536, v18
    v_add_u32 v3, 65536, v19
    v_mfma_f32_16x16x32_bf16 v[132:135], v[212:215], v[224:227], v[132:135]
    v_mfma_f32_16x16x32_bf16 v[136:139], v[216:219], v[224:227], v[136:139]
    ds_read_b64_tr_b16 v[192:193], v20 offset:16384
    v_mfma_f32_16x16x32_bf16 v[140:143], v[220:223], v[224:227], v[140:143]
    v_mfma_f32_16x16x32_bf16 v[156:159], v[220:223], v[228:231], v[156:159]
    ds_read_b128 v[224:227], v0 offset:0
    v_mfma_f32_16x16x32_bf16 v[152:155], v[216:219], v[228:231], v[152:155]
    ds_read_b64_tr_b16 v[194:195], v20 offset:17408
    v_mfma_f32_16x16x32_bf16 v[148:151], v[212:215], v[228:231], v[148:151]
    ds_read_b64_tr_b16 v[196:197], v21 offset:16384
    v_mfma_f32_16x16x32_bf16 v[144:147], v[208:211], v[228:231], v[144:147]
    ds_read_b64_tr_b16 v[198:199], v21 offset:17408
    v_mfma_f32_16x16x32_bf16 v[160:163], v[208:211], v[232:235], v[160:163]
    ds_read_b128 v[228:231], v0 offset:2048
    v_mfma_f32_16x16x32_bf16 v[164:167], v[212:215], v[232:235], v[164:167]
    ds_read_b64_tr_b16 v[200:201], v22 offset:16384
    v_mfma_f32_16x16x32_bf16 v[168:171], v[216:219], v[232:235], v[168:171]
    s_cmp_lt_u32 s54, 4
    s_cbranch_scc1 L_et
    s_waitcnt vmcnt(0)
    v_xor_b32 v112, s84, v112
    v_xor_b32 v113, s85, v113
    v_or_b32 v112, v112, v113
    v_cmp_ne_u32 vcc, 0, v112
    s_cbranch_vccnz L_et
    s_mov_b32 s6, 1
L_et:
    v_mfma_f32_16x16x32_bf16 v[172:175], v[220:223], v[232:235], v[172:175]
    v_mfma_f32_16x16x32_bf16 v[188:191], v[220:223], v[236:239], v[188:191]
    ds_read_b128 v[232:235], v2 offset:0
    v_mfma_f32_16x16x32_bf16 v[184:187], v[216:219], v[236:239], v[184:187]
    ds_read_b64_tr_b16 v[202:203], v22 offset:17408
    v_mfma_f32_16x16x32_bf16 v[180:183], v[212:215], v[236:239], v[180:183]
    ds_read_b64_tr_b16 v[204:205], v23 offset:16384
    v_mfma_f32_16x16x32_bf16 v[176:179], v[208:211], v[236:239], v[176:179]
    ds_read_b64_tr_b16 v[206:207], v23 offset:17408
    ds_read_b128 v[236:239], v2 offset:2048
    s_waitcnt lgkmcnt(9)
    v_mfma_f32_16x16x32_bf16 v[128:131], v[192:195], v[224:227], v[128:131]
    ds_read_b64_tr_b16 v[208:209], v20 offset:24576
    s_waitcnt lgkmcnt(8)
    v_mfma_f32_16x16x32_bf16 v[132:135], v[196:199], v[224:227], v[132:135]
    s_cmp_eq_u32 s6, 0
    s_cbranch_scc1 L_eo0
    s_lshl_b32 s77, s78, 13
    s_add_u32 s77, s77, s80
    s_cmp_le_u32 s78, s79
    s_cselect_b32 s77, s77, 2130706432
    s_cmp_eq_u32 s54, 6
    s_cselect_b32 s77, s86, s77
    s_add_u32 m0, s76, s82
    s_add_u32 s78, s78, 2
    buffer_load_dwordx4 v240, s[16:19], s77 offen offset:0 sc1 lds
L_eo0:
    s_waitcnt lgkmcnt(4)
    v_mfma_f32_16x16x32_bf16 v[136:139], v[200:203], v[224:227], v[136:139]
    ds_read_b64_tr_b16 v[210:211], v20 offset:25600
    s_waitcnt lgkmcnt(3)
    v_mfma_f32_16x16x32_bf16 v[140:143], v[204:207], v[224:227], v[140:143]
    s_cmp_eq_u32 s6, 0
    s_cbranch_scc1 L_eo1
    buffer_load_dwordx4 v240, s[16:19], s77 offen offset:1024 sc1 lds
L_eo1:
    v_mfma_f32_16x16x32_bf16 v[156:159], v[204:207], v[228:231], v[156:159]
    ds_read_b128 v[224:227], v1 offset:0
    ds_read_b64_tr_b16 v[212:213], v21 offset:24576
    v_mfma_f32_16x16x32_bf16 v[152:155], v[200:203], v[228:231], v[152:155]
    s_cmp_eq_u32 s6, 0
    s_cbranch_scc1 L_eo2
    buffer_load_dwordx4 v240, s[16:19], s77 offen offset:2048 sc1 lds
L_eo2:
    v_mfma_f32_16x16x32_bf16 v[148:151], v[196:199], v[228:231], v[148:151]
    s_cmp_eq_u32 s6, 0
    s_cbranch_scc1 L_eo3
    buffer_load_dwordx4 v240, s[16:19], s77 offen offset:3072 sc1 lds
L_eo3:
    ds_read_b64_tr_b16 v[214:215], v21 offset:25600
    v_mfma_f32_16x16x32_bf16 v[144:147], v[192:195], v[228:231], v[144:147]
    s_cmp_eq_u32 s6, 0
    s_cbranch_scc1 L_eo4
    s_add_u32 m0, m0, 4096
    s_add_u32 s77, s77, 4096
    buffer_load_dwordx4 v240, s[16:19], s77 offen offset:0 sc1 lds
L_eo4:
    v_mfma_f32_16x16x32_bf16 v[160:163], v[192:195], v[232:235], v[160:163]
    ds_read_b128 v[228:231], v1 offset:2048
    ds_read_b64_tr_b16 v[216:217], v22 offset:24576
    v_mfma_f32_16x16x32_bf16 v[164:167], v[196:199], v[232:235], v[164:167]
    s_cmp_eq_u32 s6, 0
    s_cbranch_scc1 L_eo5
    buffer_load_dwordx4 v240, s[16:19], s77 offen offset:1024 sc1 lds
L_eo5:
    v_mfma_f32_16x16x32_bf16 v[168:171], v[200:203], v[232:235], v[168:171]
    s_cmp_eq_u32 s6, 0
    s_cbranch_scc1 L_eo6
    buffer_load_dwordx4 v240, s[16:19], s77 offen offset:2048 sc1 lds
L_eo6:
    v_mfma_f32_16x16x32_bf16 v[172:175], v[204:207], v[232:235], v[172:175]
    ds_read_b64_tr_b16 v[218:219], v22 offset:25600
    s_waitcnt lgkmcnt(8)
    v_mfma_f32_16x16x32_bf16 v[188:191], v[204:207], v[236:239], v[188:191]
    ds_read_b128 v[232:235], v3 offset:0
    s_cmp_eq_u32 s6, 0
    s_cbranch_scc1 L_eo7
    buffer_load_dwordx4 v240, s[16:19], s77 offen offset:3072 sc1 lds
L_eo7:
    v_mfma_f32_16x16x32_bf16 v[184:187], v[200:203], v[236:239], v[184:187]
    ds_read_b64_tr_b16 v[220:221], v23 offset:24576
    v_mfma_f32_16x16x32_bf16 v[180:183], v[196:199], v[236:239], v[180:183]
    s_cmp_eq_u32 s6, 0
    s_cbranch_scc1 L_eo8
    s_add_u32 s76, s76, 32768
    s_and_b32 s76, s76, 131071
    s_add_u32 s62, s62, 1
L_eo8:
    ds_read_b64_tr_b16 v[222:223], v23 offset:25600
    v_mfma_f32_16x16x32_bf16 v[176:179], v[192:195], v[236:239], v[176:179]
    s_cmp_eq_u32 s6, 0
    s_cbranch_scc1 L_eo9
    s_lshl_b32 s77, s78, 13
    s_add_u32 s77, s77, s80
    s_cmp_le_u32 s78, s79
    s_cselect_b32 s77, s77, 2130706432
    s_add_u32 m0, s76, s82
    s_add_u32 s78, s78, 2
    buffer_load_dwordx4 v240, s[16:19], s77 offen offset:0 sc1 lds
L_eo9:
    ds_read_b128 v[236:239], v3 offset:2048
    s_waitcnt lgkmcnt(9)
    v_mfma_f32_16x16x32_bf16 v[128:131], v[208:211], v[224:227], v[128:131]
    s_waitcnt lgkmcnt(0)
    v_mfma_f32_16x16x32_bf16 v[132:135], v[212:215], v[224:227], v[132:135]
    v_mfma_f32_16x16x32_bf16 v[136:139], v[216:219], v[224:227], v[136:139]
    s_cmp_eq_u32 s6, 0
    s_cbranch_scc1 L_eo10
    buffer_load_dwordx4 v240, s[16:19], s77 offen offset:1024 sc1 lds
L_eo10:
    v_mfma_f32_16x16x32_bf16 v[140:143], v[220:223], v[224:227], v[140:143]
    v_mfma_f32_16x16x32_bf16 v[156:159], v[220:223], v[228:231], v[156:159]
    s_cmp_eq_u32 s6, 0
    s_cbranch_scc1 L_eo11
    buffer_load_dwordx4 v240, s[16:19], s77 offen offset:2048 sc1 lds
L_eo11:
    v_mfma_f32_16x16x32_bf16 v[152:155], v[216:219], v[228:231], v[152:155]
    s_cmp_eq_u32 s6, 0
    s_cbranch_scc1 L_eo12
    buffer_load_dwordx4 v240, s[16:19], s77 offen offset:3072 sc1 lds
L_eo12:
    v_mfma_f32_16x16x32_bf16 v[148:151], v[212:215], v[228:231], v[148:151]
    s_cmp_eq_u32 s6, 0
    s_cbranch_scc1 L_eo13
    s_add_u32 m0, m0, 4096
    s_add_u32 s77, s77, 4096
    buffer_load_dwordx4 v240, s[16:19], s77 offen offset:0 sc1 lds
L_eo13:
    v_mfma_f32_16x16x32_bf16 v[144:147], v[208:211], v[228:231], v[144:147]
    v_mfma_f32_16x16x32_bf16 v[160:163], v[208:211], v[232:235], v[160:163]
    s_cmp_eq_u32 s6, 0
    s_cbranch_scc1 L_eo14
    buffer_load_dwordx4 v240, s[16:19], s77 offen offset:1024 sc1 lds
L_eo14:
    v_mfma_f32_16x16x32_bf16 v[164:167], v[212:215], v[232:235], v[164:167]
    v_mfma_f32_16x16x32_bf16 v[168:171], v[216:219], v[232:235], v[168:171]
    s_cmp_eq_u32 s6, 0
    s_cbranch_scc1 L_eo15
    buffer_load_dwordx4 v240, s[16:19], s77 offen offset:2048 sc1 lds
L_eo15:
    v_mfma_f32_16x16x32_bf16 v[172:175], v[220:223], v[232:235], v[172:175]
    v_mfma_f32_16x16x32_bf16 v[188:191], v[220:223], v[236:239], v[188:191]
    s_cmp_eq_u32 s6, 0
    s_cbranch_scc1 L_eo16
    buffer_load_dwordx4 v240, s[16:19], s77 offen offset:3072 sc1 lds
L_eo16:
    v_mfma_f32_16x16x32_bf16 v[184:187], v[216:219], v[236:239], v[184:187]
    v_mfma_f32_16x16x32_bf16 v[180:183], v[212:215], v[236:239], v[180:183]
    s_cmp_eq_u32 s6, 0
    s_cbranch_scc1 L_eo17
    s_add_u32 s76, s76, 32768
    s_and_b32 s76, s76, 131071
    s_add_u32 s62, s62, 1
L_eo17:
    v_mfma_f32_16x16x32_bf16 v[176:179], v[208:211], v[236:239], v[176:179]
    s_lshr_b32 s63, s79, 1
    s_add_u32 s63, s63, 1
    s_cmp_lt_u32 s54, 4
    s_cbranch_scc1 L_nodma0
    s_cmp_lg_u32 s62, 0
    s_cbranch_scc1 L_nodma0
    s_lshr_b32 s55, s70, 1
    s_lshl_b32 s55, s55, 7
    s_add_u32 s55, s55, 73400320
    s_mov_b32 s56, 1048576
    v_lshrrev_b32 v245, 1, v240
    s_mov_b64 exec, 0xffff
L_poll1:
    buffer_load_dwordx2 v[246:247], v245, s[16:19], s55 offen sc1
    s_waitcnt vmcnt(0)
    v_xor_b32 v246, s84, v246
    v_xor_b32 v247, s85, v247
    v_or_b32 v246, v246, v247
    v_cmp_ne_u32 vcc, 0, v246
    s_cbranch_vccz L_poll1_ok
    s_sleep 4
    s_sub_u32 s56, s56, 1
    s_cmp_lg_u32 s56, 0
    s_cbranch_scc1 L_poll1
L_poll1_ok:
    s_mov_b64 exec, -1
    s_lshl_b32 s77, s78, 13
    s_add_u32 s77, s77, s80
    s_cmp_le_u32 s78, s79
    s_cselect_b32 s77, s77, 2130706432
    s_cmp_eq_u32 s54, 6
    s_cselect_b32 s77, s86, s77
    s_add_u32 m0, s76, s82
    s_add_u32 s78, s78, 2
    buffer_load_dwordx4 v240, s[16:19], s77 offen offset:0 sc1 lds
    buffer_load_dwordx4 v240, s[16:19], s77 offen offset:1024 sc1 lds
    buffer_load_dwordx4 v240, s[16:19], s77 offen offset:2048 sc1 lds
    buffer_load_dwordx4 v240, s[16:19], s77 offen offset:3072 sc1 lds
    s_add_u32 m0, m0, 4096
    s_add_u32 s77, s77, 4096
    buffer_load_dwordx4 v240, s[16:19], s77 offen offset:0 sc1 lds
    buffer_load_dwordx4 v240, s[16:19], s77 offen offset:1024 sc1 lds
    buffer_load_dwordx4 v240, s[16:19], s77 offen offset:2048 sc1 lds
    buffer_load_dwordx4 v240, s[16:19], s77 offen offset:3072 sc1 lds
    s_add_u32 s76, s76, 32768
    s_and_b32 s76, s76, 131071
    s_add_u32 s62, s62, 1
    s_lshl_b32 s77, s78, 13
    s_add_u32 s77, s77, s80
    s_cmp_le_u32 s78, s79
    s_cselect_b32 s77, s77, 2130706432
    s_add_u32 m0, s76, s82
    s_add_u32 s78, s78, 2
    buffer_load_dwordx4 v240, s[16:19], s77 offen offset:0 sc1 lds
    buffer_load_dwordx4 v240, s[16:19], s77 offen offset:1024 sc1 lds
    buffer_load_dwordx4 v240, s[16:19], s77 offen offset:2048 sc1 lds
    buffer_load_dwordx4 v240, s[16:19], s77 offen offset:3072 sc1 lds
    s_add_u32 m0, m0, 4096
    s_add_u32 s77, s77, 4096
    buffer_load_dwordx4 v240, s[16:19], s77 offen offset:0 sc1 lds
    buffer_load_dwordx4 v240, s[16:19], s77 offen offset:1024 sc1 lds
    buffer_load_dwordx4 v240, s[16:19], s77 offen offset:2048 sc1 lds
    buffer_load_dwordx4 v240, s[16:19], s77 offen offset:3072 sc1 lds
    s_add_u32 s76, s76, 32768
    s_and_b32 s76, s76, 131071
    s_add_u32 s62, s62, 1
L_nodma0:
    v_pk_mul_f32 v[160:161], v[160:161], s[92:93]
    v_pk_mul_f32 v[162:163], v[162:163], s[92:93]
    v_pk_mul_f32 v[164:165], v[164:165], s[92:93]
    v_pk_mul_f32 v[166:167], v[166:167], s[92:93]
    v_pk_mul_f32 v[168:169], v[168:169], s[92:93]
    v_pk_mul_f32 v[170:171], v[170:171], s[92:93]
    v_pk_mul_f32 v[172:173], v[172:173], s[92:93]
    v_pk_mul_f32 v[174:175], v[174:175], s[92:93]
    v_pk_mul_f32 v[176:177], v[176:177], s[92:93]
    v_pk_mul_f32 v[178:179], v[178:179], s[92:93]
    v_pk_mul_f32 v[180:181], v[180:181], s[92:93]
    v_pk_mul_f32 v[182:183], v[182:183], s[92:93]
    v_pk_mul_f32 v[184:185], v[184:185], s[92:93]
    v_pk_mul_f32 v[186:187], v[186:187], s[92:93]
    v_pk_mul_f32 v[188:189], v[188:189], s[92:93]
    v_pk_mul_f32 v[190:191], v[190:191], s[92:93]
    v_cvt_pk_bf16_f32 v96, v160, v161
    v_cvt_pk_bf16_f32 v97, v162, v163
    v_cvt_pk_bf16_f32 v98, v164, v165
    v_cvt_pk_bf16_f32 v99, v166, v167
    v_cvt_pk_bf16_f32 v100, v168, v169
    v_cvt_pk_bf16_f32 v101, v170, v171
    v_cvt_pk_bf16_f32 v102, v172, v173
    v_cvt_pk_bf16_f32 v103, v174, v175
    v_cvt_pk_bf16_f32 v104, v176, v177
    v_cvt_pk_bf16_f32 v105, v178, v179
    v_cvt_pk_bf16_f32 v106, v180, v181
    v_cvt_pk_bf16_f32 v107, v182, v183
    v_cvt_pk_bf16_f32 v108, v184, v185
    v_cvt_pk_bf16_f32 v109, v186, v187
    v_cvt_pk_bf16_f32 v110, v188, v189
    v_cvt_pk_bf16_f32 v111, v190, v191
    ds_write_b128 v9, v[96:99] offset:0
    ds_write_b128 v9, v[100:103] offset:1024
    ds_write_b128 v9, v[104:107] offset:2048
    ds_write_b128 v9, v[108:111] offset:3072
    v_pk_mul_f32 v[128:129], v[128:129], s[92:93]
    v_pk_mul_f32 v[130:131], v[130:131], s[92:93]
    v_pk_mul_f32 v[132:133], v[132:133], s[92:93]
    v_pk_mul_f32 v[134:135], v[134:135], s[92:93]
    v_pk_mul_f32 v[136:137], v[136:137], s[92:93]
    v_pk_mul_f32 v[138:139], v[138:139], s[92:93]
    v_pk_mul_f32 v[140:141], v[140:141], s[92:93]
    v_pk_mul_f32 v[142:143], v[142:143], s[92:93]
    v_pk_mul_f32 v[144:145], v[144:145], s[92:93]
    v_pk_mul_f32 v[146:147], v[146:147], s[92:93]
    v_pk_mul_f32 v[148:149], v[148:149], s[92:93]
    v_pk_mul_f32 v[150:151], v[150:151], s[92:93]
    v_pk_mul_f32 v[152:153], v[152:153], s[92:93]
    v_pk_mul_f32 v[154:155], v[154:155], s[92:93]
    v_pk_mul_f32 v[156:157], v[156:157], s[92:93]
    v_pk_mul_f32 v[158:159], v[158:159], s[92:93]
    v_xor_b32 v9, 0x4000, v9
    s_waitcnt lgkmcnt(0)
    s_barrier
    ds_read_b128 v[16:19], v9 offset:0
    ds_read_b128 v[20:23], v9 offset:1024
    ds_read_b128 v[24:27], v9 offset:2048
    ds_read_b128 v[28:31], v9 offset:3072
    v_cvt_pk_bf16_f32 v0, v128, v129
    v_cvt_pk_bf16_f32 v1, v130, v131
    v_cvt_pk_bf16_f32 v2, v132, v133
    v_cvt_pk_bf16_f32 v3, v134, v135
    v_cvt_pk_bf16_f32 v4, v136, v137
    v_cvt_pk_bf16_f32 v5, v138, v139
    v_cvt_pk_bf16_f32 v6, v140, v141
    v_cvt_pk_bf16_f32 v7, v142, v143
    v_cvt_pk_bf16_f32 v8, v144, v145
    v_cvt_pk_bf16_f32 v9, v146, v147
    v_cvt_pk_bf16_f32 v10, v148, v149
    v_cvt_pk_bf16_f32 v11, v150, v151
    v_cvt_pk_bf16_f32 v12, v152, v153
    v_cvt_pk_bf16_f32 v13, v154, v155
    v_cvt_pk_bf16_f32 v14, v156, v157
    v_cvt_pk_bf16_f32 v15, v158, v159
    v_mov_b32 v136, 0
    v_mov_b32 v137, 0
    v_mov_b32 v138, 0
    v_mov_b32 v139, 0
    v_mov_b32 v140, 0
    v_mov_b32 v141, 0
    v_mov_b32 v142, 0
    v_mov_b32 v143, 0
    v_mov_b32 v200, 0
    v_add_u32 v202, 0, v240
    v_mov_b32 v206, 0xff800000
    v_bfe_u32 v243, v241, 0, 4
    v_bfe_u32 v244, v241, 4, 2
    v_mov_b32 v207, 0
    v_mov_b32 v220, 0x3f803f80
    v_mov_b32 v221, 0x3f803f80
    v_mov_b32 v222, 0x3f803f80
    v_mov_b32 v223, 0x3f803f80
    v_mov_b32 v232, 0
    v_mov_b32 v233, 0
    v_mov_b32 v234, 0
    v_mov_b32 v235, 0
    v_mov_b32 v236, 0
    v_mov_b32 v237, 0
    v_mov_b32 v238, 0
    v_mov_b32 v239, 0
    v_lshlrev_b32 v244, 2, v244
    v_sub_u32 v203, v243, v244
    v_subrev_u32 v242, 1792, v249
    s_waitcnt lgkmcnt(0)
    s_cmp_lg_u32 s54, 3
    s_cbranch_scc1 L_noinit
    ds_write_b32 v242, v254 offset:0
    ds_write_b32 v242, v254 offset:256
    ds_write_b32 v242, v254 offset:512
    ds_write_b32 v242, v254 offset:768
    ds_write_b32 v242, v252 offset:1024
    ds_write_b32 v242, v252 offset:1280
    ds_write_b32 v242, v252 offset:1536
    ds_write_b32 v242, v252 offset:1792
    ds_write_b32 v242, v252 offset:2048
    ds_write_b32 v242, v252 offset:2304
    ds_write_b32 v242, v252 offset:2560
    ds_write_b32 v242, v252 offset:2816
L_noinit:
    s_waitcnt vmcnt(8) lgkmcnt(0)
    s_barrier
    v_mov_b32 v252, 1
    ds_read_b128 v[160:163], v202 offset:16384
    ds_read_b128 v[164:167], v202 offset:17408
    ds_read_b128 v[168:171], v202 offset:18432
    ds_read_b128 v[172:175], v202 offset:19456
    ds_read_b128 v[176:179], v202 offset:20480
    ds_read_b128 v[180:183], v202 offset:21504
    ds_read_b128 v[184:187], v202 offset:22528
    ds_read_b128 v[188:191], v202 offset:23552
    s_waitcnt lgkmcnt(0)
    s_cmp_lt_u32 s54, 4
    s_cbranch_scc0 L_a0lo
    s_mov_b32 s74, 3
    s_mov_b32 s75, 2
    v_mfma_f32_16x16x32_bf16 v[96:99], v[160:163], v[0:3], 0
    v_mfma_f32_16x16x32_bf16 v[100:103], v[160:163], v[8:11], 0
    v_mfma_f32_16x16x32_bf16 v[104:107], v[164:167], v[0:3], 0
    v_mfma_f32_16x16x32_bf16 v[108:111], v[164:167], v[8:11], 0
    v_mfma_f32_16x16x32_bf16 v[96:99], v[168:171], v[4:7], v[96:99]
    v_mfma_f32_16x16x32_bf16 v[100:103], v[168:171], v[12:15], v[100:103]
    v_mfma_f32_16x16x32_bf16 v[104:107], v[172:175], v[4:7], v[104:107]
    v_mfma_f32_16x16x32_bf16 v[108:111], v[172:175], v[12:15], v[108:111]
    v_mfma_f32_16x16x32_bf16 v[96:99], v[176:179], v[16:19], v[96:99]
    v_mfma_f32_16x16x32_bf16 v[100:103], v[176:179], v[24:27], v[100:103]
    v_mfma_f32_16x16x32_bf16 v[104:107], v[180:183], v[16:19], v[104:107]
    v_mfma_f32_16x16x32_bf16 v[108:111], v[180:183], v[24:27], v[108:111]
    v_mfma_f32_16x16x32_bf16 v[96:99], v[184:187], v[20:23], v[96:99]
    v_mfma_f32_16x16x32_bf16 v[100:103], v[184:187], v[28:31], v[100:103]
    v_mfma_f32_16x16x32_bf16 v[104:107], v[188:191], v[20:23], v[104:107]
    v_mfma_f32_16x16x32_bf16 v[108:111], v[188:191], v[28:31], v[108:111]
    s_branch L_a0j
L_a0lo:
    s_setprio 1
    s_sub_u32 s66, s54, 4
    s_mul_i32 s66, s66, 7424
    s_add_u32 s66, s66, 131072
    s_cmp_lg_u32 s73, 0
    s_cbranch_scc1 L_nomask0
    v_mov_b32 v144, 0
    v_mov_b32 v145, 0
    v_mov_b32 v146, 0
    v_mov_b32 v147, 0
    v_mov_b32 v148, 0
    v_mov_b32 v149, 0
    v_mov_b32 v150, 0
    v_mov_b32 v151, 0
    v_mov_b32 v152, 0
    v_mov_b32 v153, 0
    v_mov_b32 v154, 0
    v_mov_b32 v155, 0
    v_mov_b32 v156, 0
    v_mov_b32 v157, 0
    v_mov_b32 v158, 0
    v_mov_b32 v159, 0
    v_mov_b32 v152, v206
    v_mov_b32 v153, v206
    v_mov_b32 v154, v206
    v_mov_b32 v155, v206
    v_cmp_gt_i32 s[90:91], 0, v203
    s_nop 1
    v_cndmask_b32 v144, v144, v206, s[90:91]
    v_cmp_gt_i32 s[92:93], 1, v203
    s_nop 1
    v_cndmask_b32 v145, v145, v206, s[92:93]
    v_cmp_gt_i32 s[90:91], 2, v203
    s_nop 1
    v_cndmask_b32 v146, v146, v206, s[90:91]
    v_cmp_gt_i32 s[92:93], 3, v203
    s_nop 1
    v_cndmask_b32 v147, v147, v206, s[92:93]
    v_cmp_gt_i32 s[90:91], 0, v203
    s_nop 1
    v_cndmask_b32 v156, v156, v206, s[90:91]
    v_cmp_gt_i32 s[92:93], 1, v203
    s_nop 1
    v_cndmask_b32 v157, v157, v206, s[92:93]
    v_cmp_gt_i32 s[90:91], 2, v203
    s_nop 1
    v_cndmask_b32 v158, v158, v206, s[90:91]
    v_cmp_gt_i32 s[92:93], 3, v203
    s_nop 1
    v_cndmask_b32 v159, v159, v206, s[92:93]
    v_mfma_f32_16x16x32_bf16 v[96:99], v[160:163], v[16:19], v[144:147]
    v_mfma_f32_16x16x32_bf16 v[100:103], v[160:163], v[24:27], v[148:151]
    v_mfma_f32_16x16x32_bf16 v[104:107], v[164:167], v[16:19], v[152:155]
    v_mfma_f32_16x16x32_bf16 v[108:111], v[164:167], v[24:27], v[156:159]
    s_branch L_mask0j
L_nomask0:
    v_mfma_f32_16x16x32_bf16 v[96:99], v[160:163], v[16:19], 0
    v_mfma_f32_16x16x32_bf16 v[100:103], v[160:163], v[24:27], 0
    v_mfma_f32_16x16x32_bf16 v[104:107], v[164:167], v[16:19], 0
    v_mfma_f32_16x16x32_bf16 v[108:111], v[164:167], v[24:27], 0
L_mask0j:
    s_lshl_b32 s77, s78, 13
    s_add_u32 s77, s77, s80
    s_cmp_le_u32 s78, s79
    s_cselect_b32 s77, s77, 2130706432
    s_add_u32 m0, s76, s82
    s_add_u32 s78, s78, 2
    buffer_load_dwordx4 v240, s[16:19], s77 offen offset:0 sc1 lds
    v_mfma_f32_16x16x32_bf16 v[96:99], v[168:171], v[20:23], v[96:99]
    v_mfma_f32_16x16x32_bf16 v[100:103], v[168:171], v[28:31], v[100:103]
    buffer_load_dwordx4 v240, s[16:19], s77 offen offset:1024 sc1 lds
    v_mfma_f32_16x16x32_bf16 v[104:107], v[172:175], v[20:23], v[104:107]
    v_mfma_f32_16x16x32_bf16 v[108:111], v[172:175], v[28:31], v[108:111]
    buffer_load_dwordx4 v240, s[16:19], s77 offen offset:2048 sc1 lds
    v_mfma_f32_16x16x32_bf16 v[96:99], v[176:179], v[0:3], v[96:99]
    v_mfma_f32_16x16x32_bf16 v[100:103], v[176:179], v[8:11], v[100:103]
    buffer_load_dwordx4 v240, s[16:19], s77 offen offset:3072 sc1 lds
    v_mfma_f32_16x16x32_bf16 v[104:107], v[180:183], v[0:3], v[104:107]
    v_mfma_f32_16x16x32_bf16 v[108:111], v[180:183], v[8:11], v[108:111]
    s_add_u32 m0, m0, 4096
    s_add_u32 s77, s77, 4096
    buffer_load_dwordx4 v240, s[16:19], s77 offen offset:0 sc1 lds
    v_mfma_f32_16x16x32_bf16 v[96:99], v[184:187], v[4:7], v[96:99]
    v_mfma_f32_16x16x32_bf16 v[100:103], v[184:187], v[12:15], v[100:103]
    buffer_load_dwordx4 v240, s[16:19], s77 offen offset:1024 sc1 lds
    v_mfma_f32_16x16x32_bf16 v[104:107], v[188:191], v[4:7], v[104:107]
    v_mfma_f32_16x16x32_bf16 v[108:111], v[188:191], v[12:15], v[108:111]
    buffer_load_dwordx4 v240, s[16:19], s77 offen offset:2048 sc1 lds
    buffer_load_dwordx4 v240, s[16:19], s77 offen offset:3072 sc1 lds
    s_add_u32 s76, s76, 32768
    s_and_b32 s76, s76, 131071
    s_add_u32 s62, s62, 1
L_a0j:
    ds_read_b128 v[160:163], v202 offset:0
    ds_read_b128 v[164:167], v202 offset:1024
    ds_read_b128 v[168:171], v202 offset:2048
    ds_read_b128 v[172:175], v202 offset:3072
    ds_read_b128 v[176:179], v202 offset:4096
    ds_read_b128 v[180:183], v202 offset:5120
    ds_read_b128 v[184:187], v202 offset:6144
    v_max3_f32 v204, v96, v97, v98
    v_max3_f32 v204, v204, v99, v104
    v_max3_f32 v204, v204, v105, v106
    v_max_f32 v204, v204, v107
    v_max3_f32 v209, v100, v101, v102
    v_max3_f32 v209, v209, v103, v108
    v_max3_f32 v209, v209, v109, v110
    v_max_f32 v209, v209, v111
    v_mov_b32 v205, v204
    s_nop 1
    v_permlane32_swap_b32 v204, v205
    v_max_f32 v204, v204, v205
    v_mov_b32 v205, v204
    s_nop 1
    v_permlane16_swap_b32 v204, v205
    v_max_f32 v204, v204, v205
    v_mov_b32 v210, v209
    s_nop 1
    v_permlane32_swap_b32 v209, v210
    v_max_f32 v209, v209, v210
    v_mov_b32 v210, v209
    s_nop 1
    v_permlane16_swap_b32 v209, v210
    v_max_f32 v209, v209, v210
    v_sub_f32 v96, v96, v204
    v_sub_f32 v97, v97, v204
    v_sub_f32 v98, v98, v204
    v_sub_f32 v99, v99, v204
    v_sub_f32 v100, v100, v209
    v_sub_f32 v101, v101, v209
    v_sub_f32 v102, v102, v209
    v_sub_f32 v103, v103, v209
    v_sub_f32 v104, v104, v204
    v_sub_f32 v105, v105, v204
    v_sub_f32 v106, v106, v204
    v_sub_f32 v107, v107, v204
    v_sub_f32 v108, v108, v209
    v_sub_f32 v109, v109, v209
    v_sub_f32 v110, v110, v209
    v_sub_f32 v111, v111, v209
    v_sub_f32 v144, 0, v204
    v_sub_f32 v145, 0, v204
    v_sub_f32 v146, 0, v204
    v_sub_f32 v147, 0, v204
    v_sub_f32 v148, 0, v209
    v_sub_f32 v149, 0, v209
    v_sub_f32 v150, 0, v209
    v_sub_f32 v151, 0, v209
    v_sub_f32 v152, 0, v204
    v_sub_f32 v153, 0, v204
    v_sub_f32 v154, 0, v204
    v_sub_f32 v155, 0, v204
    v_sub_f32 v156, 0, v209
    v_sub_f32 v157, 0, v209
    v_sub_f32 v158, 0, v209
    v_sub_f32 v159, 0, v209
    s_cmp_lt_u32 s54, 4
    s_cbranch_scc0 L_lo_E0
    s_sub_u32 s74, s74, 1
L_hi_E:
    s_cbranch_scc1 L_hi_sp0
L_hi_go0:
    s_waitcnt lgkmcnt(3)
    v_mfma_f32_16x16x32_bf16 v[112:115], v[160:163], v[0:3], v[144:147]
    v_exp_f32 v192, v96
    v_mfma_f32_16x16x32_bf16 v[116:119], v[160:163], v[8:11], v[148:151]
    v_exp_f32 v193, v97
    v_mfma_f32_16x16x32_bf16 v[124:127], v[164:167], v[8:11], v[156:159]
    ds_read_b128 v[188:191], v202 offset:7168
    v_mfma_f32_16x16x32_bf16 v[120:123], v[164:167], v[0:3], v[152:155]
    v_exp_f32 v194, v98
    v_mfma_f32_16x16x32_bf16 v[112:115], v[168:171], v[4:7], v[112:115]
    ds_read_b128 v[160:163], v202 offset:16384
    v_cvt_pk_bf16_f32 v128, v192, v193
    v_mfma_f32_16x16x32_bf16 v[116:119], v[168:171], v[12:15], v[116:119]
    v_exp_f32 v195, v99
    v_mfma_f32_16x16x32_bf16 v[124:127], v[172:175], v[12:15], v[124:127]
    ds_read_b128 v[164:167], v202 offset:17408
    v_cvt_pk_bf16_f32 v129, v194, v195
    v_mfma_f32_16x16x32_bf16 v[120:123], v[172:175], v[4:7], v[120:123]
    ds_read_b128 v[168:171], v202 offset:18432
    s_waitcnt lgkmcnt(3)
    v_mfma_f32_16x16x32_bf16 v[112:115], v[176:179], v[16:19], v[112:115]
    v_exp_f32 v196, v104
    v_mfma_f32_16x16x32_bf16 v[116:119], v[176:179], v[24:27], v[116:119]
    v_exp_f32 v197, v105
    v_mfma_f32_16x16x32_bf16 v[124:127], v[180:183], v[24:27], v[124:127]
    ds_read_b128 v[172:175], v202 offset:19456
    v_cvt_pk_bf16_f32 v130, v196, v197
    v_mfma_f32_16x16x32_bf16 v[120:123], v[180:183], v[16:19], v[120:123]
    v_exp_f32 v198, v106
    v_mfma_f32_16x16x32_bf16 v[112:115], v[184:187], v[20:23], v[112:115]
    v_exp_f32 v199, v107
    v_mfma_f32_16x16x32_bf16 v[116:119], v[184:187], v[28:31], v[116:119]
    ds_read_b128 v[176:179], v202 offset:20480
    v_cvt_pk_bf16_f32 v131, v198, v199
    v_mfma_f32_16x16x32_bf16 v[124:127], v[188:191], v[28:31], v[124:127]
    v_exp_f32 v192, v100
    v_mfma_f32_16x16x32_bf16 v[224:227], v[220:223], v[128:131], v[232:235]
    v_exp_f32 v193, v101
    v_mfma_f32_16x16x32_bf16 v[120:123], v[188:191], v[20:23], v[120:123]
    ds_read_b128 v[180:183], v202 offset:21504
    s_waitcnt lgkmcnt(2)
    v_mfma_f32_16x16x32_bf16 v[32:35], v[160:163], v[136:139], v[32:35]
    ds_read_b128 v[184:187], v202 offset:22528
    ds_read_b128 v[188:191], v202 offset:23552
    v_mfma_f32_16x16x32_bf16 v[36:39], v[160:163], v[140:143], v[36:39]
    v_exp_f32 v194, v102
    v_mfma_f32_16x16x32_bf16 v[44:47], v[164:167], v[140:143], v[44:47]
    v_cvt_pk_bf16_f32 v132, v192, v193
    v_mfma_f32_16x16x32_bf16 v[40:43], v[164:167], v[136:139], v[40:43]
    v_exp_f32 v195, v103
    v_mfma_f32_16x16x32_bf16 v[48:51], v[168:171], v[136:139], v[48:51]
    ds_read_b128 v[160:163], v202 offset:8192
    v_cvt_pk_bf16_f32 v133, v194, v195
    v_mfma_f32_16x16x32_bf16 v[52:55], v[168:171], v[140:143], v[52:55]
    v_exp_f32 v196, v108
    v_mfma_f32_16x16x32_bf16 v[60:63], v[172:175], v[140:143], v[60:63]
    v_exp_f32 v197, v109
    v_mfma_f32_16x16x32_bf16 v[56:59], v[172:175], v[136:139], v[56:59]
    ds_read_b128 v[164:167], v202 offset:9216
    s_waitcnt lgkmcnt(2)
    v_mfma_f32_16x16x32_bf16 v[64:67], v[176:179], v[136:139], v[64:67]
    ds_read_b128 v[168:171], v202 offset:10240
    v_cvt_pk_bf16_f32 v134, v196, v197
    v_mfma_f32_16x16x32_bf16 v[68:71], v[176:179], v[140:143], v[68:71]
    v_exp_f32 v198, v110
    v_mfma_f32_16x16x32_bf16 v[76:79], v[180:183], v[140:143], v[76:79]
    v_exp_f32 v199, v111
    v_mfma_f32_16x16x32_bf16 v[72:75], v[180:183], v[136:139], v[72:75]
    ds_read_b128 v[172:175], v202 offset:11264
    v_cvt_pk_bf16_f32 v135, v198, v199
    v_mfma_f32_16x16x32_bf16 v[80:83], v[184:187], v[136:139], v[80:83]
    ds_read_b128 v[176:179], v202 offset:12288
    v_mfma_f32_16x16x32_bf16 v[228:231], v[220:223], v[132:135], v[236:239]
    ds_read_b128 v[180:183], v202 offset:13312
    v_mfma_f32_16x16x32_bf16 v[84:87], v[184:187], v[140:143], v[84:87]
    ds_read_b128 v[184:187], v202 offset:14336
    v_mfma_f32_16x16x32_bf16 v[92:95], v[188:191], v[140:143], v[92:95]
    s_sub_u32 s74, s74, 1
    v_mfma_f32_16x16x32_bf16 v[88:91], v[188:191], v[136:139], v[88:91]
    s_nop 1
    v_max_f32 v204, v224, v228
    v_cmp_nge_f32 vcc, s81, v204
    s_cbranch_vccnz L_hi_fbm0
L_hi_fbrm0:
L_hi_O:
    s_cbranch_scc1 L_hi_sp1
L_hi_go1:
    s_waitcnt lgkmcnt(3)
    v_mfma_f32_16x16x32_bf16 v[96:99], v[160:163], v[0:3], v[144:147]
    v_exp_f32 v192, v112
    v_mfma_f32_16x16x32_bf16 v[100:103], v[160:163], v[8:11], v[148:151]
    v_exp_f32 v193, v113
    v_mfma_f32_16x16x32_bf16 v[108:111], v[164:167], v[8:11], v[156:159]
    ds_read_b128 v[188:191], v202 offset:15360
    ds_read_b32 v253, v248
    v_mfma_f32_16x16x32_bf16 v[104:107], v[164:167], v[0:3], v[152:155]
    v_exp_f32 v194, v114
    v_mfma_f32_16x16x32_bf16 v[96:99], v[168:171], v[4:7], v[96:99]
    ds_read_b128 v[160:163], v202 offset:24576
    v_cvt_pk_bf16_f32 v136, v192, v193
    v_mfma_f32_16x16x32_bf16 v[100:103], v[168:171], v[12:15], v[100:103]
    v_exp_f32 v195, v115
    v_mfma_f32_16x16x32_bf16 v[108:111], v[172:175], v[12:15], v[108:111]
    ds_read_b128 v[164:167], v202 offset:25600
    v_cvt_pk_bf16_f32 v137, v194, v195
    v_mfma_f32_16x16x32_bf16 v[104:107], v[172:175], v[4:7], v[104:107]
    ds_read_b128 v[168:171], v202 offset:26624
    s_waitcnt lgkmcnt(4)
    v_mfma_f32_16x16x32_bf16 v[96:99], v[176:179], v[16:19], v[96:99]
    v_exp_f32 v196, v120
    v_mfma_f32_16x16x32_bf16 v[100:103], v[176:179], v[24:27], v[100:103]
    v_exp_f32 v197, v121
    v_mfma_f32_16x16x32_bf16 v[108:111], v[180:183], v[24:27], v[108:111]
    ds_read_b128 v[172:175], v202 offset:27648
    v_cvt_pk_bf16_f32 v138, v196, v197
    v_mfma_f32_16x16x32_bf16 v[104:107], v[180:183], v[16:19], v[104:107]
    v_exp_f32 v198, v122
    v_mfma_f32_16x16x32_bf16 v[96:99], v[184:187], v[20:23], v[96:99]
    v_exp_f32 v199, v123
    v_mfma_f32_16x16x32_bf16 v[100:103], v[184:187], v[28:31], v[100:103]
    ds_read_b128 v[176:179], v202 offset:28672
    v_cvt_pk_bf16_f32 v139, v198, v199
    v_mfma_f32_16x16x32_bf16 v[108:111], v[188:191], v[28:31], v[108:111]
    v_exp_f32 v192, v116
    v_mfma_f32_16x16x32_bf16 v[232:235], v[220:223], v[136:139], v[224:227]
    v_exp_f32 v193, v117
    v_mfma_f32_16x16x32_bf16 v[104:107], v[188:191], v[20:23], v[104:107]
    ds_read_b128 v[180:183], v202 offset:29696
    s_waitcnt lgkmcnt(2)
    v_mfma_f32_16x16x32_bf16 v[32:35], v[160:163], v[128:131], v[32:35]
    ds_read_b128 v[184:187], v202 offset:30720
    ds_read_b128 v[188:191], v202 offset:31744
    v_cmp_gt_u32 vcc, s61, v253
    v_mfma_f32_16x16x32_bf16 v[36:39], v[160:163], v[132:135], v[36:39]
    v_exp_f32 v194, v118
    v_mfma_f32_16x16x32_bf16 v[44:47], v[164:167], v[132:135], v[44:47]
    v_cvt_pk_bf16_f32 v140, v192, v193
    s_cbranch_vccnz L_hi_spU
L_hi_spU_r:
    v_add_u32 v202, 0x8000, v202
    v_and_b32 v202, 131071, v202
    s_add_u32 s61, s61, 1
    v_mfma_f32_16x16x32_bf16 v[40:43], v[164:167], v[128:131], v[40:43]
    v_exp_f32 v195, v119
    v_mfma_f32_16x16x32_bf16 v[48:51], v[168:171], v[128:131], v[48:51]
    ds_read_b128 v[160:163], v202 offset:0
    v_cvt_pk_bf16_f32 v141, v194, v195
    v_mfma_f32_16x16x32_bf16 v[52:55], v[168:171], v[132:135], v[52:55]
    v_exp_f32 v196, v124
    v_mfma_f32_16x16x32_bf16 v[60:63], v[172:175], v[132:135], v[60:63]
    v_exp_f32 v197, v125
    v_mfma_f32_16x16x32_bf16 v[56:59], v[172:175], v[128:131], v[56:59]
    ds_read_b128 v[164:167], v202 offset:1024
    s_waitcnt lgkmcnt(2)
    v_mfma_f32_16x16x32_bf16 v[64:67], v[176:179], v[128:131], v[64:67]
    ds_read_b128 v[168:171], v202 offset:2048
    v_cvt_pk_bf16_f32 v142, v196, v197
    v_mfma_f32_16x16x32_bf16 v[68:71], v[176:179], v[132:135], v[68:71]
    v_exp_f32 v198, v126
    v_mfma_f32_16x16x32_bf16 v[76:79], v[180:183], v[132:135], v[76:79]
    v_exp_f32 v199, v127
    v_mfma_f32_16x16x32_bf16 v[72:75], v[180:183], v[128:131], v[72:75]
    ds_read_b128 v[172:175], v202 offset:3072
    v_cvt_pk_bf16_f32 v143, v198, v199
    v_mfma_f32_16x16x32_bf16 v[80:83], v[184:187], v[128:131], v[80:83]
    ds_read_b128 v[176:179], v202 offset:4096
    v_mfma_f32_16x16x32_bf16 v[236:239], v[220:223], v[140:143], v[228:231]
    ds_read_b128 v[180:183], v202 offset:5120
    v_mfma_f32_16x16x32_bf16 v[84:87], v[184:187], v[132:135], v[84:87]
    ds_read_b128 v[184:187], v202 offset:6144
    v_mfma_f32_16x16x32_bf16 v[92:95], v[188:191], v[132:135], v[92:95]
    ds_write_b32 v249, v252
    v_add_u32 v252, 1, v252
    s_sub_u32 s74, s74, 1
    v_mfma_f32_16x16x32_bf16 v[88:91], v[188:191], v[128:131], v[88:91]
    v_max_f32 v204, v232, v236
    v_cmp_nge_f32 vcc, s81, v204
    s_cbranch_vccnz L_hi_fbm1
L_hi_fbrm1:
    s_branch L_hi_E
L_hi_fbm0:
    v_max3_f32 v204, v96, v97, v98
    v_max3_f32 v204, v204, v99, v104
    v_max3_f32 v204, v204, v105, v106
    v_max_f32 v204, v204, v107
    v_max3_f32 v209, v100, v101, v102
    v_max3_f32 v209, v209, v103, v108
    v_max3_f32 v209, v209, v109, v110
    v_max_f32 v209, v209, v111
    v_mov_b32 v205, v204
    s_nop 1
    v_permlane32_swap_b32 v204, v205
    v_max_f32 v204, v204, v205
    v_mov_b32 v205, v204
    s_nop 1
    v_permlane16_swap_b32 v204, v205
    v_max_f32 v204, v204, v205
    v_mov_b32 v210, v209
    s_nop 1
    v_permlane32_swap_b32 v209, v210
    v_max_f32 v209, v209, v210
    v_mov_b32 v210, v209
    s_nop 1
    v_permlane16_swap_b32 v209, v210
    v_max_f32 v209, v209, v210
    v_max_f32 v204, 0, v204
    v_sub_f32 v205, 0, v204
    v_exp_f32 v205, v205
    v_max_f32 v209, 0, v209
    v_sub_f32 v210, 0, v209
    v_exp_f32 v210, v210
    v_sub_f32 v96, v96, v204
    v_sub_f32 v97, v97, v204
    v_sub_f32 v98, v98, v204
    v_sub_f32 v99, v99, v204
    v_sub_f32 v100, v100, v209
    v_sub_f32 v101, v101, v209
    v_sub_f32 v102, v102, v209
    v_sub_f32 v103, v103, v209
    v_sub_f32 v104, v104, v204
    v_sub_f32 v105, v105, v204
    v_sub_f32 v106, v106, v204
    v_sub_f32 v107, v107, v204
    v_sub_f32 v108, v108, v209
    v_sub_f32 v109, v109, v209
    v_sub_f32 v110, v110, v209
    v_sub_f32 v111, v111, v209
    v_sub_f32 v112, v112, v204
    v_sub_f32 v113, v113, v204
    v_sub_f32 v114, v114, v204
    v_sub_f32 v115, v115, v204
    v_sub_f32 v116, v116, v209
    v_sub_f32 v117, v117, v209
    v_sub_f32 v118, v118, v209
    v_sub_f32 v119, v119, v209
    v_sub_f32 v120, v120, v204
    v_sub_f32 v121, v121, v204
    v_sub_f32 v122, v122, v204
    v_sub_f32 v123, v123, v204
    v_sub_f32 v124, v124, v209
    v_sub_f32 v125, v125, v209
    v_sub_f32 v126, v126, v209
    v_sub_f32 v127, v127, v209
    v_sub_f32 v144, v144, v204
    v_sub_f32 v145, v145, v204
    v_sub_f32 v146, v146, v204
    v_sub_f32 v147, v147, v204
    v_sub_f32 v148, v148, v209
    v_sub_f32 v149, v149, v209
    v_sub_f32 v150, v150, v209
    v_sub_f32 v151, v151, v209
    v_sub_f32 v152, v152, v204
    v_sub_f32 v153, v153, v204
    v_sub_f32 v154, v154, v204
    v_sub_f32 v155, v155, v204
    v_sub_f32 v156, v156, v209
    v_sub_f32 v157, v157, v209
    v_sub_f32 v158, v158, v209
    v_sub_f32 v159, v159, v209
    v_mul_f32 v32, v205, v32
    v_mul_f32 v33, v205, v33
    v_mul_f32 v34, v205, v34
    v_mul_f32 v35, v205, v35
    v_mul_f32 v36, v210, v36
    v_mul_f32 v37, v210, v37
    v_mul_f32 v38, v210, v38
    v_mul_f32 v39, v210, v39
    v_mul_f32 v40, v205, v40
    v_mul_f32 v41, v205, v41
    v_mul_f32 v42, v205, v42
    v_mul_f32 v43, v205, v43
    v_mul_f32 v44, v210, v44
    v_mul_f32 v45, v210, v45
    v_mul_f32 v46, v210, v46
    v_mul_f32 v47, v210, v47
    v_mul_f32 v48, v205, v48
    v_mul_f32 v49, v205, v49
    v_mul_f32 v50, v205, v50
    v_mul_f32 v51, v205, v51
    v_mul_f32 v52, v210, v52
    v_mul_f32 v53, v210, v53
    v_mul_f32 v54, v210, v54
    v_mul_f32 v55, v210, v55
    v_mul_f32 v56, v205, v56
    v_mul_f32 v57, v205, v57
    v_mul_f32 v58, v205, v58
    v_mul_f32 v59, v205, v59
    v_mul_f32 v60, v210, v60
    v_mul_f32 v61, v210, v61
    v_mul_f32 v62, v210, v62
    v_mul_f32 v63, v210, v63
    v_mul_f32 v64, v205, v64
    v_mul_f32 v65, v205, v65
    v_mul_f32 v66, v205, v66
    v_mul_f32 v67, v205, v67
    v_mul_f32 v68, v210, v68
    v_mul_f32 v69, v210, v69
    v_mul_f32 v70, v210, v70
    v_mul_f32 v71, v210, v71
    v_mul_f32 v72, v205, v72
    v_mul_f32 v73, v205, v73
    v_mul_f32 v74, v205, v74
    v_mul_f32 v75, v205, v75
    v_mul_f32 v76, v210, v76
    v_mul_f32 v77, v210, v77
    v_mul_f32 v78, v210, v78
    v_mul_f32 v79, v210, v79
    v_mul_f32 v80, v205, v80
    v_mul_f32 v81, v205, v81
    v_mul_f32 v82, v205, v82
    v_mul_f32 v83, v205, v83
    v_mul_f32 v84, v210, v84
    v_mul_f32 v85, v210, v85
    v_mul_f32 v86, v210, v86
    v_mul_f32 v87, v210, v87
    v_mul_f32 v88, v205, v88
    v_mul_f32 v89, v205, v89
    v_mul_f32 v90, v205, v90
    v_mul_f32 v91, v205, v91
    v_mul_f32 v92, v210, v92
    v_mul_f32 v93, v210, v93
    v_mul_f32 v94, v210, v94
    v_mul_f32 v95, v210, v95
    v_mul_f32 v232, v205, v232
    v_mul_f32 v233, v205, v233
    v_mul_f32 v234, v205, v234
    v_mul_f32 v235, v205, v235
    v_mul_f32 v236, v210, v236
    v_mul_f32 v237, v210, v237
    v_mul_f32 v238, v210, v238
    v_mul_f32 v239, v210, v239
    v_mul_f32 v200, v205, v200
    v_mul_f32 v207, v210, v207
    v_exp_f32 v192, v96
    v_exp_f32 v193, v97
    v_exp_f32 v194, v98
    v_cvt_pk_bf16_f32 v128, v192, v193
    v_exp_f32 v195, v99
    v_exp_f32 v196, v104
    v_cvt_pk_bf16_f32 v129, v194, v195
    v_exp_f32 v197, v105
    v_exp_f32 v198, v106
    v_cvt_pk_bf16_f32 v130, v196, v197
    v_exp_f32 v199, v107
    v_exp_f32 v192, v100
    v_cvt_pk_bf16_f32 v131, v198, v199
    v_exp_f32 v193, v101
    v_exp_f32 v194, v102
    v_cvt_pk_bf16_f32 v132, v192, v193
    v_mfma_f32_16x16x32_bf16 v[224:227], v[220:223], v[128:131], v[232:235]
    v_exp_f32 v195, v103
    v_exp_f32 v196, v108
    v_cvt_pk_bf16_f32 v133, v194, v195
    v_exp_f32 v197, v109
    v_exp_f32 v198, v110
    v_cvt_pk_bf16_f32 v134, v196, v197
    v_exp_f32 v199, v111
    s_nop 0
    v_cvt_pk_bf16_f32 v135, v198, v199
    s_nop 1
    v_mfma_f32_16x16x32_bf16 v[228:231], v[220:223], v[132:135], v[236:239]
    s_branch L_hi_fbrm0
L_hi_fbm1:
    v_max3_f32 v204, v112, v113, v114
    v_max3_f32 v204, v204, v115, v120
    v_max3_f32 v204, v204, v121, v122
    v_max_f32 v204, v204, v123
    v_max3_f32 v209, v116, v117, v118
    v_max3_f32 v209, v209, v119, v124
    v_max3_f32 v209, v209, v125, v126
    v_max_f32 v209, v209, v127
    v_mov_b32 v205, v204
    s_nop 1
    v_permlane32_swap_b32 v204, v205
    v_max_f32 v204, v204, v205
    v_mov_b32 v205, v204
    s_nop 1
    v_permlane16_swap_b32 v204, v205
    v_max_f32 v204, v204, v205
    v_mov_b32 v210, v209
    s_nop 1
    v_permlane32_swap_b32 v209, v210
    v_max_f32 v209, v209, v210
    v_mov_b32 v210, v209
    s_nop 1
    v_permlane16_swap_b32 v209, v210
    v_max_f32 v209, v209, v210
    v_max_f32 v204, 0, v204
    v_sub_f32 v205, 0, v204
    v_exp_f32 v205, v205
    v_max_f32 v209, 0, v209
    v_sub_f32 v210, 0, v209
    v_exp_f32 v210, v210
    v_sub_f32 v112, v112, v204
    v_sub_f32 v113, v113, v204
    v_sub_f32 v114, v114, v204
    v_sub_f32 v115, v115, v204
    v_sub_f32 v116, v116, v209
    v_sub_f32 v117, v117, v209
    v_sub_f32 v118, v118, v209
    v_sub_f32 v119, v119, v209
    v_sub_f32 v120, v120, v204
    v_sub_f32 v121, v121, v204
    v_sub_f32 v122, v122, v204
    v_sub_f32 v123, v123, v204
    v_sub_f32 v124, v124, v209
    v_sub_f32 v125, v125, v209
    v_sub_f32 v126, v126, v209
    v_sub_f32 v127, v127, v209
    v_sub_f32 v96, v96, v204
    v_sub_f32 v97, v97, v204
    v_sub_f32 v98, v98, v204
    v_sub_f32 v99, v99, v204
    v_sub_f32 v100, v100, v209
    v_sub_f32 v101, v101, v209
    v_sub_f32 v102, v102, v209
    v_sub_f32 v103, v103, v209
    v_sub_f32 v104, v104, v204
    v_sub_f32 v105, v105, v204
    v_sub_f32 v106, v106, v204
    v_sub_f32 v107, v107, v204
    v_sub_f32 v108, v108, v209
    v_sub_f32 v109, v109, v209
    v_sub_f32 v110, v110, v209
    v_sub_f32 v111, v111, v209
    v_sub_f32 v144, v144, v204
    v_sub_f32 v145, v145, v204
    v_sub_f32 v146, v146, v204
    v_sub_f32 v147, v147, v204
    v_sub_f32 v148, v148, v209
    v_sub_f32 v149, v149, v209
    v_sub_f32 v150, v150, v209
    v_sub_f32 v151, v151, v209
    v_sub_f32 v152, v152, v204
    v_sub_f32 v153, v153, v204
    v_sub_f32 v154, v154, v204
    v_sub_f32 v155, v155, v204
    v_sub_f32 v156, v156, v209
    v_sub_f32 v157, v157, v209
    v_sub_f32 v158, v158, v209
    v_sub_f32 v159, v159, v209
    v_mul_f32 v32, v205, v32
    v_mul_f32 v33, v205, v33
    v_mul_f32 v34, v205, v34
    v_mul_f32 v35, v205, v35
    v_mul_f32 v36, v210, v36
    v_mul_f32 v37, v210, v37
    v_mul_f32 v38, v210, v38
    v_mul_f32 v39, v210, v39
    v_mul_f32 v40, v205, v40
    v_mul_f32 v41, v205, v41
    v_mul_f32 v42, v205, v42
    v_mul_f32 v43, v205, v43
    v_mul_f32 v44, v210, v44
    v_mul_f32 v45, v210, v45
    v_mul_f32 v46, v210, v46
    v_mul_f32 v47, v210, v47
    v_mul_f32 v48, v205, v48
    v_mul_f32 v49, v205, v49
    v_mul_f32 v50, v205, v50
    v_mul_f32 v51, v205, v51
    v_mul_f32 v52, v210, v52
    v_mul_f32 v53, v210, v53
    v_mul_f32 v54, v210, v54
    v_mul_f32 v55, v210, v55
    v_mul_f32 v56, v205, v56
    v_mul_f32 v57, v205, v57
    v_mul_f32 v58, v205, v58
    v_mul_f32 v59, v205, v59
    v_mul_f32 v60, v210, v60
    v_mul_f32 v61, v210, v61
    v_mul_f32 v62, v210, v62
    v_mul_f32 v63, v210, v63
    v_mul_f32 v64, v205, v64
    v_mul_f32 v65, v205, v65
    v_mul_f32 v66, v205, v66
    v_mul_f32 v67, v205, v67
    v_mul_f32 v68, v210, v68
    v_mul_f32 v69, v210, v69
    v_mul_f32 v70, v210, v70
    v_mul_f32 v71, v210, v71
    v_mul_f32 v72, v205, v72
    v_mul_f32 v73, v205, v73
    v_mul_f32 v74, v205, v74
    v_mul_f32 v75, v205, v75
    v_mul_f32 v76, v210, v76
    v_mul_f32 v77, v210, v77
    v_mul_f32 v78, v210, v78
    v_mul_f32 v79, v210, v79
    v_mul_f32 v80, v205, v80
    v_mul_f32 v81, v205, v81
    v_mul_f32 v82, v205, v82
    v_mul_f32 v83, v205, v83
    v_mul_f32 v84, v210, v84
    v_mul_f32 v85, v210, v85
    v_mul_f32 v86, v210, v86
    v_mul_f32 v87, v210, v87
    v_mul_f32 v88, v205, v88
    v_mul_f32 v89, v205, v89
    v_mul_f32 v90, v205, v90
    v_mul_f32 v91, v205, v91
    v_mul_f32 v92, v210, v92
    v_mul_f32 v93, v210, v93
    v_mul_f32 v94, v210, v94
    v_mul_f32 v95, v210, v95
    v_mul_f32 v224, v205, v224
    v_mul_f32 v225, v205, v225
    v_mul_f32 v226, v205, v226
    v_mul_f32 v227, v205, v227
    v_mul_f32 v228, v210, v228
    v_mul_f32 v229, v210, v229
    v_mul_f32 v230, v210, v230
    v_mul_f32 v231, v210, v231
    v_mul_f32 v200, v205, v200
    v_mul_f32 v207, v210, v207
    v_exp_f32 v192, v112
    v_exp_f32 v193, v113
    v_exp_f32 v194, v114
    v_cvt_pk_bf16_f32 v136, v192, v193
    v_exp_f32 v195, v115
    v_exp_f32 v196, v120
    v_cvt_pk_bf16_f32 v137, v194, v195
    v_exp_f32 v197, v121
    v_exp_f32 v198, v122
    v_cvt_pk_bf16_f32 v138, v196, v197
    v_exp_f32 v199, v123
    v_exp_f32 v192, v116
    v_cvt_pk_bf16_f32 v139, v198, v199
    v_exp_f32 v193, v117
    v_exp_f32 v194, v118
    v_cvt_pk_bf16_f32 v140, v192, v193
    v_mfma_f32_16x16x32_bf16 v[232:235], v[220:223], v[136:139], v[224:227]
    v_exp_f32 v195, v119
    v_exp_f32 v196, v124
    v_cvt_pk_bf16_f32 v141, v194, v195
    v_exp_f32 v197, v125
    v_exp_f32 v198, v126
    v_cvt_pk_bf16_f32 v142, v196, v197
    v_exp_f32 v199, v127
    s_nop 0
    v_cvt_pk_bf16_f32 v143, v198, v199
    s_nop 1
    v_mfma_f32_16x16x32_bf16 v[236:239], v[220:223], v[140:143], v[228:231]
    s_branch L_hi_fbrm1
L_hi_sp0:
    s_cmp_lg_u32 s75, 0
    s_cbranch_scc1 L_hi_tail0
    s_mov_b32 s75, 1
    s_mov_b32 s74, 0
    v_mov_b32 v152, v206
    v_mov_b32 v153, v206
    v_mov_b32 v154, v206
    v_mov_b32 v155, v206
    v_cmp_gt_i32 s[90:91], 0, v203
    s_nop 1
    v_cndmask_b32 v144, v144, v206, s[90:91]
    v_cmp_gt_i32 s[92:93], 1, v203
    s_nop 1
    v_cndmask_b32 v145, v145, v206, s[92:93]
    v_cmp_gt_i32 s[90:91], 2, v203
    s_nop 1
    v_cndmask_b32 v146, v146, v206, s[90:91]
    v_cmp_gt_i32 s[92:93], 3, v203
    s_nop 1
    v_cndmask_b32 v147, v147, v206, s[92:93]
    v_cmp_gt_i32 s[90:91], 0, v203
    s_nop 1
    v_cndmask_b32 v156, v156, v206, s[90:91]
    v_cmp_gt_i32 s[92:93], 1, v203
    s_nop 1
    v_cndmask_b32 v157, v157, v206, s[92:93]
    v_cmp_gt_i32 s[90:91], 2, v203
    s_nop 1
    v_cndmask_b32 v158, v158, v206, s[90:91]
    v_cmp_gt_i32 s[92:93], 3, v203
    s_nop 1
    v_cndmask_b32 v159, v159, v206, s[92:93]
    s_branch L_hi_go0
L_hi_sp1:
    s_cmp_lg_u32 s75, 2
    s_cbranch_scc1 L_hi_spn
    s_mov_b32 s75, 0
    s_sub_u32 s74, s73, 5
    s_lshl_b32 s55, s2, 2
    s_add_u32 s55, s55, s54
    s_mul_i32 s56, s55, 5120
    buffer_load_dwordx4 v[212:215], v240, s[36:39], s56 offen offset:0
    buffer_load_dwordx4 v[212:215], v240, s[36:39], s56 offen offset:1024
    buffer_load_dwordx4 v[212:215], v240, s[36:39], s56 offen offset:2048
    buffer_load_dwordx4 v[212:215], v240, s[36:39], s56 offen offset:3072
    s_add_u32 s56, s56, 4096
    buffer_load_dwordx4 v[212:215], v240, s[36:39], s56 offen offset:0
    s_lshl_b32 s56, s55, 10
    buffer_load_dwordx4 v[212:215], v240, s[40:43], s56 offen
    s_branch L_hi_go1
L_hi_spn:
    s_cmp_lg_u32 s75, 0
    s_cbranch_scc1 L_hi_tail1
    s_mov_b32 s75, 1
    s_mov_b32 s74, 0
    v_mov_b32 v152, v206
    v_mov_b32 v153, v206
    v_mov_b32 v154, v206
    v_mov_b32 v155, v206
    v_cmp_gt_i32 s[90:91], 0, v203
    s_nop 1
    v_cndmask_b32 v144, v144, v206, s[90:91]
    v_cmp_gt_i32 s[92:93], 1, v203
    s_nop 1
    v_cndmask_b32 v145, v145, v206, s[92:93]
    v_cmp_gt_i32 s[90:91], 2, v203
    s_nop 1
    v_cndmask_b32 v146, v146, v206, s[90:91]
    v_cmp_gt_i32 s[92:93], 3, v203
    s_nop 1
    v_cndmask_b32 v147, v147, v206, s[92:93]
    v_cmp_gt_i32 s[90:91], 0, v203
    s_nop 1
    v_cndmask_b32 v156, v156, v206, s[90:91]
    v_cmp_gt_i32 s[92:93], 1, v203
    s_nop 1
    v_cndmask_b32 v157, v157, v206, s[92:93]
    v_cmp_gt_i32 s[90:91], 2, v203
    s_nop 1
    v_cndmask_b32 v158, v158, v206, s[90:91]
    v_cmp_gt_i32 s[92:93], 3, v203
    s_nop 1
    v_cndmask_b32 v159, v159, v206, s[92:93]
    s_branch L_hi_go1
L_hi_tail0:
    s_waitcnt lgkmcnt(0)
    ds_read_b128 v[160:163], v202 offset:16384
    ds_read_b128 v[164:167], v202 offset:17408
    ds_read_b128 v[168:171], v202 offset:18432
    ds_read_b128 v[172:175], v202 offset:19456
    ds_read_b128 v[176:179], v202 offset:20480
    ds_read_b128 v[180:183], v202 offset:21504
    ds_read_b128 v[184:187], v202 offset:22528
    ds_read_b128 v[188:191], v202 offset:23552
    s_waitcnt lgkmcnt(7)
    v_mfma_f32_16x16x32_bf16 v[32:35], v[160:163], v[136:139], v[32:35]
    v_exp_f32 v192, v96
    v_exp_f32 v193, v97
    v_mfma_f32_16x16x32_bf16 v[36:39], v[160:163], v[140:143], v[36:39]
    v_exp_f32 v194, v98
    v_cvt_pk_bf16_f32 v128, v192, v193
    s_waitcnt lgkmcnt(6)
    v_mfma_f32_16x16x32_bf16 v[40:43], v[164:167], v[136:139], v[40:43]
    v_exp_f32 v195, v99
    v_exp_f32 v196, v104
    v_mfma_f32_16x16x32_bf16 v[44:47], v[164:167], v[140:143], v[44:47]
    v_cvt_pk_bf16_f32 v129, v194, v195
    s_waitcnt lgkmcnt(5)
    v_mfma_f32_16x16x32_bf16 v[48:51], v[168:171], v[136:139], v[48:51]
    v_exp_f32 v197, v105
    v_exp_f32 v198, v106
    v_mfma_f32_16x16x32_bf16 v[52:55], v[168:171], v[140:143], v[52:55]
    v_cvt_pk_bf16_f32 v130, v196, v197
    v_exp_f32 v199, v107
    s_waitcnt lgkmcnt(4)
    v_mfma_f32_16x16x32_bf16 v[56:59], v[172:175], v[136:139], v[56:59]
    v_exp_f32 v192, v100
    v_cvt_pk_bf16_f32 v131, v198, v199
    v_mfma_f32_16x16x32_bf16 v[60:63], v[172:175], v[140:143], v[60:63]
    v_exp_f32 v193, v101
    s_waitcnt lgkmcnt(3)
    v_mfma_f32_16x16x32_bf16 v[64:67], v[176:179], v[136:139], v[64:67]
    v_exp_f32 v194, v102
    v_cvt_pk_bf16_f32 v132, v192, v193
    v_mfma_f32_16x16x32_bf16 v[68:71], v[176:179], v[140:143], v[68:71]
    v_mfma_f32_16x16x32_bf16 v[224:227], v[220:223], v[128:131], v[232:235]
    v_exp_f32 v195, v103
    s_waitcnt lgkmcnt(2)
    v_mfma_f32_16x16x32_bf16 v[72:75], v[180:183], v[136:139], v[72:75]
    v_exp_f32 v196, v108
    v_cvt_pk_bf16_f32 v133, v194, v195
    v_mfma_f32_16x16x32_bf16 v[76:79], v[180:183], v[140:143], v[76:79]
    v_exp_f32 v197, v109
    s_waitcnt lgkmcnt(1)
    v_mfma_f32_16x16x32_bf16 v[80:83], v[184:187], v[136:139], v[80:83]
    v_exp_f32 v198, v110
    v_cvt_pk_bf16_f32 v134, v196, v197
    v_mfma_f32_16x16x32_bf16 v[84:87], v[184:187], v[140:143], v[84:87]
    v_exp_f32 v199, v111
    s_nop 0
    v_cvt_pk_bf16_f32 v135, v198, v199
    s_waitcnt lgkmcnt(0)
    v_mfma_f32_16x16x32_bf16 v[88:91], v[188:191], v[136:139], v[88:91]
    v_mfma_f32_16x16x32_bf16 v[228:231], v[220:223], v[132:135], v[236:239]
    s_nop 7
    v_max_f32 v204, v224, v228
    v_mfma_f32_16x16x32_bf16 v[92:95], v[188:191], v[140:143], v[92:95]
    v_cmp_nge_f32 vcc, s81, v204
    s_cbranch_vccnz L_hi_fbt0
L_hi_fbrt0:
    v_mov_b32 v200, v224
    s_nop 5
    v_mov_b32 v207, v228
    ds_read_b128 v[160:163], v202 offset:24576
    ds_read_b128 v[164:167], v202 offset:25600
    ds_read_b128 v[168:171], v202 offset:26624
    ds_read_b128 v[172:175], v202 offset:27648
    ds_read_b128 v[176:179], v202 offset:28672
    ds_read_b128 v[180:183], v202 offset:29696
    ds_read_b128 v[184:187], v202 offset:30720
    ds_read_b128 v[188:191], v202 offset:31744
    s_waitcnt lgkmcnt(7)
    v_mfma_f32_16x16x32_bf16 v[32:35], v[160:163], v[128:131], v[32:35]
    v_mfma_f32_16x16x32_bf16 v[36:39], v[160:163], v[132:135], v[36:39]
    s_waitcnt lgkmcnt(6)
    v_mfma_f32_16x16x32_bf16 v[40:43], v[164:167], v[128:131], v[40:43]
    v_mfma_f32_16x16x32_bf16 v[44:47], v[164:167], v[132:135], v[44:47]
    s_waitcnt lgkmcnt(5)
    v_mfma_f32_16x16x32_bf16 v[48:51], v[168:171], v[128:131], v[48:51]
    v_mfma_f32_16x16x32_bf16 v[52:55], v[168:171], v[132:135], v[52:55]
    s_waitcnt lgkmcnt(4)
    v_mfma_f32_16x16x32_bf16 v[56:59], v[172:175], v[128:131], v[56:59]
    v_mfma_f32_16x16x32_bf16 v[60:63], v[172:175], v[132:135], v[60:63]
    s_waitcnt lgkmcnt(3)
    v_mfma_f32_16x16x32_bf16 v[64:67], v[176:179], v[128:131], v[64:67]
    v_mfma_f32_16x16x32_bf16 v[68:71], v[176:179], v[132:135], v[68:71]
    s_waitcnt lgkmcnt(2)
    v_mfma_f32_16x16x32_bf16 v[72:75], v[180:183], v[128:131], v[72:75]
    v_mfma_f32_16x16x32_bf16 v[76:79], v[180:183], v[132:135], v[76:79]
    s_waitcnt lgkmcnt(1)
    v_mfma_f32_16x16x32_bf16 v[80:83], v[184:187], v[128:131], v[80:83]
    v_mfma_f32_16x16x32_bf16 v[84:87], v[184:187], v[132:135], v[84:87]
    s_waitcnt lgkmcnt(0)
    v_mfma_f32_16x16x32_bf16 v[88:91], v[188:191], v[128:131], v[88:91]
    v_mfma_f32_16x16x32_bf16 v[92:95], v[188:191], v[132:135], v[92:95]
    s_branch L_hi_epi
L_hi_fbt0:
    v_max3_f32 v204, v96, v97, v98
    v_max3_f32 v204, v204, v99, v104
    v_max3_f32 v204, v204, v105, v106
    v_max_f32 v204, v204, v107
    v_max3_f32 v209, v100, v101, v102
    v_max3_f32 v209, v209, v103, v108
    v_max3_f32 v209, v209, v109, v110
    v_max_f32 v209, v209, v111
    v_mov_b32 v205, v204
    s_nop 1
    v_permlane32_swap_b32 v204, v205
    v_max_f32 v204, v204, v205
    v_mov_b32 v205, v204
    s_nop 1
    v_permlane16_swap_b32 v204, v205
    v_max_f32 v204, v204, v205
    v_mov_b32 v210, v209
    s_nop 1
    v_permlane32_swap_b32 v209, v210
    v_max_f32 v209, v209, v210
    v_mov_b32 v210, v209
    s_nop 1
    v_permlane16_swap_b32 v209, v210
    v_max_f32 v209, v209, v210
    v_max_f32 v204, 0, v204
    v_sub_f32 v205, 0, v204
    v_exp_f32 v205, v205
    v_max_f32 v209, 0, v209
    v_sub_f32 v210, 0, v209
    v_exp_f32 v210, v210
    v_sub_f32 v96, v96, v204
    v_sub_f32 v97, v97, v204
    v_sub_f32 v98, v98, v204
    v_sub_f32 v99, v99, v204
    v_sub_f32 v100, v100, v209
    v_sub_f32 v101, v101, v209
    v_sub_f32 v102, v102, v209
    v_sub_f32 v103, v103, v209
    v_sub_f32 v104, v104, v204
    v_sub_f32 v105, v105, v204
    v_sub_f32 v106, v106, v204
    v_sub_f32 v107, v107, v204
    v_sub_f32 v108, v108, v209
    v_sub_f32 v109, v109, v209
    v_sub_f32 v110, v110, v209
    v_sub_f32 v111, v111, v209
    v_sub_f32 v112, v112, v204
    v_sub_f32 v113, v113, v204
    v_sub_f32 v114, v114, v204
    v_sub_f32 v115, v115, v204
    v_sub_f32 v116, v116, v209
    v_sub_f32 v117, v117, v209
    v_sub_f32 v118, v118, v209
    v_sub_f32 v119, v119, v209
    v_sub_f32 v120, v120, v204
    v_sub_f32 v121, v121, v204
    v_sub_f32 v122, v122, v204
    v_sub_f32 v123, v123, v204
    v_sub_f32 v124, v124, v209
    v_sub_f32 v125, v125, v209
    v_sub_f32 v126, v126, v209
    v_sub_f32 v127, v127, v209
    v_sub_f32 v144, v144, v204
    v_sub_f32 v145, v145, v204
    v_sub_f32 v146, v146, v204
    v_sub_f32 v147, v147, v204
    v_sub_f32 v148, v148, v209
    v_sub_f32 v149, v149, v209
    v_sub_f32 v150, v150, v209
    v_sub_f32 v151, v151, v209
    v_sub_f32 v152, v152, v204
    v_sub_f32 v153, v153, v204
    v_sub_f32 v154, v154, v204
    v_sub_f32 v155, v155, v204
    v_sub_f32 v156, v156, v209
    v_sub_f32 v157, v157, v209
    v_sub_f32 v158, v158, v209
    v_sub_f32 v159, v159, v209
    v_mul_f32 v32, v205, v32
    v_mul_f32 v33, v205, v33
    v_mul_f32 v34, v205, v34
    v_mul_f32 v35, v205, v35
    v_mul_f32 v36, v210, v36
    v_mul_f32 v37, v210, v37
    v_mul_f32 v38, v210, v38
    v_mul_f32 v39, v210, v39
    v_mul_f32 v40, v205, v40
    v_mul_f32 v41, v205, v41
    v_mul_f32 v42, v205, v42
    v_mul_f32 v43, v205, v43
    v_mul_f32 v44, v210, v44
    v_mul_f32 v45, v210, v45
    v_mul_f32 v46, v210, v46
    v_mul_f32 v47, v210, v47
    v_mul_f32 v48, v205, v48
    v_mul_f32 v49, v205, v49
    v_mul_f32 v50, v205, v50
    v_mul_f32 v51, v205, v51
    v_mul_f32 v52, v210, v52
    v_mul_f32 v53, v210, v53
    v_mul_f32 v54, v210, v54
    v_mul_f32 v55, v210, v55
    v_mul_f32 v56, v205, v56
    v_mul_f32 v57, v205, v57
    v_mul_f32 v58, v205, v58
    v_mul_f32 v59, v205, v59
    v_mul_f32 v60, v210, v60
    v_mul_f32 v61, v210, v61
    v_mul_f32 v62, v210, v62
    v_mul_f32 v63, v210, v63
    v_mul_f32 v64, v205, v64
    v_mul_f32 v65, v205, v65
    v_mul_f32 v66, v205, v66
    v_mul_f32 v67, v205, v67
    v_mul_f32 v68, v210, v68
    v_mul_f32 v69, v210, v69
    v_mul_f32 v70, v210, v70
    v_mul_f32 v71, v210, v71
    v_mul_f32 v72, v205, v72
    v_mul_f32 v73, v205, v73
    v_mul_f32 v74, v205, v74
    v_mul_f32 v75, v205, v75
    v_mul_f32 v76, v210, v76
    v_mul_f32 v77, v210, v77
    v_mul_f32 v78, v210, v78
    v_mul_f32 v79, v210, v79
    v_mul_f32 v80, v205, v80
    v_mul_f32 v81, v205, v81
    v_mul_f32 v82, v205, v82
    v_mul_f32 v83, v205, v83
    v_mul_f32 v84, v210, v84
    v_mul_f32 v85, v210, v85
    v_mul_f32 v86, v210, v86
    v_mul_f32 v87, v210, v87
    v_mul_f32 v88, v205, v88
    v_mul_f32 v89, v205, v89
    v_mul_f32 v90, v205, v90
    v_mul_f32 v91, v205, v91
    v_mul_f32 v92, v210, v92
    v_mul_f32 v93, v210, v93
    v_mul_f32 v94, v210, v94
    v_mul_f32 v95, v210, v95
    v_mul_f32 v232, v205, v232
    v_mul_f32 v233, v205, v233
    v_mul_f32 v234, v205, v234
    v_mul_f32 v235, v205, v235
    v_mul_f32 v236, v210, v236
    v_mul_f32 v237, v210, v237
    v_mul_f32 v238, v210, v238
    v_mul_f32 v239, v210, v239
    v_mul_f32 v200, v205, v200
    v_mul_f32 v207, v210, v207
    v_exp_f32 v192, v96
    v_exp_f32 v193, v97
    v_exp_f32 v194, v98
    v_cvt_pk_bf16_f32 v128, v192, v193
    v_exp_f32 v195, v99
    v_exp_f32 v196, v104
    v_cvt_pk_bf16_f32 v129, v194, v195
    v_exp_f32 v197, v105
    v_exp_f32 v198, v106
    v_cvt_pk_bf16_f32 v130, v196, v197
    v_exp_f32 v199, v107
    v_exp_f32 v192, v100
    v_cvt_pk_bf16_f32 v131, v198, v199
    v_exp_f32 v193, v101
    v_exp_f32 v194, v102
    v_cvt_pk_bf16_f32 v132, v192, v193
    v_mfma_f32_16x16x32_bf16 v[224:227], v[220:223], v[128:131], v[232:235]
    v_exp_f32 v195, v103
    v_exp_f32 v196, v108
    v_cvt_pk_bf16_f32 v133, v194, v195
    v_exp_f32 v197, v109
    v_exp_f32 v198, v110
    v_cvt_pk_bf16_f32 v134, v196, v197
    v_exp_f32 v199, v111
    s_nop 0
    v_cvt_pk_bf16_f32 v135, v198, v199
    s_nop 1
    v_mfma_f32_16x16x32_bf16 v[228:231], v[220:223], v[132:135], v[236:239]
    s_branch L_hi_fbrt0
L_hi_tail1:
    s_waitcnt lgkmcnt(0)
    ds_read_b128 v[160:163], v202 offset:24576
    ds_read_b128 v[164:167], v202 offset:25600
    ds_read_b128 v[168:171], v202 offset:26624
    ds_read_b128 v[172:175], v202 offset:27648
    ds_read_b128 v[176:179], v202 offset:28672
    ds_read_b128 v[180:183], v202 offset:29696
    ds_read_b128 v[184:187], v202 offset:30720
    ds_read_b128 v[188:191], v202 offset:31744
    ds_read_b32 v253, v248
    s_waitcnt lgkmcnt(8)
    v_mfma_f32_16x16x32_bf16 v[32:35], v[160:163], v[128:131], v[32:35]
    v_exp_f32 v192, v112
    v_exp_f32 v193, v113
    v_mfma_f32_16x16x32_bf16 v[36:39], v[160:163], v[132:135], v[36:39]
    v_exp_f32 v194, v114
    v_cvt_pk_bf16_f32 v136, v192, v193
    s_waitcnt lgkmcnt(7)
    v_mfma_f32_16x16x32_bf16 v[40:43], v[164:167], v[128:131], v[40:43]
    v_exp_f32 v195, v115
    v_exp_f32 v196, v120
    v_mfma_f32_16x16x32_bf16 v[44:47], v[164:167], v[132:135], v[44:47]
    v_cvt_pk_bf16_f32 v137, v194, v195
    s_waitcnt lgkmcnt(6)
    v_mfma_f32_16x16x32_bf16 v[48:51], v[168:171], v[128:131], v[48:51]
    v_exp_f32 v197, v121
    v_exp_f32 v198, v122
    v_mfma_f32_16x16x32_bf16 v[52:55], v[168:171], v[132:135], v[52:55]
    v_cvt_pk_bf16_f32 v138, v196, v197
    v_exp_f32 v199, v123
    s_waitcnt lgkmcnt(5)
    v_mfma_f32_16x16x32_bf16 v[56:59], v[172:175], v[128:131], v[56:59]
    v_exp_f32 v192, v116
    v_cvt_pk_bf16_f32 v139, v198, v199
    v_mfma_f32_16x16x32_bf16 v[60:63], v[172:175], v[132:135], v[60:63]
    v_exp_f32 v193, v117
    s_waitcnt lgkmcnt(4)
    v_mfma_f32_16x16x32_bf16 v[64:67], v[176:179], v[128:131], v[64:67]
    v_exp_f32 v194, v118
    v_cvt_pk_bf16_f32 v140, v192, v193
    v_mfma_f32_16x16x32_bf16 v[68:71], v[176:179], v[132:135], v[68:71]
    v_mfma_f32_16x16x32_bf16 v[232:235], v[220:223], v[136:139], v[224:227]
    v_exp_f32 v195, v119
    s_waitcnt lgkmcnt(3)
    v_mfma_f32_16x16x32_bf16 v[72:75], v[180:183], v[128:131], v[72:75]
    v_exp_f32 v196, v124
    v_cvt_pk_bf16_f32 v141, v194, v195
    v_mfma_f32_16x16x32_bf16 v[76:79], v[180:183], v[132:135], v[76:79]
    v_exp_f32 v197, v125
    s_waitcnt lgkmcnt(2)
    v_mfma_f32_16x16x32_bf16 v[80:83], v[184:187], v[128:131], v[80:83]
    v_exp_f32 v198, v126
    v_cvt_pk_bf16_f32 v142, v196, v197
    v_mfma_f32_16x16x32_bf16 v[84:87], v[184:187], v[132:135], v[84:87]
    v_exp_f32 v199, v127
    s_nop 0
    v_cvt_pk_bf16_f32 v143, v198, v199
    s_waitcnt lgkmcnt(1)
    v_mfma_f32_16x16x32_bf16 v[88:91], v[188:191], v[128:131], v[88:91]
    v_mfma_f32_16x16x32_bf16 v[236:239], v[220:223], v[140:143], v[228:231]
    s_nop 7
    v_max_f32 v204, v232, v236
    v_mfma_f32_16x16x32_bf16 v[92:95], v[188:191], v[132:135], v[92:95]
    v_cmp_nge_f32 vcc, s81, v204
    s_cbranch_vccnz L_hi_fbt1
L_hi_fbrt1:
    v_mov_b32 v200, v232
    s_nop 5
    v_mov_b32 v207, v236
    s_waitcnt lgkmcnt(0)
    v_cmp_gt_u32 vcc, s61, v253
    s_cbranch_vccnz L_hi_spT
L_hi_spT_r:
    v_add_u32 v202, 0x8000, v202
    v_and_b32 v202, 131071, v202
    s_add_u32 s61, s61, 1
    ds_read_b128 v[160:163], v202 offset:16384
    ds_read_b128 v[164:167], v202 offset:17408
    ds_read_b128 v[168:171], v202 offset:18432
    ds_read_b128 v[172:175], v202 offset:19456
    ds_read_b128 v[176:179], v202 offset:20480
    ds_read_b128 v[180:183], v202 offset:21504
    ds_read_b128 v[184:187], v202 offset:22528
    ds_read_b128 v[188:191], v202 offset:23552
    s_waitcnt lgkmcnt(7)
    v_mfma_f32_16x16x32_bf16 v[32:35], v[160:163], v[136:139], v[32:35]
    v_mfma_f32_16x16x32_bf16 v[36:39], v[160:163], v[140:143], v[36:39]
    s_waitcnt lgkmcnt(6)
    v_mfma_f32_16x16x32_bf16 v[40:43], v[164:167], v[136:139], v[40:43]
    v_mfma_f32_16x16x32_bf16 v[44:47], v[164:167], v[140:143], v[44:47]
    s_waitcnt lgkmcnt(5)
    v_mfma_f32_16x16x32_bf16 v[48:51], v[168:171], v[136:139], v[48:51]
    v_mfma_f32_16x16x32_bf16 v[52:55], v[168:171], v[140:143], v[52:55]
    s_waitcnt lgkmcnt(4)
    v_mfma_f32_16x16x32_bf16 v[56:59], v[172:175], v[136:139], v[56:59]
    v_mfma_f32_16x16x32_bf16 v[60:63], v[172:175], v[140:143], v[60:63]
    s_waitcnt lgkmcnt(3)
    v_mfma_f32_16x16x32_bf16 v[64:67], v[176:179], v[136:139], v[64:67]
    v_mfma_f32_16x16x32_bf16 v[68:71], v[176:179], v[140:143], v[68:71]
    s_waitcnt lgkmcnt(2)
    v_mfma_f32_16x16x32_bf16 v[72:75], v[180:183], v[136:139], v[72:75]
    v_mfma_f32_16x16x32_bf16 v[76:79], v[180:183], v[140:143], v[76:79]
    s_waitcnt lgkmcnt(1)
    v_mfma_f32_16x16x32_bf16 v[80:83], v[184:187], v[136:139], v[80:83]
    v_mfma_f32_16x16x32_bf16 v[84:87], v[184:187], v[140:143], v[84:87]
    s_waitcnt lgkmcnt(0)
    v_mfma_f32_16x16x32_bf16 v[88:91], v[188:191], v[136:139], v[88:91]
    v_mfma_f32_16x16x32_bf16 v[92:95], v[188:191], v[140:143], v[92:95]
    s_branch L_hi_epi
L_hi_fbt1:
    v_max3_f32 v204, v112, v113, v114
    v_max3_f32 v204, v204, v115, v120
    v_max3_f32 v204, v204, v121, v122
    v_max_f32 v204, v204, v123
    v_max3_f32 v209, v116, v117, v118
    v_max3_f32 v209, v209, v119, v124
    v_max3_f32 v209, v209, v125, v126
    v_max_f32 v209, v209, v127
    v_mov_b32 v205, v204
    s_nop 1
    v_permlane32_swap_b32 v204, v205
    v_max_f32 v204, v204, v205
    v_mov_b32 v205, v204
    s_nop 1
    v_permlane16_swap_b32 v204, v205
    v_max_f32 v204, v204, v205
    v_mov_b32 v210, v209
    s_nop 1
    v_permlane32_swap_b32 v209, v210
    v_max_f32 v209, v209, v210
    v_mov_b32 v210, v209
    s_nop 1
    v_permlane16_swap_b32 v209, v210
    v_max_f32 v209, v209, v210
    v_max_f32 v204, 0, v204
    v_sub_f32 v205, 0, v204
    v_exp_f32 v205, v205
    v_max_f32 v209, 0, v209
    v_sub_f32 v210, 0, v209
    v_exp_f32 v210, v210
    v_sub_f32 v112, v112, v204
    v_sub_f32 v113, v113, v204
    v_sub_f32 v114, v114, v204
    v_sub_f32 v115, v115, v204
    v_sub_f32 v116, v116, v209
    v_sub_f32 v117, v117, v209
    v_sub_f32 v118, v118, v209
    v_sub_f32 v119, v119, v209
    v_sub_f32 v120, v120, v204
    v_sub_f32 v121, v121, v204
    v_sub_f32 v122, v122, v204
    v_sub_f32 v123, v123, v204
    v_sub_f32 v124, v124, v209
    v_sub_f32 v125, v125, v209
    v_sub_f32 v126, v126, v209
    v_sub_f32 v127, v127, v209
    v_sub_f32 v96, v96, v204
    v_sub_f32 v97, v97, v204
    v_sub_f32 v98, v98, v204
    v_sub_f32 v99, v99, v204
    v_sub_f32 v100, v100, v209
    v_sub_f32 v101, v101, v209
    v_sub_f32 v102, v102, v209
    v_sub_f32 v103, v103, v209
    v_sub_f32 v104, v104, v204
    v_sub_f32 v105, v105, v204
    v_sub_f32 v106, v106, v204
    v_sub_f32 v107, v107, v204
    v_sub_f32 v108, v108, v209
    v_sub_f32 v109, v109, v209
    v_sub_f32 v110, v110, v209
    v_sub_f32 v111, v111, v209
    v_sub_f32 v144, v144, v204
    v_sub_f32 v145, v145, v204
    v_sub_f32 v146, v146, v204
    v_sub_f32 v147, v147, v204
    v_sub_f32 v148, v148, v209
    v_sub_f32 v149, v149, v209
    v_sub_f32 v150, v150, v209
    v_sub_f32 v151, v151, v209
    v_sub_f32 v152, v152, v204
    v_sub_f32 v153, v153, v204
    v_sub_f32 v154, v154, v204
    v_sub_f32 v155, v155, v204
    v_sub_f32 v156, v156, v209
    v_sub_f32 v157, v157, v209
    v_sub_f32 v158, v158, v209
    v_sub_f32 v159, v159, v209
    v_mul_f32 v32, v205, v32
    v_mul_f32 v33, v205, v33
    v_mul_f32 v34, v205, v34
    v_mul_f32 v35, v205, v35
    v_mul_f32 v36, v210, v36
    v_mul_f32 v37, v210, v37
    v_mul_f32 v38, v210, v38
    v_mul_f32 v39, v210, v39
    v_mul_f32 v40, v205, v40
    v_mul_f32 v41, v205, v41
    v_mul_f32 v42, v205, v42
    v_mul_f32 v43, v205, v43
    v_mul_f32 v44, v210, v44
    v_mul_f32 v45, v210, v45
    v_mul_f32 v46, v210, v46
    v_mul_f32 v47, v210, v47
    v_mul_f32 v48, v205, v48
    v_mul_f32 v49, v205, v49
    v_mul_f32 v50, v205, v50
    v_mul_f32 v51, v205, v51
    v_mul_f32 v52, v210, v52
    v_mul_f32 v53, v210, v53
    v_mul_f32 v54, v210, v54
    v_mul_f32 v55, v210, v55
    v_mul_f32 v56, v205, v56
    v_mul_f32 v57, v205, v57
    v_mul_f32 v58, v205, v58
    v_mul_f32 v59, v205, v59
    v_mul_f32 v60, v210, v60
    v_mul_f32 v61, v210, v61
    v_mul_f32 v62, v210, v62
    v_mul_f32 v63, v210, v63
    v_mul_f32 v64, v205, v64
    v_mul_f32 v65, v205, v65
    v_mul_f32 v66, v205, v66
    v_mul_f32 v67, v205, v67
    v_mul_f32 v68, v210, v68
    v_mul_f32 v69, v210, v69
    v_mul_f32 v70, v210, v70
    v_mul_f32 v71, v210, v71
    v_mul_f32 v72, v205, v72
    v_mul_f32 v73, v205, v73
    v_mul_f32 v74, v205, v74
    v_mul_f32 v75, v205, v75
    v_mul_f32 v76, v210, v76
    v_mul_f32 v77, v210, v77
    v_mul_f32 v78, v210, v78
    v_mul_f32 v79, v210, v79
    v_mul_f32 v80, v205, v80
    v_mul_f32 v81, v205, v81
    v_mul_f32 v82, v205, v82
    v_mul_f32 v83, v205, v83
    v_mul_f32 v84, v210, v84
    v_mul_f32 v85, v210, v85
    v_mul_f32 v86, v210, v86
    v_mul_f32 v87, v210, v87
    v_mul_f32 v88, v205, v88
    v_mul_f32 v89, v205, v89
    v_mul_f32 v90, v205, v90
    v_mul_f32 v91, v205, v91
    v_mul_f32 v92, v210, v92
    v_mul_f32 v93, v210, v93
    v_mul_f32 v94, v210, v94
    v_mul_f32 v95, v210, v95
    v_mul_f32 v224, v205, v224
    v_mul_f32 v225, v205, v225
    v_mul_f32 v226, v205, v226
    v_mul_f32 v227, v205, v227
    v_mul_f32 v228, v210, v228
    v_mul_f32 v229, v210, v229
    v_mul_f32 v230, v210, v230
    v_mul_f32 v231, v210, v231
    v_mul_f32 v200, v205, v200
    v_mul_f32 v207, v210, v207
    v_exp_f32 v192, v112
    v_exp_f32 v193, v113
    v_exp_f32 v194, v114
    v_cvt_pk_bf16_f32 v136, v192, v193
    v_exp_f32 v195, v115
    v_exp_f32 v196, v120
    v_cvt_pk_bf16_f32 v137, v194, v195
    v_exp_f32 v197, v121
    v_exp_f32 v198, v122
    v_cvt_pk_bf16_f32 v138, v196, v197
    v_exp_f32 v199, v123
    v_exp_f32 v192, v116
    v_cvt_pk_bf16_f32 v139, v198, v199
    v_exp_f32 v193, v117
    v_exp_f32 v194, v118
    v_cvt_pk_bf16_f32 v140, v192, v193
    v_mfma_f32_16x16x32_bf16 v[232:235], v[220:223], v[136:139], v[224:227]
    v_exp_f32 v195, v119
    v_exp_f32 v196, v124
    v_cvt_pk_bf16_f32 v141, v194, v195
    v_exp_f32 v197, v125
    v_exp_f32 v198, v126
    v_cvt_pk_bf16_f32 v142, v196, v197
    v_exp_f32 v199, v127
    s_nop 0
    v_cvt_pk_bf16_f32 v143, v198, v199
    s_nop 1
    v_mfma_f32_16x16x32_bf16 v[236:239], v[220:223], v[140:143], v[228:231]
    s_branch L_hi_fbrt1
L_hi_spU:
    s_mov_b32 s56, 4194304
L_hi_spU_l:
    ds_read_b32 v253, v248
    s_waitcnt lgkmcnt(0)
    v_cmp_gt_u32 vcc, s61, v253
    s_cbranch_vccz L_hi_spU_r
    s_sleep 1
    s_sub_u32 s56, s56, 1
    s_cmp_lg_u32 s56, 0
    s_cbranch_scc1 L_hi_spU_l
    s_branch L_hi_spU_r
L_hi_spT:
    s_mov_b32 s56, 4194304
L_hi_spT_l:
    ds_read_b32 v253, v248
    s_waitcnt lgkmcnt(0)
    v_cmp_gt_u32 vcc, s61, v253
    s_cbranch_vccz L_hi_spT_r
    s_sleep 1
    s_sub_u32 s56, s56, 1
    s_cmp_lg_u32 s56, 0
    s_cbranch_scc1 L_hi_spT_l
    s_branch L_hi_spT_r
L_hi_epi:
    v_mov_b32 v252, 2147483647
    ds_write_b32 v249, v252
    s_and_b32 s55, s52, 1
    s_lshl_b32 s56, s71, 1
    s_add_u32 s55, s55, s56
    s_lshl_b32 s55, s55, 10
    s_lshr_b32 s56, s52, 1
    s_lshl_b32 s56, s56, 6
    s_add_u32 s55, s55, s56
    s_add_u32 s55, s55, 73416704
    v_bfe_u32 v242, v241, 3, 2
    v_bfe_u32 v243, v241, 0, 3
    v_lshlrev_b32 v243, 3, v243
    v_lshl_add_u32 v242, v242, 8, v243
    buffer_load_dwordx2 v[216:217], v242, s[16:19], s55 offen sc1
    v_rcp_f32 v200, v200
    v_rcp_f32 v207, v207
    s_lshr_b32 s55, s72, 6
    s_lshl_b32 s55, s55, 19
    s_lshl_b32 s56, s70, 14
    s_add_u32 s55, s55, s56
    s_and_b32 s56, s72, 32
    s_lshl_b32 s56, s56, 6
    s_add_u32 s55, s55, s56
    s_add_u32 s67, s55, 33554432
    v_mul_f32 v32, v200, v32
    v_mul_f32 v33, v200, v33
    v_mul_f32 v34, v200, v34
    v_mul_f32 v35, v200, v35
    v_mul_f32 v36, v207, v36
    v_mul_f32 v37, v207, v37
    v_mul_f32 v38, v207, v38
    v_mul_f32 v39, v207, v39
    v_mul_f32 v40, v200, v40
    v_mul_f32 v41, v200, v41
    v_mul_f32 v42, v200, v42
    v_mul_f32 v43, v200, v43
    v_mul_f32 v44, v207, v44
    v_mul_f32 v45, v207, v45
    v_mul_f32 v46, v207, v46
    v_mul_f32 v47, v207, v47
    v_cvt_pk_bf16_f32 v96, v32, v33
    v_cvt_pk_bf16_f32 v97, v34, v35
    v_cvt_pk_bf16_f32 v98, v40, v41
    v_cvt_pk_bf16_f32 v99, v42, v43
    v_cvt_pk_bf16_f32 v100, v36, v37
    v_cvt_pk_bf16_f32 v101, v38, v39
    v_cvt_pk_bf16_f32 v102, v44, v45
    v_cvt_pk_bf16_f32 v103, v46, v47
    buffer_store_dwordx4 v[96:99], v240, s[16:19], s67 offen offset:0 sc1
    buffer_store_dwordx4 v[100:103], v240, s[16:19], s67 offen offset:1024 sc1
    s_add_u32 s67, s67, 4096
    v_mul_f32 v48, v200, v48
    v_mul_f32 v49, v200, v49
    v_mul_f32 v50, v200, v50
    v_mul_f32 v51, v200, v51
    v_mul_f32 v52, v207, v52
    v_mul_f32 v53, v207, v53
    v_mul_f32 v54, v207, v54
    v_mul_f32 v55, v207, v55
    v_mul_f32 v56, v200, v56
    v_mul_f32 v57, v200, v57
    v_mul_f32 v58, v200, v58
    v_mul_f32 v59, v200, v59
    v_mul_f32 v60, v207, v60
    v_mul_f32 v61, v207, v61
    v_mul_f32 v62, v207, v62
    v_mul_f32 v63, v207, v63
    v_cvt_pk_bf16_f32 v104, v48, v49
    v_cvt_pk_bf16_f32 v105, v50, v51
    v_cvt_pk_bf16_f32 v106, v56, v57
    v_cvt_pk_bf16_f32 v107, v58, v59
    v_cvt_pk_bf16_f32 v108, v52, v53
    v_cvt_pk_bf16_f32 v109, v54, v55
    v_cvt_pk_bf16_f32 v110, v60, v61
    v_cvt_pk_bf16_f32 v111, v62, v63
    buffer_store_dwordx4 v[104:107], v240, s[16:19], s67 offen offset:0 sc1
    buffer_store_dwordx4 v[108:111], v240, s[16:19], s67 offen offset:1024 sc1
    s_add_u32 s67, s67, 4096
    v_mul_f32 v64, v200, v64
    v_mul_f32 v65, v200, v65
    v_mul_f32 v66, v200, v66
    v_mul_f32 v67, v200, v67
    v_mul_f32 v68, v207, v68
    v_mul_f32 v69, v207, v69
    v_mul_f32 v70, v207, v70
    v_mul_f32 v71, v207, v71
    v_mul_f32 v72, v200, v72
    v_mul_f32 v73, v200, v73
    v_mul_f32 v74, v200, v74
    v_mul_f32 v75, v200, v75
    v_mul_f32 v76, v207, v76
    v_mul_f32 v77, v207, v77
    v_mul_f32 v78, v207, v78
    v_mul_f32 v79, v207, v79
    v_cvt_pk_bf16_f32 v112, v64, v65
    v_cvt_pk_bf16_f32 v113, v66, v67
    v_cvt_pk_bf16_f32 v114, v72, v73
    v_cvt_pk_bf16_f32 v115, v74, v75
    v_cvt_pk_bf16_f32 v116, v68, v69
    v_cvt_pk_bf16_f32 v117, v70, v71
    v_cvt_pk_bf16_f32 v118, v76, v77
    v_cvt_pk_bf16_f32 v119, v78, v79
    buffer_store_dwordx4 v[112:115], v240, s[16:19], s67 offen offset:0 sc1
    buffer_store_dwordx4 v[116:119], v240, s[16:19], s67 offen offset:1024 sc1
    s_add_u32 s67, s67, 4096
    v_mul_f32 v80, v200, v80
    v_mul_f32 v81, v200, v81
    v_mul_f32 v82, v200, v82
    v_mul_f32 v83, v200, v83
    v_mul_f32 v84, v207, v84
    v_mul_f32 v85, v207, v85
    v_mul_f32 v86, v207, v86
    v_mul_f32 v87, v207, v87
    v_mul_f32 v88, v200, v88
    v_mul_f32 v89, v200, v89
    v_mul_f32 v90, v200, v90
    v_mul_f32 v91, v200, v91
    v_mul_f32 v92, v207, v92
    v_mul_f32 v93, v207, v93
    v_mul_f32 v94, v207, v94
    v_mul_f32 v95, v207, v95
    v_cvt_pk_bf16_f32 v120, v80, v81
    v_cvt_pk_bf16_f32 v121, v82, v83
    v_cvt_pk_bf16_f32 v122, v88, v89
    v_cvt_pk_bf16_f32 v123, v90, v91
    v_cvt_pk_bf16_f32 v124, v84, v85
    v_cvt_pk_bf16_f32 v125, v86, v87
    v_cvt_pk_bf16_f32 v126, v92, v93
    v_cvt_pk_bf16_f32 v127, v94, v95
    buffer_store_dwordx4 v[120:123], v240, s[16:19], s67 offen offset:0 sc1
    buffer_store_dwordx4 v[124:127], v240, s[16:19], s67 offen offset:1024 sc1
    s_branch L_att_done
L_lo_E0:
    s_sub_u32 s74, s74, 1
L_lo_E:
    s_cbranch_scc1 L_lo_sp0
L_lo_go0:
    s_waitcnt lgkmcnt(3)
    v_mfma_f32_16x16x32_bf16 v[112:115], v[160:163], v[16:19], v[144:147]
    v_exp_f32 v192, v96
    v_mfma_f32_16x16x32_bf16 v[116:119], v[160:163], v[24:27], v[148:151]
    v_exp_f32 v193, v97
    v_mfma_f32_16x16x32_bf16 v[124:127], v[164:167], v[24:27], v[156:159]
    ds_read_b128 v[188:191], v202 offset:7168
    ds_read_b32 v253, v250
    v_mfma_f32_16x16x32_bf16 v[120:123], v[164:167], v[16:19], v[152:155]
    v_exp_f32 v194, v98
    v_mfma_f32_16x16x32_bf16 v[112:115], v[168:171], v[20:23], v[112:115]
    ds_read_b128 v[160:163], v202 offset:16384
    v_cvt_pk_bf16_f32 v128, v192, v193
    v_mfma_f32_16x16x32_bf16 v[116:119], v[168:171], v[28:31], v[116:119]
    v_exp_f32 v195, v99
    v_mfma_f32_16x16x32_bf16 v[124:127], v[172:175], v[28:31], v[124:127]
    ds_read_b128 v[164:167], v202 offset:17408
    v_cvt_pk_bf16_f32 v129, v194, v195
    s_sub_u32 s57, s62, 3
    s_waitcnt lgkmcnt(2)
    v_cmp_gt_u32 vcc, s57, v253
    v_mfma_f32_16x16x32_bf16 v[120:123], v[172:175], v[20:23], v[120:123]
    ds_read_b128 v[168:171], v202 offset:18432
    v_mfma_f32_16x16x32_bf16 v[112:115], v[176:179], v[0:3], v[112:115]
    v_exp_f32 v196, v104
    s_cbranch_vccnz L_lo_spF
L_lo_spF_r:
    v_mfma_f32_16x16x32_bf16 v[116:119], v[176:179], v[8:11], v[116:119]
    v_exp_f32 v197, v105
    v_mfma_f32_16x16x32_bf16 v[124:127], v[180:183], v[8:11], v[124:127]
    ds_read_b128 v[172:175], v202 offset:19456
    v_cvt_pk_bf16_f32 v130, v196, v197
    s_lshl_b32 s77, s78, 13
    s_add_u32 s77, s77, s80
    s_cmp_le_u32 s78, s79
    s_cselect_b32 s77, s77, 2130706432
    s_add_u32 m0, s76, s82
    s_add_u32 s78, s78, 2
    buffer_load_dwordx4 v240, s[16:19], s77 offen offset:0 sc1 lds
    v_mfma_f32_16x16x32_bf16 v[120:123], v[180:183], v[0:3], v[120:123]
    v_exp_f32 v198, v106
    v_mfma_f32_16x16x32_bf16 v[112:115], v[184:187], v[4:7], v[112:115]
    v_exp_f32 v199, v107
    v_mfma_f32_16x16x32_bf16 v[116:119], v[184:187], v[12:15], v[116:119]
    ds_read_b128 v[176:179], v202 offset:20480
    v_cvt_pk_bf16_f32 v131, v198, v199
    v_mfma_f32_16x16x32_bf16 v[124:127], v[188:191], v[12:15], v[124:127]
    v_exp_f32 v192, v100
    buffer_load_dwordx4 v240, s[16:19], s77 offen offset:1024 sc1 lds
    v_mfma_f32_16x16x32_bf16 v[224:227], v[220:223], v[128:131], v[232:235]
    v_exp_f32 v193, v101
    v_mfma_f32_16x16x32_bf16 v[120:123], v[188:191], v[4:7], v[120:123]
    ds_read_b128 v[180:183], v202 offset:21504
    s_waitcnt lgkmcnt(2)
    v_mfma_f32_16x16x32_bf16 v[32:35], v[160:163], v[136:139], v[32:35]
    ds_read_b128 v[184:187], v202 offset:22528
    ds_read_b128 v[188:191], v202 offset:23552
    v_mfma_f32_16x16x32_bf16 v[36:39], v[160:163], v[140:143], v[36:39]
    v_exp_f32 v194, v102
    v_mfma_f32_16x16x32_bf16 v[44:47], v[164:167], v[140:143], v[44:47]
    v_cvt_pk_bf16_f32 v132, v192, v193
    buffer_load_dwordx4 v240, s[16:19], s77 offen offset:2048 sc1 lds
    v_mfma_f32_16x16x32_bf16 v[40:43], v[164:167], v[136:139], v[40:43]
    v_exp_f32 v195, v103
    v_mfma_f32_16x16x32_bf16 v[48:51], v[168:171], v[136:139], v[48:51]
    ds_read_b128 v[160:163], v202 offset:8192
    v_cvt_pk_bf16_f32 v133, v194, v195
    v_mfma_f32_16x16x32_bf16 v[52:55], v[168:171], v[140:143], v[52:55]
    v_exp_f32 v196, v108
    v_mfma_f32_16x16x32_bf16 v[60:63], v[172:175], v[140:143], v[60:63]
    v_exp_f32 v197, v109
    v_mfma_f32_16x16x32_bf16 v[56:59], v[172:175], v[136:139], v[56:59]
    ds_read_b128 v[164:167], v202 offset:9216
    s_waitcnt lgkmcnt(2)
    buffer_load_dwordx4 v240, s[16:19], s77 offen offset:3072 sc1 lds
    v_mfma_f32_16x16x32_bf16 v[64:67], v[176:179], v[136:139], v[64:67]
    ds_read_b128 v[168:171], v202 offset:10240
    v_cvt_pk_bf16_f32 v134, v196, v197
    v_mfma_f32_16x16x32_bf16 v[68:71], v[176:179], v[140:143], v[68:71]
    v_exp_f32 v198, v110
    v_mfma_f32_16x16x32_bf16 v[76:79], v[180:183], v[140:143], v[76:79]
    v_exp_f32 v199, v111
    v_mfma_f32_16x16x32_bf16 v[72:75], v[180:183], v[136:139], v[72:75]
    ds_read_b128 v[172:175], v202 offset:11264
    v_cvt_pk_bf16_f32 v135, v198, v199
    v_mfma_f32_16x16x32_bf16 v[80:83], v[184:187], v[136:139], v[80:83]
    ds_read_b128 v[176:179], v202 offset:12288
    v_mfma_f32_16x16x32_bf16 v[228:231], v[220:223], v[132:135], v[236:239]
    ds_read_b128 v[180:183], v202 offset:13312
    v_mfma_f32_16x16x32_bf16 v[84:87], v[184:187], v[140:143], v[84:87]
    ds_read_b128 v[184:187], v202 offset:14336
    v_mfma_f32_16x16x32_bf16 v[92:95], v[188:191], v[140:143], v[92:95]
    s_sub_u32 s74, s74, 1
    v_mfma_f32_16x16x32_bf16 v[88:91], v[188:191], v[136:139], v[88:91]
    s_nop 1
    v_max_f32 v204, v224, v228
    v_cmp_nge_f32 vcc, s81, v204
    s_cbranch_vccnz L_lo_fbm0
L_lo_fbrm0:
L_lo_O:
    s_cbranch_scc1 L_lo_sp1
L_lo_go1:
    s_waitcnt lgkmcnt(3)
    v_mfma_f32_16x16x32_bf16 v[96:99], v[160:163], v[16:19], v[144:147]
    v_exp_f32 v192, v112
    v_mfma_f32_16x16x32_bf16 v[100:103], v[160:163], v[24:27], v[148:151]
    v_exp_f32 v193, v113
    v_mfma_f32_16x16x32_bf16 v[108:111], v[164:167], v[24:27], v[156:159]
    ds_read_b128 v[188:191], v202 offset:15360
    ds_read_b32 v253, v248
    v_mfma_f32_16x16x32_bf16 v[104:107], v[164:167], v[16:19], v[152:155]
    v_exp_f32 v194, v114
    v_mfma_f32_16x16x32_bf16 v[96:99], v[168:171], v[20:23], v[96:99]
    ds_read_b128 v[160:163], v202 offset:24576
    v_cvt_pk_bf16_f32 v136, v192, v193
    s_mov_b32 s55, s62
    v_mov_b32 v254, s55
    s_waitcnt vmcnt(4)
    ds_write_b32 v251, v254
    v_mfma_f32_16x16x32_bf16 v[100:103], v[168:171], v[28:31], v[100:103]
    v_exp_f32 v195, v115
    v_mfma_f32_16x16x32_bf16 v[108:111], v[172:175], v[28:31], v[108:111]
    ds_read_b128 v[164:167], v202 offset:25600
    v_cvt_pk_bf16_f32 v137, v194, v195
    v_mfma_f32_16x16x32_bf16 v[104:107], v[172:175], v[20:23], v[104:107]
    ds_read_b128 v[168:171], v202 offset:26624
    s_waitcnt lgkmcnt(5)
    v_mfma_f32_16x16x32_bf16 v[96:99], v[176:179], v[0:3], v[96:99]
    v_exp_f32 v196, v120
    v_mfma_f32_16x16x32_bf16 v[100:103], v[176:179], v[8:11], v[100:103]
    v_exp_f32 v197, v121
    s_add_u32 m0, m0, 4096
    s_add_u32 s77, s77, 4096
    buffer_load_dwordx4 v240, s[16:19], s77 offen offset:0 sc1 lds
    v_mfma_f32_16x16x32_bf16 v[108:111], v[180:183], v[8:11], v[108:111]
    ds_read_b128 v[172:175], v202 offset:27648
    v_cvt_pk_bf16_f32 v138, v196, v197
    v_mfma_f32_16x16x32_bf16 v[104:107], v[180:183], v[0:3], v[104:107]
    v_exp_f32 v198, v122
    v_mfma_f32_16x16x32_bf16 v[96:99], v[184:187], v[4:7], v[96:99]
    v_exp_f32 v199, v123
    v_mfma_f32_16x16x32_bf16 v[100:103], v[184:187], v[12:15], v[100:103]
    ds_read_b128 v[176:179], v202 offset:28672
    v_cvt_pk_bf16_f32 v139, v198, v199
    buffer_load_dwordx4 v240, s[16:19], s77 offen offset:1024 sc1 lds
    v_mfma_f32_16x16x32_bf16 v[108:111], v[188:191], v[12:15], v[108:111]
    v_exp_f32 v192, v116
    v_mfma_f32_16x16x32_bf16 v[232:235], v[220:223], v[136:139], v[224:227]
    v_exp_f32 v193, v117
    v_mfma_f32_16x16x32_bf16 v[104:107], v[188:191], v[4:7], v[104:107]
    ds_read_b128 v[180:183], v202 offset:29696
    s_waitcnt lgkmcnt(2)
    v_mfma_f32_16x16x32_bf16 v[32:35], v[160:163], v[128:131], v[32:35]
    ds_read_b128 v[184:187], v202 offset:30720
    ds_read_b128 v[188:191], v202 offset:31744
    v_cmp_gt_u32 vcc, s61, v253
    v_mfma_f32_16x16x32_bf16 v[36:39], v[160:163], v[132:135], v[36:39]
    v_exp_f32 v194, v118
    v_mfma_f32_16x16x32_bf16 v[44:47], v[164:167], v[132:135], v[44:47]
    v_cvt_pk_bf16_f32 v140, v192, v193
    s_cbranch_vccnz L_lo_spU
L_lo_spU_r:
    v_add_u32 v202, 0x8000, v202
    v_and_b32 v202, 131071, v202
    s_add_u32 s61, s61, 1
    v_mfma_f32_16x16x32_bf16 v[40:43], v[164:167], v[128:131], v[40:43]
    v_exp_f32 v195, v119
    v_mfma_f32_16x16x32_bf16 v[48:51], v[168:171], v[128:131], v[48:51]
    ds_read_b128 v[160:163], v202 offset:0
    v_cvt_pk_bf16_f32 v141, v194, v195
    v_mfma_f32_16x16x32_bf16 v[52:55], v[168:171], v[132:135], v[52:55]
    v_exp_f32 v196, v124
    buffer_load_dwordx4 v240, s[16:19], s77 offen offset:2048 sc1 lds
    v_mfma_f32_16x16x32_bf16 v[60:63], v[172:175], v[132:135], v[60:63]
    v_exp_f32 v197, v125
    v_mfma_f32_16x16x32_bf16 v[56:59], v[172:175], v[128:131], v[56:59]
    ds_read_b128 v[164:167], v202 offset:1024
    s_waitcnt lgkmcnt(2)
    v_mfma_f32_16x16x32_bf16 v[64:67], v[176:179], v[128:131], v[64:67]
    ds_read_b128 v[168:171], v202 offset:2048
    v_cvt_pk_bf16_f32 v142, v196, v197
    v_mfma_f32_16x16x32_bf16 v[68:71], v[176:179], v[132:135], v[68:71]
    v_exp_f32 v198, v126
    v_mfma_f32_16x16x32_bf16 v[76:79], v[180:183], v[132:135], v[76:79]
    v_exp_f32 v199, v127
    buffer_load_dwordx4 v240, s[16:19], s77 offen offset:3072 sc1 lds
    v_mfma_f32_16x16x32_bf16 v[72:75], v[180:183], v[128:131], v[72:75]
    ds_read_b128 v[172:175], v202 offset:3072
    v_cvt_pk_bf16_f32 v143, v198, v199
    v_mfma_f32_16x16x32_bf16 v[80:83], v[184:187], v[128:131], v[80:83]
    ds_read_b128 v[176:179], v202 offset:4096
    v_mfma_f32_16x16x32_bf16 v[236:239], v[220:223], v[140:143], v[228:231]
    ds_read_b128 v[180:183], v202 offset:5120
    s_add_u32 s76, s76, 32768
    s_and_b32 s76, s76, 131071
    s_add_u32 s62, s62, 1
    v_mfma_f32_16x16x32_bf16 v[84:87], v[184:187], v[132:135], v[84:87]
    ds_read_b128 v[184:187], v202 offset:6144
    v_mfma_f32_16x16x32_bf16 v[92:95], v[188:191], v[132:135], v[92:95]
    ds_write_b32 v249, v252
    v_add_u32 v252, 1, v252
    s_sub_u32 s74, s74, 1
    v_mfma_f32_16x16x32_bf16 v[88:91], v[188:191], v[128:131], v[88:91]
    v_max_f32 v204, v232, v236
    v_cmp_nge_f32 vcc, s81, v204
    s_cbranch_vccnz L_lo_fbm1
L_lo_fbrm1:
    s_branch L_lo_E
L_lo_fbm0:
    v_max3_f32 v204, v96, v97, v98
    v_max3_f32 v204, v204, v99, v104
    v_max3_f32 v204, v204, v105, v106
    v_max_f32 v204, v204, v107
    v_max3_f32 v209, v100, v101, v102
    v_max3_f32 v209, v209, v103, v108
    v_max3_f32 v209, v209, v109, v110
    v_max_f32 v209, v209, v111
    v_mov_b32 v205, v204
    s_nop 1
    v_permlane32_swap_b32 v204, v205
    v_max_f32 v204, v204, v205
    v_mov_b32 v205, v204
    s_nop 1
    v_permlane16_swap_b32 v204, v205
    v_max_f32 v204, v204, v205
    v_mov_b32 v210, v209
    s_nop 1
    v_permlane32_swap_b32 v209, v210
    v_max_f32 v209, v209, v210
    v_mov_b32 v210, v209
    s_nop 1
    v_permlane16_swap_b32 v209, v210
    v_max_f32 v209, v209, v210
    v_max_f32 v204, 0, v204
    v_sub_f32 v205, 0, v204
    v_exp_f32 v205, v205
    v_max_f32 v209, 0, v209
    v_sub_f32 v210, 0, v209
    v_exp_f32 v210, v210
    v_sub_f32 v96, v96, v204
    v_sub_f32 v97, v97, v204
    v_sub_f32 v98, v98, v204
    v_sub_f32 v99, v99, v204
    v_sub_f32 v100, v100, v209
    v_sub_f32 v101, v101, v209
    v_sub_f32 v102, v102, v209
    v_sub_f32 v103, v103, v209
    v_sub_f32 v104, v104, v204
    v_sub_f32 v105, v105, v204
    v_sub_f32 v106, v106, v204
    v_sub_f32 v107, v107, v204
    v_sub_f32 v108, v108, v209
    v_sub_f32 v109, v109, v209
    v_sub_f32 v110, v110, v209
    v_sub_f32 v111, v111, v209
    v_sub_f32 v112, v112, v204
    v_sub_f32 v113, v113, v204
    v_sub_f32 v114, v114, v204
    v_sub_f32 v115, v115, v204
    v_sub_f32 v116, v116, v209
    v_sub_f32 v117, v117, v209
    v_sub_f32 v118, v118, v209
    v_sub_f32 v119, v119, v209
    v_sub_f32 v120, v120, v204
    v_sub_f32 v121, v121, v204
    v_sub_f32 v122, v122, v204
    v_sub_f32 v123, v123, v204
    v_sub_f32 v124, v124, v209
    v_sub_f32 v125, v125, v209
    v_sub_f32 v126, v126, v209
    v_sub_f32 v127, v127, v209
    v_sub_f32 v144, v144, v204
    v_sub_f32 v145, v145, v204
    v_sub_f32 v146, v146, v204
    v_sub_f32 v147, v147, v204
    v_sub_f32 v148, v148, v209
    v_sub_f32 v149, v149, v209
    v_sub_f32 v150, v150, v209
    v_sub_f32 v151, v151, v209
    v_sub_f32 v152, v152, v204
    v_sub_f32 v153, v153, v204
    v_sub_f32 v154, v154, v204
    v_sub_f32 v155, v155, v204
    v_sub_f32 v156, v156, v209
    v_sub_f32 v157, v157, v209
    v_sub_f32 v158, v158, v209
    v_sub_f32 v159, v159, v209
    v_mul_f32 v32, v205, v32
    v_mul_f32 v33, v205, v33
    v_mul_f32 v34, v205, v34
    v_mul_f32 v35, v205, v35
    v_mul_f32 v36, v210, v36
    v_mul_f32 v37, v210, v37
    v_mul_f32 v38, v210, v38
    v_mul_f32 v39, v210, v39
    v_mul_f32 v40, v205, v40
    v_mul_f32 v41, v205, v41
    v_mul_f32 v42, v205, v42
    v_mul_f32 v43, v205, v43
    v_mul_f32 v44, v210, v44
    v_mul_f32 v45, v210, v45
    v_mul_f32 v46, v210, v46
    v_mul_f32 v47, v210, v47
    v_mul_f32 v48, v205, v48
    v_mul_f32 v49, v205, v49
    v_mul_f32 v50, v205, v50
    v_mul_f32 v51, v205, v51
    v_mul_f32 v52, v210, v52
    v_mul_f32 v53, v210, v53
    v_mul_f32 v54, v210, v54
    v_mul_f32 v55, v210, v55
    v_mul_f32 v56, v205, v56
    v_mul_f32 v57, v205, v57
    v_mul_f32 v58, v205, v58
    v_mul_f32 v59, v205, v59
    v_mul_f32 v60, v210, v60
    v_mul_f32 v61, v210, v61
    v_mul_f32 v62, v210, v62
    v_mul_f32 v63, v210, v63
    v_mul_f32 v64, v205, v64
    v_mul_f32 v65, v205, v65
    v_mul_f32 v66, v205, v66
    v_mul_f32 v67, v205, v67
    v_mul_f32 v68, v210, v68
    v_mul_f32 v69, v210, v69
    v_mul_f32 v70, v210, v70
    v_mul_f32 v71, v210, v71
    v_mul_f32 v72, v205, v72
    v_mul_f32 v73, v205, v73
    v_mul_f32 v74, v205, v74
    v_mul_f32 v75, v205, v75
    v_mul_f32 v76, v210, v76
    v_mul_f32 v77, v210, v77
    v_mul_f32 v78, v210, v78
    v_mul_f32 v79, v210, v79
    v_mul_f32 v80, v205, v80
    v_mul_f32 v81, v205, v81
    v_mul_f32 v82, v205, v82
    v_mul_f32 v83, v205, v83
    v_mul_f32 v84, v210, v84
    v_mul_f32 v85, v210, v85
    v_mul_f32 v86, v210, v86
    v_mul_f32 v87, v210, v87
    v_mul_f32 v88, v205, v88
    v_mul_f32 v89, v205, v89
    v_mul_f32 v90, v205, v90
    v_mul_f32 v91, v205, v91
    v_mul_f32 v92, v210, v92
    v_mul_f32 v93, v210, v93
    v_mul_f32 v94, v210, v94
    v_mul_f32 v95, v210, v95
    v_mul_f32 v232, v205, v232
    v_mul_f32 v233, v205, v233
    v_mul_f32 v234, v205, v234
    v_mul_f32 v235, v205, v235
    v_mul_f32 v236, v210, v236
    v_mul_f32 v237, v210, v237
    v_mul_f32 v238, v210, v238
    v_mul_f32 v239, v210, v239
    v_mul_f32 v200, v205, v200
    v_mul_f32 v207, v210, v207
    v_exp_f32 v192, v96
    v_exp_f32 v193, v97
    v_exp_f32 v194, v98
    v_cvt_pk_bf16_f32 v128, v192, v193
    v_exp_f32 v195, v99
    v_exp_f32 v196, v104
    v_cvt_pk_bf16_f32 v129, v194, v195
    v_exp_f32 v197, v105
    v_exp_f32 v198, v106
    v_cvt_pk_bf16_f32 v130, v196, v197
    v_exp_f32 v199, v107
    v_exp_f32 v192, v100
    v_cvt_pk_bf16_f32 v131, v198, v199
    v_exp_f32 v193, v101
    v_exp_f32 v194, v102
    v_cvt_pk_bf16_f32 v132, v192, v193
    v_mfma_f32_16x16x32_bf16 v[224:227], v[220:223], v[128:131], v[232:235]
    v_exp_f32 v195, v103
    v_exp_f32 v196, v108
    v_cvt_pk_bf16_f32 v133, v194, v195
    v_exp_f32 v197, v109
    v_exp_f32 v198, v110
    v_cvt_pk_bf16_f32 v134, v196, v197
    v_exp_f32 v199, v111
    s_nop 0
    v_cvt_pk_bf16_f32 v135, v198, v199
    s_nop 1
    v_mfma_f32_16x16x32_bf16 v[228:231], v[220:223], v[132:135], v[236:239]
    s_branch L_lo_fbrm0
L_lo_fbm1:
    v_max3_f32 v204, v112, v113, v114
    v_max3_f32 v204, v204, v115, v120
    v_max3_f32 v204, v204, v121, v122
    v_max_f32 v204, v204, v123
    v_max3_f32 v209, v116, v117, v118
    v_max3_f32 v209, v209, v119, v124
    v_max3_f32 v209, v209, v125, v126
    v_max_f32 v209, v209, v127
    v_mov_b32 v205, v204
    s_nop 1
    v_permlane32_swap_b32 v204, v205
    v_max_f32 v204, v204, v205
    v_mov_b32 v205, v204
    s_nop 1
    v_permlane16_swap_b32 v204, v205
    v_max_f32 v204, v204, v205
    v_mov_b32 v210, v209
    s_nop 1
    v_permlane32_swap_b32 v209, v210
    v_max_f32 v209, v209, v210
    v_mov_b32 v210, v209
    s_nop 1
    v_permlane16_swap_b32 v209, v210
    v_max_f32 v209, v209, v210
    v_max_f32 v204, 0, v204
    v_sub_f32 v205, 0, v204
    v_exp_f32 v205, v205
    v_max_f32 v209, 0, v209
    v_sub_f32 v210, 0, v209
    v_exp_f32 v210, v210
    v_sub_f32 v112, v112, v204
    v_sub_f32 v113, v113, v204
    v_sub_f32 v114, v114, v204
    v_sub_f32 v115, v115, v204
    v_sub_f32 v116, v116, v209
    v_sub_f32 v117, v117, v209
    v_sub_f32 v118, v118, v209
    v_sub_f32 v119, v119, v209
    v_sub_f32 v120, v120, v204
    v_sub_f32 v121, v121, v204
    v_sub_f32 v122, v122, v204
    v_sub_f32 v123, v123, v204
    v_sub_f32 v124, v124, v209
    v_sub_f32 v125, v125, v209
    v_sub_f32 v126, v126, v209
    v_sub_f32 v127, v127, v209
    v_sub_f32 v96, v96, v204
    v_sub_f32 v97, v97, v204
    v_sub_f32 v98, v98, v204
    v_sub_f32 v99, v99, v204
    v_sub_f32 v100, v100, v209
    v_sub_f32 v101, v101, v209
    v_sub_f32 v102, v102, v209
    v_sub_f32 v103, v103, v209
    v_sub_f32 v104, v104, v204
    v_sub_f32 v105, v105, v204
    v_sub_f32 v106, v106, v204
    v_sub_f32 v107, v107, v204
    v_sub_f32 v108, v108, v209
    v_sub_f32 v109, v109, v209
    v_sub_f32 v110, v110, v209
    v_sub_f32 v111, v111, v209
    v_sub_f32 v144, v144, v204
    v_sub_f32 v145, v145, v204
    v_sub_f32 v146, v146, v204
    v_sub_f32 v147, v147, v204
    v_sub_f32 v148, v148, v209
    v_sub_f32 v149, v149, v209
    v_sub_f32 v150, v150, v209
    v_sub_f32 v151, v151, v209
    v_sub_f32 v152, v152, v204
    v_sub_f32 v153, v153, v204
    v_sub_f32 v154, v154, v204
    v_sub_f32 v155, v155, v204
    v_sub_f32 v156, v156, v209
    v_sub_f32 v157, v157, v209
    v_sub_f32 v158, v158, v209
    v_sub_f32 v159, v159, v209
    v_mul_f32 v32, v205, v32
    v_mul_f32 v33, v205, v33
    v_mul_f32 v34, v205, v34
    v_mul_f32 v35, v205, v35
    v_mul_f32 v36, v210, v36
    v_mul_f32 v37, v210, v37
    v_mul_f32 v38, v210, v38
    v_mul_f32 v39, v210, v39
    v_mul_f32 v40, v205, v40
    v_mul_f32 v41, v205, v41
    v_mul_f32 v42, v205, v42
    v_mul_f32 v43, v205, v43
    v_mul_f32 v44, v210, v44
    v_mul_f32 v45, v210, v45
    v_mul_f32 v46, v210, v46
    v_mul_f32 v47, v210, v47
    v_mul_f32 v48, v205, v48
    v_mul_f32 v49, v205, v49
    v_mul_f32 v50, v205, v50
    v_mul_f32 v51, v205, v51
    v_mul_f32 v52, v210, v52
    v_mul_f32 v53, v210, v53
    v_mul_f32 v54, v210, v54
    v_mul_f32 v55, v210, v55
    v_mul_f32 v56, v205, v56
    v_mul_f32 v57, v205, v57
    v_mul_f32 v58, v205, v58
    v_mul_f32 v59, v205, v59
    v_mul_f32 v60, v210, v60
    v_mul_f32 v61, v210, v61
    v_mul_f32 v62, v210, v62
    v_mul_f32 v63, v210, v63
    v_mul_f32 v64, v205, v64
    v_mul_f32 v65, v205, v65
    v_mul_f32 v66, v205, v66
    v_mul_f32 v67, v205, v67
    v_mul_f32 v68, v210, v68
    v_mul_f32 v69, v210, v69
    v_mul_f32 v70, v210, v70
    v_mul_f32 v71, v210, v71
    v_mul_f32 v72, v205, v72
    v_mul_f32 v73, v205, v73
    v_mul_f32 v74, v205, v74
    v_mul_f32 v75, v205, v75
    v_mul_f32 v76, v210, v76
    v_mul_f32 v77, v210, v77
    v_mul_f32 v78, v210, v78
    v_mul_f32 v79, v210, v79
    v_mul_f32 v80, v205, v80
    v_mul_f32 v81, v205, v81
    v_mul_f32 v82, v205, v82
    v_mul_f32 v83, v205, v83
    v_mul_f32 v84, v210, v84
    v_mul_f32 v85, v210, v85
    v_mul_f32 v86, v210, v86
    v_mul_f32 v87, v210, v87
    v_mul_f32 v88, v205, v88
    v_mul_f32 v89, v205, v89
    v_mul_f32 v90, v205, v90
    v_mul_f32 v91, v205, v91
    v_mul_f32 v92, v210, v92
    v_mul_f32 v93, v210, v93
    v_mul_f32 v94, v210, v94
    v_mul_f32 v95, v210, v95
    v_mul_f32 v224, v205, v224
    v_mul_f32 v225, v205, v225
    v_mul_f32 v226, v205, v226
    v_mul_f32 v227, v205, v227
    v_mul_f32 v228, v210, v228
    v_mul_f32 v229, v210, v229
    v_mul_f32 v230, v210, v230
    v_mul_f32 v231, v210, v231
    v_mul_f32 v200, v205, v200
    v_mul_f32 v207, v210, v207
    v_exp_f32 v192, v112
    v_exp_f32 v193, v113
    v_exp_f32 v194, v114
    v_cvt_pk_bf16_f32 v136, v192, v193
    v_exp_f32 v195, v115
    v_exp_f32 v196, v120
    v_cvt_pk_bf16_f32 v137, v194, v195
    v_exp_f32 v197, v121
    v_exp_f32 v198, v122
    v_cvt_pk_bf16_f32 v138, v196, v197
    v_exp_f32 v199, v123
    v_exp_f32 v192, v116
    v_cvt_pk_bf16_f32 v139, v198, v199
    v_exp_f32 v193, v117
    v_exp_f32 v194, v118
    v_cvt_pk_bf16_f32 v140, v192, v193
    v_mfma_f32_16x16x32_bf16 v[232:235], v[220:223], v[136:139], v[224:227]
    v_exp_f32 v195, v119
    v_exp_f32 v196, v124
    v_cvt_pk_bf16_f32 v141, v194, v195
    v_exp_f32 v197, v125
    v_exp_f32 v198, v126
    v_cvt_pk_bf16_f32 v142, v196, v197
    v_exp_f32 v199, v127
    s_nop 0
    v_cvt_pk_bf16_f32 v143, v198, v199
    s_nop 1
    v_mfma_f32_16x16x32_bf16 v[236:239], v[220:223], v[140:143], v[228:231]
    s_branch L_lo_fbrm1
L_lo_sp0:
    s_cmp_lg_u32 s75, 0
    s_cbranch_scc1 L_lo_tail0
    s_mov_b32 s75, 1
    s_mov_b32 s74, 0
    v_mov_b32 v152, v206
    v_mov_b32 v153, v206
    v_mov_b32 v154, v206
    v_mov_b32 v155, v206
    v_cmp_gt_i32 s[90:91], 0, v203
    s_nop 1
    v_cndmask_b32 v144, v144, v206, s[90:91]
    v_cmp_gt_i32 s[92:93], 1, v203
    s_nop 1
    v_cndmask_b32 v145, v145, v206, s[92:93]
    v_cmp_gt_i32 s[90:91], 2, v203
    s_nop 1
    v_cndmask_b32 v146, v146, v206, s[90:91]
    v_cmp_gt_i32 s[92:93], 3, v203
    s_nop 1
    v_cndmask_b32 v147, v147, v206, s[92:93]
    v_cmp_gt_i32 s[90:91], 0, v203
    s_nop 1
    v_cndmask_b32 v156, v156, v206, s[90:91]
    v_cmp_gt_i32 s[92:93], 1, v203
    s_nop 1
    v_cndmask_b32 v157, v157, v206, s[92:93]
    v_cmp_gt_i32 s[90:91], 2, v203
    s_nop 1
    v_cndmask_b32 v158, v158, v206, s[90:91]
    v_cmp_gt_i32 s[92:93], 3, v203
    s_nop 1
    v_cndmask_b32 v159, v159, v206, s[92:93]
    s_branch L_lo_go0
L_lo_sp1:
    s_cmp_lg_u32 s75, 0
    s_cbranch_scc1 L_lo_tail1
    s_mov_b32 s75, 1
    s_mov_b32 s74, 0
    v_mov_b32 v152, v206
    v_mov_b32 v153, v206
    v_mov_b32 v154, v206
    v_mov_b32 v155, v206
    v_cmp_gt_i32 s[90:91], 0, v203
    s_nop 1
    v_cndmask_b32 v144, v144, v206, s[90:91]
    v_cmp_gt_i32 s[92:93], 1, v203
    s_nop 1
    v_cndmask_b32 v145, v145, v206, s[92:93]
    v_cmp_gt_i32 s[90:91], 2, v203
    s_nop 1
    v_cndmask_b32 v146, v146, v206, s[90:91]
    v_cmp_gt_i32 s[92:93], 3, v203
    s_nop 1
    v_cndmask_b32 v147, v147, v206, s[92:93]
    v_cmp_gt_i32 s[90:91], 0, v203
    s_nop 1
    v_cndmask_b32 v156, v156, v206, s[90:91]
    v_cmp_gt_i32 s[92:93], 1, v203
    s_nop 1
    v_cndmask_b32 v157, v157, v206, s[92:93]
    v_cmp_gt_i32 s[90:91], 2, v203
    s_nop 1
    v_cndmask_b32 v158, v158, v206, s[90:91]
    v_cmp_gt_i32 s[92:93], 3, v203
    s_nop 1
    v_cndmask_b32 v159, v159, v206, s[92:93]
    s_branch L_lo_go1
L_lo_tail0:
    s_waitcnt lgkmcnt(0)
    ds_read_b128 v[160:163], v202 offset:16384
    ds_read_b128 v[164:167], v202 offset:17408
    ds_read_b128 v[168:171], v202 offset:18432
    ds_read_b128 v[172:175], v202 offset:19456
    ds_read_b128 v[176:179], v202 offset:20480
    ds_read_b128 v[180:183], v202 offset:21504
    ds_read_b128 v[184:187], v202 offset:22528
    ds_read_b128 v[188:191], v202 offset:23552
    s_waitcnt lgkmcnt(7)
    v_mfma_f32_16x16x32_bf16 v[32:35], v[160:163], v[136:139], v[32:35]
    v_exp_f32 v192, v96
    v_exp_f32 v193, v97
    v_mfma_f32_16x16x32_bf16 v[36:39], v[160:163], v[140:143], v[36:39]
    v_exp_f32 v194, v98
    v_cvt_pk_bf16_f32 v128, v192, v193
    s_waitcnt lgkmcnt(6)
    v_mfma_f32_16x16x32_bf16 v[40:43], v[164:167], v[136:139], v[40:43]
    v_exp_f32 v195, v99
    v_exp_f32 v196, v104
    v_mfma_f32_16x16x32_bf16 v[44:47], v[164:167], v[140:143], v[44:47]
    v_cvt_pk_bf16_f32 v129, v194, v195
    s_waitcnt lgkmcnt(5)
    v_mfma_f32_16x16x32_bf16 v[48:51], v[168:171], v[136:139], v[48:51]
    v_exp_f32 v197, v105
    v_exp_f32 v198, v106
    v_mfma_f32_16x16x32_bf16 v[52:55], v[168:171], v[140:143], v[52:55]
    v_cvt_pk_bf16_f32 v130, v196, v197
    v_exp_f32 v199, v107
    s_waitcnt lgkmcnt(4)
    v_mfma_f32_16x16x32_bf16 v[56:59], v[172:175], v[136:139], v[56:59]
    v_exp_f32 v192, v100
    v_cvt_pk_bf16_f32 v131, v198, v199
    v_mfma_f32_16x16x32_bf16 v[60:63], v[172:175], v[140:143], v[60:63]
    v_exp_f32 v193, v101
    s_waitcnt lgkmcnt(3)
    v_mfma_f32_16x16x32_bf16 v[64:67], v[176:179], v[136:139], v[64:67]
    v_exp_f32 v194, v102
    v_cvt_pk_bf16_f32 v132, v192, v193
    v_mfma_f32_16x16x32_bf16 v[68:71], v[176:179], v[140:143], v[68:71]
    v_mfma_f32_16x16x32_bf16 v[224:227], v[220:223], v[128:131], v[232:235]
    v_exp_f32 v195, v103
    s_waitcnt lgkmcnt(2)
    v_mfma_f32_16x16x32_bf16 v[72:75], v[180:183], v[136:139], v[72:75]
    v_exp_f32 v196, v108
    v_cvt_pk_bf16_f32 v133, v194, v195
    v_mfma_f32_16x16x32_bf16 v[76:79], v[180:183], v[140:143], v[76:79]
    v_exp_f32 v197, v109
    s_waitcnt lgkmcnt(1)
    v_mfma_f32_16x16x32_bf16 v[80:83], v[184:187], v[136:139], v[80:83]
    v_exp_f32 v198, v110
    v_cvt_pk_bf16_f32 v134, v196, v197
    v_mfma_f32_16x16x32_bf16 v[84:87], v[184:187], v[140:143], v[84:87]
    v_exp_f32 v199, v111
    s_nop 0
    v_cvt_pk_bf16_f32 v135, v198, v199
    s_waitcnt lgkmcnt(0)
    v_mfma_f32_16x16x32_bf16 v[88:91], v[188:191], v[136:139], v[88:91]
    v_mfma_f32_16x16x32_bf16 v[228:231], v[220:223], v[132:135], v[236:239]
    s_nop 7
    v_max_f32 v204, v224, v228
    v_mfma_f32_16x16x32_bf16 v[92:95], v[188:191], v[140:143], v[92:95]
    v_cmp_nge_f32 vcc, s81, v204
    s_cbranch_vccnz L_lo_fbt0
L_lo_fbrt0:
    v_mov_b32 v200, v224
    s_nop 5
    v_mov_b32 v207, v228
    ds_read_b128 v[160:163], v202 offset:24576
    ds_read_b128 v[164:167], v202 offset:25600
    ds_read_b128 v[168:171], v202 offset:26624
    ds_read_b128 v[172:175], v202 offset:27648
    ds_read_b128 v[176:179], v202 offset:28672
    ds_read_b128 v[180:183], v202 offset:29696
    ds_read_b128 v[184:187], v202 offset:30720
    ds_read_b128 v[188:191], v202 offset:31744
    s_waitcnt lgkmcnt(7)
    v_mfma_f32_16x16x32_bf16 v[32:35], v[160:163], v[128:131], v[32:35]
    v_mfma_f32_16x16x32_bf16 v[36:39], v[160:163], v[132:135], v[36:39]
    s_waitcnt lgkmcnt(6)
    v_mfma_f32_16x16x32_bf16 v[40:43], v[164:167], v[128:131], v[40:43]
    v_mfma_f32_16x16x32_bf16 v[44:47], v[164:167], v[132:135], v[44:47]
    s_waitcnt lgkmcnt(5)
    v_mfma_f32_16x16x32_bf16 v[48:51], v[168:171], v[128:131], v[48:51]
    v_mfma_f32_16x16x32_bf16 v[52:55], v[168:171], v[132:135], v[52:55]
    s_waitcnt lgkmcnt(4)
    v_mfma_f32_16x16x32_bf16 v[56:59], v[172:175], v[128:131], v[56:59]
    v_mfma_f32_16x16x32_bf16 v[60:63], v[172:175], v[132:135], v[60:63]
    s_waitcnt lgkmcnt(3)
    v_mfma_f32_16x16x32_bf16 v[64:67], v[176:179], v[128:131], v[64:67]
    v_mfma_f32_16x16x32_bf16 v[68:71], v[176:179], v[132:135], v[68:71]
    s_waitcnt lgkmcnt(2)
    v_mfma_f32_16x16x32_bf16 v[72:75], v[180:183], v[128:131], v[72:75]
    v_mfma_f32_16x16x32_bf16 v[76:79], v[180:183], v[132:135], v[76:79]
    s_waitcnt lgkmcnt(1)
    v_mfma_f32_16x16x32_bf16 v[80:83], v[184:187], v[128:131], v[80:83]
    v_mfma_f32_16x16x32_bf16 v[84:87], v[184:187], v[132:135], v[84:87]
    s_waitcnt lgkmcnt(0)
    v_mfma_f32_16x16x32_bf16 v[88:91], v[188:191], v[128:131], v[88:91]
    v_mfma_f32_16x16x32_bf16 v[92:95], v[188:191], v[132:135], v[92:95]
    s_branch L_lo_epi
L_lo_fbt0:
    v_max3_f32 v204, v96, v97, v98
    v_max3_f32 v204, v204, v99, v104
    v_max3_f32 v204, v204, v105, v106
    v_max_f32 v204, v204, v107
    v_max3_f32 v209, v100, v101, v102
    v_max3_f32 v209, v209, v103, v108
    v_max3_f32 v209, v209, v109, v110
    v_max_f32 v209, v209, v111
    v_mov_b32 v205, v204
    s_nop 1
    v_permlane32_swap_b32 v204, v205
    v_max_f32 v204, v204, v205
    v_mov_b32 v205, v204
    s_nop 1
    v_permlane16_swap_b32 v204, v205
    v_max_f32 v204, v204, v205
    v_mov_b32 v210, v209
    s_nop 1
    v_permlane32_swap_b32 v209, v210
    v_max_f32 v209, v209, v210
    v_mov_b32 v210, v209
    s_nop 1
    v_permlane16_swap_b32 v209, v210
    v_max_f32 v209, v209, v210
    v_max_f32 v204, 0, v204
    v_sub_f32 v205, 0, v204
    v_exp_f32 v205, v205
    v_max_f32 v209, 0, v209
    v_sub_f32 v210, 0, v209
    v_exp_f32 v210, v210
    v_sub_f32 v96, v96, v204
    v_sub_f32 v97, v97, v204
    v_sub_f32 v98, v98, v204
    v_sub_f32 v99, v99, v204
    v_sub_f32 v100, v100, v209
    v_sub_f32 v101, v101, v209
    v_sub_f32 v102, v102, v209
    v_sub_f32 v103, v103, v209
    v_sub_f32 v104, v104, v204
    v_sub_f32 v105, v105, v204
    v_sub_f32 v106, v106, v204
    v_sub_f32 v107, v107, v204
    v_sub_f32 v108, v108, v209
    v_sub_f32 v109, v109, v209
    v_sub_f32 v110, v110, v209
    v_sub_f32 v111, v111, v209
    v_sub_f32 v112, v112, v204
    v_sub_f32 v113, v113, v204
    v_sub_f32 v114, v114, v204
    v_sub_f32 v115, v115, v204
    v_sub_f32 v116, v116, v209
    v_sub_f32 v117, v117, v209
    v_sub_f32 v118, v118, v209
    v_sub_f32 v119, v119, v209
    v_sub_f32 v120, v120, v204
    v_sub_f32 v121, v121, v204
    v_sub_f32 v122, v122, v204
    v_sub_f32 v123, v123, v204
    v_sub_f32 v124, v124, v209
    v_sub_f32 v125, v125, v209
    v_sub_f32 v126, v126, v209
    v_sub_f32 v127, v127, v209
    v_sub_f32 v144, v144, v204
    v_sub_f32 v145, v145, v204
    v_sub_f32 v146, v146, v204
    v_sub_f32 v147, v147, v204
    v_sub_f32 v148, v148, v209
    v_sub_f32 v149, v149, v209
    v_sub_f32 v150, v150, v209
    v_sub_f32 v151, v151, v209
    v_sub_f32 v152, v152, v204
    v_sub_f32 v153, v153, v204
    v_sub_f32 v154, v154, v204
    v_sub_f32 v155, v155, v204
    v_sub_f32 v156, v156, v209
    v_sub_f32 v157, v157, v209
    v_sub_f32 v158, v158, v209
    v_sub_f32 v159, v159, v209
    v_mul_f32 v32, v205, v32
    v_mul_f32 v33, v205, v33
    v_mul_f32 v34, v205, v34
    v_mul_f32 v35, v205, v35
    v_mul_f32 v36, v210, v36
    v_mul_f32 v37, v210, v37
    v_mul_f32 v38, v210, v38
    v_mul_f32 v39, v210, v39
    v_mul_f32 v40, v205, v40
    v_mul_f32 v41, v205, v41
    v_mul_f32 v42, v205, v42
    v_mul_f32 v43, v205, v43
    v_mul_f32 v44, v210, v44
    v_mul_f32 v45, v210, v45
    v_mul_f32 v46, v210, v46
    v_mul_f32 v47, v210, v47
    v_mul_f32 v48, v205, v48
    v_mul_f32 v49, v205, v49
    v_mul_f32 v50, v205, v50
    v_mul_f32 v51, v205, v51
    v_mul_f32 v52, v210, v52
    v_mul_f32 v53, v210, v53
    v_mul_f32 v54, v210, v54
    v_mul_f32 v55, v210, v55
    v_mul_f32 v56, v205, v56
    v_mul_f32 v57, v205, v57
    v_mul_f32 v58, v205, v58
    v_mul_f32 v59, v205, v59
    v_mul_f32 v60, v210, v60
    v_mul_f32 v61, v210, v61
    v_mul_f32 v62, v210, v62
    v_mul_f32 v63, v210, v63
    v_mul_f32 v64, v205, v64
    v_mul_f32 v65, v205, v65
    v_mul_f32 v66, v205, v66
    v_mul_f32 v67, v205, v67
    v_mul_f32 v68, v210, v68
    v_mul_f32 v69, v210, v69
    v_mul_f32 v70, v210, v70
    v_mul_f32 v71, v210, v71
    v_mul_f32 v72, v205, v72
    v_mul_f32 v73, v205, v73
    v_mul_f32 v74, v205, v74
    v_mul_f32 v75, v205, v75
    v_mul_f32 v76, v210, v76
    v_mul_f32 v77, v210, v77
    v_mul_f32 v78, v210, v78
    v_mul_f32 v79, v210, v79
    v_mul_f32 v80, v205, v80
    v_mul_f32 v81, v205, v81
    v_mul_f32 v82, v205, v82
    v_mul_f32 v83, v205, v83
    v_mul_f32 v84, v210, v84
    v_mul_f32 v85, v210, v85
    v_mul_f32 v86, v210, v86
    v_mul_f32 v87, v210, v87
    v_mul_f32 v88, v205, v88
    v_mul_f32 v89, v205, v89
    v_mul_f32 v90, v205, v90
    v_mul_f32 v91, v205, v91
    v_mul_f32 v92, v210, v92
    v_mul_f32 v93, v210, v93
    v_mul_f32 v94, v210, v94
    v_mul_f32 v95, v210, v95
    v_mul_f32 v232, v205, v232
    v_mul_f32 v233, v205, v233
    v_mul_f32 v234, v205, v234
    v_mul_f32 v235, v205, v235
    v_mul_f32 v236, v210, v236
    v_mul_f32 v237, v210, v237
    v_mul_f32 v238, v210, v238
    v_mul_f32 v239, v210, v239
    v_mul_f32 v200, v205, v200
    v_mul_f32 v207, v210, v207
    v_exp_f32 v192, v96
    v_exp_f32 v193, v97
    v_exp_f32 v194, v98
    v_cvt_pk_bf16_f32 v128, v192, v193
    v_exp_f32 v195, v99
    v_exp_f32 v196, v104
    v_cvt_pk_bf16_f32 v129, v194, v195
    v_exp_f32 v197, v105
    v_exp_f32 v198, v106
    v_cvt_pk_bf16_f32 v130, v196, v197
    v_exp_f32 v199, v107
    v_exp_f32 v192, v100
    v_cvt_pk_bf16_f32 v131, v198, v199
    v_exp_f32 v193, v101
    v_exp_f32 v194, v102
    v_cvt_pk_bf16_f32 v132, v192, v193
    v_mfma_f32_16x16x32_bf16 v[224:227], v[220:223], v[128:131], v[232:235]
    v_exp_f32 v195, v103
    v_exp_f32 v196, v108
    v_cvt_pk_bf16_f32 v133, v194, v195
    v_exp_f32 v197, v109
    v_exp_f32 v198, v110
    v_cvt_pk_bf16_f32 v134, v196, v197
    v_exp_f32 v199, v111
    s_nop 0
    v_cvt_pk_bf16_f32 v135, v198, v199
    s_nop 1
    v_mfma_f32_16x16x32_bf16 v[228:231], v[220:223], v[132:135], v[236:239]
    s_branch L_lo_fbrt0
L_lo_tail1:
    s_waitcnt lgkmcnt(0)
    ds_read_b128 v[160:163], v202 offset:24576
    ds_read_b128 v[164:167], v202 offset:25600
    ds_read_b128 v[168:171], v202 offset:26624
    ds_read_b128 v[172:175], v202 offset:27648
    ds_read_b128 v[176:179], v202 offset:28672
    ds_read_b128 v[180:183], v202 offset:29696
    ds_read_b128 v[184:187], v202 offset:30720
    ds_read_b128 v[188:191], v202 offset:31744
    ds_read_b32 v253, v248
    s_add_u32 m0, m0, 4096
    s_add_u32 s77, s77, 4096
    buffer_load_dwordx4 v240, s[16:19], s77 offen offset:0 sc1 lds
    buffer_load_dwordx4 v240, s[16:19], s77 offen offset:1024 sc1 lds
    buffer_load_dwordx4 v240, s[16:19], s77 offen offset:2048 sc1 lds
    buffer_load_dwordx4 v240, s[16:19], s77 offen offset:3072 sc1 lds
    s_add_u32 s76, s76, 32768
    s_and_b32 s76, s76, 131071
    s_add_u32 s62, s62, 1
    s_add_u32 s55, s62, 4294967295
    v_mov_b32 v254, s55
    s_waitcnt vmcnt(8)
    ds_write_b32 v251, v254
    s_waitcnt lgkmcnt(9)
    v_mfma_f32_16x16x32_bf16 v[32:35], v[160:163], v[128:131], v[32:35]
    v_exp_f32 v192, v112
    v_exp_f32 v193, v113
    v_mfma_f32_16x16x32_bf16 v[36:39], v[160:163], v[132:135], v[36:39]
    v_exp_f32 v194, v114
    v_cvt_pk_bf16_f32 v136, v192, v193
    s_waitcnt lgkmcnt(8)
    v_mfma_f32_16x16x32_bf16 v[40:43], v[164:167], v[128:131], v[40:43]
    v_exp_f32 v195, v115
    v_exp_f32 v196, v120
    v_mfma_f32_16x16x32_bf16 v[44:47], v[164:167], v[132:135], v[44:47]
    v_cvt_pk_bf16_f32 v137, v194, v195
    s_waitcnt lgkmcnt(7)
    v_mfma_f32_16x16x32_bf16 v[48:51], v[168:171], v[128:131], v[48:51]
    v_exp_f32 v197, v121
    v_exp_f32 v198, v122
    v_mfma_f32_16x16x32_bf16 v[52:55], v[168:171], v[132:135], v[52:55]
    v_cvt_pk_bf16_f32 v138, v196, v197
    v_exp_f32 v199, v123
    s_waitcnt lgkmcnt(6)
    v_mfma_f32_16x16x32_bf16 v[56:59], v[172:175], v[128:131], v[56:59]
    v_exp_f32 v192, v116
    v_cvt_pk_bf16_f32 v139, v198, v199
    v_mfma_f32_16x16x32_bf16 v[60:63], v[172:175], v[132:135], v[60:63]
    v_exp_f32 v193, v117
    s_waitcnt lgkmcnt(5)
    v_mfma_f32_16x16x32_bf16 v[64:67], v[176:179], v[128:131], v[64:67]
    v_exp_f32 v194, v118
    v_cvt_pk_bf16_f32 v140, v192, v193
    v_mfma_f32_16x16x32_bf16 v[68:71], v[176:179], v[132:135], v[68:71]
    v_mfma_f32_16x16x32_bf16 v[232:235], v[220:223], v[136:139], v[224:227]
    v_exp_f32 v195, v119
    s_waitcnt lgkmcnt(4)
    v_mfma_f32_16x16x32_bf16 v[72:75], v[180:183], v[128:131], v[72:75]
    v_exp_f32 v196, v124
    v_cvt_pk_bf16_f32 v141, v194, v195
    v_mfma_f32_16x16x32_bf16 v[76:79], v[180:183], v[132:135], v[76:79]
    v_exp_f32 v197, v125
    s_waitcnt lgkmcnt(3)
    v_mfma_f32_16x16x32_bf16 v[80:83], v[184:187], v[128:131], v[80:83]
    v_exp_f32 v198, v126
    v_cvt_pk_bf16_f32 v142, v196, v197
    v_mfma_f32_16x16x32_bf16 v[84:87], v[184:187], v[132:135], v[84:87]
    v_exp_f32 v199, v127
    s_nop 0
    v_cvt_pk_bf16_f32 v143, v198, v199
    s_waitcnt lgkmcnt(2)
    v_mfma_f32_16x16x32_bf16 v[88:91], v[188:191], v[128:131], v[88:91]
    v_mfma_f32_16x16x32_bf16 v[236:239], v[220:223], v[140:143], v[228:231]
    s_nop 7
    v_max_f32 v204, v232, v236
    v_mfma_f32_16x16x32_bf16 v[92:95], v[188:191], v[132:135], v[92:95]
    v_cmp_nge_f32 vcc, s81, v204
    s_cbranch_vccnz L_lo_fbt1
L_lo_fbrt1:
    v_mov_b32 v200, v232
    s_nop 5
    v_mov_b32 v207, v236
    s_waitcnt lgkmcnt(1)
    v_cmp_gt_u32 vcc, s61, v253
    s_cbranch_vccnz L_lo_spT
L_lo_spT_r:
    v_add_u32 v202, 0x8000, v202
    v_and_b32 v202, 131071, v202
    s_add_u32 s61, s61, 1
    ds_read_b128 v[160:163], v202 offset:16384
    ds_read_b128 v[164:167], v202 offset:17408
    ds_read_b128 v[168:171], v202 offset:18432
    ds_read_b128 v[172:175], v202 offset:19456
    ds_read_b128 v[176:179], v202 offset:20480
    ds_read_b128 v[180:183], v202 offset:21504
    ds_read_b128 v[184:187], v202 offset:22528
    ds_read_b128 v[188:191], v202 offset:23552
    s_waitcnt lgkmcnt(7)
    v_mfma_f32_16x16x32_bf16 v[32:35], v[160:163], v[136:139], v[32:35]
    v_mfma_f32_16x16x32_bf16 v[36:39], v[160:163], v[140:143], v[36:39]
    s_waitcnt lgkmcnt(6)
    v_mfma_f32_16x16x32_bf16 v[40:43], v[164:167], v[136:139], v[40:43]
    v_mfma_f32_16x16x32_bf16 v[44:47], v[164:167], v[140:143], v[44:47]
    s_waitcnt lgkmcnt(5)
    v_mfma_f32_16x16x32_bf16 v[48:51], v[168:171], v[136:139], v[48:51]
    v_mfma_f32_16x16x32_bf16 v[52:55], v[168:171], v[140:143], v[52:55]
    s_waitcnt lgkmcnt(4)
    v_mfma_f32_16x16x32_bf16 v[56:59], v[172:175], v[136:139], v[56:59]
    v_mfma_f32_16x16x32_bf16 v[60:63], v[172:175], v[140:143], v[60:63]
    s_waitcnt lgkmcnt(3)
    v_mfma_f32_16x16x32_bf16 v[64:67], v[176:179], v[136:139], v[64:67]
    v_mfma_f32_16x16x32_bf16 v[68:71], v[176:179], v[140:143], v[68:71]
    s_waitcnt lgkmcnt(2)
    v_mfma_f32_16x16x32_bf16 v[72:75], v[180:183], v[136:139], v[72:75]
    v_mfma_f32_16x16x32_bf16 v[76:79], v[180:183], v[140:143], v[76:79]
    s_waitcnt lgkmcnt(1)
    v_mfma_f32_16x16x32_bf16 v[80:83], v[184:187], v[136:139], v[80:83]
    v_mfma_f32_16x16x32_bf16 v[84:87], v[184:187], v[140:143], v[84:87]
    s_waitcnt lgkmcnt(0)
    v_mfma_f32_16x16x32_bf16 v[88:91], v[188:191], v[136:139], v[88:91]
    v_mfma_f32_16x16x32_bf16 v[92:95], v[188:191], v[140:143], v[92:95]
    s_branch L_lo_epi
L_lo_fbt1:
    v_max3_f32 v204, v112, v113, v114
    v_max3_f32 v204, v204, v115, v120
    v_max3_f32 v204, v204, v121, v122
    v_max_f32 v204, v204, v123
    v_max3_f32 v209, v116, v117, v118
    v_max3_f32 v209, v209, v119, v124
    v_max3_f32 v209, v209, v125, v126
    v_max_f32 v209, v209, v127
    v_mov_b32 v205, v204
    s_nop 1
    v_permlane32_swap_b32 v204, v205
    v_max_f32 v204, v204, v205
    v_mov_b32 v205, v204
    s_nop 1
    v_permlane16_swap_b32 v204, v205
    v_max_f32 v204, v204, v205
    v_mov_b32 v210, v209
    s_nop 1
    v_permlane32_swap_b32 v209, v210
    v_max_f32 v209, v209, v210
    v_mov_b32 v210, v209
    s_nop 1
    v_permlane16_swap_b32 v209, v210
    v_max_f32 v209, v209, v210
    v_max_f32 v204, 0, v204
    v_sub_f32 v205, 0, v204
    v_exp_f32 v205, v205
    v_max_f32 v209, 0, v209
    v_sub_f32 v210, 0, v209
    v_exp_f32 v210, v210
    v_sub_f32 v112, v112, v204
    v_sub_f32 v113, v113, v204
    v_sub_f32 v114, v114, v204
    v_sub_f32 v115, v115, v204
    v_sub_f32 v116, v116, v209
    v_sub_f32 v117, v117, v209
    v_sub_f32 v118, v118, v209
    v_sub_f32 v119, v119, v209
    v_sub_f32 v120, v120, v204
    v_sub_f32 v121, v121, v204
    v_sub_f32 v122, v122, v204
    v_sub_f32 v123, v123, v204
    v_sub_f32 v124, v124, v209
    v_sub_f32 v125, v125, v209
    v_sub_f32 v126, v126, v209
    v_sub_f32 v127, v127, v209
    v_sub_f32 v96, v96, v204
    v_sub_f32 v97, v97, v204
    v_sub_f32 v98, v98, v204
    v_sub_f32 v99, v99, v204
    v_sub_f32 v100, v100, v209
    v_sub_f32 v101, v101, v209
    v_sub_f32 v102, v102, v209
    v_sub_f32 v103, v103, v209
    v_sub_f32 v104, v104, v204
    v_sub_f32 v105, v105, v204
    v_sub_f32 v106, v106, v204
    v_sub_f32 v107, v107, v204
    v_sub_f32 v108, v108, v209
    v_sub_f32 v109, v109, v209
    v_sub_f32 v110, v110, v209
    v_sub_f32 v111, v111, v209
    v_sub_f32 v144, v144, v204
    v_sub_f32 v145, v145, v204
    v_sub_f32 v146, v146, v204
    v_sub_f32 v147, v147, v204
    v_sub_f32 v148, v148, v209
    v_sub_f32 v149, v149, v209
    v_sub_f32 v150, v150, v209
    v_sub_f32 v151, v151, v209
    v_sub_f32 v152, v152, v204
    v_sub_f32 v153, v153, v204
    v_sub_f32 v154, v154, v204
    v_sub_f32 v155, v155, v204
    v_sub_f32 v156, v156, v209
    v_sub_f32 v157, v157, v209
    v_sub_f32 v158, v158, v209
    v_sub_f32 v159, v159, v209
    v_mul_f32 v32, v205, v32
    v_mul_f32 v33, v205, v33
    v_mul_f32 v34, v205, v34
    v_mul_f32 v35, v205, v35
    v_mul_f32 v36, v210, v36
    v_mul_f32 v37, v210, v37
    v_mul_f32 v38, v210, v38
    v_mul_f32 v39, v210, v39
    v_mul_f32 v40, v205, v40
    v_mul_f32 v41, v205, v41
    v_mul_f32 v42, v205, v42
    v_mul_f32 v43, v205, v43
    v_mul_f32 v44, v210, v44
    v_mul_f32 v45, v210, v45
    v_mul_f32 v46, v210, v46
    v_mul_f32 v47, v210, v47
    v_mul_f32 v48, v205, v48
    v_mul_f32 v49, v205, v49
    v_mul_f32 v50, v205, v50
    v_mul_f32 v51, v205, v51
    v_mul_f32 v52, v210, v52
    v_mul_f32 v53, v210, v53
    v_mul_f32 v54, v210, v54
    v_mul_f32 v55, v210, v55
    v_mul_f32 v56, v205, v56
    v_mul_f32 v57, v205, v57
    v_mul_f32 v58, v205, v58
    v_mul_f32 v59, v205, v59
    v_mul_f32 v60, v210, v60
    v_mul_f32 v61, v210, v61
    v_mul_f32 v62, v210, v62
    v_mul_f32 v63, v210, v63
    v_mul_f32 v64, v205, v64
    v_mul_f32 v65, v205, v65
    v_mul_f32 v66, v205, v66
    v_mul_f32 v67, v205, v67
    v_mul_f32 v68, v210, v68
    v_mul_f32 v69, v210, v69
    v_mul_f32 v70, v210, v70
    v_mul_f32 v71, v210, v71
    v_mul_f32 v72, v205, v72
    v_mul_f32 v73, v205, v73
    v_mul_f32 v74, v205, v74
    v_mul_f32 v75, v205, v75
    v_mul_f32 v76, v210, v76
    v_mul_f32 v77, v210, v77
    v_mul_f32 v78, v210, v78
    v_mul_f32 v79, v210, v79
    v_mul_f32 v80, v205, v80
    v_mul_f32 v81, v205, v81
    v_mul_f32 v82, v205, v82
    v_mul_f32 v83, v205, v83
    v_mul_f32 v84, v210, v84
    v_mul_f32 v85, v210, v85
    v_mul_f32 v86, v210, v86
    v_mul_f32 v87, v210, v87
    v_mul_f32 v88, v205, v88
    v_mul_f32 v89, v205, v89
    v_mul_f32 v90, v205, v90
    v_mul_f32 v91, v205, v91
    v_mul_f32 v92, v210, v92
    v_mul_f32 v93, v210, v93
    v_mul_f32 v94, v210, v94
    v_mul_f32 v95, v210, v95
    v_mul_f32 v224, v205, v224
    v_mul_f32 v225, v205, v225
    v_mul_f32 v226, v205, v226
    v_mul_f32 v227, v205, v227
    v_mul_f32 v228, v210, v228
    v_mul_f32 v229, v210, v229
    v_mul_f32 v230, v210, v230
    v_mul_f32 v231, v210, v231
    v_mul_f32 v200, v205, v200
    v_mul_f32 v207, v210, v207
    v_exp_f32 v192, v112
    v_exp_f32 v193, v113
    v_exp_f32 v194, v114
    v_cvt_pk_bf16_f32 v136, v192, v193
    v_exp_f32 v195, v115
    v_exp_f32 v196, v120
    v_cvt_pk_bf16_f32 v137, v194, v195
    v_exp_f32 v197, v121
    v_exp_f32 v198, v122
    v_cvt_pk_bf16_f32 v138, v196, v197
    v_exp_f32 v199, v123
    v_exp_f32 v192, v116
    v_cvt_pk_bf16_f32 v139, v198, v199
    v_exp_f32 v193, v117
    v_exp_f32 v194, v118
    v_cvt_pk_bf16_f32 v140, v192, v193
    v_mfma_f32_16x16x32_bf16 v[232:235], v[220:223], v[136:139], v[224:227]
    v_exp_f32 v195, v119
    v_exp_f32 v196, v124
    v_cvt_pk_bf16_f32 v141, v194, v195
    v_exp_f32 v197, v125
    v_exp_f32 v198, v126
    v_cvt_pk_bf16_f32 v142, v196, v197
    v_exp_f32 v199, v127
    s_nop 0
    v_cvt_pk_bf16_f32 v143, v198, v199
    s_nop 1
    v_mfma_f32_16x16x32_bf16 v[236:239], v[220:223], v[140:143], v[228:231]
    s_branch L_lo_fbrt1
L_lo_spF:
    s_mov_b32 s56, 4194304
L_lo_spF_l:
    ds_read_b32 v253, v250
    s_waitcnt lgkmcnt(0)
    v_cmp_gt_u32 vcc, s57, v253
    s_cbranch_vccz L_lo_spF_r
    s_sleep 1
    s_sub_u32 s56, s56, 1
    s_cmp_lg_u32 s56, 0
    s_cbranch_scc1 L_lo_spF_l
    s_branch L_lo_spF_r
L_lo_spU:
    s_mov_b32 s56, 4194304
L_lo_spU_l:
    ds_read_b32 v253, v248
    s_waitcnt lgkmcnt(0)
    v_cmp_gt_u32 vcc, s61, v253
    s_cbranch_vccz L_lo_spU_r
    s_sleep 1
    s_sub_u32 s56, s56, 1
    s_cmp_lg_u32 s56, 0
    s_cbranch_scc1 L_lo_spU_l
    s_branch L_lo_spU_r
L_lo_spT:
    s_mov_b32 s56, 4194304
L_lo_spT_l:
    ds_read_b32 v253, v248
    s_waitcnt lgkmcnt(0)
    v_cmp_gt_u32 vcc, s61, v253
    s_cbranch_vccz L_lo_spT_r
    s_sleep 1
    s_sub_u32 s56, s56, 1
    s_cmp_lg_u32 s56, 0
    s_cbranch_scc1 L_lo_spT_l
    s_branch L_lo_spT_r
L_lo_epi:
    s_setprio 0
    v_mov_b32 v252, 2147483647
    ds_write_b32 v249, v252
    s_cmp_gt_u32 s62, s63
    s_cbranch_scc1 L_lo_ld1_skip
    ds_read_b32 v253, v250
    s_sub_u32 s57, s62, 3
    s_waitcnt lgkmcnt(0)
    v_cmp_gt_u32 vcc, s57, v253
    s_cbranch_vccnz L_lo_ld1
L_lo_ld1_r:
    s_lshl_b32 s77, s78, 13
    s_add_u32 s77, s77, s80
    s_cmp_le_u32 s78, s79
    s_cselect_b32 s77, s77, 2130706432
    s_add_u32 m0, s76, s82
    s_add_u32 s78, s78, 2
    buffer_load_dwordx4 v240, s[16:19], s77 offen offset:0 sc1 lds
    buffer_load_dwordx4 v240, s[16:19], s77 offen offset:1024 sc1 lds
    ds_read_b32 v253, v250
    s_waitcnt lgkmcnt(0)
    buffer_load_dwordx4 v240, s[16:19], s77 offen offset:2048 sc1 lds
    buffer_load_dwordx4 v240, s[16:19], s77 offen offset:3072 sc1 lds
    ds_read_b32 v253, v250
    s_waitcnt lgkmcnt(0)
    s_add_u32 m0, m0, 4096
    s_add_u32 s77, s77, 4096
    buffer_load_dwordx4 v240, s[16:19], s77 offen offset:0 sc1 lds
    buffer_load_dwordx4 v240, s[16:19], s77 offen offset:1024 sc1 lds
    ds_read_b32 v253, v250
    s_waitcnt lgkmcnt(0)
    buffer_load_dwordx4 v240, s[16:19], s77 offen offset:2048 sc1 lds
    buffer_load_dwordx4 v240, s[16:19], s77 offen offset:3072 sc1 lds
    s_add_u32 s76, s76, 32768
    s_and_b32 s76, s76, 131071
    s_add_u32 s62, s62, 1
    s_add_u32 s55, s62, 4294967295
    v_mov_b32 v254, s55
    s_waitcnt vmcnt(8)
    ds_write_b32 v251, v254
L_lo_ld1_skip:
    v_rcp_f32 v200, v200
    v_rcp_f32 v207, v207
    s_lshr_b32 s55, s72, 6
    s_lshl_b32 s55, s55, 19
    s_lshl_b32 s56, s70, 14
    s_add_u32 s55, s55, s56
    s_and_b32 s56, s72, 32
    s_lshl_b32 s56, s56, 6
    s_add_u32 s55, s55, s56
    s_add_u32 s67, s55, 33554432
    v_mul_f32 v32, v200, v32
    v_mul_f32 v33, v200, v33
    v_mul_f32 v34, v200, v34
    v_mul_f32 v35, v200, v35
    v_mul_f32 v36, v207, v36
    v_mul_f32 v37, v207, v37
    v_mul_f32 v38, v207, v38
    v_mul_f32 v39, v207, v39
    v_mul_f32 v40, v200, v40
    v_mul_f32 v41, v200, v41
    v_mul_f32 v42, v200, v42
    v_mul_f32 v43, v200, v43
    v_mul_f32 v44, v207, v44
    v_mul_f32 v45, v207, v45
    v_mul_f32 v46, v207, v46
    v_mul_f32 v47, v207, v47
    v_cvt_pk_bf16_f32 v96, v32, v33
    v_cvt_pk_bf16_f32 v97, v34, v35
    v_cvt_pk_bf16_f32 v98, v40, v41
    v_cvt_pk_bf16_f32 v99, v42, v43
    v_cvt_pk_bf16_f32 v100, v36, v37
    v_cvt_pk_bf16_f32 v101, v38, v39
    v_cvt_pk_bf16_f32 v102, v44, v45
    v_cvt_pk_bf16_f32 v103, v46, v47
    buffer_store_dwordx4 v[96:99], v240, s[16:19], s67 offen offset:0 sc1
    buffer_store_dwordx4 v[100:103], v240, s[16:19], s67 offen offset:1024 sc1
    s_add_u32 s67, s67, 4096
    v_mul_f32 v48, v200, v48
    v_mul_f32 v49, v200, v49
    v_mul_f32 v50, v200, v50
    v_mul_f32 v51, v200, v51
    v_mul_f32 v52, v207, v52
    v_mul_f32 v53, v207, v53
    v_mul_f32 v54, v207, v54
    v_mul_f32 v55, v207, v55
    v_mul_f32 v56, v200, v56
    v_mul_f32 v57, v200, v57
    v_mul_f32 v58, v200, v58
    v_mul_f32 v59, v200, v59
    v_mul_f32 v60, v207, v60
    v_mul_f32 v61, v207, v61
    v_mul_f32 v62, v207, v62
    v_mul_f32 v63, v207, v63
    v_cvt_pk_bf16_f32 v104, v48, v49
    v_cvt_pk_bf16_f32 v105, v50, v51
    v_cvt_pk_bf16_f32 v106, v56, v57
    v_cvt_pk_bf16_f32 v107, v58, v59
    v_cvt_pk_bf16_f32 v108, v52, v53
    v_cvt_pk_bf16_f32 v109, v54, v55
    v_cvt_pk_bf16_f32 v110, v60, v61
    v_cvt_pk_bf16_f32 v111, v62, v63
    buffer_store_dwordx4 v[104:107], v240, s[16:19], s67 offen offset:0 sc1
    buffer_store_dwordx4 v[108:111], v240, s[16:19], s67 offen offset:1024 sc1
    s_add_u32 s67, s67, 4096
    s_cmp_gt_u32 s62, s63
    s_cbranch_scc1 L_lo_ld2_skip
    ds_read_b32 v253, v250
    s_sub_u32 s57, s62, 3
    s_waitcnt lgkmcnt(0)
    v_cmp_gt_u32 vcc, s57, v253
    s_cbranch_vccnz L_lo_ld2
L_lo_ld2_r:
    s_lshl_b32 s77, s78, 13
    s_add_u32 s77, s77, s80
    s_cmp_le_u32 s78, s79
    s_cselect_b32 s77, s77, 2130706432
    s_add_u32 m0, s76, s82
    s_add_u32 s78, s78, 2
    buffer_load_dwordx4 v240, s[16:19], s77 offen offset:0 sc1 lds
    buffer_load_dwordx4 v240, s[16:19], s77 offen offset:1024 sc1 lds
    ds_read_b32 v253, v250
    s_waitcnt lgkmcnt(0)
    buffer_load_dwordx4 v240, s[16:19], s77 offen offset:2048 sc1 lds
    buffer_load_dwordx4 v240, s[16:19], s77 offen offset:3072 sc1 lds
    ds_read_b32 v253, v250
    s_waitcnt lgkmcnt(0)
    s_add_u32 m0, m0, 4096
    s_add_u32 s77, s77, 4096
    buffer_load_dwordx4 v240, s[16:19], s77 offen offset:0 sc1 lds
    buffer_load_dwordx4 v240, s[16:19], s77 offen offset:1024 sc1 lds
    ds_read_b32 v253, v250
    s_waitcnt lgkmcnt(0)
    buffer_load_dwordx4 v240, s[16:19], s77 offen offset:2048 sc1 lds
    buffer_load_dwordx4 v240, s[16:19], s77 offen offset:3072 sc1 lds
    s_add_u32 s76, s76, 32768
    s_and_b32 s76, s76, 131071
    s_add_u32 s62, s62, 1
    s_add_u32 s55, s62, 4294967295
    v_mov_b32 v254, s55
    s_waitcnt vmcnt(12)
    ds_write_b32 v251, v254
L_lo_ld2_skip:
    v_mul_f32 v64, v200, v64
    v_mul_f32 v65, v200, v65
    v_mul_f32 v66, v200, v66
    v_mul_f32 v67, v200, v67
    v_mul_f32 v68, v207, v68
    v_mul_f32 v69, v207, v69
    v_mul_f32 v70, v207, v70
    v_mul_f32 v71, v207, v71
    v_mul_f32 v72, v200, v72
    v_mul_f32 v73, v200, v73
    v_mul_f32 v74, v200, v74
    v_mul_f32 v75, v200, v75
    v_mul_f32 v76, v207, v76
    v_mul_f32 v77, v207, v77
    v_mul_f32 v78, v207, v78
    v_mul_f32 v79, v207, v79
    v_cvt_pk_bf16_f32 v112, v64, v65
    v_cvt_pk_bf16_f32 v113, v66, v67
    v_cvt_pk_bf16_f32 v114, v72, v73
    v_cvt_pk_bf16_f32 v115, v74, v75
    v_cvt_pk_bf16_f32 v116, v68, v69
    v_cvt_pk_bf16_f32 v117, v70, v71
    v_cvt_pk_bf16_f32 v118, v76, v77
    v_cvt_pk_bf16_f32 v119, v78, v79
    buffer_store_dwordx4 v[112:115], v240, s[16:19], s67 offen offset:0 sc1
    buffer_store_dwordx4 v[116:119], v240, s[16:19], s67 offen offset:1024 sc1
    s_add_u32 s67, s67, 4096
    v_mul_f32 v80, v200, v80
    v_mul_f32 v81, v200, v81
    v_mul_f32 v82, v200, v82
    v_mul_f32 v83, v200, v83
    v_mul_f32 v84, v207, v84
    v_mul_f32 v85, v207, v85
    v_mul_f32 v86, v207, v86
    v_mul_f32 v87, v207, v87
    v_mul_f32 v88, v200, v88
    v_mul_f32 v89, v200, v89
    v_mul_f32 v90, v200, v90
    v_mul_f32 v91, v200, v91
    v_mul_f32 v92, v207, v92
    v_mul_f32 v93, v207, v93
    v_mul_f32 v94, v207, v94
    v_mul_f32 v95, v207, v95
    v_cvt_pk_bf16_f32 v120, v80, v81
    v_cvt_pk_bf16_f32 v121, v82, v83
    v_cvt_pk_bf16_f32 v122, v88, v89
    v_cvt_pk_bf16_f32 v123, v90, v91
    v_cvt_pk_bf16_f32 v124, v84, v85
    v_cvt_pk_bf16_f32 v125, v86, v87
    v_cvt_pk_bf16_f32 v126, v92, v93
    v_cvt_pk_bf16_f32 v127, v94, v95
    buffer_store_dwordx4 v[120:123], v240, s[16:19], s67 offen offset:0 sc1
    buffer_store_dwordx4 v[124:127], v240, s[16:19], s67 offen offset:1024 sc1
    s_mov_b32 s83, s2
    v_lshrrev_b32 v245, 1, v240
    v_min_u32 v245, 112, v245
    s_lshr_b32 s55, s83, 4
    s_lshl_b32 s55, s55, 7
    s_add_u32 s55, s55, 73404416
    buffer_load_dwordx2 v[0:1], v245, s[16:19], s55 offen sc1
    s_lshr_b32 s55, s83, 2
    s_max_u32 s55, s55, 1
    s_sub_u32 s55, s55, 1
    s_lshr_b32 s55, s55, 2
    s_lshl_b32 s55, s55, 7
    s_add_u32 s55, s55, 73404416
    buffer_load_dwordx2 v[2:3], v245, s[16:19], s55 offen sc1
    s_lshl_b32 s4, s2, 2
    s_add_u32 s4, s4, s54
    s_sub_u32 s4, s4, 132
    s_sub_u32 s55, s71, 1
    s_cmp_ge_u32 s55, 4
    s_cbranch_scc1 L_lo_nort
    s_add_u32 s55, s4, 0
    s_mul_i32 s5, s55, 6554
    s_lshr_b32 s5, s5, 16
    s_mul_i32 s56, s5, 10
    s_sub_u32 s6, s55, s56
    v_bfe_u32 v242, v241, 3, 3
    v_mul_u32_u24 v242, 1280, v242
    v_bfe_u32 v243, v241, 0, 3
    v_lshl_add_u32 v242, v243, 4, v242
    v_add_u32 v32, 0, v242
    v_add_u32 v33, 9216, v242
    v_add_u32 v34, 18432, v242
    v_add_u32 v35, 27648, v242
    s_mov_b32 m0, s66
    s_mul_i32 s55, s5, 40960
    s_lshl_b32 s56, s6, 7
    s_add_u32 s55, s55, s56
    s_cmp_ge_u32 s5, 128
    s_cbranch_scc1 L_rt0_b
    buffer_load_dwordx4 v32, s[36:39], s55 offen offset:0  lds
    buffer_load_dwordx4 v33, s[36:39], s55 offen offset:1024  lds
    buffer_load_dwordx4 v34, s[36:39], s55 offen offset:2048  lds
    buffer_load_dwordx4 v35, s[36:39], s55 offen offset:3072  lds
    s_branch L_rt0_j
L_rt0_b:
    s_sub_u32 s55, s55, 5242880
    buffer_load_dwordx4 v32, s[40:43], s55 offen offset:0 lds
    buffer_load_dwordx4 v33, s[40:43], s55 offen offset:1024 lds
    buffer_load_dwordx4 v34, s[40:43], s55 offen offset:2048 lds
    buffer_load_dwordx4 v35, s[40:43], s55 offen offset:3072 lds
L_rt0_j:
    s_cmp_gt_u32 s62, s63
    s_cbranch_scc1 L_lo_ld3_skip
    ds_read_b32 v253, v250
    s_sub_u32 s57, s62, 3
    s_waitcnt lgkmcnt(0)
    v_cmp_gt_u32 vcc, s57, v253
    s_cbranch_vccnz L_lo_ld3
L_lo_ld3_r:
    s_lshl_b32 s77, s78, 13
    s_add_u32 s77, s77, s80
    s_cmp_le_u32 s78, s79
    s_cselect_b32 s77, s77, 2130706432
    s_add_u32 m0, s76, s82
    s_add_u32 s78, s78, 2
    buffer_load_dwordx4 v240, s[16:19], s77 offen offset:0 sc1 lds
    buffer_load_dwordx4 v240, s[16:19], s77 offen offset:1024 sc1 lds
    ds_read_b32 v253, v250
    s_waitcnt lgkmcnt(0)
    buffer_load_dwordx4 v240, s[16:19], s77 offen offset:2048 sc1 lds
    buffer_load_dwordx4 v240, s[16:19], s77 offen offset:3072 sc1 lds
    ds_read_b32 v253, v250
    s_waitcnt lgkmcnt(0)
    s_add_u32 m0, m0, 4096
    s_add_u32 s77, s77, 4096
    buffer_load_dwordx4 v240, s[16:19], s77 offen offset:0 sc1 lds
    buffer_load_dwordx4 v240, s[16:19], s77 offen offset:1024 sc1 lds
    ds_read_b32 v253, v250
    s_waitcnt lgkmcnt(0)
    buffer_load_dwordx4 v240, s[16:19], s77 offen offset:2048 sc1 lds
    buffer_load_dwordx4 v240, s[16:19], s77 offen offset:3072 sc1 lds
    s_add_u32 s76, s76, 32768
    s_and_b32 s76, s76, 131071
    s_add_u32 s62, s62, 1
    s_add_u32 s55, s62, 4294967295
    v_mov_b32 v254, s55
    s_waitcnt vmcnt(18)
    ds_write_b32 v251, v254
L_lo_ld3_skip:
    v_bfe_u32 v242, v241, 2, 2
    v_bfe_u32 v243, v241, 0, 2
    v_lshlrev_b32 v243, 3, v243
    v_lshl_add_u32 v242, v242, 7, v243
    v_add_u32 v242, s66, v242
    s_waitcnt vmcnt(0)
    s_cmp_ge_u32 s5, 128
    s_cbranch_scc1 L_rt0_b2
    v_bfe_u32 v243, v241, 4, 2
    v_lshl_add_u32 v36, v243, 9, v242
    s_mul_i32 s58, s5, 5120
    s_add_u32 s58, s58, 62914560
    ds_read_b64_tr_b16 v[40:41], v36 offset:0
    ds_read_b64_tr_b16 v[42:43], v36 offset:2048
    ds_read_b64_tr_b16 v[44:45], v36 offset:32
    ds_read_b64_tr_b16 v[46:47], v36 offset:2080
    ds_read_b64_tr_b16 v[48:49], v36 offset:64
    ds_read_b64_tr_b16 v[50:51], v36 offset:2112
    ds_read_b64_tr_b16 v[52:53], v36 offset:96
    ds_read_b64_tr_b16 v[54:55], v36 offset:2144
    s_lshl_b32 s55, s6, 2
    s_add_u32 s55, s55, 0
    s_mul_i32 s56, s55, 205
    s_lshr_b32 s56, s56, 10
    s_mul_i32 s57, s56, 5
    s_sub_u32 s55, s55, s57
    s_lshl_b32 s55, s55, 10
    s_mul_i32 s56, s56, 655360
    s_add_u32 s55, s55, s56
    s_add_u32 s55, s55, s58
    s_waitcnt lgkmcnt(6)
    buffer_store_dwordx4 v[40:43], v240, s[16:19], s55 offen sc1
    s_lshl_b32 s55, s6, 2
    s_add_u32 s55, s55, 1
    s_mul_i32 s56, s55, 205
    s_lshr_b32 s56, s56, 10
    s_mul_i32 s57, s56, 5
    s_sub_u32 s55, s55, s57
    s_lshl_b32 s55, s55, 10
    s_mul_i32 s56, s56, 655360
    s_add_u32 s55, s55, s56
    s_add_u32 s55, s55, s58
    s_waitcnt lgkmcnt(4)
    buffer_store_dwordx4 v[44:47], v240, s[16:19], s55 offen sc1
    s_lshl_b32 s55, s6, 2
    s_add_u32 s55, s55, 2
    s_mul_i32 s56, s55, 205
    s_lshr_b32 s56, s56, 10
    s_mul_i32 s57, s56, 5
    s_sub_u32 s55, s55, s57
    s_lshl_b32 s55, s55, 10
    s_mul_i32 s56, s56, 655360
    s_add_u32 s55, s55, s56
    s_add_u32 s55, s55, s58
    s_waitcnt lgkmcnt(2)
    buffer_store_dwordx4 v[48:51], v240, s[16:19], s55 offen sc1
    s_lshl_b32 s55, s6, 2
    s_add_u32 s55, s55, 3
    s_mul_i32 s56, s55, 205
    s_lshr_b32 s56, s56, 10
    s_mul_i32 s57, s56, 5
    s_sub_u32 s55, s55, s57
    s_lshl_b32 s55, s55, 10
    s_mul_i32 s56, s56, 655360
    s_add_u32 s55, s55, s56
    s_add_u32 s55, s55, s58
    s_waitcnt lgkmcnt(0)
    buffer_store_dwordx4 v[52:55], v240, s[16:19], s55 offen sc1
    s_branch L_rt0_j2
L_rt0_b2:
    v_bfe_u32 v243, v241, 4, 2
    v_lshl_add_u32 v36, v243, 10, v242
    s_sub_u32 s58, s5, 128
    s_mul_i32 s58, s58, 5120
    s_add_u32 s58, s58, 69206016
    s_cmp_lt_u32 s5, 148
    s_cselect_b32 s58, s58, 2130706432
    ds_read_b64_tr_b16 v[40:41], v36 offset:0
    ds_read_b64_tr_b16 v[42:43], v36 offset:512
    ds_read_b64_tr_b16 v[44:45], v36 offset:32
    ds_read_b64_tr_b16 v[46:47], v36 offset:544
    ds_read_b64_tr_b16 v[48:49], v36 offset:64
    ds_read_b64_tr_b16 v[50:51], v36 offset:576
    ds_read_b64_tr_b16 v[52:53], v36 offset:96
    ds_read_b64_tr_b16 v[54:55], v36 offset:608
    s_lshl_b32 s55, s6, 2
    s_add_u32 s55, s55, 0
    s_mul_i32 s56, s55, 205
    s_lshr_b32 s56, s56, 10
    s_mul_i32 s57, s56, 5
    s_sub_u32 s55, s55, s57
    s_lshl_b32 s55, s55, 10
    s_mul_i32 s56, s56, 102400
    s_add_u32 s55, s55, s56
    s_add_u32 s55, s55, s58
    s_waitcnt lgkmcnt(6)
    buffer_store_dwordx4 v[40:43], v240, s[16:19], s55 offen sc1
    s_lshl_b32 s55, s6, 2
    s_add_u32 s55, s55, 1
    s_mul_i32 s56, s55, 205
    s_lshr_b32 s56, s56, 10
    s_mul_i32 s57, s56, 5
    s_sub_u32 s55, s55, s57
    s_lshl_b32 s55, s55, 10
    s_mul_i32 s56, s56, 102400
    s_add_u32 s55, s55, s56
    s_add_u32 s55, s55, s58
    s_waitcnt lgkmcnt(4)
    buffer_store_dwordx4 v[44:47], v240, s[16:19], s55 offen sc1
    s_lshl_b32 s55, s6, 2
    s_add_u32 s55, s55, 2
    s_mul_i32 s56, s55, 205
    s_lshr_b32 s56, s56, 10
    s_mul_i32 s57, s56, 5
    s_sub_u32 s55, s55, s57
    s_lshl_b32 s55, s55, 10
    s_mul_i32 s56, s56, 102400
    s_add_u32 s55, s55, s56
    s_add_u32 s55, s55, s58
    s_waitcnt lgkmcnt(2)
    buffer_store_dwordx4 v[48:51], v240, s[16:19], s55 offen sc1
    s_lshl_b32 s55, s6, 2
    s_add_u32 s55, s55, 3
    s_mul_i32 s56, s55, 205
    s_lshr_b32 s56, s56, 10
    s_mul_i32 s57, s56, 5
    s_sub_u32 s55, s55, s57
    s_lshl_b32 s55, s55, 10
    s_mul_i32 s56, s56, 102400
    s_add_u32 s55, s55, s56
    s_add_u32 s55, s55, s58
    s_waitcnt lgkmcnt(0)
    buffer_store_dwordx4 v[52:55], v240, s[16:19], s55 offen sc1
L_rt0_j2:
    s_add_u32 s55, s4, 512
    s_mul_i32 s5, s55, 6554
    s_lshr_b32 s5, s5, 16
    s_mul_i32 s56, s5, 10
    s_sub_u32 s6, s55, s56
    v_bfe_u32 v242, v241, 3, 3
    v_mul_u32_u24 v242, 1280, v242
    v_bfe_u32 v243, v241, 0, 3
    v_lshl_add_u32 v242, v243, 4, v242
    v_add_u32 v32, 0, v242
    v_add_u32 v33, 9216, v242
    v_add_u32 v34, 18432, v242
    v_add_u32 v35, 27648, v242
    s_mov_b32 m0, s66
    s_mul_i32 s55, s5, 40960
    s_lshl_b32 s56, s6, 7
    s_add_u32 s55, s55, s56
    s_cmp_ge_u32 s5, 128
    s_cbranch_scc1 L_rt1_b
    buffer_load_dwordx4 v32, s[36:39], s55 offen offset:0  lds
    buffer_load_dwordx4 v33, s[36:39], s55 offen offset:1024  lds
    buffer_load_dwordx4 v34, s[36:39], s55 offen offset:2048  lds
    buffer_load_dwordx4 v35, s[36:39], s55 offen offset:3072  lds
    s_branch L_rt1_j
L_rt1_b:
    s_sub_u32 s55, s55, 5242880
    buffer_load_dwordx4 v32, s[40:43], s55 offen offset:0 lds
    buffer_load_dwordx4 v33, s[40:43], s55 offen offset:1024 lds
    buffer_load_dwordx4 v34, s[40:43], s55 offen offset:2048 lds
    buffer_load_dwordx4 v35, s[40:43], s55 offen offset:3072 lds
L_rt1_j:
    s_cmp_gt_u32 s62, s63
    s_cbranch_scc1 L_lo_ld4_skip
    ds_read_b32 v253, v250
    s_sub_u32 s57, s62, 3
    s_waitcnt lgkmcnt(0)
    v_cmp_gt_u32 vcc, s57, v253
    s_cbranch_vccnz L_lo_ld4
L_lo_ld4_r:
    s_lshl_b32 s77, s78, 13
    s_add_u32 s77, s77, s80
    s_cmp_le_u32 s78, s79
    s_cselect_b32 s77, s77, 2130706432
    s_add_u32 m0, s76, s82
    s_add_u32 s78, s78, 2
    buffer_load_dwordx4 v240, s[16:19], s77 offen offset:0 sc1 lds
    buffer_load_dwordx4 v240, s[16:19], s77 offen offset:1024 sc1 lds
    ds_read_b32 v253, v250
    s_waitcnt lgkmcnt(0)
    buffer_load_dwordx4 v240, s[16:19], s77 offen offset:2048 sc1 lds
    buffer_load_dwordx4 v240, s[16:19], s77 offen offset:3072 sc1 lds
    ds_read_b32 v253, v250
    s_waitcnt lgkmcnt(0)
    s_add_u32 m0, m0, 4096
    s_add_u32 s77, s77, 4096
    buffer_load_dwordx4 v240, s[16:19], s77 offen offset:0 sc1 lds
    buffer_load_dwordx4 v240, s[16:19], s77 offen offset:1024 sc1 lds
    ds_read_b32 v253, v250
    s_waitcnt lgkmcnt(0)
    buffer_load_dwordx4 v240, s[16:19], s77 offen offset:2048 sc1 lds
    buffer_load_dwordx4 v240, s[16:19], s77 offen offset:3072 sc1 lds
    s_add_u32 s76, s76, 32768
    s_and_b32 s76, s76, 131071
    s_add_u32 s62, s62, 1
    s_add_u32 s55, s62, 4294967295
    v_mov_b32 v254, s55
    ds_write_b32 v251, v254
L_lo_ld4_skip:
    v_bfe_u32 v242, v241, 2, 2
    v_bfe_u32 v243, v241, 0, 2
    v_lshlrev_b32 v243, 3, v243
    v_lshl_add_u32 v242, v242, 7, v243
    v_add_u32 v242, s66, v242
    s_waitcnt vmcnt(0)
    s_cmp_ge_u32 s5, 128
    s_cbranch_scc1 L_rt1_b2
    v_bfe_u32 v243, v241, 4, 2
    v_lshl_add_u32 v36, v243, 9, v242
    s_mul_i32 s58, s5, 5120
    s_add_u32 s58, s58, 62914560
    ds_read_b64_tr_b16 v[40:41], v36 offset:0
    ds_read_b64_tr_b16 v[42:43], v36 offset:2048
    ds_read_b64_tr_b16 v[44:45], v36 offset:32
    ds_read_b64_tr_b16 v[46:47], v36 offset:2080
    ds_read_b64_tr_b16 v[48:49], v36 offset:64
    ds_read_b64_tr_b16 v[50:51], v36 offset:2112
    ds_read_b64_tr_b16 v[52:53], v36 offset:96
    ds_read_b64_tr_b16 v[54:55], v36 offset:2144
    s_lshl_b32 s55, s6, 2
    s_add_u32 s55, s55, 0
    s_mul_i32 s56, s55, 205
    s_lshr_b32 s56, s56, 10
    s_mul_i32 s57, s56, 5
    s_sub_u32 s55, s55, s57
    s_lshl_b32 s55, s55, 10
    s_mul_i32 s56, s56, 655360
    s_add_u32 s55, s55, s56
    s_add_u32 s55, s55, s58
    s_waitcnt lgkmcnt(6)
    buffer_store_dwordx4 v[40:43], v240, s[16:19], s55 offen sc1
    s_lshl_b32 s55, s6, 2
    s_add_u32 s55, s55, 1
    s_mul_i32 s56, s55, 205
    s_lshr_b32 s56, s56, 10
    s_mul_i32 s57, s56, 5
    s_sub_u32 s55, s55, s57
    s_lshl_b32 s55, s55, 10
    s_mul_i32 s56, s56, 655360
    s_add_u32 s55, s55, s56
    s_add_u32 s55, s55, s58
    s_waitcnt lgkmcnt(4)
    buffer_store_dwordx4 v[44:47], v240, s[16:19], s55 offen sc1
    s_lshl_b32 s55, s6, 2
    s_add_u32 s55, s55, 2
    s_mul_i32 s56, s55, 205
    s_lshr_b32 s56, s56, 10
    s_mul_i32 s57, s56, 5
    s_sub_u32 s55, s55, s57
    s_lshl_b32 s55, s55, 10
    s_mul_i32 s56, s56, 655360
    s_add_u32 s55, s55, s56
    s_add_u32 s55, s55, s58
    s_waitcnt lgkmcnt(2)
    buffer_store_dwordx4 v[48:51], v240, s[16:19], s55 offen sc1
    s_lshl_b32 s55, s6, 2
    s_add_u32 s55, s55, 3
    s_mul_i32 s56, s55, 205
    s_lshr_b32 s56, s56, 10
    s_mul_i32 s57, s56, 5
    s_sub_u32 s55, s55, s57
    s_lshl_b32 s55, s55, 10
    s_mul_i32 s56, s56, 655360
    s_add_u32 s55, s55, s56
    s_add_u32 s55, s55, s58
    s_waitcnt lgkmcnt(0)
    buffer_store_dwordx4 v[52:55], v240, s[16:19], s55 offen sc1
    s_branch L_rt1_j2
L_rt1_b2:
    v_bfe_u32 v243, v241, 4, 2
    v_lshl_add_u32 v36, v243, 10, v242
    s_sub_u32 s58, s5, 128
    s_mul_i32 s58, s58, 5120
    s_add_u32 s58, s58, 69206016
    s_cmp_lt_u32 s5, 148
    s_cselect_b32 s58, s58, 2130706432
    ds_read_b64_tr_b16 v[40:41], v36 offset:0
    ds_read_b64_tr_b16 v[42:43], v36 offset:512
    ds_read_b64_tr_b16 v[44:45], v36 offset:32
    ds_read_b64_tr_b16 v[46:47], v36 offset:544
    ds_read_b64_tr_b16 v[48:49], v36 offset:64
    ds_read_b64_tr_b16 v[50:51], v36 offset:576
    ds_read_b64_tr_b16 v[52:53], v36 offset:96
    ds_read_b64_tr_b16 v[54:55], v36 offset:608
    s_lshl_b32 s55, s6, 2
    s_add_u32 s55, s55, 0
    s_mul_i32 s56, s55, 205
    s_lshr_b32 s56, s56, 10
    s_mul_i32 s57, s56, 5
    s_sub_u32 s55, s55, s57
    s_lshl_b32 s55, s55, 10
    s_mul_i32 s56, s56, 102400
    s_add_u32 s55, s55, s56
    s_add_u32 s55, s55, s58
    s_waitcnt lgkmcnt(6)
    buffer_store_dwordx4 v[40:43], v240, s[16:19], s55 offen sc1
    s_lshl_b32 s55, s6, 2
    s_add_u32 s55, s55, 1
    s_mul_i32 s56, s55, 205
    s_lshr_b32 s56, s56, 10
    s_mul_i32 s57, s56, 5
    s_sub_u32 s55, s55, s57
    s_lshl_b32 s55, s55, 10
    s_mul_i32 s56, s56, 102400
    s_add_u32 s55, s55, s56
    s_add_u32 s55, s55, s58
    s_waitcnt lgkmcnt(4)
    buffer_store_dwordx4 v[44:47], v240, s[16:19], s55 offen sc1
    s_lshl_b32 s55, s6, 2
    s_add_u32 s55, s55, 2
    s_mul_i32 s56, s55, 205
    s_lshr_b32 s56, s56, 10
    s_mul_i32 s57, s56, 5
    s_sub_u32 s55, s55, s57
    s_lshl_b32 s55, s55, 10
    s_mul_i32 s56, s56, 102400
    s_add_u32 s55, s55, s56
    s_add_u32 s55, s55, s58
    s_waitcnt lgkmcnt(2)
    buffer_store_dwordx4 v[48:51], v240, s[16:19], s55 offen sc1
    s_lshl_b32 s55, s6, 2
    s_add_u32 s55, s55, 3
    s_mul_i32 s56, s55, 205
    s_lshr_b32 s56, s56, 10
    s_mul_i32 s57, s56, 5
    s_sub_u32 s55, s55, s57
    s_lshl_b32 s55, s55, 10
    s_mul_i32 s56, s56, 102400
    s_add_u32 s55, s55, s56
    s_add_u32 s55, s55, s58
    s_waitcnt lgkmcnt(0)
    buffer_store_dwordx4 v[52:55], v240, s[16:19], s55 offen sc1
L_rt1_j2:
    s_add_u32 s55, s4, 1024
    s_mul_i32 s5, s55, 6554
    s_lshr_b32 s5, s5, 16
    s_mul_i32 s56, s5, 10
    s_sub_u32 s6, s55, s56
    v_bfe_u32 v242, v241, 3, 3
    v_mul_u32_u24 v242, 1280, v242
    v_bfe_u32 v243, v241, 0, 3
    v_lshl_add_u32 v242, v243, 4, v242
    v_add_u32 v32, 0, v242
    v_add_u32 v33, 9216, v242
    v_add_u32 v34, 18432, v242
    v_add_u32 v35, 27648, v242
    s_mov_b32 m0, s66
    s_mul_i32 s55, s5, 40960
    s_lshl_b32 s56, s6, 7
    s_add_u32 s55, s55, s56
    s_cmp_ge_u32 s5, 128
    s_cbranch_scc1 L_rt2_b
    buffer_load_dwordx4 v32, s[36:39], s55 offen offset:0  lds
    buffer_load_dwordx4 v33, s[36:39], s55 offen offset:1024  lds
    buffer_load_dwordx4 v34, s[36:39], s55 offen offset:2048  lds
    buffer_load_dwordx4 v35, s[36:39], s55 offen offset:3072  lds
    s_branch L_rt2_j
L_rt2_b:
    s_sub_u32 s55, s55, 5242880
    buffer_load_dwordx4 v32, s[40:43], s55 offen offset:0 lds
    buffer_load_dwordx4 v33, s[40:43], s55 offen offset:1024 lds
    buffer_load_dwordx4 v34, s[40:43], s55 offen offset:2048 lds
    buffer_load_dwordx4 v35, s[40:43], s55 offen offset:3072 lds
L_rt2_j:
    s_cmp_gt_u32 s62, s63
    s_cbranch_scc1 L_lo_ld5_skip
    ds_read_b32 v253, v250
    s_sub_u32 s57, s62, 3
    s_waitcnt lgkmcnt(0)
    v_cmp_gt_u32 vcc, s57, v253
    s_cbranch_vccnz L_lo_ld5
L_lo_ld5_r:
    s_lshl_b32 s77, s78, 13
    s_add_u32 s77, s77, s80
    s_cmp_le_u32 s78, s79
    s_cselect_b32 s77, s77, 2130706432
    s_add_u32 m0, s76, s82
    s_add_u32 s78, s78, 2
    buffer_load_dwordx4 v240, s[16:19], s77 offen offset:0 sc1 lds
    buffer_load_dwordx4 v240, s[16:19], s77 offen offset:1024 sc1 lds
    ds_read_b32 v253, v250
    s_waitcnt lgkmcnt(0)
    buffer_load_dwordx4 v240, s[16:19], s77 offen offset:2048 sc1 lds
    buffer_load_dwordx4 v240, s[16:19], s77 offen offset:3072 sc1 lds
    ds_read_b32 v253, v250
    s_waitcnt lgkmcnt(0)
    s_add_u32 m0, m0, 4096
    s_add_u32 s77, s77, 4096
    buffer_load_dwordx4 v240, s[16:19], s77 offen offset:0 sc1 lds
    buffer_load_dwordx4 v240, s[16:19], s77 offen offset:1024 sc1 lds
    ds_read_b32 v253, v250
    s_waitcnt lgkmcnt(0)
    buffer_load_dwordx4 v240, s[16:19], s77 offen offset:2048 sc1 lds
    buffer_load_dwordx4 v240, s[16:19], s77 offen offset:3072 sc1 lds
    s_add_u32 s76, s76, 32768
    s_and_b32 s76, s76, 131071
    s_add_u32 s62, s62, 1
    s_add_u32 s55, s62, 4294967295
    v_mov_b32 v254, s55
    ds_write_b32 v251, v254
L_lo_ld5_skip:
    s_lshl_b32 s55, s73, 8
    s_lshl_b32 s56, s70, 3
    s_add_u32 s55, s55, s56
    s_add_u32 s55, s55, 73416704
    v_mov_b32 v242, s84
    v_mov_b32 v243, s85
    v_mov_b32 v244, 0
    s_mov_b64 exec, 1
    buffer_store_dwordx2 v[242:243], v244, s[16:19], s55 offen sc1
    s_mov_b64 exec, -1
    v_bfe_u32 v242, v241, 2, 2
    v_bfe_u32 v243, v241, 0, 2
    v_lshlrev_b32 v243, 3, v243
    v_lshl_add_u32 v242, v242, 7, v243
    v_add_u32 v242, s66, v242
    s_waitcnt vmcnt(1)
    s_cmp_ge_u32 s5, 128
    s_cbranch_scc1 L_rt2_b2
    v_bfe_u32 v243, v241, 4, 2
    v_lshl_add_u32 v36, v243, 9, v242
    s_mul_i32 s58, s5, 5120
    s_add_u32 s58, s58, 62914560
    ds_read_b64_tr_b16 v[40:41], v36 offset:0
    ds_read_b64_tr_b16 v[42:43], v36 offset:2048
    ds_read_b64_tr_b16 v[44:45], v36 offset:32
    ds_read_b64_tr_b16 v[46:47], v36 offset:2080
    ds_read_b64_tr_b16 v[48:49], v36 offset:64
    ds_read_b64_tr_b16 v[50:51], v36 offset:2112
    ds_read_b64_tr_b16 v[52:53], v36 offset:96
    ds_read_b64_tr_b16 v[54:55], v36 offset:2144
    s_lshl_b32 s55, s6, 2
    s_add_u32 s55, s55, 0
    s_mul_i32 s56, s55, 205
    s_lshr_b32 s56, s56, 10
    s_mul_i32 s57, s56, 5
    s_sub_u32 s55, s55, s57
    s_lshl_b32 s55, s55, 10
    s_mul_i32 s56, s56, 655360
    s_add_u32 s55, s55, s56
    s_add_u32 s55, s55, s58
    s_waitcnt lgkmcnt(6)
    buffer_store_dwordx4 v[40:43], v240, s[16:19], s55 offen sc1
    s_lshl_b32 s55, s6, 2
    s_add_u32 s55, s55, 1
    s_mul_i32 s56, s55, 205
    s_lshr_b32 s56, s56, 10
    s_mul_i32 s57, s56, 5
    s_sub_u32 s55, s55, s57
    s_lshl_b32 s55, s55, 10
    s_mul_i32 s56, s56, 655360
    s_add_u32 s55, s55, s56
    s_add_u32 s55, s55, s58
    s_waitcnt lgkmcnt(4)
    buffer_store_dwordx4 v[44:47], v240, s[16:19], s55 offen sc1
    s_lshl_b32 s55, s6, 2
    s_add_u32 s55, s55, 2
    s_mul_i32 s56, s55, 205
    s_lshr_b32 s56, s56, 10
    s_mul_i32 s57, s56, 5
    s_sub_u32 s55, s55, s57
    s_lshl_b32 s55, s55, 10
    s_mul_i32 s56, s56, 655360
    s_add_u32 s55, s55, s56
    s_add_u32 s55, s55, s58
    s_waitcnt lgkmcnt(2)
    buffer_store_dwordx4 v[48:51], v240, s[16:19], s55 offen sc1
    s_lshl_b32 s55, s6, 2
    s_add_u32 s55, s55, 3
    s_mul_i32 s56, s55, 205
    s_lshr_b32 s56, s56, 10
    s_mul_i32 s57, s56, 5
    s_sub_u32 s55, s55, s57
    s_lshl_b32 s55, s55, 10
    s_mul_i32 s56, s56, 655360
    s_add_u32 s55, s55, s56
    s_add_u32 s55, s55, s58
    s_waitcnt lgkmcnt(0)
    buffer_store_dwordx4 v[52:55], v240, s[16:19], s55 offen sc1
    s_branch L_rt2_j2
L_rt2_b2:
    v_bfe_u32 v243, v241, 4, 2
    v_lshl_add_u32 v36, v243, 10, v242
    s_sub_u32 s58, s5, 128
    s_mul_i32 s58, s58, 5120
    s_add_u32 s58, s58, 69206016
    s_cmp_lt_u32 s5, 148
    s_cselect_b32 s58, s58, 2130706432
    ds_read_b64_tr_b16 v[40:41], v36 offset:0
    ds_read_b64_tr_b16 v[42:43], v36 offset:512
    ds_read_b64_tr_b16 v[44:45], v36 offset:32
    ds_read_b64_tr_b16 v[46:47], v36 offset:544
    ds_read_b64_tr_b16 v[48:49], v36 offset:64
    ds_read_b64_tr_b16 v[50:51], v36 offset:576
    ds_read_b64_tr_b16 v[52:53], v36 offset:96
    ds_read_b64_tr_b16 v[54:55], v36 offset:608
    s_lshl_b32 s55, s6, 2
    s_add_u32 s55, s55, 0
    s_mul_i32 s56, s55, 205
    s_lshr_b32 s56, s56, 10
    s_mul_i32 s57, s56, 5
    s_sub_u32 s55, s55, s57
    s_lshl_b32 s55, s55, 10
    s_mul_i32 s56, s56, 102400
    s_add_u32 s55, s55, s56
    s_add_u32 s55, s55, s58
    s_waitcnt lgkmcnt(6)
    buffer_store_dwordx4 v[40:43], v240, s[16:19], s55 offen sc1
    s_lshl_b32 s55, s6, 2
    s_add_u32 s55, s55, 1
    s_mul_i32 s56, s55, 205
    s_lshr_b32 s56, s56, 10
    s_mul_i32 s57, s56, 5
    s_sub_u32 s55, s55, s57
    s_lshl_b32 s55, s55, 10
    s_mul_i32 s56, s56, 102400
    s_add_u32 s55, s55, s56
    s_add_u32 s55, s55, s58
    s_waitcnt lgkmcnt(4)
    buffer_store_dwordx4 v[44:47], v240, s[16:19], s55 offen sc1
    s_lshl_b32 s55, s6, 2
    s_add_u32 s55, s55, 2
    s_mul_i32 s56, s55, 205
    s_lshr_b32 s56, s56, 10
    s_mul_i32 s57, s56, 5
    s_sub_u32 s55, s55, s57
    s_lshl_b32 s55, s55, 10
    s_mul_i32 s56, s56, 102400
    s_add_u32 s55, s55, s56
    s_add_u32 s55, s55, s58
    s_waitcnt lgkmcnt(2)
    buffer_store_dwordx4 v[48:51], v240, s[16:19], s55 offen sc1
    s_lshl_b32 s55, s6, 2
    s_add_u32 s55, s55, 3
    s_mul_i32 s56, s55, 205
    s_lshr_b32 s56, s56, 10
    s_mul_i32 s57, s56, 5
    s_sub_u32 s55, s55, s57
    s_lshl_b32 s55, s55, 10
    s_mul_i32 s56, s56, 102400
    s_add_u32 s55, s55, s56
    s_add_u32 s55, s55, s58
    s_waitcnt lgkmcnt(0)
    buffer_store_dwordx4 v[52:55], v240, s[16:19], s55 offen sc1
L_rt2_j2:
    s_cmp_gt_u32 s62, s63
    s_cbranch_scc1 L_lo_ld6_skip
    ds_read_b32 v253, v250
    s_sub_u32 s57, s62, 3
    s_waitcnt lgkmcnt(0)
    v_cmp_gt_u32 vcc, s57, v253
    s_cbranch_vccnz L_lo_ld6
L_lo_ld6_r:
    s_lshl_b32 s77, s78, 13
    s_add_u32 s77, s77, s80
    s_cmp_le_u32 s78, s79
    s_cselect_b32 s77, s77, 2130706432
    s_add_u32 m0, s76, s82
    s_add_u32 s78, s78, 2
    buffer_load_dwordx4 v240, s[16:19], s77 offen offset:0 sc1 lds
    buffer_load_dwordx4 v240, s[16:19], s77 offen offset:1024 sc1 lds
    ds_read_b32 v253, v250
    s_waitcnt lgkmcnt(0)
    buffer_load_dwordx4 v240, s[16:19], s77 offen offset:2048 sc1 lds
    buffer_load_dwordx4 v240, s[16:19], s77 offen offset:3072 sc1 lds
    ds_read_b32 v253, v250
    s_waitcnt lgkmcnt(0)
    s_add_u32 m0, m0, 4096
    s_add_u32 s77, s77, 4096
    buffer_load_dwordx4 v240, s[16:19], s77 offen offset:0 sc1 lds
    buffer_load_dwordx4 v240, s[16:19], s77 offen offset:1024 sc1 lds
    ds_read_b32 v253, v250
    s_waitcnt lgkmcnt(0)
    buffer_load_dwordx4 v240, s[16:19], s77 offen offset:2048 sc1 lds
    buffer_load_dwordx4 v240, s[16:19], s77 offen offset:3072 sc1 lds
    s_add_u32 s76, s76, 32768
    s_and_b32 s76, s76, 131071
    s_add_u32 s62, s62, 1
    s_add_u32 s55, s62, 4294967295
    v_mov_b32 v254, s55
    ds_write_b32 v251, v254
L_lo_ld6_skip:
    s_cmp_gt_u32 s62, s63
    s_cbranch_scc1 L_lo_ld7_skip
    ds_read_b32 v253, v250
    s_sub_u32 s57, s62, 3
    s_waitcnt lgkmcnt(0)
    v_cmp_gt_u32 vcc, s57, v253
    s_cbranch_vccnz L_lo_ld7
L_lo_ld7_r:
    s_lshl_b32 s77, s78, 13
    s_add_u32 s77, s77, s80
    s_cmp_le_u32 s78, s79
    s_cselect_b32 s77, s77, 2130706432
    s_add_u32 m0, s76, s82
    s_add_u32 s78, s78, 2
    buffer_load_dwordx4 v240, s[16:19], s77 offen offset:0 sc1 lds
    buffer_load_dwordx4 v240, s[16:19], s77 offen offset:1024 sc1 lds
    ds_read_b32 v253, v250
    s_waitcnt lgkmcnt(0)
    buffer_load_dwordx4 v240, s[16:19], s77 offen offset:2048 sc1 lds
    buffer_load_dwordx4 v240, s[16:19], s77 offen offset:3072 sc1 lds
    ds_read_b32 v253, v250
    s_waitcnt lgkmcnt(0)
    s_add_u32 m0, m0, 4096
    s_add_u32 s77, s77, 4096
    buffer_load_dwordx4 v240, s[16:19], s77 offen offset:0 sc1 lds
    buffer_load_dwordx4 v240, s[16:19], s77 offen offset:1024 sc1 lds
    ds_read_b32 v253, v250
    s_waitcnt lgkmcnt(0)
    buffer_load_dwordx4 v240, s[16:19], s77 offen offset:2048 sc1 lds
    buffer_load_dwordx4 v240, s[16:19], s77 offen offset:3072 sc1 lds
    s_add_u32 s76, s76, 32768
    s_and_b32 s76, s76, 131071
    s_add_u32 s62, s62, 1
    s_add_u32 s55, s62, 4294967295
    v_mov_b32 v254, s55
    s_waitcnt vmcnt(8)
    ds_write_b32 v251, v254
L_lo_ld7_skip:
    s_lshl_b32 s55, s4, 3
    s_add_u32 s55, s55, 73408512
    v_mov_b32 v242, s84
    v_mov_b32 v243, s85
    v_mov_b32 v244, 0
    s_waitcnt vmcnt(0)
    s_mov_b64 exec, 1
    buffer_store_dwordx2 v[242:243], v244, s[16:19], s55 offen sc1
    s_mov_b64 exec, -1
    s_branch L_lo_rtj
L_lo_nort:
    s_cmp_gt_u32 s62, s63
    s_cbranch_scc1 L_lo_ld8_skip
    ds_read_b32 v253, v250
    s_sub_u32 s57, s62, 3
    s_waitcnt lgkmcnt(0)
    v_cmp_gt_u32 vcc, s57, v253
    s_cbranch_vccnz L_lo_ld8
L_lo_ld8_r:
    s_lshl_b32 s77, s78, 13
    s_add_u32 s77, s77, s80
    s_cmp_le_u32 s78, s79
    s_cselect_b32 s77, s77, 2130706432
    s_add_u32 m0, s76, s82
    s_add_u32 s78, s78, 2
    buffer_load_dwordx4 v240, s[16:19], s77 offen offset:0 sc1 lds
    buffer_load_dwordx4 v240, s[16:19], s77 offen offset:1024 sc1 lds
    ds_read_b32 v253, v250
    s_waitcnt lgkmcnt(0)
    buffer_load_dwordx4 v240, s[16:19], s77 offen offset:2048 sc1 lds
    buffer_load_dwordx4 v240, s[16:19], s77 offen offset:3072 sc1 lds
    ds_read_b32 v253, v250
    s_waitcnt lgkmcnt(0)
    s_add_u32 m0, m0, 4096
    s_add_u32 s77, s77, 4096
    buffer_load_dwordx4 v240, s[16:19], s77 offen offset:0 sc1 lds
    buffer_load_dwordx4 v240, s[16:19], s77 offen offset:1024 sc1 lds
    ds_read_b32 v253, v250
    s_waitcnt lgkmcnt(0)
    buffer_load_dwordx4 v240, s[16:19], s77 offen offset:2048 sc1 lds
    buffer_load_dwordx4 v240, s[16:19], s77 offen offset:3072 sc1 lds
    s_add_u32 s76, s76, 32768
    s_and_b32 s76, s76, 131071
    s_add_u32 s62, s62, 1
    s_add_u32 s55, s62, 4294967295
    v_mov_b32 v254, s55
    s_waitcnt vmcnt(14)
    ds_write_b32 v251, v254
L_lo_ld8_skip:
    s_cmp_gt_u32 s62, s63
    s_cbranch_scc1 L_lo_ld9_skip
    ds_read_b32 v253, v250
    s_sub_u32 s57, s62, 3
    s_waitcnt lgkmcnt(0)
    v_cmp_gt_u32 vcc, s57, v253
    s_cbranch_vccnz L_lo_ld9
L_lo_ld9_r:
    s_lshl_b32 s77, s78, 13
    s_add_u32 s77, s77, s80
    s_cmp_le_u32 s78, s79
    s_cselect_b32 s77, s77, 2130706432
    s_add_u32 m0, s76, s82
    s_add_u32 s78, s78, 2
    buffer_load_dwordx4 v240, s[16:19], s77 offen offset:0 sc1 lds
    buffer_load_dwordx4 v240, s[16:19], s77 offen offset:1024 sc1 lds
    ds_read_b32 v253, v250
    s_waitcnt lgkmcnt(0)
    buffer_load_dwordx4 v240, s[16:19], s77 offen offset:2048 sc1 lds
    buffer_load_dwordx4 v240, s[16:19], s77 offen offset:3072 sc1 lds
    ds_read_b32 v253, v250
    s_waitcnt lgkmcnt(0)
    s_add_u32 m0, m0, 4096
    s_add_u32 s77, s77, 4096
    buffer_load_dwordx4 v240, s[16:19], s77 offen offset:0 sc1 lds
    buffer_load_dwordx4 v240, s[16:19], s77 offen offset:1024 sc1 lds
    ds_read_b32 v253, v250
    s_waitcnt lgkmcnt(0)
    buffer_load_dwordx4 v240, s[16:19], s77 offen offset:2048 sc1 lds
    buffer_load_dwordx4 v240, s[16:19], s77 offen offset:3072 sc1 lds
    s_add_u32 s76, s76, 32768
    s_and_b32 s76, s76, 131071
    s_add_u32 s62, s62, 1
    s_add_u32 s55, s62, 4294967295
    v_mov_b32 v254, s55
    s_waitcnt vmcnt(8)
    ds_write_b32 v251, v254
L_lo_ld9_skip:
    s_cmp_gt_u32 s62, s63
    s_cbranch_scc1 L_lo_ld10_skip
    ds_read_b32 v253, v250
    s_sub_u32 s57, s62, 3
    s_waitcnt lgkmcnt(0)
    v_cmp_gt_u32 vcc, s57, v253
    s_cbranch_vccnz L_lo_ld10
L_lo_ld10_r:
    s_lshl_b32 s77, s78, 13
    s_add_u32 s77, s77, s80
    s_cmp_le_u32 s78, s79
    s_cselect_b32 s77, s77, 2130706432
    s_add_u32 m0, s76, s82
    s_add_u32 s78, s78, 2
    buffer_load_dwordx4 v240, s[16:19], s77 offen offset:0 sc1 lds
    buffer_load_dwordx4 v240, s[16:19], s77 offen offset:1024 sc1 lds
    ds_read_b32 v253, v250
    s_waitcnt lgkmcnt(0)
    buffer_load_dwordx4 v240, s[16:19], s77 offen offset:2048 sc1 lds
    buffer_load_dwordx4 v240, s[16:19], s77 offen offset:3072 sc1 lds
    ds_read_b32 v253, v250
    s_waitcnt lgkmcnt(0)
    s_add_u32 m0, m0, 4096
    s_add_u32 s77, s77, 4096
    buffer_load_dwordx4 v240, s[16:19], s77 offen offset:0 sc1 lds
    buffer_load_dwordx4 v240, s[16:19], s77 offen offset:1024 sc1 lds
    ds_read_b32 v253, v250
    s_waitcnt lgkmcnt(0)
    buffer_load_dwordx4 v240, s[16:19], s77 offen offset:2048 sc1 lds
    buffer_load_dwordx4 v240, s[16:19], s77 offen offset:3072 sc1 lds
    s_add_u32 s76, s76, 32768
    s_and_b32 s76, s76, 131071
    s_add_u32 s62, s62, 1
    s_add_u32 s55, s62, 4294967295
    v_mov_b32 v254, s55
    s_waitcnt vmcnt(8)
    ds_write_b32 v251, v254
L_lo_ld10_skip:
    s_lshl_b32 s55, s73, 8
    s_lshl_b32 s56, s70, 3
    s_add_u32 s55, s55, s56
    s_add_u32 s55, s55, 73416704
    v_mov_b32 v242, s84
    v_mov_b32 v243, s85
    v_mov_b32 v244, 0
    s_waitcnt vmcnt(2)
    s_mov_b64 exec, 1
    buffer_store_dwordx2 v[242:243], v244, s[16:19], s55 offen sc1
    s_mov_b64 exec, -1
    s_waitcnt vmcnt(1)
L_lo_rtj:
    v_xor_b32 v0, s84, v0
    v_xor_b32 v1, s85, v1
    v_xor_b32 v2, s84, v2
    v_xor_b32 v3, s85, v3
    v_or3_b32 v0, v0, v1, v2
    v_or_b32 v0, v0, v3
    v_cmp_ne_u32 vcc, 0, v0
    s_cbranch_vccz L_pq0ok
    s_lshr_b32 s55, s83, 4
    s_lshl_b32 s55, s55, 7
    s_add_u32 s55, s55, 73404416
    s_mov_b32 s56, 1048576
    v_lshrrev_b32 v245, 1, v240
    s_mov_b64 exec, 0x7fff
L_pq00:
    buffer_load_dwordx2 v[246:247], v245, s[16:19], s55 offen sc1
    s_waitcnt vmcnt(0)
    v_xor_b32 v246, s84, v246
    v_xor_b32 v247, s85, v247
    v_or_b32 v246, v246, v247
    v_cmp_ne_u32 vcc, 0, v246
    s_cbranch_vccz L_pq00_ok
    s_sleep 4
    s_sub_u32 s56, s56, 1
    s_cmp_lg_u32 s56, 0
    s_cbranch_scc1 L_pq00
L_pq00_ok:
    s_mov_b64 exec, -1
    s_lshr_b32 s55, s83, 2
    s_max_u32 s55, s55, 1
    s_sub_u32 s55, s55, 1
    s_lshr_b32 s55, s55, 2
    s_lshl_b32 s55, s55, 7
    s_add_u32 s55, s55, 73404416
    s_mov_b32 s56, 1048576
    v_lshrrev_b32 v245, 1, v240
    s_mov_b64 exec, 0x7fff
L_pq01:
    buffer_load_dwordx2 v[246:247], v245, s[16:19], s55 offen sc1
    s_waitcnt vmcnt(0)
    v_xor_b32 v246, s84, v246
    v_xor_b32 v247, s85, v247
    v_or_b32 v246, v246, v247
    v_cmp_ne_u32 vcc, 0, v246
    s_cbranch_vccz L_pq01_ok
    s_sleep 4
    s_sub_u32 s56, s56, 1
    s_cmp_lg_u32 s56, 0
    s_cbranch_scc1 L_pq01
L_pq01_ok:
    s_mov_b64 exec, -1
L_pq0ok:
    s_lshr_b32 s55, s83, 2
    s_lshl_b32 s55, s55, 5
    v_bfe_u32 v242, v241, 0, 5
    v_add_u32 v32, s55, v242
    s_and_b32 s55, s83, 3
    s_lshl_b32 s55, s55, 2
    s_add_u32 s55, s55, s54
    s_sub_u32 s55, s55, 4
    s_lshl_b32 s55, s55, 1
    v_bfe_u32 v242, v241, 5, 1
    v_add_u32 v33, s55, v242
    v_mul_u32_u24 v33, 20, v33
    v_lshl_add_u32 v34, v242, 2, v33
    v_add_u32 v35, 8, v34
    v_lshlrev_b32 v243, 4, v242
    v_sub_u32 v36, v33, v243
    v_add_u32 v36, 16, v36
    v_lshrrev_b32 v242, 6, v32
    v_mul_u32_u24 v242, 81920, v242
    v_bfe_u32 v243, v32, 4, 2
    v_lshl_add_u32 v242, v243, 10, v242
    v_and_b32 v243, 15, v32
    v_lshl_add_u32 v242, v243, 4, v242
    v_lshrrev_b32 v243, 5, v34
    v_lshl_add_u32 v230, v243, 12, v242
    v_bfe_u32 v243, v34, 3, 2
    v_lshl_add_u32 v230, v243, 8, v230
    v_and_b32 v243, 7, v34
    v_lshl_add_u32 v230, v243, 1, v230
    v_lshrrev_b32 v243, 5, v35
    v_lshl_add_u32 v231, v243, 12, v242
    v_bfe_u32 v243, v35, 3, 2
    v_lshl_add_u32 v231, v243, 8, v231
    v_and_b32 v243, 7, v35
    v_lshl_add_u32 v231, v243, 1, v231
    v_lshrrev_b32 v243, 5, v36
    v_lshl_add_u32 v232, v243, 12, v242
    v_bfe_u32 v243, v36, 3, 2
    v_lshl_add_u32 v232, v243, 8, v232
    v_and_b32 v243, 7, v36
    v_lshl_add_u32 v232, v243, 1, v232
    v_and_b32 v243, 7, v34
    v_lshlrev_b32 v243, 1, v243
    v_lshrrev_b32 v34, 3, v34
    v_lshl_add_u32 v34, v34, 9, v243
    v_and_b32 v243, 7, v35
    v_lshlrev_b32 v243, 1, v243
    v_lshrrev_b32 v35, 3, v35
    v_lshl_add_u32 v35, v35, 9, v243
    v_and_b32 v243, 7, v36
    v_lshlrev_b32 v243, 1, v243
    v_lshrrev_b32 v36, 3, v36
    v_lshl_add_u32 v36, v36, 9, v243
    v_bfe_u32 v242, v241, 0, 5
    v_lshlrev_b32 v242, 4, v242
    v_add_u32 v34, v34, v242
    v_add_u32 v35, v35, v242
    v_add_u32 v36, v36, v242
    s_lshr_b32 s55, s83, 2
    s_mul_i32 s86, s55, 122880
    s_add_u32 s86, s86, 50331648
    buffer_load_dwordx4 v[48:51], v34, s[16:19], s86 offen sc1
    buffer_load_dwordx4 v[52:55], v35, s[16:19], s86 offen sc1
    buffer_load_dwordx2 v[56:57], v36, s[16:19], s86 offen sc1
    s_cmp_eq_u32 s55, 0
    s_cselect_b32 s56, 0, 122880
    s_sub_u32 s86, s86, s56
    v_bfe_u32 v243, v241, 5, 1
    v_mul_lo_u32 v243, v243, s56
    v_add_u32 v40, v242, v243
    s_and_b32 s55, s83, 3
    s_lshl_b32 s55, s55, 2
    s_add_u32 s55, s55, s54
    s_sub_u32 s55, s55, 4
    s_mul_i32 s55, s55, 2560
    s_add_u32 s95, s86, s55
    s_add_u32 m0, s66, 0
    s_add_u32 s55, s95, 40960
    buffer_load_dwordx4 v40, s[16:19], s55 offen sc1 lds
    s_add_u32 m0, s66, 1024
    s_add_u32 s55, s95, 41472
    buffer_load_dwordx4 v40, s[16:19], s55 offen sc1 lds
    s_add_u32 m0, s66, 2048
    s_add_u32 s55, s95, 41984
    buffer_load_dwordx4 v40, s[16:19], s55 offen sc1 lds
    s_add_u32 m0, s66, 3072
    s_add_u32 s55, s95, 42496
    buffer_load_dwordx4 v40, s[16:19], s55 offen sc1 lds
    s_add_u32 m0, s66, 4096
    s_add_u32 s55, s95, 43008
    buffer_load_dwordx4 v40, s[16:19], s55 offen sc1 lds
    v_bfe_u32 v243, v241, 5, 1
    v_add_u32 v242, s66, v242
    v_add_u32 v242, 288, v242
    v_mul_u32_u24 v244, 3072, v243
    v_add_u32 v41, v242, v244
    v_lshl_add_u32 v42, v243, 3, v242
    s_sub_u32 s6, s63, 0
L_lo_rest:
    s_cmp_gt_u32 s62, s6
    s_cbranch_scc1 L_lo_fin
    ds_read_b32 v253, v250
    s_sub_u32 s57, s62, 3
    s_waitcnt lgkmcnt(0)
    v_cmp_gt_u32 vcc, s57, v253
    s_cbranch_vccnz L_lo_ldr
L_lo_ldr_r:
    s_lshl_b32 s77, s78, 13
    s_add_u32 s77, s77, s80
    s_cmp_le_u32 s78, s79
    s_cselect_b32 s77, s77, 2130706432
    s_add_u32 m0, s76, s82
    s_add_u32 s78, s78, 2
    buffer_load_dwordx4 v240, s[16:19], s77 offen offset:0 sc1 lds
    ds_read_b32 v253, v250
    s_waitcnt lgkmcnt(0)
    ds_read_b32 v253, v250
    s_waitcnt lgkmcnt(0)
    buffer_load_dwordx4 v240, s[16:19], s77 offen offset:1024 sc1 lds
    ds_read_b32 v253, v250
    s_waitcnt lgkmcnt(0)
    ds_read_b32 v253, v250
    s_waitcnt lgkmcnt(0)
    buffer_load_dwordx4 v240, s[16:19], s77 offen offset:2048 sc1 lds
    ds_read_b32 v253, v250
    s_waitcnt lgkmcnt(0)
    ds_read_b32 v253, v250
    s_waitcnt lgkmcnt(0)
    buffer_load_dwordx4 v240, s[16:19], s77 offen offset:3072 sc1 lds
    s_mov_b32 s55, s62
    v_mov_b32 v254, s55
    s_waitcnt vmcnt(4)
    ds_write_b32 v251, v254
    s_add_u32 m0, m0, 4096
    s_add_u32 s77, s77, 4096
    buffer_load_dwordx4 v240, s[16:19], s77 offen offset:0 sc1 lds
    ds_read_b32 v253, v250
    s_waitcnt lgkmcnt(0)
    ds_read_b32 v253, v250
    s_waitcnt lgkmcnt(0)
    buffer_load_dwordx4 v240, s[16:19], s77 offen offset:1024 sc1 lds
    ds_read_b32 v253, v250
    s_waitcnt lgkmcnt(0)
    ds_read_b32 v253, v250
    s_waitcnt lgkmcnt(0)
    buffer_load_dwordx4 v240, s[16:19], s77 offen offset:2048 sc1 lds
    ds_read_b32 v253, v250
    s_waitcnt lgkmcnt(0)
    ds_read_b32 v253, v250
    s_waitcnt lgkmcnt(0)
    buffer_load_dwordx4 v240, s[16:19], s77 offen offset:3072 sc1 lds
    s_add_u32 s76, s76, 32768
    s_and_b32 s76, s76, 131071
    s_add_u32 s62, s62, 1
    s_branch L_lo_rest
L_lo_fin:
    s_mov_b32 s55, s62
    v_mov_b32 v254, s55
    s_waitcnt vmcnt(0)
    ds_write_b32 v251, v254
    s_mov_b32 s55, 73408512
    buffer_load_dwordx4 v[16:19], v240, s[16:19], s55 offen offset:0 sc1
    buffer_load_dwordx4 v[20:23], v240, s[16:19], s55 offen offset:1024 sc1
    buffer_load_dwordx4 v[24:27], v240, s[16:19], s55 offen offset:2048 sc1
    buffer_load_dwordx4 v[28:31], v240, s[16:19], s55 offen offset:3072 sc1
    ds_read_b128 v[58:61], v41 offset:224
    ds_read_b128 v[62:65], v41 offset:1248
    ds_read_b64 v[66:67], v42 offset:2272
    ds_read_b128 v[68:71], v41 offset:192
    ds_read_b128 v[72:75], v41 offset:1216
    ds_read_b64 v[76:77], v42 offset:2240
    ds_read_b128 v[78:81], v41 offset:160
    ds_read_b128 v[82:85], v41 offset:1184
    ds_read_b64 v[86:87], v42 offset:2208
    ds_read_b128 v[88:91], v41 offset:128
    ds_read_b128 v[92:95], v41 offset:1152
    ds_read_b64 v[96:97], v42 offset:2176
    ds_read_b128 v[98:101], v41 offset:96
    ds_read_b128 v[102:105], v41 offset:1120
    ds_read_b64 v[106:107], v42 offset:2144
    ds_read_b128 v[108:111], v41 offset:64
    ds_read_b128 v[112:115], v41 offset:1088
    ds_read_b64 v[116:117], v42 offset:2112
    ds_read_b128 v[118:121], v41 offset:32
    ds_read_b128 v[122:125], v41 offset:1056
    ds_read_b64 v[126:127], v42 offset:2080
    ds_read_b128 v[128:131], v41 offset:0
    ds_read_b128 v[132:135], v41 offset:1024
    ds_read_b64 v[136:137], v42 offset:2048
    s_waitcnt lgkmcnt(0)
    s_add_u32 m0, s66, 0
    s_add_u32 s55, s95, 81920
    buffer_load_dwordx4 v40, s[16:19], s55 offen sc1 lds
    s_add_u32 m0, s66, 1024
    s_add_u32 s55, s95, 82432
    buffer_load_dwordx4 v40, s[16:19], s55 offen sc1 lds
    s_add_u32 m0, s66, 2048
    s_add_u32 s55, s95, 82944
    buffer_load_dwordx4 v40, s[16:19], s55 offen sc1 lds
    s_add_u32 m0, s66, 3072
    s_add_u32 s55, s95, 83456
    buffer_load_dwordx4 v40, s[16:19], s55 offen sc1 lds
    s_add_u32 m0, s66, 4096
    s_add_u32 s55, s95, 83968
    buffer_load_dwordx4 v40, s[16:19], s55 offen sc1 lds
    v_dot2_f32_bf16 v218, v48, v58, 0
    v_dot2_f32_bf16 v218, v49, v59, v218
    v_dot2_f32_bf16 v218, v50, v60, v218
    v_dot2_f32_bf16 v218, v51, v61, v218
    v_dot2_f32_bf16 v218, v52, v62, v218
    v_dot2_f32_bf16 v218, v53, v63, v218
    v_dot2_f32_bf16 v218, v54, v64, v218
    v_dot2_f32_bf16 v218, v55, v65, v218
    v_dot2_f32_bf16 v218, v56, v66, v218
    v_dot2_f32_bf16 v218, v57, v67, v218
    v_dot2_f32_bf16 v219, v48, v68, 0
    v_dot2_f32_bf16 v219, v49, v69, v219
    v_dot2_f32_bf16 v219, v50, v70, v219
    v_dot2_f32_bf16 v219, v51, v71, v219
    v_dot2_f32_bf16 v219, v52, v72, v219
    v_dot2_f32_bf16 v219, v53, v73, v219
    v_dot2_f32_bf16 v219, v54, v74, v219
    v_dot2_f32_bf16 v219, v55, v75, v219
    v_dot2_f32_bf16 v219, v56, v76, v219
    v_dot2_f32_bf16 v219, v57, v77, v219
    v_dot2_f32_bf16 v220, v48, v78, 0
    v_dot2_f32_bf16 v220, v49, v79, v220
    v_dot2_f32_bf16 v220, v50, v80, v220
    v_dot2_f32_bf16 v220, v51, v81, v220
    v_dot2_f32_bf16 v220, v52, v82, v220
    v_dot2_f32_bf16 v220, v53, v83, v220
    v_dot2_f32_bf16 v220, v54, v84, v220
    v_dot2_f32_bf16 v220, v55, v85, v220
    v_dot2_f32_bf16 v220, v56, v86, v220
    v_dot2_f32_bf16 v220, v57, v87, v220
    v_dot2_f32_bf16 v221, v48, v88, 0
    v_dot2_f32_bf16 v221, v49, v89, v221
    v_dot2_f32_bf16 v221, v50, v90, v221
    v_dot2_f32_bf16 v221, v51, v91, v221
    v_dot2_f32_bf16 v221, v52, v92, v221
    v_dot2_f32_bf16 v221, v53, v93, v221
    v_dot2_f32_bf16 v221, v54, v94, v221
    v_dot2_f32_bf16 v221, v55, v95, v221
    v_dot2_f32_bf16 v221, v56, v96, v221
    v_dot2_f32_bf16 v221, v57, v97, v221
    v_dot2_f32_bf16 v222, v48, v98, 0
    v_dot2_f32_bf16 v222, v49, v99, v222
    v_dot2_f32_bf16 v222, v50, v100, v222
    v_dot2_f32_bf16 v222, v51, v101, v222
    v_dot2_f32_bf16 v222, v52, v102, v222
    v_dot2_f32_bf16 v222, v53, v103, v222
    v_dot2_f32_bf16 v222, v54, v104, v222
    v_dot2_f32_bf16 v222, v55, v105, v222
    v_dot2_f32_bf16 v222, v56, v106, v222
    v_dot2_f32_bf16 v222, v57, v107, v222
    v_dot2_f32_bf16 v223, v48, v108, 0
    v_dot2_f32_bf16 v223, v49, v109, v223
    v_dot2_f32_bf16 v223, v50, v110, v223
    v_dot2_f32_bf16 v223, v51, v111, v223
    v_dot2_f32_bf16 v223, v52, v112, v223
    v_dot2_f32_bf16 v223, v53, v113, v223
    v_dot2_f32_bf16 v223, v54, v114, v223
    v_dot2_f32_bf16 v223, v55, v115, v223
    v_dot2_f32_bf16 v223, v56, v116, v223
    v_dot2_f32_bf16 v223, v57, v117, v223
    v_dot2_f32_bf16 v224, v48, v118, 0
    v_dot2_f32_bf16 v224, v49, v119, v224
    v_dot2_f32_bf16 v224, v50, v120, v224
    v_dot2_f32_bf16 v224, v51, v121, v224
    v_dot2_f32_bf16 v224, v52, v122, v224
    v_dot2_f32_bf16 v224, v53, v123, v224
    v_dot2_f32_bf16 v224, v54, v124, v224
    v_dot2_f32_bf16 v224, v55, v125, v224
    v_dot2_f32_bf16 v224, v56, v126, v224
    v_dot2_f32_bf16 v224, v57, v127, v224
    v_dot2_f32_bf16 v225, v48, v128, 0
    v_dot2_f32_bf16 v225, v49, v129, v225
    v_dot2_f32_bf16 v225, v50, v130, v225
    v_dot2_f32_bf16 v225, v51, v131, v225
    v_dot2_f32_bf16 v225, v52, v132, v225
    v_dot2_f32_bf16 v225, v53, v133, v225
    v_dot2_f32_bf16 v225, v54, v134, v225
    v_dot2_f32_bf16 v225, v55, v135, v225
    v_dot2_f32_bf16 v225, v56, v136, v225
    v_dot2_f32_bf16 v225, v57, v137, v225
    s_mov_b32 s86, 0x3e64f92e
    s_mov_b32 s87, 0xffff0000
    s_mov_b32 s88, 0x3fb8aa3b
    v_cvt_pk_bf16_f32 v226, v218, v219
    v_cvt_pk_bf16_f32 v227, v220, v221
    v_cvt_pk_bf16_f32 v228, v222, v223
    v_cvt_pk_bf16_f32 v229, v224, v225
    v_lshlrev_b32 v218, 16, v226
    v_and_b32 v219, s87, v226
    v_lshlrev_b32 v220, 16, v227
    v_and_b32 v221, s87, v227
    v_lshlrev_b32 v222, 16, v228
    v_and_b32 v223, s87, v228
    v_lshlrev_b32 v224, 16, v229
    v_and_b32 v225, s87, v229
    v_mul_f32 v218, s86, v218
    v_mul_f32 v219, s86, v219
    v_mul_f32 v220, s86, v220
    v_mul_f32 v221, s86, v221
    v_mul_f32 v222, s86, v222
    v_mul_f32 v223, s86, v223
    v_mul_f32 v224, s86, v224
    v_mul_f32 v225, s86, v225
    v_cvt_pk_bf16_f32 v226, v218, v219
    v_cvt_pk_bf16_f32 v227, v220, v221
    v_cvt_pk_bf16_f32 v228, v222, v223
    v_cvt_pk_bf16_f32 v229, v224, v225
    v_lshlrev_b32 v218, 16, v226
    v_and_b32 v219, s87, v226
    v_lshlrev_b32 v220, 16, v227
    v_and_b32 v221, s87, v227
    v_lshlrev_b32 v222, 16, v228
    v_and_b32 v223, s87, v228
    v_lshlrev_b32 v224, 16, v229
    v_and_b32 v225, s87, v229
    v_mov_b32 v243, 0xce6e6b28
    v_cmp_gt_u32 s[92:93], 2, v32
    s_nop 1
    v_cndmask_b32 v219, v219, v243, s[92:93]
    v_cmp_gt_u32 s[90:91], 4, v32
    s_nop 1
    v_cndmask_b32 v220, v220, v243, s[90:91]
    v_cmp_gt_u32 s[92:93], 6, v32
    s_nop 1
    v_cndmask_b32 v221, v221, v243, s[92:93]
    v_cmp_gt_u32 s[90:91], 8, v32
    s_nop 1
    v_cndmask_b32 v222, v222, v243, s[90:91]
    v_cmp_gt_u32 s[92:93], 10, v32
    s_nop 1
    v_cndmask_b32 v223, v223, v243, s[92:93]
    v_cmp_gt_u32 s[90:91], 12, v32
    s_nop 1
    v_cndmask_b32 v224, v224, v243, s[90:91]
    v_cmp_gt_u32 s[92:93], 14, v32
    s_nop 1
    v_cndmask_b32 v225, v225, v243, s[92:93]
    v_max3_f32 v242, v218, v219, v220
    v_max3_f32 v242, v242, v221, v222
    v_max3_f32 v242, v242, v223, v224
    v_max_f32 v242, v242, v225
    v_sub_f32 v218, v218, v242
    v_sub_f32 v219, v219, v242
    v_sub_f32 v220, v220, v242
    v_sub_f32 v221, v221, v242
    v_sub_f32 v222, v222, v242
    v_sub_f32 v223, v223, v242
    v_sub_f32 v224, v224, v242
    v_sub_f32 v225, v225, v242
    v_mul_f32 v218, s88, v218
    v_mul_f32 v219, s88, v219
    v_mul_f32 v220, s88, v220
    v_mul_f32 v221, s88, v221
    v_mul_f32 v222, s88, v222
    v_mul_f32 v223, s88, v223
    v_mul_f32 v224, s88, v224
    v_mul_f32 v225, s88, v225
    v_exp_f32 v218, v218
    v_exp_f32 v219, v219
    v_exp_f32 v220, v220
    v_exp_f32 v221, v221
    v_exp_f32 v222, v222
    v_exp_f32 v223, v223
    v_exp_f32 v224, v224
    v_exp_f32 v225, v225
    v_add_f32 v242, v218, v219
    v_add_f32 v242, v242, v220
    v_add_f32 v242, v242, v221
    v_add_f32 v242, v242, v222
    v_add_f32 v242, v242, v223
    v_add_f32 v242, v242, v224
    v_add_f32 v242, v242, v225
    v_rcp_f32 v242, v242
    s_nop 0
    v_mul_f32 v218, v242, v218
    v_mul_f32 v219, v242, v219
    v_mul_f32 v220, v242, v220
    v_mul_f32 v221, v242, v221
    v_mul_f32 v222, v242, v222
    v_mul_f32 v223, v242, v223
    v_mul_f32 v224, v242, v224
    v_mul_f32 v225, v242, v225
    v_cvt_pk_bf16_f32 v226, v218, v219
    v_cvt_pk_bf16_f32 v227, v220, v221
    v_cvt_pk_bf16_f32 v228, v222, v223
    v_cvt_pk_bf16_f32 v229, v224, v225
    s_waitcnt vmcnt(0)
    ds_read_b128 v[138:141], v41 offset:224
    ds_read_b128 v[142:145], v41 offset:1248
    ds_read_b64 v[146:147], v42 offset:2272
    ds_read_b128 v[148:151], v41 offset:192
    ds_read_b128 v[152:155], v41 offset:1216
    ds_read_b64 v[156:157], v42 offset:2240
    ds_read_b128 v[158:161], v41 offset:160
    ds_read_b128 v[162:165], v41 offset:1184
    ds_read_b64 v[166:167], v42 offset:2208
    ds_read_b128 v[168:171], v41 offset:128
    ds_read_b128 v[172:175], v41 offset:1152
    ds_read_b64 v[176:177], v42 offset:2176
    ds_read_b128 v[178:181], v41 offset:96
    ds_read_b128 v[182:185], v41 offset:1120
    ds_read_b64 v[186:187], v42 offset:2144
    ds_read_b128 v[188:191], v41 offset:64
    ds_read_b128 v[192:195], v41 offset:1088
    ds_read_b64 v[196:197], v42 offset:2112
    ds_read_b128 v[198:201], v41 offset:32
    ds_read_b128 v[202:205], v41 offset:1056
    ds_read_b64 v[206:207], v42 offset:2080
    ds_read_b128 v[208:211], v41 offset:0
    ds_read_b128 v[212:215], v41 offset:1024
    ds_read_b64 v[216:217], v42 offset:2048
    s_mov_b32 s86, 0x05040100
    s_mov_b32 s87, 0x07060302
    s_waitcnt lgkmcnt(15)
    v_perm_b32 v218, v148, v138, s86
    v_perm_b32 v219, v148, v138, s87
    v_dot2_f32_bf16 v48, v218, v226, 0
    v_dot2_f32_bf16 v49, v219, v226, 0
    v_perm_b32 v220, v149, v139, s86
    v_perm_b32 v221, v149, v139, s87
    v_dot2_f32_bf16 v50, v220, v226, 0
    v_dot2_f32_bf16 v51, v221, v226, 0
    v_perm_b32 v222, v150, v140, s86
    v_perm_b32 v223, v150, v140, s87
    v_dot2_f32_bf16 v52, v222, v226, 0
    v_dot2_f32_bf16 v53, v223, v226, 0
    v_perm_b32 v224, v151, v141, s86
    v_perm_b32 v225, v151, v141, s87
    v_dot2_f32_bf16 v54, v224, v226, 0
    v_dot2_f32_bf16 v55, v225, v226, 0
    v_perm_b32 v218, v152, v142, s86
    v_perm_b32 v219, v152, v142, s87
    v_dot2_f32_bf16 v56, v218, v226, 0
    v_dot2_f32_bf16 v57, v219, v226, 0
    v_perm_b32 v220, v153, v143, s86
    v_perm_b32 v221, v153, v143, s87
    v_dot2_f32_bf16 v58, v220, v226, 0
    v_dot2_f32_bf16 v59, v221, v226, 0
    v_perm_b32 v222, v154, v144, s86
    v_perm_b32 v223, v154, v144, s87
    v_dot2_f32_bf16 v60, v222, v226, 0
    v_dot2_f32_bf16 v61, v223, v226, 0
    v_perm_b32 v224, v155, v145, s86
    v_perm_b32 v225, v155, v145, s87
    v_dot2_f32_bf16 v62, v224, v226, 0
    v_dot2_f32_bf16 v63, v225, v226, 0
    v_perm_b32 v218, v156, v146, s86
    v_perm_b32 v219, v156, v146, s87
    v_dot2_f32_bf16 v64, v218, v226, 0
    v_dot2_f32_bf16 v65, v219, v226, 0
    v_perm_b32 v220, v157, v147, s86
    v_perm_b32 v221, v157, v147, s87
    v_dot2_f32_bf16 v66, v220, v226, 0
    v_dot2_f32_bf16 v67, v221, v226, 0
    s_waitcnt lgkmcnt(14)
    v_perm_b32 v222, v168, v158, s86
    v_perm_b32 v223, v168, v158, s87
    v_dot2_f32_bf16 v48, v222, v227, v48
    v_dot2_f32_bf16 v49, v223, v227, v49
    v_perm_b32 v224, v169, v159, s86
    v_perm_b32 v225, v169, v159, s87
    v_dot2_f32_bf16 v50, v224, v227, v50
    v_dot2_f32_bf16 v51, v225, v227, v51
    v_perm_b32 v218, v170, v160, s86
    v_perm_b32 v219, v170, v160, s87
    v_dot2_f32_bf16 v52, v218, v227, v52
    v_dot2_f32_bf16 v53, v219, v227, v53
    v_perm_b32 v220, v171, v161, s86
    v_perm_b32 v221, v171, v161, s87
    v_dot2_f32_bf16 v54, v220, v227, v54
    v_dot2_f32_bf16 v55, v221, v227, v55
    s_waitcnt lgkmcnt(13)
    v_perm_b32 v222, v172, v162, s86
    v_perm_b32 v223, v172, v162, s87
    v_dot2_f32_bf16 v56, v222, v227, v56
    v_dot2_f32_bf16 v57, v223, v227, v57
    v_perm_b32 v224, v173, v163, s86
    v_perm_b32 v225, v173, v163, s87
    v_dot2_f32_bf16 v58, v224, v227, v58
    v_dot2_f32_bf16 v59, v225, v227, v59
    v_perm_b32 v218, v174, v164, s86
    v_perm_b32 v219, v174, v164, s87
    v_dot2_f32_bf16 v60, v218, v227, v60
    v_dot2_f32_bf16 v61, v219, v227, v61
    v_perm_b32 v220, v175, v165, s86
    v_perm_b32 v221, v175, v165, s87
    v_dot2_f32_bf16 v62, v220, v227, v62
    v_dot2_f32_bf16 v63, v221, v227, v63
    s_waitcnt lgkmcnt(12)
    v_perm_b32 v222, v176, v166, s86
    v_perm_b32 v223, v176, v166, s87
    v_dot2_f32_bf16 v64, v222, v227, v64
    v_dot2_f32_bf16 v65, v223, v227, v65
    v_perm_b32 v224, v177, v167, s86
    v_perm_b32 v225, v177, v167, s87
    v_dot2_f32_bf16 v66, v224, v227, v66
    v_dot2_f32_bf16 v67, v225, v227, v67
    s_mov_b32 s86, 0x05040100
    s_mov_b32 s87, 0x07060302
    s_waitcnt lgkmcnt(8)
    v_perm_b32 v218, v188, v178, s86
    v_perm_b32 v219, v188, v178, s87
    v_dot2_f32_bf16 v48, v218, v228, v48
    v_dot2_f32_bf16 v49, v219, v228, v49
    v_perm_b32 v220, v189, v179, s86
    v_perm_b32 v221, v189, v179, s87
    v_dot2_f32_bf16 v50, v220, v228, v50
    v_dot2_f32_bf16 v51, v221, v228, v51
    v_perm_b32 v222, v190, v180, s86
    v_perm_b32 v223, v190, v180, s87
    v_dot2_f32_bf16 v52, v222, v228, v52
    v_dot2_f32_bf16 v53, v223, v228, v53
    v_perm_b32 v224, v191, v181, s86
    v_perm_b32 v225, v191, v181, s87
    v_dot2_f32_bf16 v54, v224, v228, v54
    v_dot2_f32_bf16 v55, v225, v228, v55
    s_waitcnt lgkmcnt(7)
    v_perm_b32 v218, v192, v182, s86
    v_perm_b32 v219, v192, v182, s87
    v_dot2_f32_bf16 v56, v218, v228, v56
    v_dot2_f32_bf16 v57, v219, v228, v57
    v_perm_b32 v220, v193, v183, s86
    v_perm_b32 v221, v193, v183, s87
    v_dot2_f32_bf16 v58, v220, v228, v58
    v_dot2_f32_bf16 v59, v221, v228, v59
    v_perm_b32 v222, v194, v184, s86
    v_perm_b32 v223, v194, v184, s87
    v_dot2_f32_bf16 v60, v222, v228, v60
    v_dot2_f32_bf16 v61, v223, v228, v61
    v_perm_b32 v224, v195, v185, s86
    v_perm_b32 v225, v195, v185, s87
    v_dot2_f32_bf16 v62, v224, v228, v62
    v_dot2_f32_bf16 v63, v225, v228, v63
    s_waitcnt lgkmcnt(6)
    v_perm_b32 v218, v196, v186, s86
    v_perm_b32 v219, v196, v186, s87
    v_dot2_f32_bf16 v64, v218, v228, v64
    v_dot2_f32_bf16 v65, v219, v228, v65
    v_perm_b32 v220, v197, v187, s86
    v_perm_b32 v221, v197, v187, s87
    v_dot2_f32_bf16 v66, v220, v228, v66
    v_dot2_f32_bf16 v67, v221, v228, v67
    s_waitcnt lgkmcnt(2)
    v_perm_b32 v222, v208, v198, s86
    v_perm_b32 v223, v208, v198, s87
    v_dot2_f32_bf16 v48, v222, v229, v48
    v_dot2_f32_bf16 v49, v223, v229, v49
    v_perm_b32 v224, v209, v199, s86
    v_perm_b32 v225, v209, v199, s87
    v_dot2_f32_bf16 v50, v224, v229, v50
    v_dot2_f32_bf16 v51, v225, v229, v51
    v_perm_b32 v218, v210, v200, s86
    v_perm_b32 v219, v210, v200, s87
    v_dot2_f32_bf16 v52, v218, v229, v52
    v_dot2_f32_bf16 v53, v219, v229, v53
    v_perm_b32 v220, v211, v201, s86
    v_perm_b32 v221, v211, v201, s87
    v_dot2_f32_bf16 v54, v220, v229, v54
    v_dot2_f32_bf16 v55, v221, v229, v55
    s_waitcnt lgkmcnt(1)
    v_perm_b32 v222, v212, v202, s86
    v_perm_b32 v223, v212, v202, s87
    v_dot2_f32_bf16 v56, v222, v229, v56
    v_dot2_f32_bf16 v57, v223, v229, v57
    v_perm_b32 v224, v213, v203, s86
    v_perm_b32 v225, v213, v203, s87
    v_dot2_f32_bf16 v58, v224, v229, v58
    v_dot2_f32_bf16 v59, v225, v229, v59
    v_perm_b32 v218, v214, v204, s86
    v_perm_b32 v219, v214, v204, s87
    v_dot2_f32_bf16 v60, v218, v229, v60
    v_dot2_f32_bf16 v61, v219, v229, v61
    v_perm_b32 v220, v215, v205, s86
    v_perm_b32 v221, v215, v205, s87
    v_dot2_f32_bf16 v62, v220, v229, v62
    v_dot2_f32_bf16 v63, v221, v229, v63
    s_waitcnt lgkmcnt(0)
    v_perm_b32 v222, v216, v206, s86
    v_perm_b32 v223, v216, v206, s87
    v_dot2_f32_bf16 v64, v222, v229, v64
    v_dot2_f32_bf16 v65, v223, v229, v65
    v_perm_b32 v224, v217, v207, s86
    v_perm_b32 v225, v217, v207, s87
    v_dot2_f32_bf16 v66, v224, v229, v66
    v_dot2_f32_bf16 v67, v225, v229, v67
    v_cvt_pk_bf16_f32 v72, v48, v49
    v_cvt_pk_bf16_f32 v73, v50, v51
    v_cvt_pk_bf16_f32 v74, v52, v53
    v_cvt_pk_bf16_f32 v75, v54, v55
    v_cvt_pk_bf16_f32 v76, v56, v57
    v_cvt_pk_bf16_f32 v77, v58, v59
    v_cvt_pk_bf16_f32 v78, v60, v61
    v_cvt_pk_bf16_f32 v79, v62, v63
    v_cvt_pk_bf16_f32 v80, v64, v65
    v_cvt_pk_bf16_f32 v81, v66, v67
    s_mov_b32 s86, 58720256
    buffer_store_dwordx4 v[72:75], v230, s[16:19], s86 offen sc1
    buffer_store_dwordx4 v[76:79], v231, s[16:19], s86 offen sc1
    buffer_store_dwordx2 v[80:81], v232, s[16:19], s86 offen sc1
    s_mov_b32 s55, 73408512
    s_mov_b32 s56, 1048576
    s_branch L_pollA_c
L_pollA:
    buffer_load_dwordx4 v[16:19], v240, s[16:19], s55 offen offset:0 sc1
    buffer_load_dwordx4 v[20:23], v240, s[16:19], s55 offen offset:1024 sc1
    buffer_load_dwordx4 v[24:27], v240, s[16:19], s55 offen offset:2048 sc1
    buffer_load_dwordx4 v[28:31], v240, s[16:19], s55 offen offset:3072 sc1
    s_waitcnt vmcnt(0)
L_pollA_c:
    v_xor_b32 v16, s84, v16
    v_xor_b32 v17, s85, v17
    v_xor_b32 v18, s84, v18
    v_xor_b32 v19, s85, v19
    v_xor_b32 v20, s84, v20
    v_xor_b32 v21, s85, v21
    v_xor_b32 v22, s84, v22
    v_xor_b32 v23, s85, v23
    v_xor_b32 v24, s84, v24
    v_xor_b32 v25, s85, v25
    v_xor_b32 v26, s84, v26
    v_xor_b32 v27, s85, v27
    v_xor_b32 v28, s84, v28
    v_xor_b32 v29, s85, v29
    v_xor_b32 v30, s84, v30
    v_xor_b32 v31, s85, v31
    v_or3_b32 v16, v16, v17, v18
    v_or3_b32 v16, v16, v19, v20
    v_or3_b32 v16, v16, v21, v22
    v_or3_b32 v16, v16, v23, v24
    v_or3_b32 v16, v16, v25, v26
    v_or3_b32 v16, v16, v27, v28
    v_or3_b32 v16, v16, v29, v30
    v_or_b32 v16, v16, v31
    v_cmp_ne_u32 vcc, 0, v16
    s_cbranch_vccz L_pollA_ok
    s_sleep 4
    s_sub_u32 s56, s56, 1
    s_cmp_lg_u32 s56, 0
    s_cbranch_scc1 L_pollA
L_pollA_ok:
    s_branch L_att_done
L_lo_ld1:
    s_mov_b32 s56, 4194304
L_lo_ld1_l:
    ds_read_b32 v253, v250
    s_waitcnt lgkmcnt(0)
    v_cmp_gt_u32 vcc, s57, v253
    s_cbranch_vccz L_lo_ld1_r
    s_sleep 1
    s_sub_u32 s56, s56, 1
    s_cmp_lg_u32 s56, 0
    s_cbranch_scc1 L_lo_ld1_l
    s_branch L_lo_ld1_r
L_lo_ld2:
    s_mov_b32 s56, 4194304
L_lo_ld2_l:
    ds_read_b32 v253, v250
    s_waitcnt lgkmcnt(0)
    v_cmp_gt_u32 vcc, s57, v253
    s_cbranch_vccz L_lo_ld2_r
    s_sleep 1
    s_sub_u32 s56, s56, 1
    s_cmp_lg_u32 s56, 0
    s_cbranch_scc1 L_lo_ld2_l
    s_branch L_lo_ld2_r
L_lo_ld3:
    s_mov_b32 s56, 4194304
L_lo_ld3_l:
    ds_read_b32 v253, v250
    s_waitcnt lgkmcnt(0)
    v_cmp_gt_u32 vcc, s57, v253
    s_cbranch_vccz L_lo_ld3_r
    s_sleep 1
    s_sub_u32 s56, s56, 1
    s_cmp_lg_u32 s56, 0
    s_cbranch_scc1 L_lo_ld3_l
    s_branch L_lo_ld3_r
L_lo_ld4:
    s_mov_b32 s56, 4194304
L_lo_ld4_l:
    ds_read_b32 v253, v250
    s_waitcnt lgkmcnt(0)
    v_cmp_gt_u32 vcc, s57, v253
    s_cbranch_vccz L_lo_ld4_r
    s_sleep 1
    s_sub_u32 s56, s56, 1
    s_cmp_lg_u32 s56, 0
    s_cbranch_scc1 L_lo_ld4_l
    s_branch L_lo_ld4_r
L_lo_ld5:
    s_mov_b32 s56, 4194304
L_lo_ld5_l:
    ds_read_b32 v253, v250
    s_waitcnt lgkmcnt(0)
    v_cmp_gt_u32 vcc, s57, v253
    s_cbranch_vccz L_lo_ld5_r
    s_sleep 1
    s_sub_u32 s56, s56, 1
    s_cmp_lg_u32 s56, 0
    s_cbranch_scc1 L_lo_ld5_l
    s_branch L_lo_ld5_r
L_lo_ld6:
    s_mov_b32 s56, 4194304
L_lo_ld6_l:
    ds_read_b32 v253, v250
    s_waitcnt lgkmcnt(0)
    v_cmp_gt_u32 vcc, s57, v253
    s_cbranch_vccz L_lo_ld6_r
    s_sleep 1
    s_sub_u32 s56, s56, 1
    s_cmp_lg_u32 s56, 0
    s_cbranch_scc1 L_lo_ld6_l
    s_branch L_lo_ld6_r
L_lo_ld7:
    s_mov_b32 s56, 4194304
L_lo_ld7_l:
    ds_read_b32 v253, v250
    s_waitcnt lgkmcnt(0)
    v_cmp_gt_u32 vcc, s57, v253
    s_cbranch_vccz L_lo_ld7_r
    s_sleep 1
    s_sub_u32 s56, s56, 1
    s_cmp_lg_u32 s56, 0
    s_cbranch_scc1 L_lo_ld7_l
    s_branch L_lo_ld7_r
L_lo_ld8:
    s_mov_b32 s56, 4194304
L_lo_ld8_l:
    ds_read_b32 v253, v250
    s_waitcnt lgkmcnt(0)
    v_cmp_gt_u32 vcc, s57, v253
    s_cbranch_vccz L_lo_ld8_r
    s_sleep 1
    s_sub_u32 s56, s56, 1
    s_cmp_lg_u32 s56, 0
    s_cbranch_scc1 L_lo_ld8_l
    s_branch L_lo_ld8_r
L_lo_ld9:
    s_mov_b32 s56, 4194304
L_lo_ld9_l:
    ds_read_b32 v253, v250
    s_waitcnt lgkmcnt(0)
    v_cmp_gt_u32 vcc, s57, v253
    s_cbranch_vccz L_lo_ld9_r
    s_sleep 1
    s_sub_u32 s56, s56, 1
    s_cmp_lg_u32 s56, 0
    s_cbranch_scc1 L_lo_ld9_l
    s_branch L_lo_ld9_r
L_lo_ld10:
    s_mov_b32 s56, 4194304
L_lo_ld10_l:
    ds_read_b32 v253, v250
    s_waitcnt lgkmcnt(0)
    v_cmp_gt_u32 vcc, s57, v253
    s_cbranch_vccz L_lo_ld10_r
    s_sleep 1
    s_sub_u32 s56, s56, 1
    s_cmp_lg_u32 s56, 0
    s_cbranch_scc1 L_lo_ld10_l
    s_branch L_lo_ld10_r
L_lo_ldr:
    s_mov_b32 s56, 4194304
L_lo_ldr_l:
    ds_read_b32 v253, v250
    s_waitcnt lgkmcnt(0)
    v_cmp_gt_u32 vcc, s57, v253
    s_cbranch_vccz L_lo_ldr_r
    s_sleep 1
    s_sub_u32 s56, s56, 1
    s_cmp_lg_u32 s56, 0
    s_cbranch_scc1 L_lo_ldr_l
    s_branch L_lo_ldr_r
L_att_done:
    s_lshr_b32 s79, s52, 1
    s_and_b32 s77, s52, 1
    s_lshl_b32 s55, s71, 1
    s_add_u32 s77, s77, s55
    s_and_b32 s78, s53, 3
    s_lshl_b32 s80, s77, 2
    s_add_u32 s80, s80, s78
    s_and_b32 s55, s54, 2
    s_lshl_b32 s55, s55, 12
    s_and_b32 s56, s54, 1
    s_lshl_b32 s56, s56, 11
    s_add_u32 s55, s55, s56
    v_add_u32 v232, s55, v240
    s_lshr_b32 s56, s54, 2
    s_mul_i32 s55, s56, 10240
    s_add_u32 s55, s55, 65536
    v_add_u32 v233, s55, v240
    v_add_u32 v234, 40960, v233
    s_mul_i32 s55, s56, 3072
    s_add_u32 s55, s55, 65536
    v_add_u32 v237, s55, v240
    v_add_u32 v238, 40960, v237
    s_and_b32 s55, s54, 3
    s_lshl_b32 s56, s55, 10
    v_add_u32 v236, s56, v240
    v_bfe_u32 v242, v241, 0, 4
    v_mul_u32_u24 v242, 2560, v242
    v_bfe_u32 v243, v241, 4, 2
    v_lshl_add_u32 v235, v243, 3, v242
    s_lshl_b32 s88, s77, 2
    s_add_u32 s88, s88, s79
    s_mul_i32 s88, s88, 81920
    s_lshl_b32 s55, s78, 1
    s_lshr_b32 s56, s54, 2
    s_add_u32 s55, s55, s56
    s_mul_i32 s55, s55, 160
    s_add_u32 s88, s88, s55
    s_lshl_b32 s61, s77, 1
    s_lshr_b32 s55, s79, 1
    s_add_u32 s61, s61, s55
    s_lshl_b32 s62, s78, 1
    s_and_b32 s55, s79, 1
    s_add_u32 s62, s62, s55
    s_lshl_b32 s82, s61, 2
    s_and_b32 s55, s54, 3
    s_add_u32 s82, s82, s55
    s_mul_i32 s82, s82, 40960
    s_mul_i32 s55, s62, 160
    s_add_u32 s82, s82, s55
    s_lshr_b32 s55, s54, 2
    s_mul_i32 s55, s55, 96
    s_add_u32 s82, s82, s55
    s_cmp_lt_u32 s54, 4
    s_cbranch_scc0 L_o_lo
    s_and_b32 s55, s54, 3
    s_mul_i32 s87, s55, 4096
    s_lshl_b32 s86, s77, 1
    s_bfe_u32 s56, s54, 0x10001
    s_add_u32 s86, s86, s56
    s_lshl_b32 s86, s86, 7
    s_lshl_b32 s56, s79, 5
    s_add_u32 s86, s86, s56
    s_and_b32 s56, s54, 1
    s_add_u32 s86, s86, s56
    s_mul_i32 s86, s86, 4096
    s_add_u32 s86, s86, 33554432
    s_mul_i32 s76, s61, 81920
    s_add_u32 s76, s76, s87
    s_add_u32 s76, s76, 58720256
    v_mov_b32 v130, 161792
    s_lshl_b32 s72, s77, 10
    s_lshl_b32 s56, s79, 6
    s_add_u32 s72, s72, s56
    s_add_u32 s72, s72, 73416704
    v_bfe_u32 v242, v241, 3, 2
    v_bfe_u32 v243, v241, 0, 3
    v_lshlrev_b32 v243, 3, v243
    v_lshl_add_u32 v131, v242, 8, v243
    s_lshl_b32 s55, s73, 8
    s_lshl_b32 s56, s70, 3
    s_add_u32 s55, s55, s56
    s_add_u32 s55, s55, 73416704
    v_mov_b32 v242, s84
    v_mov_b32 v243, s85
    v_mov_b32 v244, 0
    s_waitcnt vmcnt(0)
    s_mov_b64 exec, 1
    buffer_store_dwordx2 v[242:243], v244, s[16:19], s55 offen sc1
    s_mov_b64 exec, -1
    s_cmp_lg_u32 s54, 0
    s_cbranch_scc1 L_nodec
    s_mov_b32 s56, 1048576
    v_mov_b32 v128, v216
    v_mov_b32 v129, v217
L_dec:
    v_xor_b32 v128, s84, v128
    v_xor_b32 v129, s85, v129
    v_or_b32 v128, v128, v129
    v_cmp_ne_u32 vcc, 0, v128
    s_mov_b32 s55, 0x7fffffff
    s_and_b32 s57, vcc_lo, 0x0f0f0f0f
    s_cbranch_scc0 L_decd
    s_mov_b32 s55, 0x7ffffffe
    s_and_b32 s57, vcc_lo, 0xf0f0f0f0
    s_cbranch_scc0 L_decd
    s_sleep 2
    buffer_load_dwordx2 v[128:129], v131, s[16:19], s72 offen sc1
    s_waitcnt vmcnt(0)
    s_sub_u32 s56, s56, 1
    s_cbranch_scc0 L_dec
L_decd:
    v_mov_b32 v128, s55
    ds_write_b32 v130, v128
L_nodec:
    s_waitcnt lgkmcnt(0)
    s_barrier
    ds_read_b32 v132, v130
    s_waitcnt lgkmcnt(0)
    v_readfirstlane_b32 s55, v132
    s_nop 0
    s_bitcmp1_b32 s55, 0
    s_cselect_b32 s56, 0, 65536
    s_cselect_b32 s89, 0, 4294836224
    s_add_u32 s86, s86, s56
    s_add_u32 m0, s87, 0
    s_add_u32 s57, s86, 4096
    buffer_load_dwordx4 v240, s[16:19], s86 offen offset:0 sc1 lds
    buffer_load_dwordx4 v240, s[16:19], s86 offen offset:1024 sc1 lds
    buffer_load_dwordx4 v240, s[16:19], s86 offen offset:2048 sc1 lds
    buffer_load_dwordx4 v240, s[16:19], s86 offen offset:3072 sc1 lds
    s_add_u32 s86, s86, 8192
    s_add_u32 m0, s87, 16384
    s_add_u32 s57, s86, 4096
    buffer_load_dwordx4 v240, s[16:19], s86 offen offset:0 sc1 lds
    buffer_load_dwordx4 v240, s[16:19], s86 offen offset:1024 sc1 lds
    buffer_load_dwordx4 v240, s[16:19], s86 offen offset:2048 sc1 lds
    buffer_load_dwordx4 v240, s[16:19], s86 offen offset:3072 sc1 lds
    s_add_u32 s86, s86, 8192
    s_add_u32 m0, s87, 32768
    s_add_u32 s57, s86, 4096
    buffer_load_dwordx4 v240, s[16:19], s86 offen offset:0 sc1 lds
    buffer_load_dwordx4 v240, s[16:19], s86 offen offset:1024 sc1 lds
    buffer_load_dwordx4 v240, s[16:19], s86 offen offset:2048 sc1 lds
    buffer_load_dwordx4 v240, s[16:19], s86 offen offset:3072 sc1 lds
    s_add_u32 s86, s86, 8192
    s_add_u32 m0, s87, 49152
    s_add_u32 s57, s86, 4096
    buffer_load_dwordx4 v240, s[16:19], s86 offen offset:0 sc1 lds
    buffer_load_dwordx4 v240, s[16:19], s86 offen offset:1024 sc1 lds
    buffer_load_dwordx4 v240, s[16:19], s86 offen offset:2048 sc1 lds
    buffer_load_dwordx4 v240, s[16:19], s86 offen offset:3072 sc1 lds
    s_add_u32 s86, s86, 8192
    s_mov_b32 s73, 0
    s_waitcnt vmcnt(12)
    s_barrier
    ds_read_b128 v[52:55], v232 offset:0
    ds_read_b128 v[60:63], v233 offset:0
    ds_read_b128 v[56:59], v232 offset:1024
    ds_read_b128 v[64:67], v233 offset:1024
    ds_read_b128 v[68:71], v233 offset:2048
    ds_read_b128 v[72:75], v233 offset:3072
    ds_read_b128 v[76:79], v233 offset:4096
    s_waitcnt lgkmcnt(5)
    v_mfma_f32_16x16x32_bf16 v[0:3], v[60:63], v[52:55], 0
    ds_read_b128 v[80:83], v232 offset:4096
    s_waitcnt lgkmcnt(5)
    v_mfma_f32_16x16x32_bf16 v[20:23], v[60:63], v[56:59], 0
    ds_read_b128 v[88:91], v233 offset:5120
    s_waitcnt lgkmcnt(5)
    v_mfma_f32_16x16x32_bf16 v[24:27], v[64:67], v[56:59], 0
    ds_read_b128 v[84:87], v232 offset:5120
    v_mfma_f32_16x16x32_bf16 v[4:7], v[64:67], v[52:55], 0
    s_waitcnt lgkmcnt(5)
    v_mfma_f32_16x16x32_bf16 v[8:11], v[68:71], v[52:55], 0
    ds_read_b128 v[92:95], v233 offset:6144
    v_mfma_f32_16x16x32_bf16 v[28:31], v[68:71], v[56:59], 0
    ds_read_b128 v[96:99], v233 offset:7168
    s_waitcnt lgkmcnt(6)
    v_mfma_f32_16x16x32_bf16 v[32:35], v[72:75], v[56:59], 0
    v_mfma_f32_16x16x32_bf16 v[12:15], v[72:75], v[52:55], 0
    ds_read_b128 v[100:103], v233 offset:8192
    s_waitcnt lgkmcnt(6)
    v_mfma_f32_16x16x32_bf16 v[16:19], v[76:79], v[52:55], 0
    ds_read_b128 v[104:107], v233 offset:9216
    v_mfma_f32_16x16x32_bf16 v[36:39], v[76:79], v[56:59], 0
    s_waitcnt lgkmcnt(5)
    v_mfma_f32_16x16x32_bf16 v[0:3], v[88:91], v[80:83], v[0:3]
    s_waitcnt vmcnt(8)
    s_waitcnt lgkmcnt(0)
    s_barrier
    ds_read_b128 v[52:55], v232 offset:16384
    v_mfma_f32_16x16x32_bf16 v[20:23], v[88:91], v[84:87], v[20:23]
    s_add_u32 m0, s87, 0
    s_add_u32 s57, s86, 4096
    buffer_load_dwordx4 v240, s[16:19], s86 offen offset:0 sc1 lds
    v_mfma_f32_16x16x32_bf16 v[24:27], v[92:95], v[84:87], v[24:27]
    ds_read_b128 v[60:63], v233 offset:20480
    v_mfma_f32_16x16x32_bf16 v[4:7], v[92:95], v[80:83], v[4:7]
    ds_read_b128 v[56:59], v232 offset:17408
    v_mfma_f32_16x16x32_bf16 v[8:11], v[96:99], v[80:83], v[8:11]
    buffer_load_dwordx4 v240, s[16:19], s86 offen offset:1024 sc1 lds
    v_mfma_f32_16x16x32_bf16 v[28:31], v[96:99], v[84:87], v[28:31]
    ds_read_b128 v[64:67], v233 offset:21504
    v_mfma_f32_16x16x32_bf16 v[32:35], v[100:103], v[84:87], v[32:35]
    ds_read_b128 v[68:71], v233 offset:22528
    v_mfma_f32_16x16x32_bf16 v[12:15], v[100:103], v[80:83], v[12:15]
    buffer_load_dwordx4 v240, s[16:19], s86 offen offset:2048 sc1 lds
    v_mfma_f32_16x16x32_bf16 v[16:19], v[104:107], v[80:83], v[16:19]
    ds_read_b128 v[72:75], v233 offset:23552
    v_mfma_f32_16x16x32_bf16 v[36:39], v[104:107], v[84:87], v[36:39]
    ds_read_b128 v[76:79], v233 offset:24576
    s_waitcnt lgkmcnt(5)
    v_mfma_f32_16x16x32_bf16 v[0:3], v[60:63], v[52:55], v[0:3]
    ds_read_b128 v[80:83], v232 offset:20480
    s_waitcnt lgkmcnt(5)
    v_mfma_f32_16x16x32_bf16 v[20:23], v[60:63], v[56:59], v[20:23]
    buffer_load_dwordx4 v240, s[16:19], s86 offen offset:3072 sc1 lds
    s_waitcnt lgkmcnt(4)
    v_mfma_f32_16x16x32_bf16 v[24:27], v[64:67], v[56:59], v[24:27]
    ds_read_b128 v[88:91], v233 offset:25600
    v_mfma_f32_16x16x32_bf16 v[4:7], v[64:67], v[52:55], v[4:7]
    ds_read_b128 v[84:87], v232 offset:21504
    s_waitcnt lgkmcnt(5)
    v_mfma_f32_16x16x32_bf16 v[8:11], v[68:71], v[52:55], v[8:11]
    s_add_u32 s86, s86, 8192
    v_mfma_f32_16x16x32_bf16 v[28:31], v[68:71], v[56:59], v[28:31]
    ds_read_b128 v[92:95], v233 offset:26624
    s_waitcnt lgkmcnt(5)
    v_mfma_f32_16x16x32_bf16 v[32:35], v[72:75], v[56:59], v[32:35]
    ds_read_b128 v[96:99], v233 offset:27648
    v_mfma_f32_16x16x32_bf16 v[12:15], v[72:75], v[52:55], v[12:15]
    ds_read_b128 v[100:103], v233 offset:28672
    s_waitcnt lgkmcnt(6)
    v_mfma_f32_16x16x32_bf16 v[16:19], v[76:79], v[52:55], v[16:19]
    ds_read_b128 v[104:107], v233 offset:29696
    v_mfma_f32_16x16x32_bf16 v[36:39], v[76:79], v[56:59], v[36:39]
    s_waitcnt lgkmcnt(5)
    v_mfma_f32_16x16x32_bf16 v[0:3], v[88:91], v[80:83], v[0:3]
    s_waitcnt vmcnt(8)
    s_waitcnt lgkmcnt(0)
    s_barrier
    ds_read_b128 v[52:55], v232 offset:32768
    v_mfma_f32_16x16x32_bf16 v[20:23], v[88:91], v[84:87], v[20:23]
    s_add_u32 m0, s87, 16384
    s_add_u32 s57, s86, 4096
    buffer_load_dwordx4 v240, s[16:19], s86 offen offset:0 sc1 lds
    v_mfma_f32_16x16x32_bf16 v[24:27], v[92:95], v[84:87], v[24:27]
    ds_read_b128 v[60:63], v234 offset:0
    v_mfma_f32_16x16x32_bf16 v[4:7], v[92:95], v[80:83], v[4:7]
    ds_read_b128 v[56:59], v232 offset:33792
    v_mfma_f32_16x16x32_bf16 v[8:11], v[96:99], v[80:83], v[8:11]
    buffer_load_dwordx4 v240, s[16:19], s86 offen offset:1024 sc1 lds
    v_mfma_f32_16x16x32_bf16 v[28:31], v[96:99], v[84:87], v[28:31]
    ds_read_b128 v[64:67], v234 offset:1024
    v_mfma_f32_16x16x32_bf16 v[32:35], v[100:103], v[84:87], v[32:35]
    ds_read_b128 v[68:71], v234 offset:2048
    v_mfma_f32_16x16x32_bf16 v[12:15], v[100:103], v[80:83], v[12:15]
    buffer_load_dwordx4 v240, s[16:19], s86 offen offset:2048 sc1 lds
    v_mfma_f32_16x16x32_bf16 v[16:19], v[104:107], v[80:83], v[16:19]
    ds_read_b128 v[72:75], v234 offset:3072
    v_mfma_f32_16x16x32_bf16 v[36:39], v[104:107], v[84:87], v[36:39]
    ds_read_b128 v[76:79], v234 offset:4096
    s_waitcnt lgkmcnt(5)
    v_mfma_f32_16x16x32_bf16 v[0:3], v[60:63], v[52:55], v[0:3]
    ds_read_b128 v[80:83], v232 offset:36864
    s_waitcnt lgkmcnt(5)
    v_mfma_f32_16x16x32_bf16 v[20:23], v[60:63], v[56:59], v[20:23]
    buffer_load_dwordx4 v240, s[16:19], s86 offen offset:3072 sc1 lds
    s_waitcnt lgkmcnt(4)
    v_mfma_f32_16x16x32_bf16 v[24:27], v[64:67], v[56:59], v[24:27]
    ds_read_b128 v[88:91], v234 offset:5120
    v_mfma_f32_16x16x32_bf16 v[4:7], v[64:67], v[52:55], v[4:7]
    ds_read_b128 v[84:87], v232 offset:37888
    s_waitcnt lgkmcnt(5)
    v_mfma_f32_16x16x32_bf16 v[8:11], v[68:71], v[52:55], v[8:11]
    s_add_u32 s86, s86, 8192
    v_mfma_f32_16x16x32_bf16 v[28:31], v[68:71], v[56:59], v[28:31]
    ds_read_b128 v[92:95], v234 offset:6144
    s_waitcnt lgkmcnt(5)
    v_mfma_f32_16x16x32_bf16 v[32:35], v[72:75], v[56:59], v[32:35]
    ds_read_b128 v[96:99], v234 offset:7168
    v_mfma_f32_16x16x32_bf16 v[12:15], v[72:75], v[52:55], v[12:15]
    ds_read_b128 v[100:103], v234 offset:8192
    s_waitcnt lgkmcnt(6)
    v_mfma_f32_16x16x32_bf16 v[16:19], v[76:79], v[52:55], v[16:19]
    ds_read_b128 v[104:107], v234 offset:9216
    v_mfma_f32_16x16x32_bf16 v[36:39], v[76:79], v[56:59], v[36:39]
    buffer_load_dwordx2 v[128:129], v131, s[16:19], s72 offen sc1
    s_waitcnt lgkmcnt(5)
    v_mfma_f32_16x16x32_bf16 v[0:3], v[88:91], v[80:83], v[0:3]
    s_waitcnt vmcnt(9)
    s_waitcnt lgkmcnt(0)
    s_barrier
    ds_read_b128 v[52:55], v232 offset:49152
    v_mfma_f32_16x16x32_bf16 v[20:23], v[88:91], v[84:87], v[20:23]
    s_add_u32 m0, s87, 32768
    s_add_u32 s57, s86, 4096
    buffer_load_dwordx4 v240, s[16:19], s86 offen offset:0 sc1 lds
    v_mfma_f32_16x16x32_bf16 v[24:27], v[92:95], v[84:87], v[24:27]
    ds_read_b128 v[60:63], v234 offset:20480
    v_mfma_f32_16x16x32_bf16 v[4:7], v[92:95], v[80:83], v[4:7]
    ds_read_b128 v[56:59], v232 offset:50176
    v_mfma_f32_16x16x32_bf16 v[8:11], v[96:99], v[80:83], v[8:11]
    buffer_load_dwordx4 v240, s[16:19], s86 offen offset:1024 sc1 lds
    v_mfma_f32_16x16x32_bf16 v[28:31], v[96:99], v[84:87], v[28:31]
    ds_read_b128 v[64:67], v234 offset:21504
    v_mfma_f32_16x16x32_bf16 v[32:35], v[100:103], v[84:87], v[32:35]
    ds_read_b128 v[68:71], v234 offset:22528
    v_mfma_f32_16x16x32_bf16 v[12:15], v[100:103], v[80:83], v[12:15]
    buffer_load_dwordx4 v240, s[16:19], s86 offen offset:2048 sc1 lds
    v_mfma_f32_16x16x32_bf16 v[16:19], v[104:107], v[80:83], v[16:19]
    ds_read_b128 v[72:75], v234 offset:23552
    v_mfma_f32_16x16x32_bf16 v[36:39], v[104:107], v[84:87], v[36:39]
    ds_read_b128 v[76:79], v234 offset:24576
    s_waitcnt lgkmcnt(5)
    v_mfma_f32_16x16x32_bf16 v[0:3], v[60:63], v[52:55], v[0:3]
    ds_read_b128 v[80:83], v232 offset:53248
    s_waitcnt lgkmcnt(5)
    v_mfma_f32_16x16x32_bf16 v[20:23], v[60:63], v[56:59], v[20:23]
    buffer_load_dwordx4 v240, s[16:19], s86 offen offset:3072 sc1 lds
    s_waitcnt lgkmcnt(4)
    v_mfma_f32_16x16x32_bf16 v[24:27], v[64:67], v[56:59], v[24:27]
    ds_read_b128 v[88:91], v234 offset:25600
    v_mfma_f32_16x16x32_bf16 v[4:7], v[64:67], v[52:55], v[4:7]
    ds_read_b128 v[84:87], v232 offset:54272
    s_waitcnt lgkmcnt(5)
    v_mfma_f32_16x16x32_bf16 v[8:11], v[68:71], v[52:55], v[8:11]
    s_add_u32 s86, s86, 8192
    v_mfma_f32_16x16x32_bf16 v[28:31], v[68:71], v[56:59], v[28:31]
    ds_read_b128 v[92:95], v234 offset:26624
    s_waitcnt lgkmcnt(5)
    v_mfma_f32_16x16x32_bf16 v[32:35], v[72:75], v[56:59], v[32:35]
    ds_read_b128 v[96:99], v234 offset:27648
    v_mfma_f32_16x16x32_bf16 v[12:15], v[72:75], v[52:55], v[12:15]
    ds_read_b128 v[100:103], v234 offset:28672
    s_waitcnt lgkmcnt(6)
    v_mfma_f32_16x16x32_bf16 v[16:19], v[76:79], v[52:55], v[16:19]
    ds_read_b128 v[104:107], v234 offset:29696
    v_mfma_f32_16x16x32_bf16 v[36:39], v[76:79], v[56:59], v[36:39]
    s_waitcnt lgkmcnt(5)
    v_mfma_f32_16x16x32_bf16 v[0:3], v[88:91], v[80:83], v[0:3]
    s_waitcnt vmcnt(9)
    s_waitcnt lgkmcnt(0)
    s_barrier
    ds_read_b128 v[52:55], v232 offset:0
    v_mfma_f32_16x16x32_bf16 v[20:23], v[88:91], v[84:87], v[20:23]
    s_add_u32 m0, s87, 49152
    s_add_u32 s57, s86, 4096
    buffer_load_dwordx4 v240, s[16:19], s86 offen offset:0 sc1 lds
    v_mfma_f32_16x16x32_bf16 v[24:27], v[92:95], v[84:87], v[24:27]
    ds_read_b128 v[60:63], v233 offset:0
    v_mfma_f32_16x16x32_bf16 v[4:7], v[92:95], v[80:83], v[4:7]
    ds_read_b128 v[56:59], v232 offset:1024
    v_mfma_f32_16x16x32_bf16 v[8:11], v[96:99], v[80:83], v[8:11]
    buffer_load_dwordx4 v240, s[16:19], s86 offen offset:1024 sc1 lds
    v_mfma_f32_16x16x32_bf16 v[28:31], v[96:99], v[84:87], v[28:31]
    ds_read_b128 v[64:67], v233 offset:1024
    v_mfma_f32_16x16x32_bf16 v[32:35], v[100:103], v[84:87], v[32:35]
    ds_read_b128 v[68:71], v233 offset:2048
    v_mfma_f32_16x16x32_bf16 v[12:15], v[100:103], v[80:83], v[12:15]
    buffer_load_dwordx4 v240, s[16:19], s86 offen offset:2048 sc1 lds
    v_mfma_f32_16x16x32_bf16 v[16:19], v[104:107], v[80:83], v[16:19]
    ds_read_b128 v[72:75], v233 offset:3072
    v_mfma_f32_16x16x32_bf16 v[36:39], v[104:107], v[84:87], v[36:39]
    ds_read_b128 v[76:79], v233 offset:4096
    s_waitcnt lgkmcnt(5)
    v_mfma_f32_16x16x32_bf16 v[0:3], v[60:63], v[52:55], v[0:3]
    ds_read_b128 v[80:83], v232 offset:4096
    s_waitcnt lgkmcnt(5)
    v_mfma_f32_16x16x32_bf16 v[20:23], v[60:63], v[56:59], v[20:23]
    buffer_load_dwordx4 v240, s[16:19], s86 offen offset:3072 sc1 lds
    s_waitcnt lgkmcnt(4)
    v_mfma_f32_16x16x32_bf16 v[24:27], v[64:67], v[56:59], v[24:27]
    ds_read_b128 v[88:91], v233 offset:5120
    v_mfma_f32_16x16x32_bf16 v[4:7], v[64:67], v[52:55], v[4:7]
    ds_read_b128 v[84:87], v232 offset:5120
    s_waitcnt lgkmcnt(5)
    v_mfma_f32_16x16x32_bf16 v[8:11], v[68:71], v[52:55], v[8:11]
    s_add_u32 s86, s86, 8192
    v_mfma_f32_16x16x32_bf16 v[28:31], v[68:71], v[56:59], v[28:31]
    ds_read_b128 v[92:95], v233 offset:6144
    s_waitcnt lgkmcnt(5)
    v_mfma_f32_16x16x32_bf16 v[32:35], v[72:75], v[56:59], v[32:35]
    ds_read_b128 v[96:99], v233 offset:7168
    v_mfma_f32_16x16x32_bf16 v[12:15], v[72:75], v[52:55], v[12:15]
    ds_read_b128 v[100:103], v233 offset:8192
    s_waitcnt lgkmcnt(6)
    v_mfma_f32_16x16x32_bf16 v[16:19], v[76:79], v[52:55], v[16:19]
    ds_read_b128 v[104:107], v233 offset:9216
    v_mfma_f32_16x16x32_bf16 v[36:39], v[76:79], v[56:59], v[36:39]
    s_waitcnt lgkmcnt(5)
    v_mfma_f32_16x16x32_bf16 v[0:3], v[88:91], v[80:83], v[0:3]
    s_waitcnt vmcnt(9)
    s_waitcnt lgkmcnt(0)
    s_barrier
    ds_read_b128 v[52:55], v232 offset:16384
    v_mfma_f32_16x16x32_bf16 v[20:23], v[88:91], v[84:87], v[20:23]
    s_waitcnt vmcnt(8)
    v_xor_b32 v128, s84, v128
    v_xor_b32 v129, s85, v129
    v_or_b32 v128, v128, v129
    v_cmp_ne_u32 vcc, 0, v128
    s_cbranch_vccz L_fcok
    v_mov_b32 v245, v131
    s_mov_b32 s56, 1048576
L_poll3:
    buffer_load_dwordx2 v[246:247], v245, s[16:19], s72 offen sc1
    s_waitcnt vmcnt(0)
    v_xor_b32 v246, s84, v246
    v_xor_b32 v247, s85, v247
    v_or_b32 v246, v246, v247
    v_cmp_ne_u32 vcc, 0, v246
    s_cbranch_vccz L_poll3_ok
    s_sleep 4
    s_sub_u32 s56, s56, 1
    s_cmp_lg_u32 s56, 0
    s_cbranch_scc1 L_poll3
L_poll3_ok:
L_fcok:
    s_add_u32 s86, s86, s89
    s_add_u32 m0, s87, 0
    s_add_u32 s57, s86, 4096
    buffer_load_dwordx4 v240, s[16:19], s86 offen offset:0 sc1 lds
    v_mfma_f32_16x16x32_bf16 v[24:27], v[92:95], v[84:87], v[24:27]
    ds_read_b128 v[60:63], v233 offset:20480
    v_mfma_f32_16x16x32_bf16 v[4:7], v[92:95], v[80:83], v[4:7]
    ds_read_b128 v[56:59], v232 offset:17408
    v_mfma_f32_16x16x32_bf16 v[8:11], v[96:99], v[80:83], v[8:11]
    buffer_load_dwordx4 v240, s[16:19], s86 offen offset:1024 sc1 lds
    v_mfma_f32_16x16x32_bf16 v[28:31], v[96:99], v[84:87], v[28:31]
    ds_read_b128 v[64:67], v233 offset:21504
    v_mfma_f32_16x16x32_bf16 v[32:35], v[100:103], v[84:87], v[32:35]
    ds_read_b128 v[68:71], v233 offset:22528
    v_mfma_f32_16x16x32_bf16 v[12:15], v[100:103], v[80:83], v[12:15]
    buffer_load_dwordx4 v240, s[16:19], s86 offen offset:2048 sc1 lds
    v_mfma_f32_16x16x32_bf16 v[16:19], v[104:107], v[80:83], v[16:19]
    ds_read_b128 v[72:75], v233 offset:23552
    v_mfma_f32_16x16x32_bf16 v[36:39], v[104:107], v[84:87], v[36:39]
    ds_read_b128 v[76:79], v233 offset:24576
    s_waitcnt lgkmcnt(5)
    v_mfma_f32_16x16x32_bf16 v[0:3], v[60:63], v[52:55], v[0:3]
    ds_read_b128 v[80:83], v232 offset:20480
    s_waitcnt lgkmcnt(5)
    v_mfma_f32_16x16x32_bf16 v[20:23], v[60:63], v[56:59], v[20:23]
    buffer_load_dwordx4 v240, s[16:19], s86 offen offset:3072 sc1 lds
    s_waitcnt lgkmcnt(4)
    v_mfma_f32_16x16x32_bf16 v[24:27], v[64:67], v[56:59], v[24:27]
    ds_read_b128 v[88:91], v233 offset:25600
    v_mfma_f32_16x16x32_bf16 v[4:7], v[64:67], v[52:55], v[4:7]
    ds_read_b128 v[84:87], v232 offset:21504
    s_waitcnt lgkmcnt(5)
    v_mfma_f32_16x16x32_bf16 v[8:11], v[68:71], v[52:55], v[8:11]
    s_add_u32 s86, s86, 8192
    v_mfma_f32_16x16x32_bf16 v[28:31], v[68:71], v[56:59], v[28:31]
    ds_read_b128 v[92:95], v233 offset:26624
    s_waitcnt lgkmcnt(5)
    v_mfma_f32_16x16x32_bf16 v[32:35], v[72:75], v[56:59], v[32:35]
    ds_read_b128 v[96:99], v233 offset:27648
    v_mfma_f32_16x16x32_bf16 v[12:15], v[72:75], v[52:55], v[12:15]
    ds_read_b128 v[100:103], v233 offset:28672
    s_waitcnt lgkmcnt(6)
    v_mfma_f32_16x16x32_bf16 v[16:19], v[76:79], v[52:55], v[16:19]
    ds_read_b128 v[104:107], v233 offset:29696
    v_mfma_f32_16x16x32_bf16 v[36:39], v[76:79], v[56:59], v[36:39]
    s_waitcnt lgkmcnt(5)
    v_mfma_f32_16x16x32_bf16 v[0:3], v[88:91], v[80:83], v[0:3]
    s_waitcnt vmcnt(8)
    s_waitcnt lgkmcnt(0)
    s_barrier
    ds_read_b128 v[52:55], v232 offset:32768
    v_mfma_f32_16x16x32_bf16 v[20:23], v[88:91], v[84:87], v[20:23]
    s_add_u32 m0, s87, 16384
    s_add_u32 s57, s86, 4096
    buffer_load_dwordx4 v240, s[16:19], s86 offen offset:0 sc1 lds
    v_mfma_f32_16x16x32_bf16 v[24:27], v[92:95], v[84:87], v[24:27]
    ds_read_b128 v[60:63], v234 offset:0
    v_mfma_f32_16x16x32_bf16 v[4:7], v[92:95], v[80:83], v[4:7]
    ds_read_b128 v[56:59], v232 offset:33792
    v_mfma_f32_16x16x32_bf16 v[8:11], v[96:99], v[80:83], v[8:11]
    buffer_load_dwordx4 v240, s[16:19], s86 offen offset:1024 sc1 lds
    v_mfma_f32_16x16x32_bf16 v[28:31], v[96:99], v[84:87], v[28:31]
    ds_read_b128 v[64:67], v234 offset:1024
    v_mfma_f32_16x16x32_bf16 v[32:35], v[100:103], v[84:87], v[32:35]
    ds_read_b128 v[68:71], v234 offset:2048
    v_mfma_f32_16x16x32_bf16 v[12:15], v[100:103], v[80:83], v[12:15]
    buffer_load_dwordx4 v240, s[16:19], s86 offen offset:2048 sc1 lds
    v_mfma_f32_16x16x32_bf16 v[16:19], v[104:107], v[80:83], v[16:19]
    ds_read_b128 v[72:75], v234 offset:3072
    v_mfma_f32_16x16x32_bf16 v[36:39], v[104:107], v[84:87], v[36:39]
    ds_read_b128 v[76:79], v234 offset:4096
    s_waitcnt lgkmcnt(5)
    v_mfma_f32_16x16x32_bf16 v[0:3], v[60:63], v[52:55], v[0:3]
    ds_read_b128 v[80:83], v232 offset:36864
    s_waitcnt lgkmcnt(5)
    v_mfma_f32_16x16x32_bf16 v[20:23], v[60:63], v[56:59], v[20:23]
    buffer_load_dwordx4 v240, s[16:19], s86 offen offset:3072 sc1 lds
    s_waitcnt lgkmcnt(4)
    v_mfma_f32_16x16x32_bf16 v[24:27], v[64:67], v[56:59], v[24:27]
    ds_read_b128 v[88:91], v234 offset:5120
    v_mfma_f32_16x16x32_bf16 v[4:7], v[64:67], v[52:55], v[4:7]
    ds_read_b128 v[84:87], v232 offset:37888
    s_waitcnt lgkmcnt(5)
    v_mfma_f32_16x16x32_bf16 v[8:11], v[68:71], v[52:55], v[8:11]
    s_add_u32 s86, s86, 8192
    v_mfma_f32_16x16x32_bf16 v[28:31], v[68:71], v[56:59], v[28:31]
    ds_read_b128 v[92:95], v234 offset:6144
    s_waitcnt lgkmcnt(5)
    v_mfma_f32_16x16x32_bf16 v[32:35], v[72:75], v[56:59], v[32:35]
    ds_read_b128 v[96:99], v234 offset:7168
    v_mfma_f32_16x16x32_bf16 v[12:15], v[72:75], v[52:55], v[12:15]
    ds_read_b128 v[100:103], v234 offset:8192
    s_waitcnt lgkmcnt(6)
    v_mfma_f32_16x16x32_bf16 v[16:19], v[76:79], v[52:55], v[16:19]
    ds_read_b128 v[104:107], v234 offset:9216
    v_mfma_f32_16x16x32_bf16 v[36:39], v[76:79], v[56:59], v[36:39]
    s_waitcnt lgkmcnt(5)
    v_mfma_f32_16x16x32_bf16 v[0:3], v[88:91], v[80:83], v[0:3]
    s_waitcnt vmcnt(8)
    s_waitcnt lgkmcnt(0)
    s_barrier
    ds_read_b128 v[52:55], v232 offset:49152
    v_mfma_f32_16x16x32_bf16 v[20:23], v[88:91], v[84:87], v[20:23]
    s_add_u32 m0, s87, 32768
    s_add_u32 s57, s86, 4096
    buffer_load_dwordx4 v240, s[16:19], s86 offen offset:0 sc1 lds
    v_mfma_f32_16x16x32_bf16 v[24:27], v[92:95], v[84:87], v[24:27]
    ds_read_b128 v[60:63], v234 offset:20480
    v_mfma_f32_16x16x32_bf16 v[4:7], v[92:95], v[80:83], v[4:7]
    ds_read_b128 v[56:59], v232 offset:50176
    v_mfma_f32_16x16x32_bf16 v[8:11], v[96:99], v[80:83], v[8:11]
    buffer_load_dwordx4 v240, s[16:19], s86 offen offset:1024 sc1 lds
    v_mfma_f32_16x16x32_bf16 v[28:31], v[96:99], v[84:87], v[28:31]
    ds_read_b128 v[64:67], v234 offset:21504
    v_mfma_f32_16x16x32_bf16 v[32:35], v[100:103], v[84:87], v[32:35]
    ds_read_b128 v[68:71], v234 offset:22528
    v_mfma_f32_16x16x32_bf16 v[12:15], v[100:103], v[80:83], v[12:15]
    buffer_load_dwordx4 v240, s[16:19], s86 offen offset:2048 sc1 lds
    v_mfma_f32_16x16x32_bf16 v[16:19], v[104:107], v[80:83], v[16:19]
    ds_read_b128 v[72:75], v234 offset:23552
    v_mfma_f32_16x16x32_bf16 v[36:39], v[104:107], v[84:87], v[36:39]
    ds_read_b128 v[76:79], v234 offset:24576
    s_waitcnt lgkmcnt(5)
    v_mfma_f32_16x16x32_bf16 v[0:3], v[60:63], v[52:55], v[0:3]
    ds_read_b128 v[80:83], v232 offset:53248
    s_waitcnt lgkmcnt(5)
    v_mfma_f32_16x16x32_bf16 v[20:23], v[60:63], v[56:59], v[20:23]
    buffer_load_dwordx4 v240, s[16:19], s86 offen offset:3072 sc1 lds
    s_waitcnt lgkmcnt(4)
    v_mfma_f32_16x16x32_bf16 v[24:27], v[64:67], v[56:59], v[24:27]
    ds_read_b128 v[88:91], v234 offset:25600
    v_mfma_f32_16x16x32_bf16 v[4:7], v[64:67], v[52:55], v[4:7]
    ds_read_b128 v[84:87], v232 offset:54272
    s_waitcnt lgkmcnt(5)
    v_mfma_f32_16x16x32_bf16 v[8:11], v[68:71], v[52:55], v[8:11]
    s_add_u32 s86, s86, 8192
    v_mfma_f32_16x16x32_bf16 v[28:31], v[68:71], v[56:59], v[28:31]
    ds_read_b128 v[92:95], v234 offset:26624
    s_waitcnt lgkmcnt(5)
    v_mfma_f32_16x16x32_bf16 v[32:35], v[72:75], v[56:59], v[32:35]
    ds_read_b128 v[96:99], v234 offset:27648
    v_mfma_f32_16x16x32_bf16 v[12:15], v[72:75], v[52:55], v[12:15]
    ds_read_b128 v[100:103], v234 offset:28672
    s_waitcnt lgkmcnt(6)
    v_mfma_f32_16x16x32_bf16 v[16:19], v[76:79], v[52:55], v[16:19]
    ds_read_b128 v[104:107], v234 offset:29696
    v_mfma_f32_16x16x32_bf16 v[36:39], v[76:79], v[56:59], v[36:39]
    s_waitcnt lgkmcnt(5)
    v_mfma_f32_16x16x32_bf16 v[0:3], v[88:91], v[80:83], v[0:3]
    s_waitcnt vmcnt(8)
    s_waitcnt lgkmcnt(0)
    s_barrier
    ds_read_b128 v[52:55], v232 offset:0
    v_mfma_f32_16x16x32_bf16 v[20:23], v[88:91], v[84:87], v[20:23]
    s_add_u32 m0, s87, 49152
    s_add_u32 s57, s86, 4096
    buffer_load_dwordx4 v240, s[16:19], s86 offen offset:0 sc1 lds
    v_mfma_f32_16x16x32_bf16 v[24:27], v[92:95], v[84:87], v[24:27]
    ds_read_b128 v[60:63], v233 offset:0
    v_mfma_f32_16x16x32_bf16 v[4:7], v[92:95], v[80:83], v[4:7]
    ds_read_b128 v[56:59], v232 offset:1024
    v_mfma_f32_16x16x32_bf16 v[8:11], v[96:99], v[80:83], v[8:11]
    buffer_load_dwordx4 v240, s[16:19], s86 offen offset:1024 sc1 lds
    v_mfma_f32_16x16x32_bf16 v[28:31], v[96:99], v[84:87], v[28:31]
    ds_read_b128 v[64:67], v233 offset:1024
    v_mfma_f32_16x16x32_bf16 v[32:35], v[100:103], v[84:87], v[32:35]
    ds_read_b128 v[68:71], v233 offset:2048
    v_mfma_f32_16x16x32_bf16 v[12:15], v[100:103], v[80:83], v[12:15]
    buffer_load_dwordx4 v240, s[16:19], s86 offen offset:2048 sc1 lds
    v_mfma_f32_16x16x32_bf16 v[16:19], v[104:107], v[80:83], v[16:19]
    ds_read_b128 v[72:75], v233 offset:3072
    v_mfma_f32_16x16x32_bf16 v[36:39], v[104:107], v[84:87], v[36:39]
    ds_read_b128 v[76:79], v233 offset:4096
    s_waitcnt lgkmcnt(5)
    v_mfma_f32_16x16x32_bf16 v[172:175], v[60:63], v[52:55], 0
    ds_read_b128 v[80:83], v232 offset:4096
    s_waitcnt lgkmcnt(5)
    v_mfma_f32_16x16x32_bf16 v[192:195], v[60:63], v[56:59], 0
    buffer_load_dwordx4 v240, s[16:19], s86 offen offset:3072 sc1 lds
    s_waitcnt lgkmcnt(4)
    v_mfma_f32_16x16x32_bf16 v[196:199], v[64:67], v[56:59], 0
    ds_read_b128 v[88:91], v233 offset:5120
    v_mfma_f32_16x16x32_bf16 v[176:179], v[64:67], v[52:55], 0
    ds_read_b128 v[84:87], v232 offset:5120
    s_waitcnt lgkmcnt(5)
    v_mfma_f32_16x16x32_bf16 v[180:183], v[68:71], v[52:55], 0
    s_add_u32 s86, s86, 8192
    v_mfma_f32_16x16x32_bf16 v[200:203], v[68:71], v[56:59], 0
    ds_read_b128 v[92:95], v233 offset:6144
    s_waitcnt lgkmcnt(5)
    v_mfma_f32_16x16x32_bf16 v[204:207], v[72:75], v[56:59], 0
    ds_read_b128 v[96:99], v233 offset:7168
    v_mfma_f32_16x16x32_bf16 v[184:187], v[72:75], v[52:55], 0
    ds_read_b128 v[100:103], v233 offset:8192
    s_waitcnt lgkmcnt(6)
    v_mfma_f32_16x16x32_bf16 v[188:191], v[76:79], v[52:55], 0
    ds_read_b128 v[104:107], v233 offset:9216
    v_mfma_f32_16x16x32_bf16 v[208:211], v[76:79], v[56:59], 0
    s_waitcnt lgkmcnt(5)
    v_mfma_f32_16x16x32_bf16 v[172:175], v[88:91], v[80:83], v[172:175]
    s_waitcnt vmcnt(8)
    s_waitcnt lgkmcnt(0)
    s_barrier
    ds_read_b128 v[52:55], v232 offset:16384
    v_mfma_f32_16x16x32_bf16 v[192:195], v[88:91], v[84:87], v[192:195]
    s_add_u32 m0, s87, 0
    s_add_u32 s57, s86, 4096
    buffer_load_dwordx4 v240, s[16:19], s86 offen offset:0 sc1 lds
    v_mfma_f32_16x16x32_bf16 v[196:199], v[92:95], v[84:87], v[196:199]
    ds_read_b128 v[60:63], v233 offset:20480
    v_mfma_f32_16x16x32_bf16 v[176:179], v[92:95], v[80:83], v[176:179]
    ds_read_b128 v[56:59], v232 offset:17408
    v_mfma_f32_16x16x32_bf16 v[180:183], v[96:99], v[80:83], v[180:183]
    buffer_load_dwordx4 v240, s[16:19], s86 offen offset:1024 sc1 lds
    v_mfma_f32_16x16x32_bf16 v[200:203], v[96:99], v[84:87], v[200:203]
    ds_read_b128 v[64:67], v233 offset:21504
    v_mfma_f32_16x16x32_bf16 v[204:207], v[100:103], v[84:87], v[204:207]
    ds_read_b128 v[68:71], v233 offset:22528
    v_mfma_f32_16x16x32_bf16 v[184:187], v[100:103], v[80:83], v[184:187]
    buffer_load_dwordx4 v240, s[16:19], s86 offen offset:2048 sc1 lds
    v_mfma_f32_16x16x32_bf16 v[188:191], v[104:107], v[80:83], v[188:191]
    ds_read_b128 v[72:75], v233 offset:23552
    v_mfma_f32_16x16x32_bf16 v[208:211], v[104:107], v[84:87], v[208:211]
    ds_read_b128 v[76:79], v233 offset:24576
    s_waitcnt lgkmcnt(5)
    v_mfma_f32_16x16x32_bf16 v[172:175], v[60:63], v[52:55], v[172:175]
    ds_read_b128 v[80:83], v232 offset:20480
    s_waitcnt lgkmcnt(5)
    v_mfma_f32_16x16x32_bf16 v[192:195], v[60:63], v[56:59], v[192:195]
    buffer_load_dwordx4 v240, s[16:19], s86 offen offset:3072 sc1 lds
    s_waitcnt lgkmcnt(4)
    v_mfma_f32_16x16x32_bf16 v[196:199], v[64:67], v[56:59], v[196:199]
    ds_read_b128 v[88:91], v233 offset:25600
    v_mfma_f32_16x16x32_bf16 v[176:179], v[64:67], v[52:55], v[176:179]
    ds_read_b128 v[84:87], v232 offset:21504
    s_waitcnt lgkmcnt(5)
    v_mfma_f32_16x16x32_bf16 v[180:183], v[68:71], v[52:55], v[180:183]
    s_add_u32 s86, s86, 8192
    v_mfma_f32_16x16x32_bf16 v[200:203], v[68:71], v[56:59], v[200:203]
    ds_read_b128 v[92:95], v233 offset:26624
    s_waitcnt lgkmcnt(5)
    v_mfma_f32_16x16x32_bf16 v[204:207], v[72:75], v[56:59], v[204:207]
    ds_read_b128 v[96:99], v233 offset:27648
    v_mfma_f32_16x16x32_bf16 v[184:187], v[72:75], v[52:55], v[184:187]
    ds_read_b128 v[100:103], v233 offset:28672
    s_waitcnt lgkmcnt(6)
    v_mfma_f32_16x16x32_bf16 v[188:191], v[76:79], v[52:55], v[188:191]
    ds_read_b128 v[104:107], v233 offset:29696
    v_mfma_f32_16x16x32_bf16 v[208:211], v[76:79], v[56:59], v[208:211]
    s_lshl_b32 s55, s61, 8
    s_add_u32 s55, s55, 73433088
    v_lshrrev_b32 v245, 1, v240
    v_and_b32 v245, 0xf8, v245
    buffer_load_dwordx2 v[112:113], v245, s[16:19], s55 offen sc1
    s_waitcnt lgkmcnt(5)
    v_mfma_f32_16x16x32_bf16 v[172:175], v[88:91], v[80:83], v[172:175]
    s_waitcnt vmcnt(9)
    s_waitcnt lgkmcnt(0)
    s_barrier
    ds_read_b128 v[52:55], v232 offset:32768
    v_mfma_f32_16x16x32_bf16 v[192:195], v[88:91], v[84:87], v[192:195]
    s_add_u32 m0, s87, 16384
    s_add_u32 s57, s86, 4096
    buffer_load_dwordx4 v240, s[16:19], s86 offen offset:0 sc1 lds
    v_mfma_f32_16x16x32_bf16 v[196:199], v[92:95], v[84:87], v[196:199]
    ds_read_b128 v[60:63], v234 offset:0
    v_mfma_f32_16x16x32_bf16 v[176:179], v[92:95], v[80:83], v[176:179]
    ds_read_b128 v[56:59], v232 offset:33792
    v_mfma_f32_16x16x32_bf16 v[180:183], v[96:99], v[80:83], v[180:183]
    buffer_load_dwordx4 v240, s[16:19], s86 offen offset:1024 sc1 lds
    v_mfma_f32_16x16x32_bf16 v[200:203], v[96:99], v[84:87], v[200:203]
    ds_read_b128 v[64:67], v234 offset:1024
    v_mfma_f32_16x16x32_bf16 v[204:207], v[100:103], v[84:87], v[204:207]
    ds_read_b128 v[68:71], v234 offset:2048
    v_mfma_f32_16x16x32_bf16 v[184:187], v[100:103], v[80:83], v[184:187]
    buffer_load_dwordx4 v240, s[16:19], s86 offen offset:2048 sc1 lds
    v_mfma_f32_16x16x32_bf16 v[188:191], v[104:107], v[80:83], v[188:191]
    ds_read_b128 v[72:75], v234 offset:3072
    v_mfma_f32_16x16x32_bf16 v[208:211], v[104:107], v[84:87], v[208:211]
    ds_read_b128 v[76:79], v234 offset:4096
    s_waitcnt lgkmcnt(5)
    v_mfma_f32_16x16x32_bf16 v[172:175], v[60:63], v[52:55], v[172:175]
    ds_read_b128 v[80:83], v232 offset:36864
    s_waitcnt lgkmcnt(5)
    v_mfma_f32_16x16x32_bf16 v[192:195], v[60:63], v[56:59], v[192:195]
    buffer_load_dwordx4 v240, s[16:19], s86 offen offset:3072 sc1 lds
    s_waitcnt lgkmcnt(4)
    v_mfma_f32_16x16x32_bf16 v[196:199], v[64:67], v[56:59], v[196:199]
    ds_read_b128 v[88:91], v234 offset:5120
    v_mfma_f32_16x16x32_bf16 v[176:179], v[64:67], v[52:55], v[176:179]
    ds_read_b128 v[84:87], v232 offset:37888
    s_waitcnt lgkmcnt(5)
    v_mfma_f32_16x16x32_bf16 v[180:183], v[68:71], v[52:55], v[180:183]
    s_add_u32 s86, s86, 8192
    v_mfma_f32_16x16x32_bf16 v[200:203], v[68:71], v[56:59], v[200:203]
    ds_read_b128 v[92:95], v234 offset:6144
    s_waitcnt lgkmcnt(5)
    v_mfma_f32_16x16x32_bf16 v[204:207], v[72:75], v[56:59], v[204:207]
    ds_read_b128 v[96:99], v234 offset:7168
    v_mfma_f32_16x16x32_bf16 v[184:187], v[72:75], v[52:55], v[184:187]
    ds_read_b128 v[100:103], v234 offset:8192
    s_waitcnt lgkmcnt(6)
    v_mfma_f32_16x16x32_bf16 v[188:191], v[76:79], v[52:55], v[188:191]
    ds_read_b128 v[104:107], v234 offset:9216
    v_mfma_f32_16x16x32_bf16 v[208:211], v[76:79], v[56:59], v[208:211]
    s_waitcnt lgkmcnt(5)
    v_mfma_f32_16x16x32_bf16 v[172:175], v[88:91], v[80:83], v[172:175]
    s_waitcnt vmcnt(9)
    s_waitcnt lgkmcnt(0)
    s_barrier
    ds_read_b128 v[52:55], v232 offset:49152
    v_mfma_f32_16x16x32_bf16 v[192:195], v[88:91], v[84:87], v[192:195]
    s_add_u32 m0, s87, 32768
    s_add_u32 s57, s86, 4096
    buffer_load_dwordx4 v240, s[16:19], s86 offen offset:0 sc1 lds
    v_mfma_f32_16x16x32_bf16 v[196:199], v[92:95], v[84:87], v[196:199]
    ds_read_b128 v[60:63], v234 offset:20480
    v_mfma_f32_16x16x32_bf16 v[176:179], v[92:95], v[80:83], v[176:179]
    ds_read_b128 v[56:59], v232 offset:50176
    v_mfma_f32_16x16x32_bf16 v[180:183], v[96:99], v[80:83], v[180:183]
    buffer_load_dwordx4 v240, s[16:19], s86 offen offset:1024 sc1 lds
    v_mfma_f32_16x16x32_bf16 v[200:203], v[96:99], v[84:87], v[200:203]
    ds_read_b128 v[64:67], v234 offset:21504
    v_mfma_f32_16x16x32_bf16 v[204:207], v[100:103], v[84:87], v[204:207]
    ds_read_b128 v[68:71], v234 offset:22528
    v_mfma_f32_16x16x32_bf16 v[184:187], v[100:103], v[80:83], v[184:187]
    buffer_load_dwordx4 v240, s[16:19], s86 offen offset:2048 sc1 lds
    v_mfma_f32_16x16x32_bf16 v[188:191], v[104:107], v[80:83], v[188:191]
    ds_read_b128 v[72:75], v234 offset:23552
    v_mfma_f32_16x16x32_bf16 v[208:211], v[104:107], v[84:87], v[208:211]
    ds_read_b128 v[76:79], v234 offset:24576
    s_waitcnt lgkmcnt(5)
    v_mfma_f32_16x16x32_bf16 v[172:175], v[60:63], v[52:55], v[172:175]
    ds_read_b128 v[80:83], v232 offset:53248
    s_waitcnt lgkmcnt(5)
    v_mfma_f32_16x16x32_bf16 v[192:195], v[60:63], v[56:59], v[192:195]
    buffer_load_dwordx4 v240, s[16:19], s86 offen offset:3072 sc1 lds
    s_waitcnt lgkmcnt(4)
    v_mfma_f32_16x16x32_bf16 v[196:199], v[64:67], v[56:59], v[196:199]
    ds_read_b128 v[88:91], v234 offset:25600
    v_mfma_f32_16x16x32_bf16 v[176:179], v[64:67], v[52:55], v[176:179]
    ds_read_b128 v[84:87], v232 offset:54272
    s_waitcnt lgkmcnt(5)
    v_mfma_f32_16x16x32_bf16 v[180:183], v[68:71], v[52:55], v[180:183]
    s_add_u32 s86, s86, 8192
    v_mfma_f32_16x16x32_bf16 v[200:203], v[68:71], v[56:59], v[200:203]
    ds_read_b128 v[92:95], v234 offset:26624
    s_waitcnt lgkmcnt(5)
    v_mfma_f32_16x16x32_bf16 v[204:207], v[72:75], v[56:59], v[204:207]
    ds_read_b128 v[96:99], v234 offset:27648
    v_mfma_f32_16x16x32_bf16 v[184:187], v[72:75], v[52:55], v[184:187]
    ds_read_b128 v[100:103], v234 offset:28672
    s_waitcnt lgkmcnt(6)
    v_mfma_f32_16x16x32_bf16 v[188:191], v[76:79], v[52:55], v[188:191]
    ds_read_b128 v[104:107], v234 offset:29696
    v_mfma_f32_16x16x32_bf16 v[208:211], v[76:79], v[56:59], v[208:211]
    s_waitcnt lgkmcnt(5)
    v_mfma_f32_16x16x32_bf16 v[172:175], v[88:91], v[80:83], v[172:175]
    s_waitcnt vmcnt(9)
    s_waitcnt lgkmcnt(0)
    s_barrier
    ds_read_b128 v[52:55], v232 offset:0
    v_mfma_f32_16x16x32_bf16 v[192:195], v[88:91], v[84:87], v[192:195]
    s_add_u32 m0, s87, 49152
    s_add_u32 s57, s86, 4096
    buffer_load_dwordx4 v240, s[16:19], s86 offen offset:0 sc1 lds
    v_mfma_f32_16x16x32_bf16 v[196:199], v[92:95], v[84:87], v[196:199]
    ds_read_b128 v[60:63], v233 offset:0
    v_mfma_f32_16x16x32_bf16 v[176:179], v[92:95], v[80:83], v[176:179]
    ds_read_b128 v[56:59], v232 offset:1024
    v_mfma_f32_16x16x32_bf16 v[180:183], v[96:99], v[80:83], v[180:183]
    buffer_load_dwordx4 v240, s[16:19], s86 offen offset:1024 sc1 lds
    v_mfma_f32_16x16x32_bf16 v[200:203], v[96:99], v[84:87], v[200:203]
    ds_read_b128 v[64:67], v233 offset:1024
    v_mfma_f32_16x16x32_bf16 v[204:207], v[100:103], v[84:87], v[204:207]
    ds_read_b128 v[68:71], v233 offset:2048
    v_mfma_f32_16x16x32_bf16 v[184:187], v[100:103], v[80:83], v[184:187]
    buffer_load_dwordx4 v240, s[16:19], s86 offen offset:2048 sc1 lds
    v_mfma_f32_16x16x32_bf16 v[188:191], v[104:107], v[80:83], v[188:191]
    ds_read_b128 v[72:75], v233 offset:3072
    v_mfma_f32_16x16x32_bf16 v[208:211], v[104:107], v[84:87], v[208:211]
    ds_read_b128 v[76:79], v233 offset:4096
    s_waitcnt lgkmcnt(5)
    v_mfma_f32_16x16x32_bf16 v[172:175], v[60:63], v[52:55], v[172:175]
    ds_read_b128 v[80:83], v232 offset:4096
    s_waitcnt lgkmcnt(5)
    v_mfma_f32_16x16x32_bf16 v[192:195], v[60:63], v[56:59], v[192:195]
    buffer_load_dwordx4 v240, s[16:19], s86 offen offset:3072 sc1 lds
    s_waitcnt lgkmcnt(4)
    v_mfma_f32_16x16x32_bf16 v[196:199], v[64:67], v[56:59], v[196:199]
    ds_read_b128 v[88:91], v233 offset:5120
    v_mfma_f32_16x16x32_bf16 v[176:179], v[64:67], v[52:55], v[176:179]
    ds_read_b128 v[84:87], v232 offset:5120
    s_waitcnt lgkmcnt(5)
    v_mfma_f32_16x16x32_bf16 v[180:183], v[68:71], v[52:55], v[180:183]
    s_add_u32 s86, s86, 8192
    v_mfma_f32_16x16x32_bf16 v[200:203], v[68:71], v[56:59], v[200:203]
    ds_read_b128 v[92:95], v233 offset:6144
    s_waitcnt lgkmcnt(5)
    v_mfma_f32_16x16x32_bf16 v[204:207], v[72:75], v[56:59], v[204:207]
    ds_read_b128 v[96:99], v233 offset:7168
    v_mfma_f32_16x16x32_bf16 v[184:187], v[72:75], v[52:55], v[184:187]
    ds_read_b128 v[100:103], v233 offset:8192
    s_waitcnt lgkmcnt(6)
    v_mfma_f32_16x16x32_bf16 v[188:191], v[76:79], v[52:55], v[188:191]
    ds_read_b128 v[104:107], v233 offset:9216
    v_mfma_f32_16x16x32_bf16 v[208:211], v[76:79], v[56:59], v[208:211]
    s_waitcnt lgkmcnt(5)
    v_mfma_f32_16x16x32_bf16 v[172:175], v[88:91], v[80:83], v[172:175]
    s_waitcnt vmcnt(8)
    s_waitcnt lgkmcnt(0)
    s_barrier
    ds_read_b128 v[52:55], v232 offset:16384
    v_mfma_f32_16x16x32_bf16 v[192:195], v[88:91], v[84:87], v[192:195]
    v_xor_b32 v112, s84, v112
    v_xor_b32 v113, s85, v113
    v_or_b32 v112, v112, v113
    v_cmp_ne_u32 vcc, 0, v112
    s_cbranch_vccz L_fbok
    s_lshl_b32 s55, s61, 8
    s_add_u32 s55, s55, 73433088
    s_mov_b32 s56, 1048576
    v_lshrrev_b32 v245, 1, v240
    s_mov_b64 exec, 0xffffffff
L_poll4:
    buffer_load_dwordx2 v[246:247], v245, s[16:19], s55 offen sc1
    s_waitcnt vmcnt(0)
    v_xor_b32 v246, s84, v246
    v_xor_b32 v247, s85, v247
    v_or_b32 v246, v246, v247
    v_cmp_ne_u32 vcc, 0, v246
    s_cbranch_vccz L_poll4_ok
    s_sleep 4
    s_sub_u32 s56, s56, 1
    s_cmp_lg_u32 s56, 0
    s_cbranch_scc1 L_poll4
L_poll4_ok:
    s_mov_b64 exec, -1
L_fbok:
    s_add_u32 m0, s87, 0
    s_add_u32 s57, s76, 4096
    buffer_load_dwordx4 v240, s[16:19], s76 offen offset:0 sc1 lds
    v_mfma_f32_16x16x32_bf16 v[196:199], v[92:95], v[84:87], v[196:199]
    ds_read_b128 v[60:63], v233 offset:20480
    v_mfma_f32_16x16x32_bf16 v[176:179], v[92:95], v[80:83], v[176:179]
    ds_read_b128 v[56:59], v232 offset:17408
    v_mfma_f32_16x16x32_bf16 v[180:183], v[96:99], v[80:83], v[180:183]
    buffer_load_dwordx4 v240, s[16:19], s76 offen offset:1024 sc1 lds
    v_mfma_f32_16x16x32_bf16 v[200:203], v[96:99], v[84:87], v[200:203]
    ds_read_b128 v[64:67], v233 offset:21504
    v_mfma_f32_16x16x32_bf16 v[204:207], v[100:103], v[84:87], v[204:207]
    ds_read_b128 v[68:71], v233 offset:22528
    v_mfma_f32_16x16x32_bf16 v[184:187], v[100:103], v[80:83], v[184:187]
    buffer_load_dwordx4 v240, s[16:19], s76 offen offset:2048 sc1 lds
    v_mfma_f32_16x16x32_bf16 v[188:191], v[104:107], v[80:83], v[188:191]
    ds_read_b128 v[72:75], v233 offset:23552
    v_mfma_f32_16x16x32_bf16 v[208:211], v[104:107], v[84:87], v[208:211]
    ds_read_b128 v[76:79], v233 offset:24576
    s_waitcnt lgkmcnt(5)
    v_mfma_f32_16x16x32_bf16 v[172:175], v[60:63], v[52:55], v[172:175]
    ds_read_b128 v[80:83], v232 offset:20480
    s_waitcnt lgkmcnt(5)
    v_mfma_f32_16x16x32_bf16 v[192:195], v[60:63], v[56:59], v[192:195]
    buffer_load_dwordx4 v240, s[16:19], s76 offen offset:3072 sc1 lds
    s_waitcnt lgkmcnt(4)
    v_mfma_f32_16x16x32_bf16 v[196:199], v[64:67], v[56:59], v[196:199]
    ds_read_b128 v[88:91], v233 offset:25600
    v_mfma_f32_16x16x32_bf16 v[176:179], v[64:67], v[52:55], v[176:179]
    ds_read_b128 v[84:87], v232 offset:21504
    s_waitcnt lgkmcnt(5)
    v_mfma_f32_16x16x32_bf16 v[180:183], v[68:71], v[52:55], v[180:183]
    s_add_u32 s76, s76, 16384
    v_mfma_f32_16x16x32_bf16 v[200:203], v[68:71], v[56:59], v[200:203]
    ds_read_b128 v[92:95], v233 offset:26624
    s_waitcnt lgkmcnt(5)
    v_mfma_f32_16x16x32_bf16 v[204:207], v[72:75], v[56:59], v[204:207]
    ds_read_b128 v[96:99], v233 offset:27648
    v_mfma_f32_16x16x32_bf16 v[184:187], v[72:75], v[52:55], v[184:187]
    ds_read_b128 v[100:103], v233 offset:28672
    s_waitcnt lgkmcnt(6)
    v_mfma_f32_16x16x32_bf16 v[188:191], v[76:79], v[52:55], v[188:191]
    ds_read_b128 v[104:107], v233 offset:29696
    v_mfma_f32_16x16x32_bf16 v[208:211], v[76:79], v[56:59], v[208:211]
    s_waitcnt lgkmcnt(5)
    v_mfma_f32_16x16x32_bf16 v[172:175], v[88:91], v[80:83], v[172:175]
    s_waitcnt vmcnt(8)
    s_waitcnt lgkmcnt(0)
    s_barrier
    ds_read_b128 v[52:55], v232 offset:32768
    v_mfma_f32_16x16x32_bf16 v[192:195], v[88:91], v[84:87], v[192:195]
    s_add_u32 m0, s87, 16384
    s_add_u32 s57, s76, 4096
    buffer_load_dwordx4 v240, s[16:19], s76 offen offset:0 sc1 lds
    v_mfma_f32_16x16x32_bf16 v[196:199], v[92:95], v[84:87], v[196:199]
    ds_read_b128 v[60:63], v234 offset:0
    v_mfma_f32_16x16x32_bf16 v[176:179], v[92:95], v[80:83], v[176:179]
    ds_read_b128 v[56:59], v232 offset:33792
    v_mfma_f32_16x16x32_bf16 v[180:183], v[96:99], v[80:83], v[180:183]
    buffer_load_dwordx4 v240, s[16:19], s76 offen offset:1024 sc1 lds
    v_mfma_f32_16x16x32_bf16 v[200:203], v[96:99], v[84:87], v[200:203]
    ds_read_b128 v[64:67], v234 offset:1024
    v_mfma_f32_16x16x32_bf16 v[204:207], v[100:103], v[84:87], v[204:207]
    ds_read_b128 v[68:71], v234 offset:2048
    v_mfma_f32_16x16x32_bf16 v[184:187], v[100:103], v[80:83], v[184:187]
    buffer_load_dwordx4 v240, s[16:19], s76 offen offset:2048 sc1 lds
    v_mfma_f32_16x16x32_bf16 v[188:191], v[104:107], v[80:83], v[188:191]
    ds_read_b128 v[72:75], v234 offset:3072
    v_mfma_f32_16x16x32_bf16 v[208:211], v[104:107], v[84:87], v[208:211]
    ds_read_b128 v[76:79], v234 offset:4096
    s_waitcnt lgkmcnt(5)
    v_mfma_f32_16x16x32_bf16 v[172:175], v[60:63], v[52:55], v[172:175]
    ds_read_b128 v[80:83], v232 offset:36864
    s_waitcnt lgkmcnt(5)
    v_mfma_f32_16x16x32_bf16 v[192:195], v[60:63], v[56:59], v[192:195]
    buffer_load_dwordx4 v240, s[16:19], s76 offen offset:3072 sc1 lds
    s_waitcnt lgkmcnt(4)
    v_mfma_f32_16x16x32_bf16 v[196:199], v[64:67], v[56:59], v[196:199]
    ds_read_b128 v[88:91], v234 offset:5120
    v_mfma_f32_16x16x32_bf16 v[176:179], v[64:67], v[52:55], v[176:179]
    ds_read_b128 v[84:87], v232 offset:37888
    s_waitcnt lgkmcnt(5)
    v_mfma_f32_16x16x32_bf16 v[180:183], v[68:71], v[52:55], v[180:183]
    s_add_u32 s76, s76, 16384
    v_mfma_f32_16x16x32_bf16 v[200:203], v[68:71], v[56:59], v[200:203]
    ds_read_b128 v[92:95], v234 offset:6144
    s_waitcnt lgkmcnt(5)
    v_mfma_f32_16x16x32_bf16 v[204:207], v[72:75], v[56:59], v[204:207]
    ds_read_b128 v[96:99], v234 offset:7168
    v_mfma_f32_16x16x32_bf16 v[184:187], v[72:75], v[52:55], v[184:187]
    ds_read_b128 v[100:103], v234 offset:8192
    s_waitcnt lgkmcnt(6)
    v_mfma_f32_16x16x32_bf16 v[188:191], v[76:79], v[52:55], v[188:191]
    ds_read_b128 v[104:107], v234 offset:9216
    v_mfma_f32_16x16x32_bf16 v[208:211], v[76:79], v[56:59], v[208:211]
    s_waitcnt lgkmcnt(5)
    v_mfma_f32_16x16x32_bf16 v[172:175], v[88:91], v[80:83], v[172:175]
    s_waitcnt vmcnt(8)
    s_waitcnt lgkmcnt(0)
    s_barrier
    ds_read_b128 v[52:55], v232 offset:49152
    v_mfma_f32_16x16x32_bf16 v[192:195], v[88:91], v[84:87], v[192:195]
    s_add_u32 m0, s87, 32768
    s_add_u32 s57, s76, 4096
    buffer_load_dwordx4 v240, s[16:19], s76 offen offset:0 sc1 lds
    v_mfma_f32_16x16x32_bf16 v[196:199], v[92:95], v[84:87], v[196:199]
    ds_read_b128 v[60:63], v234 offset:20480
    v_mfma_f32_16x16x32_bf16 v[176:179], v[92:95], v[80:83], v[176:179]
    ds_read_b128 v[56:59], v232 offset:50176
    v_mfma_f32_16x16x32_bf16 v[180:183], v[96:99], v[80:83], v[180:183]
    buffer_load_dwordx4 v240, s[16:19], s76 offen offset:1024 sc1 lds
    v_mfma_f32_16x16x32_bf16 v[200:203], v[96:99], v[84:87], v[200:203]
    ds_read_b128 v[64:67], v234 offset:21504
    v_mfma_f32_16x16x32_bf16 v[204:207], v[100:103], v[84:87], v[204:207]
    ds_read_b128 v[68:71], v234 offset:22528
    v_mfma_f32_16x16x32_bf16 v[184:187], v[100:103], v[80:83], v[184:187]
    buffer_load_dwordx4 v240, s[16:19], s76 offen offset:2048 sc1 lds
    v_mfma_f32_16x16x32_bf16 v[188:191], v[104:107], v[80:83], v[188:191]
    ds_read_b128 v[72:75], v234 offset:23552
    v_mfma_f32_16x16x32_bf16 v[208:211], v[104:107], v[84:87], v[208:211]
    ds_read_b128 v[76:79], v234 offset:24576
    s_waitcnt lgkmcnt(5)
    v_mfma_f32_16x16x32_bf16 v[172:175], v[60:63], v[52:55], v[172:175]
    ds_read_b128 v[80:83], v232 offset:53248
    s_waitcnt lgkmcnt(5)
    v_mfma_f32_16x16x32_bf16 v[192:195], v[60:63], v[56:59], v[192:195]
    buffer_load_dwordx4 v240, s[16:19], s76 offen offset:3072 sc1 lds
    s_waitcnt lgkmcnt(4)
    v_mfma_f32_16x16x32_bf16 v[196:199], v[64:67], v[56:59], v[196:199]
    ds_read_b128 v[88:91], v234 offset:25600
    v_mfma_f32_16x16x32_bf16 v[176:179], v[64:67], v[52:55], v[176:179]
    ds_read_b128 v[84:87], v232 offset:54272
    s_waitcnt lgkmcnt(5)
    v_mfma_f32_16x16x32_bf16 v[180:183], v[68:71], v[52:55], v[180:183]
    s_add_u32 s76, s76, 16384
    v_mfma_f32_16x16x32_bf16 v[200:203], v[68:71], v[56:59], v[200:203]
    ds_read_b128 v[92:95], v234 offset:26624
    s_waitcnt lgkmcnt(5)
    v_mfma_f32_16x16x32_bf16 v[204:207], v[72:75], v[56:59], v[204:207]
    ds_read_b128 v[96:99], v234 offset:27648
    v_mfma_f32_16x16x32_bf16 v[184:187], v[72:75], v[52:55], v[184:187]
    ds_read_b128 v[100:103], v234 offset:28672
    s_waitcnt lgkmcnt(6)
    v_mfma_f32_16x16x32_bf16 v[188:191], v[76:79], v[52:55], v[188:191]
    ds_read_b128 v[104:107], v234 offset:29696
    v_mfma_f32_16x16x32_bf16 v[208:211], v[76:79], v[56:59], v[208:211]
    s_waitcnt lgkmcnt(5)
    v_mfma_f32_16x16x32_bf16 v[172:175], v[88:91], v[80:83], v[172:175]
    s_waitcnt vmcnt(8)
    s_waitcnt lgkmcnt(0)
    s_barrier
    v_mfma_f32_16x16x32_bf16 v[192:195], v[88:91], v[84:87], v[192:195]
    ds_read_b128 v[52:55], v236 offset:0
    v_mfma_f32_16x16x32_bf16 v[196:199], v[92:95], v[84:87], v[196:199]
    s_add_u32 m0, s87, 49152
    s_add_u32 s57, s76, 4096
    buffer_load_dwordx4 v240, s[16:19], s76 offen offset:0 sc1 lds
    v_mfma_f32_16x16x32_bf16 v[176:179], v[92:95], v[80:83], v[176:179]
    ds_read_b128 v[56:59], v237 offset:0
    v_mfma_f32_16x16x32_bf16 v[180:183], v[96:99], v[80:83], v[180:183]
    v_mfma_f32_16x16x32_bf16 v[200:203], v[96:99], v[84:87], v[200:203]
    ds_read_b128 v[60:63], v237 offset:1024
    v_mfma_f32_16x16x32_bf16 v[204:207], v[100:103], v[84:87], v[204:207]
    buffer_load_dwordx4 v240, s[16:19], s76 offen offset:1024 sc1 lds
    v_mfma_f32_16x16x32_bf16 v[184:187], v[100:103], v[80:83], v[184:187]
    ds_read_b128 v[64:67], v237 offset:2048
    v_mfma_f32_16x16x32_bf16 v[188:191], v[104:107], v[80:83], v[188:191]
    buffer_load_dwordx4 v240, s[16:19], s76 offen offset:2048 sc1 lds
    v_mfma_f32_16x16x32_bf16 v[208:211], v[104:107], v[84:87], v[208:211]
    s_waitcnt lgkmcnt(2)
    v_mfma_f32_16x16x32_bf16 v[40:43], v[56:59], v[52:55], 0
    ds_read_b128 v[80:83], v236 offset:4096
    buffer_load_dwordx4 v240, s[16:19], s76 offen offset:3072 sc1 lds
    s_waitcnt lgkmcnt(2)
    v_mfma_f32_16x16x32_bf16 v[44:47], v[60:63], v[52:55], 0
    ds_read_b128 v[84:87], v237 offset:5120
    ds_read_b128 v[88:91], v237 offset:6144
    s_waitcnt lgkmcnt(3)
    v_mfma_f32_16x16x32_bf16 v[48:51], v[64:67], v[52:55], 0
    s_add_u32 s76, s76, 16384
    ds_read_b128 v[92:95], v237 offset:7168
    s_waitcnt lgkmcnt(2)
    v_mfma_f32_16x16x32_bf16 v[40:43], v[84:87], v[80:83], v[40:43]
    ds_read_b128 v[52:55], v236 offset:8192
    ds_read_b128 v[56:59], v237 offset:10240
    ds_read_b128 v[60:63], v237 offset:11264
    ds_read_b128 v[64:67], v237 offset:12288
    v_pk_add_f32 v[0:1], v[0:1], v[172:173]
    v_pk_add_f32 v[2:3], v[2:3], v[174:175]
    v_pk_add_f32 v[4:5], v[4:5], v[176:177]
    v_pk_add_f32 v[6:7], v[6:7], v[178:179]
    v_pk_add_f32 v[8:9], v[8:9], v[180:181]
    s_waitcnt lgkmcnt(5)
    v_mfma_f32_16x16x32_bf16 v[44:47], v[88:91], v[80:83], v[44:47]
    v_pk_add_f32 v[10:11], v[10:11], v[182:183]
    v_pk_add_f32 v[12:13], v[12:13], v[184:185]
    v_pk_add_f32 v[14:15], v[14:15], v[186:187]
    v_pk_add_f32 v[16:17], v[16:17], v[188:189]
    v_pk_add_f32 v[18:19], v[18:19], v[190:191]
    v_pk_add_f32 v[20:21], v[20:21], v[192:193]
    v_pk_add_f32 v[22:23], v[22:23], v[194:195]
    v_pk_add_f32 v[24:25], v[24:25], v[196:197]
    s_waitcnt lgkmcnt(4)
    v_mfma_f32_16x16x32_bf16 v[48:51], v[92:95], v[80:83], v[48:51]
    v_pk_add_f32 v[26:27], v[26:27], v[198:199]
    v_pk_add_f32 v[28:29], v[28:29], v[200:201]
    v_pk_add_f32 v[30:31], v[30:31], v[202:203]
    v_pk_add_f32 v[32:33], v[32:33], v[204:205]
    v_pk_add_f32 v[34:35], v[34:35], v[206:207]
    v_pk_add_f32 v[36:37], v[36:37], v[208:209]
    v_pk_add_f32 v[38:39], v[38:39], v[210:211]
    s_and_b32 s55, s54, 3
    s_cmp_eq_u32 s55, s79
    s_cbranch_scc1 L_sndhi
    s_lshl_b32 s67, s80, 2
    s_add_u32 s67, s67, s55
    s_lshl_b32 s67, s67, 2
    s_add_u32 s67, s67, s79
    s_mul_i32 s67, s67, 20480
    s_add_u32 s67, s67, 75497472
    v_cvt_pk_bf16_f32 v0, v0, v1
    v_cvt_pk_bf16_f32 v1, v2, v3
    v_cvt_pk_bf16_f32 v2, v4, v5
    v_cvt_pk_bf16_f32 v3, v6, v7
    v_cvt_pk_bf16_f32 v4, v8, v9
    v_cvt_pk_bf16_f32 v5, v10, v11
    v_cvt_pk_bf16_f32 v6, v12, v13
    v_cvt_pk_bf16_f32 v7, v14, v15
    v_cvt_pk_bf16_f32 v8, v16, v17
    v_cvt_pk_bf16_f32 v9, v18, v19
    v_cvt_pk_bf16_f32 v10, v20, v21
    v_cvt_pk_bf16_f32 v11, v22, v23
    v_cvt_pk_bf16_f32 v12, v24, v25
    v_cvt_pk_bf16_f32 v13, v26, v27
    v_cvt_pk_bf16_f32 v14, v28, v29
    v_cvt_pk_bf16_f32 v15, v30, v31
    v_cvt_pk_bf16_f32 v16, v32, v33
    v_cvt_pk_bf16_f32 v17, v34, v35
    v_cvt_pk_bf16_f32 v18, v36, v37
    v_cvt_pk_bf16_f32 v19, v38, v39
    buffer_store_dwordx4 v[0:3], v240, s[16:19], s67 offen offset:0 sc1
    buffer_store_dwordx4 v[4:7], v240, s[16:19], s67 offen offset:1024 sc1
    buffer_store_dwordx4 v[8:11], v240, s[16:19], s67 offen offset:2048 sc1
    buffer_store_dwordx4 v[12:15], v240, s[16:19], s67 offen offset:3072 sc1
    s_add_u32 s67, s67, 4096
    buffer_store_dwordx4 v[16:19], v240, s[16:19], s67 offen offset:0 sc1
L_sndhi:
    s_waitcnt lgkmcnt(2)
    v_mfma_f32_16x16x32_bf16 v[40:43], v[56:59], v[52:55], v[40:43]
    ds_read_b128 v[80:83], v236 offset:12288
    ds_read_b128 v[84:87], v237 offset:15360
    s_waitcnt lgkmcnt(3)
    v_mfma_f32_16x16x32_bf16 v[44:47], v[60:63], v[52:55], v[44:47]
    ds_read_b128 v[88:91], v237 offset:16384
    s_waitcnt lgkmcnt(3)
    v_mfma_f32_16x16x32_bf16 v[48:51], v[64:67], v[52:55], v[48:51]
    ds_read_b128 v[92:95], v237 offset:17408
    s_waitcnt lgkmcnt(2)
    v_mfma_f32_16x16x32_bf16 v[40:43], v[84:87], v[80:83], v[40:43]
    s_waitcnt vmcnt(8)
    s_waitcnt lgkmcnt(0)
    s_barrier
    ds_read_b128 v[52:55], v236 offset:16384
    s_add_u32 m0, s87, 0
    s_add_u32 s57, s76, 4096
    buffer_load_dwordx4 v240, s[16:19], s76 offen offset:0 sc1 lds
    v_mfma_f32_16x16x32_bf16 v[44:47], v[88:91], v[80:83], v[44:47]
    ds_read_b128 v[56:59], v237 offset:20480
    ds_read_b128 v[60:63], v237 offset:21504
    v_mfma_f32_16x16x32_bf16 v[48:51], v[92:95], v[80:83], v[48:51]
    buffer_load_dwordx4 v240, s[16:19], s76 offen offset:1024 sc1 lds
    ds_read_b128 v[64:67], v237 offset:22528
    s_waitcnt lgkmcnt(2)
    v_mfma_f32_16x16x32_bf16 v[40:43], v[56:59], v[52:55], v[40:43]
    ds_read_b128 v[80:83], v236 offset:20480
    buffer_load_dwordx4 v240, s[16:19], s76 offen offset:2048 sc1 lds
    s_waitcnt lgkmcnt(2)
    v_mfma_f32_16x16x32_bf16 v[44:47], v[60:63], v[52:55], v[44:47]
    ds_read_b128 v[84:87], v237 offset:25600
    ds_read_b128 v[88:91], v237 offset:26624
    s_waitcnt lgkmcnt(3)
    v_mfma_f32_16x16x32_bf16 v[48:51], v[64:67], v[52:55], v[48:51]
    buffer_load_dwordx4 v240, s[16:19], s76 offen offset:3072 sc1 lds
    ds_read_b128 v[92:95], v237 offset:27648
    s_waitcnt lgkmcnt(2)
    v_mfma_f32_16x16x32_bf16 v[40:43], v[84:87], v[80:83], v[40:43]
    ds_read_b128 v[52:55], v236 offset:24576
    s_add_u32 s76, s76, 16384
    s_waitcnt lgkmcnt(2)
    v_mfma_f32_16x16x32_bf16 v[44:47], v[88:91], v[80:83], v[44:47]
    ds_read_b128 v[56:59], v237 offset:30720
    ds_read_b128 v[60:63], v237 offset:31744
    s_waitcnt lgkmcnt(3)
    v_mfma_f32_16x16x32_bf16 v[48:51], v[92:95], v[80:83], v[48:51]
    ds_read_b128 v[64:67], v237 offset:32768
    s_waitcnt lgkmcnt(2)
    v_mfma_f32_16x16x32_bf16 v[40:43], v[56:59], v[52:55], v[40:43]
    ds_read_b128 v[80:83], v236 offset:28672
    ds_read_b128 v[84:87], v237 offset:35840
    s_waitcnt lgkmcnt(3)
    v_mfma_f32_16x16x32_bf16 v[44:47], v[60:63], v[52:55], v[44:47]
    ds_read_b128 v[88:91], v237 offset:36864
    s_waitcnt lgkmcnt(3)
    v_mfma_f32_16x16x32_bf16 v[48:51], v[64:67], v[52:55], v[48:51]
    ds_read_b128 v[92:95], v237 offset:37888
    s_waitcnt lgkmcnt(2)
    v_mfma_f32_16x16x32_bf16 v[40:43], v[84:87], v[80:83], v[40:43]
    s_waitcnt vmcnt(8)
    s_waitcnt lgkmcnt(0)
    s_barrier
    ds_read_b128 v[52:55], v236 offset:32768
    v_mfma_f32_16x16x32_bf16 v[44:47], v[88:91], v[80:83], v[44:47]
    ds_read_b128 v[56:59], v238 offset:0
    ds_read_b128 v[60:63], v238 offset:1024
    v_mfma_f32_16x16x32_bf16 v[48:51], v[92:95], v[80:83], v[48:51]
    ds_read_b128 v[64:67], v238 offset:2048
    s_waitcnt lgkmcnt(2)
    v_mfma_f32_16x16x32_bf16 v[40:43], v[56:59], v[52:55], v[40:43]
    ds_read_b128 v[80:83], v236 offset:36864
    ds_read_b128 v[84:87], v238 offset:5120
    s_waitcnt lgkmcnt(3)
    v_mfma_f32_16x16x32_bf16 v[44:47], v[60:63], v[52:55], v[44:47]
    ds_read_b128 v[88:91], v238 offset:6144
    s_waitcnt lgkmcnt(3)
    v_mfma_f32_16x16x32_bf16 v[48:51], v[64:67], v[52:55], v[48:51]
    ds_read_b128 v[92:95], v238 offset:7168
    s_waitcnt lgkmcnt(2)
    v_mfma_f32_16x16x32_bf16 v[40:43], v[84:87], v[80:83], v[40:43]
    ds_read_b128 v[52:55], v236 offset:40960
    ds_read_b128 v[56:59], v238 offset:10240
    s_waitcnt lgkmcnt(3)
    v_mfma_f32_16x16x32_bf16 v[44:47], v[88:91], v[80:83], v[44:47]
    ds_read_b128 v[60:63], v238 offset:11264
    s_waitcnt lgkmcnt(3)
    v_mfma_f32_16x16x32_bf16 v[48:51], v[92:95], v[80:83], v[48:51]
    ds_read_b128 v[64:67], v238 offset:12288
    s_waitcnt lgkmcnt(2)
    v_mfma_f32_16x16x32_bf16 v[40:43], v[56:59], v[52:55], v[40:43]
    ds_read_b128 v[80:83], v236 offset:45056
    ds_read_b128 v[84:87], v238 offset:15360
    s_waitcnt lgkmcnt(3)
    v_mfma_f32_16x16x32_bf16 v[44:47], v[60:63], v[52:55], v[44:47]
    ds_read_b128 v[88:91], v238 offset:16384
    ds_read_b128 v[92:95], v238 offset:17408
    s_waitcnt lgkmcnt(4)
    v_mfma_f32_16x16x32_bf16 v[48:51], v[64:67], v[52:55], v[48:51]
    s_and_b32 s55, s54, 3
    s_cmp_eq_u32 s55, s79
    s_cbranch_scc1 L_sflhi
    s_lshl_b32 s56, s80, 2
    s_add_u32 s55, s55, s56
    s_lshl_b32 s55, s55, 6
    s_lshl_b32 s56, s79, 3
    s_add_u32 s55, s55, s56
    s_add_u32 s55, s55, 73449472
    v_mov_b32 v242, s84
    v_mov_b32 v243, s85
    v_mov_b32 v244, 0
    s_waitcnt vmcnt(4)
    s_mov_b64 exec, 1
    buffer_store_dwordx2 v[242:243], v244, s[16:19], s55 offen sc1
    s_mov_b64 exec, -1
L_sflhi:
    s_waitcnt lgkmcnt(2)
    v_mfma_f32_16x16x32_bf16 v[40:43], v[84:87], v[80:83], v[40:43]
    s_waitcnt vmcnt(4)
    s_waitcnt lgkmcnt(0)
    s_barrier
    ds_read_b128 v[52:55], v236 offset:49152
    v_mfma_f32_16x16x32_bf16 v[44:47], v[88:91], v[80:83], v[44:47]
    ds_read_b128 v[56:59], v238 offset:20480
    ds_read_b128 v[60:63], v238 offset:21504
    v_mfma_f32_16x16x32_bf16 v[48:51], v[92:95], v[80:83], v[48:51]
    ds_read_b128 v[64:67], v238 offset:22528
    s_waitcnt lgkmcnt(2)
    v_mfma_f32_16x16x32_bf16 v[40:43], v[56:59], v[52:55], v[40:43]
    ds_read_b128 v[80:83], v236 offset:53248
    ds_read_b128 v[84:87], v238 offset:25600
    s_waitcnt lgkmcnt(3)
    v_mfma_f32_16x16x32_bf16 v[44:47], v[60:63], v[52:55], v[44:47]
    ds_read_b128 v[88:91], v238 offset:26624
    s_waitcnt lgkmcnt(3)
    v_mfma_f32_16x16x32_bf16 v[48:51], v[64:67], v[52:55], v[48:51]
    ds_read_b128 v[92:95], v238 offset:27648
    s_waitcnt lgkmcnt(2)
    v_mfma_f32_16x16x32_bf16 v[40:43], v[84:87], v[80:83], v[40:43]
    ds_read_b128 v[52:55], v236 offset:57344
    ds_read_b128 v[56:59], v238 offset:30720
    s_waitcnt lgkmcnt(3)
    v_mfma_f32_16x16x32_bf16 v[44:47], v[88:91], v[80:83], v[44:47]
    ds_read_b128 v[60:63], v238 offset:31744
    s_waitcnt lgkmcnt(3)
    v_mfma_f32_16x16x32_bf16 v[48:51], v[92:95], v[80:83], v[48:51]
    ds_read_b128 v[64:67], v238 offset:32768
    s_waitcnt lgkmcnt(2)
    v_mfma_f32_16x16x32_bf16 v[40:43], v[56:59], v[52:55], v[40:43]
    ds_read_b128 v[80:83], v236 offset:61440
    ds_read_b128 v[84:87], v238 offset:35840
    s_waitcnt lgkmcnt(3)
    v_mfma_f32_16x16x32_bf16 v[44:47], v[60:63], v[52:55], v[44:47]
    ds_read_b128 v[88:91], v238 offset:36864
    s_waitcnt lgkmcnt(3)
    v_mfma_f32_16x16x32_bf16 v[48:51], v[64:67], v[52:55], v[48:51]
    ds_read_b128 v[92:95], v238 offset:37888
    s_waitcnt lgkmcnt(2)
    v_mfma_f32_16x16x32_bf16 v[40:43], v[84:87], v[80:83], v[40:43]
    s_waitcnt vmcnt(0)
    s_waitcnt lgkmcnt(0)
    s_barrier
    ds_read_b128 v[52:55], v236 offset:0
    v_mfma_f32_16x16x32_bf16 v[44:47], v[88:91], v[80:83], v[44:47]
    ds_read_b128 v[56:59], v237 offset:0
    ds_read_b128 v[60:63], v237 offset:1024
    v_mfma_f32_16x16x32_bf16 v[48:51], v[92:95], v[80:83], v[48:51]
    ds_read_b128 v[64:67], v237 offset:2048
    s_and_b32 s55, s54, 3
    s_cmp_eq_u32 s55, s79
    s_cbranch_scc0 L_fxrhi
    s_lshl_b32 s67, s80, 2
    s_add_u32 s67, s67, s79
    s_lshl_b32 s55, s67, 6
    s_add_u32 s55, s55, 73449472
    v_bfe_u32 v242, v241, 0, 2
    v_min_u32 v242, 2, v242
    v_add_u32 v242, s79, v242
    v_add_u32 v242, 1, v242
    v_and_b32 v242, 3, v242
    v_lshlrev_b32 v245, 3, v242
    buffer_load_dwordx2 v[238:239], v245, s[16:19], s55 offen sc1
L_fxrhi:
    s_waitcnt lgkmcnt(2)
    v_mfma_f32_16x16x32_bf16 v[40:43], v[56:59], v[52:55], v[40:43]
    ds_read_b128 v[80:83], v236 offset:4096
    ds_read_b128 v[84:87], v237 offset:5120
    s_waitcnt lgkmcnt(3)
    v_mfma_f32_16x16x32_bf16 v[44:47], v[60:63], v[52:55], v[44:47]
    ds_read_b128 v[88:91], v237 offset:6144
    s_waitcnt lgkmcnt(3)
    v_mfma_f32_16x16x32_bf16 v[48:51], v[64:67], v[52:55], v[48:51]
    ds_read_b128 v[92:95], v237 offset:7168
    s_waitcnt lgkmcnt(2)
    v_mfma_f32_16x16x32_bf16 v[40:43], v[84:87], v[80:83], v[40:43]
    ds_read_b128 v[52:55], v236 offset:8192
    ds_read_b128 v[56:59], v237 offset:10240
    s_waitcnt lgkmcnt(3)
    v_mfma_f32_16x16x32_bf16 v[44:47], v[88:91], v[80:83], v[44:47]
    ds_read_b128 v[60:63], v237 offset:11264
    ds_read_b128 v[64:67], v237 offset:12288
    s_waitcnt lgkmcnt(4)
    v_mfma_f32_16x16x32_bf16 v[48:51], v[92:95], v[80:83], v[48:51]
    s_and_b32 s55, s54, 3
    s_cmp_eq_u32 s55, s79
    s_cbranch_scc0 L_fxthi
    s_waitcnt vmcnt(0)
    v_xor_b32 v238, s84, v238
    v_xor_b32 v239, s85, v239
    v_or_b32 v238, v238, v239
    v_cmp_ne_u32 vcc, 0, v238
    s_cbranch_vccnz L_fxthi
    s_mov_b32 s73, 1
    s_mul_i32 s67, s67, 81920
    s_add_u32 s67, s67, 75497472
    s_add_u32 s55, s79, 1
    s_and_b32 s55, s55, 3
    s_mul_i32 s55, s55, 20480
    s_add_u32 s55, s55, s67
    buffer_load_dwordx4 v[112:115], v240, s[16:19], s55 offen offset:0 sc1
    buffer_load_dwordx4 v[116:119], v240, s[16:19], s55 offen offset:1024 sc1
    buffer_load_dwordx4 v[120:123], v240, s[16:19], s55 offen offset:2048 sc1
    buffer_load_dwordx4 v[124:127], v240, s[16:19], s55 offen offset:3072 sc1
    s_add_u32 s55, s55, 4096
    buffer_load_dwordx4 v[128:131], v240, s[16:19], s55 offen offset:0 sc1
    s_add_u32 s55, s79, 2
    s_and_b32 s55, s55, 3
    s_mul_i32 s55, s55, 20480
    s_add_u32 s55, s55, s67
    buffer_load_dwordx4 v[132:135], v240, s[16:19], s55 offen offset:0 sc1
    buffer_load_dwordx4 v[136:139], v240, s[16:19], s55 offen offset:1024 sc1
    buffer_load_dwordx4 v[140:143], v240, s[16:19], s55 offen offset:2048 sc1
    buffer_load_dwordx4 v[144:147], v240, s[16:19], s55 offen offset:3072 sc1
    s_add_u32 s55, s55, 4096
    buffer_load_dwordx4 v[148:151], v240, s[16:19], s55 offen offset:0 sc1
    s_add_u32 s55, s79, 3
    s_and_b32 s55, s55, 3
    s_mul_i32 s55, s55, 20480
    s_add_u32 s55, s55, s67
    buffer_load_dwordx4 v[152:155], v240, s[16:19], s55 offen offset:0 sc1
    buffer_load_dwordx4 v[156:159], v240, s[16:19], s55 offen offset:1024 sc1
    buffer_load_dwordx4 v[160:163], v240, s[16:19], s55 offen offset:2048 sc1
    buffer_load_dwordx4 v[164:167], v240, s[16:19], s55 offen offset:3072 sc1
    s_add_u32 s55, s55, 4096
    buffer_load_dwordx4 v[168:171], v240, s[16:19], s55 offen offset:0 sc1
L_fxthi:
    s_waitcnt lgkmcnt(2)
    v_mfma_f32_16x16x32_bf16 v[40:43], v[56:59], v[52:55], v[40:43]
    ds_read_b128 v[80:83], v236 offset:12288
    ds_read_b128 v[84:87], v237 offset:15360
    s_waitcnt lgkmcnt(3)
    v_mfma_f32_16x16x32_bf16 v[44:47], v[60:63], v[52:55], v[44:47]
    ds_read_b128 v[88:91], v237 offset:16384
    s_waitcnt lgkmcnt(3)
    v_mfma_f32_16x16x32_bf16 v[48:51], v[64:67], v[52:55], v[48:51]
    ds_read_b128 v[92:95], v237 offset:17408
    s_waitcnt lgkmcnt(2)
    v_mfma_f32_16x16x32_bf16 v[40:43], v[84:87], v[80:83], v[40:43]
    s_waitcnt lgkmcnt(1)
    v_mfma_f32_16x16x32_bf16 v[44:47], v[88:91], v[80:83], v[44:47]
    s_waitcnt lgkmcnt(0)
    v_mfma_f32_16x16x32_bf16 v[48:51], v[92:95], v[80:83], v[48:51]
    s_nop 3
    v_cvt_pk_bf16_f32 v40, v40, v41
    v_cvt_pk_bf16_f32 v41, v42, v43
    buffer_store_dwordx2 v[40:41], v235, s[44:47], s82 offen offset:1280
    v_cvt_pk_bf16_f32 v44, v44, v45
    v_cvt_pk_bf16_f32 v45, v46, v47
    buffer_store_dwordx2 v[44:45], v235, s[44:47], s82 offen offset:1312
    v_cvt_pk_bf16_f32 v48, v48, v49
    v_cvt_pk_bf16_f32 v49, v50, v51
    buffer_store_dwordx2 v[48:49], v235, s[44:47], s82 offen offset:1344
    s_and_b32 s55, s54, 3
    s_cmp_eq_u32 s55, s79
    s_cbranch_scc0 L_o_done
    s_cmp_lg_u32 s73, 0
    s_cbranch_scc1 L_gothi
    s_lshl_b32 s67, s80, 2
    s_add_u32 s67, s67, s79
    s_lshl_b32 s55, s67, 6
    s_add_u32 s55, s55, 73449472
    v_bfe_u32 v242, v241, 0, 2
    v_min_u32 v242, 2, v242
    v_add_u32 v242, s79, v242
    v_add_u32 v242, 1, v242
    v_and_b32 v242, 3, v242
    v_lshlrev_b32 v245, 3, v242
    s_mov_b32 s56, 1048576
    s_mov_b64 exec, 0x7
L_poll5hi:
    buffer_load_dwordx2 v[246:247], v245, s[16:19], s55 offen sc1
    s_waitcnt vmcnt(0)
    v_xor_b32 v246, s84, v246
    v_xor_b32 v247, s85, v247
    v_or_b32 v246, v246, v247
    v_cmp_ne_u32 vcc, 0, v246
    s_cbranch_vccz L_poll5hi_ok
    s_sleep 4
    s_sub_u32 s56, s56, 1
    s_cmp_lg_u32 s56, 0
    s_cbranch_scc1 L_poll5hi
L_poll5hi_ok:
    s_mov_b64 exec, -1
    s_mul_i32 s67, s67, 81920
    s_add_u32 s67, s67, 75497472
    s_add_u32 s55, s79, 1
    s_and_b32 s55, s55, 3
    s_mul_i32 s55, s55, 20480
    s_add_u32 s55, s55, s67
    buffer_load_dwordx4 v[112:115], v240, s[16:19], s55 offen offset:0 sc1
    buffer_load_dwordx4 v[116:119], v240, s[16:19], s55 offen offset:1024 sc1
    buffer_load_dwordx4 v[120:123], v240, s[16:19], s55 offen offset:2048 sc1
    buffer_load_dwordx4 v[124:127], v240, s[16:19], s55 offen offset:3072 sc1
    s_add_u32 s55, s55, 4096
    buffer_load_dwordx4 v[128:131], v240, s[16:19], s55 offen offset:0 sc1
    s_add_u32 s55, s79, 2
    s_and_b32 s55, s55, 3
    s_mul_i32 s55, s55, 20480
    s_add_u32 s55, s55, s67
    buffer_load_dwordx4 v[132:135], v240, s[16:19], s55 offen offset:0 sc1
    buffer_load_dwordx4 v[136:139], v240, s[16:19], s55 offen offset:1024 sc1
    buffer_load_dwordx4 v[140:143], v240, s[16:19], s55 offen offset:2048 sc1
    buffer_load_dwordx4 v[144:147], v240, s[16:19], s55 offen offset:3072 sc1
    s_add_u32 s55, s55, 4096
    buffer_load_dwordx4 v[148:151], v240, s[16:19], s55 offen offset:0 sc1
    s_add_u32 s55, s79, 3
    s_and_b32 s55, s55, 3
    s_mul_i32 s55, s55, 20480
    s_add_u32 s55, s55, s67
    buffer_load_dwordx4 v[152:155], v240, s[16:19], s55 offen offset:0 sc1
    buffer_load_dwordx4 v[156:159], v240, s[16:19], s55 offen offset:1024 sc1
    buffer_load_dwordx4 v[160:163], v240, s[16:19], s55 offen offset:2048 sc1
    buffer_load_dwordx4 v[164:167], v240, s[16:19], s55 offen offset:3072 sc1
    s_add_u32 s55, s55, 4096
    buffer_load_dwordx4 v[168:171], v240, s[16:19], s55 offen offset:0 sc1
L_gothi:
    s_waitcnt vmcnt(0)
    s_mov_b32 s55, 0x3f80
    s_mov_b32 s56, 0x3f800000
    v_dot2_f32_bf16 v0, v112, s55, v0
    v_dot2_f32_bf16 v1, v112, s56, v1
    v_dot2_f32_bf16 v2, v113, s55, v2
    v_dot2_f32_bf16 v3, v113, s56, v3
    v_dot2_f32_bf16 v4, v114, s55, v4
    v_dot2_f32_bf16 v5, v114, s56, v5
    v_dot2_f32_bf16 v6, v115, s55, v6
    v_dot2_f32_bf16 v7, v115, s56, v7
    v_dot2_f32_bf16 v8, v116, s55, v8
    v_dot2_f32_bf16 v9, v116, s56, v9
    v_dot2_f32_bf16 v10, v117, s55, v10
    v_dot2_f32_bf16 v11, v117, s56, v11
    v_dot2_f32_bf16 v12, v118, s55, v12
    v_dot2_f32_bf16 v13, v118, s56, v13
    v_dot2_f32_bf16 v14, v119, s55, v14
    v_dot2_f32_bf16 v15, v119, s56, v15
    v_dot2_f32_bf16 v16, v120, s55, v16
    v_dot2_f32_bf16 v17, v120, s56, v17
    v_dot2_f32_bf16 v18, v121, s55, v18
    v_dot2_f32_bf16 v19, v121, s56, v19
    v_dot2_f32_bf16 v20, v122, s55, v20
    v_dot2_f32_bf16 v21, v122, s56, v21
    v_dot2_f32_bf16 v22, v123, s55, v22
    v_dot2_f32_bf16 v23, v123, s56, v23
    v_dot2_f32_bf16 v24, v124, s55, v24
    v_dot2_f32_bf16 v25, v124, s56, v25
    v_dot2_f32_bf16 v26, v125, s55, v26
    v_dot2_f32_bf16 v27, v125, s56, v27
    v_dot2_f32_bf16 v28, v126, s55, v28
    v_dot2_f32_bf16 v29, v126, s56, v29
    v_dot2_f32_bf16 v30, v127, s55, v30
    v_dot2_f32_bf16 v31, v127, s56, v31
    v_dot2_f32_bf16 v32, v128, s55, v32
    v_dot2_f32_bf16 v33, v128, s56, v33
    v_dot2_f32_bf16 v34, v129, s55, v34
    v_dot2_f32_bf16 v35, v129, s56, v35
    v_dot2_f32_bf16 v36, v130, s55, v36
    v_dot2_f32_bf16 v37, v130, s56, v37
    v_dot2_f32_bf16 v38, v131, s55, v38
    v_dot2_f32_bf16 v39, v131, s56, v39
    v_dot2_f32_bf16 v0, v132, s55, v0
    v_dot2_f32_bf16 v1, v132, s56, v1
    v_dot2_f32_bf16 v2, v133, s55, v2
    v_dot2_f32_bf16 v3, v133, s56, v3
    v_dot2_f32_bf16 v4, v134, s55, v4
    v_dot2_f32_bf16 v5, v134, s56, v5
    v_dot2_f32_bf16 v6, v135, s55, v6
    v_dot2_f32_bf16 v7, v135, s56, v7
    v_dot2_f32_bf16 v8, v136, s55, v8
    v_dot2_f32_bf16 v9, v136, s56, v9
    v_dot2_f32_bf16 v10, v137, s55, v10
    v_dot2_f32_bf16 v11, v137, s56, v11
    v_dot2_f32_bf16 v12, v138, s55, v12
    v_dot2_f32_bf16 v13, v138, s56, v13
    v_dot2_f32_bf16 v14, v139, s55, v14
    v_dot2_f32_bf16 v15, v139, s56, v15
    v_dot2_f32_bf16 v16, v140, s55, v16
    v_dot2_f32_bf16 v17, v140, s56, v17
    v_dot2_f32_bf16 v18, v141, s55, v18
    v_dot2_f32_bf16 v19, v141, s56, v19
    v_dot2_f32_bf16 v20, v142, s55, v20
    v_dot2_f32_bf16 v21, v142, s56, v21
    v_dot2_f32_bf16 v22, v143, s55, v22
    v_dot2_f32_bf16 v23, v143, s56, v23
    v_dot2_f32_bf16 v24, v144, s55, v24
    v_dot2_f32_bf16 v25, v144, s56, v25
    v_dot2_f32_bf16 v26, v145, s55, v26
    v_dot2_f32_bf16 v27, v145, s56, v27
    v_dot2_f32_bf16 v28, v146, s55, v28
    v_dot2_f32_bf16 v29, v146, s56, v29
    v_dot2_f32_bf16 v30, v147, s55, v30
    v_dot2_f32_bf16 v31, v147, s56, v31
    v_dot2_f32_bf16 v32, v148, s55, v32
    v_dot2_f32_bf16 v33, v148, s56, v33
    v_dot2_f32_bf16 v34, v149, s55, v34
    v_dot2_f32_bf16 v35, v149, s56, v35
    v_dot2_f32_bf16 v36, v150, s55, v36
    v_dot2_f32_bf16 v37, v150, s56, v37
    v_dot2_f32_bf16 v38, v151, s55, v38
    v_dot2_f32_bf16 v39, v151, s56, v39
    v_dot2_f32_bf16 v0, v152, s55, v0
    v_dot2_f32_bf16 v1, v152, s56, v1
    v_dot2_f32_bf16 v2, v153, s55, v2
    v_dot2_f32_bf16 v3, v153, s56, v3
    v_dot2_f32_bf16 v4, v154, s55, v4
    v_dot2_f32_bf16 v5, v154, s56, v5
    v_dot2_f32_bf16 v6, v155, s55, v6
    v_dot2_f32_bf16 v7, v155, s56, v7
    v_dot2_f32_bf16 v8, v156, s55, v8
    v_dot2_f32_bf16 v9, v156, s56, v9
    v_dot2_f32_bf16 v10, v157, s55, v10
    v_dot2_f32_bf16 v11, v157, s56, v11
    v_dot2_f32_bf16 v12, v158, s55, v12
    v_dot2_f32_bf16 v13, v158, s56, v13
    v_dot2_f32_bf16 v14, v159, s55, v14
    v_dot2_f32_bf16 v15, v159, s56, v15
    v_dot2_f32_bf16 v16, v160, s55, v16
    v_dot2_f32_bf16 v17, v160, s56, v17
    v_dot2_f32_bf16 v18, v161, s55, v18
    v_dot2_f32_bf16 v19, v161, s56, v19
    v_dot2_f32_bf16 v20, v162, s55, v20
    v_dot2_f32_bf16 v21, v162, s56, v21
    v_dot2_f32_bf16 v22, v163, s55, v22
    v_dot2_f32_bf16 v23, v163, s56, v23
    v_dot2_f32_bf16 v24, v164, s55, v24
    v_dot2_f32_bf16 v25, v164, s56, v25
    v_dot2_f32_bf16 v26, v165, s55, v26
    v_dot2_f32_bf16 v27, v165, s56, v27
    v_dot2_f32_bf16 v28, v166, s55, v28
    v_dot2_f32_bf16 v29, v166, s56, v29
    v_dot2_f32_bf16 v30, v167, s55, v30
    v_dot2_f32_bf16 v31, v167, s56, v31
    v_dot2_f32_bf16 v32, v168, s55, v32
    v_dot2_f32_bf16 v33, v168, s56, v33
    v_dot2_f32_bf16 v34, v169, s55, v34
    v_dot2_f32_bf16 v35, v169, s56, v35
    v_dot2_f32_bf16 v36, v170, s55, v36
    v_dot2_f32_bf16 v37, v170, s56, v37
    v_dot2_f32_bf16 v38, v171, s55, v38
    v_dot2_f32_bf16 v39, v171, s56, v39
    s_add_u32 s55, s88, 40960
    v_cvt_pk_bf16_f32 v0, v0, v1
    v_cvt_pk_bf16_f32 v1, v2, v3
    buffer_store_dwordx2 v[0:1], v235, s[44:47], s88 offen offset:0
    v_cvt_pk_bf16_f32 v4, v4, v5
    v_cvt_pk_bf16_f32 v5, v6, v7
    buffer_store_dwordx2 v[4:5], v235, s[44:47], s88 offen offset:32
    v_cvt_pk_bf16_f32 v8, v8, v9
    v_cvt_pk_bf16_f32 v9, v10, v11
    buffer_store_dwordx2 v[8:9], v235, s[44:47], s88 offen offset:64
    v_cvt_pk_bf16_f32 v12, v12, v13
    v_cvt_pk_bf16_f32 v13, v14, v15
    buffer_store_dwordx2 v[12:13], v235, s[44:47], s88 offen offset:96
    v_cvt_pk_bf16_f32 v16, v16, v17
    v_cvt_pk_bf16_f32 v17, v18, v19
    buffer_store_dwordx2 v[16:17], v235, s[44:47], s88 offen offset:128
    v_cvt_pk_bf16_f32 v20, v20, v21
    v_cvt_pk_bf16_f32 v21, v22, v23
    buffer_store_dwordx2 v[20:21], v235, s[44:47], s55 offen offset:0
    v_cvt_pk_bf16_f32 v24, v24, v25
    v_cvt_pk_bf16_f32 v25, v26, v27
    buffer_store_dwordx2 v[24:25], v235, s[44:47], s55 offen offset:32
    v_cvt_pk_bf16_f32 v28, v28, v29
    v_cvt_pk_bf16_f32 v29, v30, v31
    buffer_store_dwordx2 v[28:29], v235, s[44:47], s55 offen offset:64
    v_cvt_pk_bf16_f32 v32, v32, v33
    v_cvt_pk_bf16_f32 v33, v34, v35
    buffer_store_dwordx2 v[32:33], v235, s[44:47], s55 offen offset:96
    v_cvt_pk_bf16_f32 v36, v36, v37
    v_cvt_pk_bf16_f32 v37, v38, v39
    buffer_store_dwordx2 v[36:37], v235, s[44:47], s55 offen offset:128
    s_branch L_o_done
L_o_lo:
    s_and_b32 s55, s54, 3
    s_mul_i32 s87, s55, 5120
    s_lshl_b32 s86, s78, 1
    s_bfe_u32 s56, s54, 0x10001
    s_add_u32 s86, s86, s56
    s_lshl_b32 s86, s86, 7
    s_lshl_b32 s56, s79, 5
    s_add_u32 s86, s86, s56
    s_and_b32 s56, s54, 1
    s_add_u32 s86, s86, s56
    s_mul_i32 s86, s86, 5120
    s_add_u32 s86, s86, 62914560
    s_mul_i32 s76, s62, 102400
    s_add_u32 s76, s76, s87
    s_add_u32 s76, s76, 69206016
    v_mov_b32 v130, 161792
    s_waitcnt lgkmcnt(0)
    s_barrier
    ds_read_b32 v132, v130
    s_waitcnt lgkmcnt(0)
    v_readfirstlane_b32 s55, v132
    s_nop 0
    s_bitcmp1_b32 s55, 0
    s_cselect_b32 s56, 0, 81920
    s_cselect_b32 s89, 0, 4294803456
    s_add_u32 s86, s86, s56
    s_add_u32 m0, s87, 65536
    s_add_u32 s57, s86, 4096
    buffer_load_dwordx4 v240, s[16:19], s86 offen offset:0 sc1 lds
    buffer_load_dwordx4 v240, s[16:19], s86 offen offset:1024 sc1 lds
    buffer_load_dwordx4 v240, s[16:19], s86 offen offset:2048 sc1 lds
    buffer_load_dwordx4 v240, s[16:19], s86 offen offset:3072 sc1 lds
    s_add_u32 m0, m0, 4096
    s_add_u32 s86, s86, 10240
    buffer_load_dwordx4 v240, s[16:19], s57 offen offset:0 sc1 lds
    s_add_u32 m0, s87, 86016
    s_add_u32 s57, s86, 4096
    buffer_load_dwordx4 v240, s[16:19], s86 offen offset:0 sc1 lds
    buffer_load_dwordx4 v240, s[16:19], s86 offen offset:1024 sc1 lds
    buffer_load_dwordx4 v240, s[16:19], s86 offen offset:2048 sc1 lds
    buffer_load_dwordx4 v240, s[16:19], s86 offen offset:3072 sc1 lds
    s_add_u32 m0, m0, 4096
    s_add_u32 s86, s86, 10240
    buffer_load_dwordx4 v240, s[16:19], s57 offen offset:0 sc1 lds
    s_add_u32 m0, s87, 106496
    s_add_u32 s57, s86, 4096
    buffer_load_dwordx4 v240, s[16:19], s86 offen offset:0 sc1 lds
    buffer_load_dwordx4 v240, s[16:19], s86 offen offset:1024 sc1 lds
    buffer_load_dwordx4 v240, s[16:19], s86 offen offset:2048 sc1 lds
    buffer_load_dwordx4 v240, s[16:19], s86 offen offset:3072 sc1 lds
    s_add_u32 m0, m0, 4096
    s_add_u32 s86, s86, 10240
    buffer_load_dwordx4 v240, s[16:19], s57 offen offset:0 sc1 lds
    s_add_u32 m0, s87, 126976
    s_add_u32 s57, s86, 4096
    buffer_load_dwordx4 v240, s[16:19], s86 offen offset:0 sc1 lds
    buffer_load_dwordx4 v240, s[16:19], s86 offen offset:1024 sc1 lds
    buffer_load_dwordx4 v240, s[16:19], s86 offen offset:2048 sc1 lds
    buffer_load_dwordx4 v240, s[16:19], s86 offen offset:3072 sc1 lds
    s_add_u32 m0, m0, 4096
    s_add_u32 s86, s86, 10240
    buffer_load_dwordx4 v240, s[16:19], s57 offen offset:0 sc1 lds
    s_mov_b32 s73, 0
    s_waitcnt vmcnt(15)
    s_barrier
    s_lshl_b32 s55, s2, 2
    s_add_u32 s55, s55, s54
    s_lshl_b32 s55, s55, 3
    s_add_u32 s55, s55, 73433056
    v_mov_b32 v242, s84
    v_mov_b32 v243, s85
    v_mov_b32 v244, 0
    s_mov_b64 exec, 1
    buffer_store_dwordx2 v[242:243], v244, s[16:19], s55 offen sc1
    s_mov_b64 exec, -1
    ds_read_b128 v[52:55], v232 offset:0
    ds_read_b128 v[60:63], v233 offset:0
    ds_read_b128 v[56:59], v232 offset:1024
    ds_read_b128 v[64:67], v233 offset:1024
    ds_read_b128 v[68:71], v233 offset:2048
    ds_read_b128 v[72:75], v233 offset:3072
    ds_read_b128 v[76:79], v233 offset:4096
    s_waitcnt lgkmcnt(5)
    v_mfma_f32_16x16x32_bf16 v[0:3], v[60:63], v[52:55], 0
    ds_read_b128 v[80:83], v232 offset:4096
    s_waitcnt lgkmcnt(5)
    v_mfma_f32_16x16x32_bf16 v[20:23], v[60:63], v[56:59], 0
    ds_read_b128 v[88:91], v233 offset:5120
    s_waitcnt lgkmcnt(5)
    v_mfma_f32_16x16x32_bf16 v[24:27], v[64:67], v[56:59], 0
    ds_read_b128 v[84:87], v232 offset:5120
    v_mfma_f32_16x16x32_bf16 v[4:7], v[64:67], v[52:55], 0
    s_waitcnt lgkmcnt(5)
    v_mfma_f32_16x16x32_bf16 v[8:11], v[68:71], v[52:55], 0
    ds_read_b128 v[92:95], v233 offset:6144
    v_mfma_f32_16x16x32_bf16 v[28:31], v[68:71], v[56:59], 0
    ds_read_b128 v[96:99], v233 offset:7168
    s_waitcnt lgkmcnt(6)
    v_mfma_f32_16x16x32_bf16 v[32:35], v[72:75], v[56:59], 0
    v_mfma_f32_16x16x32_bf16 v[12:15], v[72:75], v[52:55], 0
    ds_read_b128 v[100:103], v233 offset:8192
    s_waitcnt lgkmcnt(6)
    v_mfma_f32_16x16x32_bf16 v[16:19], v[76:79], v[52:55], 0
    ds_read_b128 v[104:107], v233 offset:9216
    v_mfma_f32_16x16x32_bf16 v[36:39], v[76:79], v[56:59], 0
    s_waitcnt lgkmcnt(5)
    v_mfma_f32_16x16x32_bf16 v[0:3], v[88:91], v[80:83], v[0:3]
    s_waitcnt vmcnt(11)
    s_waitcnt lgkmcnt(0)
    s_barrier
    ds_read_b128 v[52:55], v232 offset:16384
    v_mfma_f32_16x16x32_bf16 v[20:23], v[88:91], v[84:87], v[20:23]
    s_add_u32 m0, s87, 65536
    s_add_u32 s57, s86, 4096
    buffer_load_dwordx4 v240, s[16:19], s86 offen offset:0 sc1 lds
    v_mfma_f32_16x16x32_bf16 v[24:27], v[92:95], v[84:87], v[24:27]
    ds_read_b128 v[60:63], v233 offset:20480
    v_mfma_f32_16x16x32_bf16 v[4:7], v[92:95], v[80:83], v[4:7]
    ds_read_b128 v[56:59], v232 offset:17408
    v_mfma_f32_16x16x32_bf16 v[8:11], v[96:99], v[80:83], v[8:11]
    buffer_load_dwordx4 v240, s[16:19], s86 offen offset:1024 sc1 lds
    v_mfma_f32_16x16x32_bf16 v[28:31], v[96:99], v[84:87], v[28:31]
    ds_read_b128 v[64:67], v233 offset:21504
    v_mfma_f32_16x16x32_bf16 v[32:35], v[100:103], v[84:87], v[32:35]
    ds_read_b128 v[68:71], v233 offset:22528
    v_mfma_f32_16x16x32_bf16 v[12:15], v[100:103], v[80:83], v[12:15]
    buffer_load_dwordx4 v240, s[16:19], s86 offen offset:2048 sc1 lds
    v_mfma_f32_16x16x32_bf16 v[16:19], v[104:107], v[80:83], v[16:19]
    ds_read_b128 v[72:75], v233 offset:23552
    v_mfma_f32_16x16x32_bf16 v[36:39], v[104:107], v[84:87], v[36:39]
    ds_read_b128 v[76:79], v233 offset:24576
    s_waitcnt lgkmcnt(5)
    v_mfma_f32_16x16x32_bf16 v[0:3], v[60:63], v[52:55], v[0:3]
    ds_read_b128 v[80:83], v232 offset:20480
    s_waitcnt lgkmcnt(5)
    v_mfma_f32_16x16x32_bf16 v[20:23], v[60:63], v[56:59], v[20:23]
    buffer_load_dwordx4 v240, s[16:19], s86 offen offset:3072 sc1 lds
    s_waitcnt lgkmcnt(4)
    v_mfma_f32_16x16x32_bf16 v[24:27], v[64:67], v[56:59], v[24:27]
    ds_read_b128 v[88:91], v233 offset:25600
    v_mfma_f32_16x16x32_bf16 v[4:7], v[64:67], v[52:55], v[4:7]
    ds_read_b128 v[84:87], v232 offset:21504
    s_waitcnt lgkmcnt(5)
    v_mfma_f32_16x16x32_bf16 v[8:11], v[68:71], v[52:55], v[8:11]
    s_add_u32 m0, m0, 4096
    s_add_u32 s86, s86, 10240
    buffer_load_dwordx4 v240, s[16:19], s57 offen offset:0 sc1 lds
    v_mfma_f32_16x16x32_bf16 v[28:31], v[68:71], v[56:59], v[28:31]
    ds_read_b128 v[92:95], v233 offset:26624
    s_waitcnt lgkmcnt(5)
    v_mfma_f32_16x16x32_bf16 v[32:35], v[72:75], v[56:59], v[32:35]
    ds_read_b128 v[96:99], v233 offset:27648
    v_mfma_f32_16x16x32_bf16 v[12:15], v[72:75], v[52:55], v[12:15]
    ds_read_b128 v[100:103], v233 offset:28672
    s_waitcnt lgkmcnt(6)
    v_mfma_f32_16x16x32_bf16 v[16:19], v[76:79], v[52:55], v[16:19]
    ds_read_b128 v[104:107], v233 offset:29696
    v_mfma_f32_16x16x32_bf16 v[36:39], v[76:79], v[56:59], v[36:39]
    s_waitcnt lgkmcnt(5)
    v_mfma_f32_16x16x32_bf16 v[0:3], v[88:91], v[80:83], v[0:3]
    s_waitcnt vmcnt(11)
    s_waitcnt lgkmcnt(0)
    s_barrier
    ds_read_b128 v[52:55], v232 offset:32768
    v_mfma_f32_16x16x32_bf16 v[20:23], v[88:91], v[84:87], v[20:23]
    s_add_u32 m0, s87, 86016
    s_add_u32 s57, s86, 4096
    buffer_load_dwordx4 v240, s[16:19], s86 offen offset:0 sc1 lds
    v_mfma_f32_16x16x32_bf16 v[24:27], v[92:95], v[84:87], v[24:27]
    ds_read_b128 v[60:63], v234 offset:0
    v_mfma_f32_16x16x32_bf16 v[4:7], v[92:95], v[80:83], v[4:7]
    ds_read_b128 v[56:59], v232 offset:33792
    v_mfma_f32_16x16x32_bf16 v[8:11], v[96:99], v[80:83], v[8:11]
    buffer_load_dwordx4 v240, s[16:19], s86 offen offset:1024 sc1 lds
    v_mfma_f32_16x16x32_bf16 v[28:31], v[96:99], v[84:87], v[28:31]
    ds_read_b128 v[64:67], v234 offset:1024
    v_mfma_f32_16x16x32_bf16 v[32:35], v[100:103], v[84:87], v[32:35]
    ds_read_b128 v[68:71], v234 offset:2048
    v_mfma_f32_16x16x32_bf16 v[12:15], v[100:103], v[80:83], v[12:15]
    buffer_load_dwordx4 v240, s[16:19], s86 offen offset:2048 sc1 lds
    v_mfma_f32_16x16x32_bf16 v[16:19], v[104:107], v[80:83], v[16:19]
    ds_read_b128 v[72:75], v234 offset:3072
    v_mfma_f32_16x16x32_bf16 v[36:39], v[104:107], v[84:87], v[36:39]
    ds_read_b128 v[76:79], v234 offset:4096
    s_waitcnt lgkmcnt(5)
    v_mfma_f32_16x16x32_bf16 v[0:3], v[60:63], v[52:55], v[0:3]
    ds_read_b128 v[80:83], v232 offset:36864
    s_waitcnt lgkmcnt(5)
    v_mfma_f32_16x16x32_bf16 v[20:23], v[60:63], v[56:59], v[20:23]
    buffer_load_dwordx4 v240, s[16:19], s86 offen offset:3072 sc1 lds
    s_waitcnt lgkmcnt(4)
    v_mfma_f32_16x16x32_bf16 v[24:27], v[64:67], v[56:59], v[24:27]
    ds_read_b128 v[88:91], v234 offset:5120
    v_mfma_f32_16x16x32_bf16 v[4:7], v[64:67], v[52:55], v[4:7]
    ds_read_b128 v[84:87], v232 offset:37888
    s_waitcnt lgkmcnt(5)
    v_mfma_f32_16x16x32_bf16 v[8:11], v[68:71], v[52:55], v[8:11]
    s_add_u32 m0, m0, 4096
    s_add_u32 s86, s86, 10240
    buffer_load_dwordx4 v240, s[16:19], s57 offen offset:0 sc1 lds
    v_mfma_f32_16x16x32_bf16 v[28:31], v[68:71], v[56:59], v[28:31]
    ds_read_b128 v[92:95], v234 offset:6144
    s_waitcnt lgkmcnt(5)
    v_mfma_f32_16x16x32_bf16 v[32:35], v[72:75], v[56:59], v[32:35]
    ds_read_b128 v[96:99], v234 offset:7168
    v_mfma_f32_16x16x32_bf16 v[12:15], v[72:75], v[52:55], v[12:15]
    ds_read_b128 v[100:103], v234 offset:8192
    s_waitcnt lgkmcnt(6)
    v_mfma_f32_16x16x32_bf16 v[16:19], v[76:79], v[52:55], v[16:19]
    ds_read_b128 v[104:107], v234 offset:9216
    v_mfma_f32_16x16x32_bf16 v[36:39], v[76:79], v[56:59], v[36:39]
    s_waitcnt lgkmcnt(5)
    v_mfma_f32_16x16x32_bf16 v[0:3], v[88:91], v[80:83], v[0:3]
    s_waitcnt vmcnt(11)
    s_waitcnt lgkmcnt(0)
    s_barrier
    ds_read_b128 v[52:55], v232 offset:49152
    v_mfma_f32_16x16x32_bf16 v[20:23], v[88:91], v[84:87], v[20:23]
    s_add_u32 m0, s87, 106496
    s_add_u32 s57, s86, 4096
    buffer_load_dwordx4 v240, s[16:19], s86 offen offset:0 sc1 lds
    v_mfma_f32_16x16x32_bf16 v[24:27], v[92:95], v[84:87], v[24:27]
    ds_read_b128 v[60:63], v234 offset:20480
    v_mfma_f32_16x16x32_bf16 v[4:7], v[92:95], v[80:83], v[4:7]
    ds_read_b128 v[56:59], v232 offset:50176
    v_mfma_f32_16x16x32_bf16 v[8:11], v[96:99], v[80:83], v[8:11]
    buffer_load_dwordx4 v240, s[16:19], s86 offen offset:1024 sc1 lds
    v_mfma_f32_16x16x32_bf16 v[28:31], v[96:99], v[84:87], v[28:31]
    ds_read_b128 v[64:67], v234 offset:21504
    v_mfma_f32_16x16x32_bf16 v[32:35], v[100:103], v[84:87], v[32:35]
    ds_read_b128 v[68:71], v234 offset:22528
    v_mfma_f32_16x16x32_bf16 v[12:15], v[100:103], v[80:83], v[12:15]
    buffer_load_dwordx4 v240, s[16:19], s86 offen offset:2048 sc1 lds
    v_mfma_f32_16x16x32_bf16 v[16:19], v[104:107], v[80:83], v[16:19]
    ds_read_b128 v[72:75], v234 offset:23552
    v_mfma_f32_16x16x32_bf16 v[36:39], v[104:107], v[84:87], v[36:39]
    ds_read_b128 v[76:79], v234 offset:24576
    s_waitcnt lgkmcnt(5)
    v_mfma_f32_16x16x32_bf16 v[0:3], v[60:63], v[52:55], v[0:3]
    ds_read_b128 v[80:83], v232 offset:53248
    s_waitcnt lgkmcnt(5)
    v_mfma_f32_16x16x32_bf16 v[20:23], v[60:63], v[56:59], v[20:23]
    buffer_load_dwordx4 v240, s[16:19], s86 offen offset:3072 sc1 lds
    s_waitcnt lgkmcnt(4)
    v_mfma_f32_16x16x32_bf16 v[24:27], v[64:67], v[56:59], v[24:27]
    ds_read_b128 v[88:91], v234 offset:25600
    v_mfma_f32_16x16x32_bf16 v[4:7], v[64:67], v[52:55], v[4:7]
    ds_read_b128 v[84:87], v232 offset:54272
    s_waitcnt lgkmcnt(5)
    v_mfma_f32_16x16x32_bf16 v[8:11], v[68:71], v[52:55], v[8:11]
    s_add_u32 m0, m0, 4096
    s_add_u32 s86, s86, 10240
    buffer_load_dwordx4 v240, s[16:19], s57 offen offset:0 sc1 lds
    v_mfma_f32_16x16x32_bf16 v[28:31], v[68:71], v[56:59], v[28:31]
    ds_read_b128 v[92:95], v234 offset:26624
    s_waitcnt lgkmcnt(5)
    v_mfma_f32_16x16x32_bf16 v[32:35], v[72:75], v[56:59], v[32:35]
    ds_read_b128 v[96:99], v234 offset:27648
    v_mfma_f32_16x16x32_bf16 v[12:15], v[72:75], v[52:55], v[12:15]
    ds_read_b128 v[100:103], v234 offset:28672
    s_waitcnt lgkmcnt(6)
    v_mfma_f32_16x16x32_bf16 v[16:19], v[76:79], v[52:55], v[16:19]
    ds_read_b128 v[104:107], v234 offset:29696
    v_mfma_f32_16x16x32_bf16 v[36:39], v[76:79], v[56:59], v[36:39]
    s_waitcnt lgkmcnt(5)
    v_mfma_f32_16x16x32_bf16 v[0:3], v[88:91], v[80:83], v[0:3]
    s_waitcnt vmcnt(10)
    s_waitcnt lgkmcnt(0)
    s_barrier
    ds_read_b128 v[52:55], v232 offset:0
    v_mfma_f32_16x16x32_bf16 v[20:23], v[88:91], v[84:87], v[20:23]
    s_add_u32 m0, s87, 126976
    s_add_u32 s57, s86, 4096
    buffer_load_dwordx4 v240, s[16:19], s86 offen offset:0 sc1 lds
    v_mfma_f32_16x16x32_bf16 v[24:27], v[92:95], v[84:87], v[24:27]
    ds_read_b128 v[60:63], v233 offset:0
    v_mfma_f32_16x16x32_bf16 v[4:7], v[92:95], v[80:83], v[4:7]
    ds_read_b128 v[56:59], v232 offset:1024
    v_mfma_f32_16x16x32_bf16 v[8:11], v[96:99], v[80:83], v[8:11]
    buffer_load_dwordx4 v240, s[16:19], s86 offen offset:1024 sc1 lds
    v_mfma_f32_16x16x32_bf16 v[28:31], v[96:99], v[84:87], v[28:31]
    ds_read_b128 v[64:67], v233 offset:1024
    v_mfma_f32_16x16x32_bf16 v[32:35], v[100:103], v[84:87], v[32:35]
    ds_read_b128 v[68:71], v233 offset:2048
    v_mfma_f32_16x16x32_bf16 v[12:15], v[100:103], v[80:83], v[12:15]
    buffer_load_dwordx4 v240, s[16:19], s86 offen offset:2048 sc1 lds
    v_mfma_f32_16x16x32_bf16 v[16:19], v[104:107], v[80:83], v[16:19]
    ds_read_b128 v[72:75], v233 offset:3072
    v_mfma_f32_16x16x32_bf16 v[36:39], v[104:107], v[84:87], v[36:39]
    ds_read_b128 v[76:79], v233 offset:4096
    s_waitcnt lgkmcnt(5)
    v_mfma_f32_16x16x32_bf16 v[0:3], v[60:63], v[52:55], v[0:3]
    ds_read_b128 v[80:83], v232 offset:4096
    s_waitcnt lgkmcnt(5)
    v_mfma_f32_16x16x32_bf16 v[20:23], v[60:63], v[56:59], v[20:23]
    buffer_load_dwordx4 v240, s[16:19], s86 offen offset:3072 sc1 lds
    s_waitcnt lgkmcnt(4)
    v_mfma_f32_16x16x32_bf16 v[24:27], v[64:67], v[56:59], v[24:27]
    ds_read_b128 v[88:91], v233 offset:5120
    v_mfma_f32_16x16x32_bf16 v[4:7], v[64:67], v[52:55], v[4:7]
    ds_read_b128 v[84:87], v232 offset:5120
    s_waitcnt lgkmcnt(5)
    v_mfma_f32_16x16x32_bf16 v[8:11], v[68:71], v[52:55], v[8:11]
    s_add_u32 m0, m0, 4096
    s_add_u32 s86, s86, 10240
    buffer_load_dwordx4 v240, s[16:19], s57 offen offset:0 sc1 lds
    v_mfma_f32_16x16x32_bf16 v[28:31], v[68:71], v[56:59], v[28:31]
    ds_read_b128 v[92:95], v233 offset:6144
    s_waitcnt lgkmcnt(5)
    v_mfma_f32_16x16x32_bf16 v[32:35], v[72:75], v[56:59], v[32:35]
    ds_read_b128 v[96:99], v233 offset:7168
    v_mfma_f32_16x16x32_bf16 v[12:15], v[72:75], v[52:55], v[12:15]
    ds_read_b128 v[100:103], v233 offset:8192
    s_waitcnt lgkmcnt(6)
    v_mfma_f32_16x16x32_bf16 v[16:19], v[76:79], v[52:55], v[16:19]
    ds_read_b128 v[104:107], v233 offset:9216
    v_mfma_f32_16x16x32_bf16 v[36:39], v[76:79], v[56:59], v[36:39]
    s_waitcnt lgkmcnt(5)
    v_mfma_f32_16x16x32_bf16 v[0:3], v[88:91], v[80:83], v[0:3]
    s_waitcnt vmcnt(10)
    s_waitcnt lgkmcnt(0)
    s_barrier
    ds_read_b128 v[52:55], v232 offset:16384
    v_mfma_f32_16x16x32_bf16 v[20:23], v[88:91], v[84:87], v[20:23]
    s_add_u32 s86, s86, s89
    s_add_u32 m0, s87, 65536
    s_add_u32 s57, s86, 4096
    buffer_load_dwordx4 v240, s[16:19], s86 offen offset:0 sc1 lds
    v_mfma_f32_16x16x32_bf16 v[24:27], v[92:95], v[84:87], v[24:27]
    ds_read_b128 v[60:63], v233 offset:20480
    v_mfma_f32_16x16x32_bf16 v[4:7], v[92:95], v[80:83], v[4:7]
    ds_read_b128 v[56:59], v232 offset:17408
    v_mfma_f32_16x16x32_bf16 v[8:11], v[96:99], v[80:83], v[8:11]
    buffer_load_dwordx4 v240, s[16:19], s86 offen offset:1024 sc1 lds
    v_mfma_f32_16x16x32_bf16 v[28:31], v[96:99], v[84:87], v[28:31]
    ds_read_b128 v[64:67], v233 offset:21504
    v_mfma_f32_16x16x32_bf16 v[32:35], v[100:103], v[84:87], v[32:35]
    ds_read_b128 v[68:71], v233 offset:22528
    v_mfma_f32_16x16x32_bf16 v[12:15], v[100:103], v[80:83], v[12:15]
    buffer_load_dwordx4 v240, s[16:19], s86 offen offset:2048 sc1 lds
    v_mfma_f32_16x16x32_bf16 v[16:19], v[104:107], v[80:83], v[16:19]
    ds_read_b128 v[72:75], v233 offset:23552
    v_mfma_f32_16x16x32_bf16 v[36:39], v[104:107], v[84:87], v[36:39]
    ds_read_b128 v[76:79], v233 offset:24576
    s_waitcnt lgkmcnt(5)
    v_mfma_f32_16x16x32_bf16 v[0:3], v[60:63], v[52:55], v[0:3]
    ds_read_b128 v[80:83], v232 offset:20480
    s_waitcnt lgkmcnt(5)
    v_mfma_f32_16x16x32_bf16 v[20:23], v[60:63], v[56:59], v[20:23]
    buffer_load_dwordx4 v240, s[16:19], s86 offen offset:3072 sc1 lds
    s_waitcnt lgkmcnt(4)
    v_mfma_f32_16x16x32_bf16 v[24:27], v[64:67], v[56:59], v[24:27]
    ds_read_b128 v[88:91], v233 offset:25600
    v_mfma_f32_16x16x32_bf16 v[4:7], v[64:67], v[52:55], v[4:7]
    ds_read_b128 v[84:87], v232 offset:21504
    s_waitcnt lgkmcnt(5)
    v_mfma_f32_16x16x32_bf16 v[8:11], v[68:71], v[52:55], v[8:11]
    s_add_u32 m0, m0, 4096
    s_add_u32 s86, s86, 10240
    buffer_load_dwordx4 v240, s[16:19], s57 offen offset:0 sc1 lds
    v_mfma_f32_16x16x32_bf16 v[28:31], v[68:71], v[56:59], v[28:31]
    ds_read_b128 v[92:95], v233 offset:26624
    s_waitcnt lgkmcnt(5)
    v_mfma_f32_16x16x32_bf16 v[32:35], v[72:75], v[56:59], v[32:35]
    ds_read_b128 v[96:99], v233 offset:27648
    v_mfma_f32_16x16x32_bf16 v[12:15], v[72:75], v[52:55], v[12:15]
    ds_read_b128 v[100:103], v233 offset:28672
    s_waitcnt lgkmcnt(6)
    v_mfma_f32_16x16x32_bf16 v[16:19], v[76:79], v[52:55], v[16:19]
    ds_read_b128 v[104:107], v233 offset:29696
    v_mfma_f32_16x16x32_bf16 v[36:39], v[76:79], v[56:59], v[36:39]
    s_waitcnt lgkmcnt(5)
    v_mfma_f32_16x16x32_bf16 v[0:3], v[88:91], v[80:83], v[0:3]
    s_waitcnt vmcnt(10)
    s_waitcnt lgkmcnt(0)
    s_barrier
    ds_read_b128 v[52:55], v232 offset:32768
    v_mfma_f32_16x16x32_bf16 v[20:23], v[88:91], v[84:87], v[20:23]
    s_add_u32 m0, s87, 86016
    s_add_u32 s57, s86, 4096
    buffer_load_dwordx4 v240, s[16:19], s86 offen offset:0 sc1 lds
    v_mfma_f32_16x16x32_bf16 v[24:27], v[92:95], v[84:87], v[24:27]
    ds_read_b128 v[60:63], v234 offset:0
    v_mfma_f32_16x16x32_bf16 v[4:7], v[92:95], v[80:83], v[4:7]
    ds_read_b128 v[56:59], v232 offset:33792
    v_mfma_f32_16x16x32_bf16 v[8:11], v[96:99], v[80:83], v[8:11]
    buffer_load_dwordx4 v240, s[16:19], s86 offen offset:1024 sc1 lds
    v_mfma_f32_16x16x32_bf16 v[28:31], v[96:99], v[84:87], v[28:31]
    ds_read_b128 v[64:67], v234 offset:1024
    v_mfma_f32_16x16x32_bf16 v[32:35], v[100:103], v[84:87], v[32:35]
    ds_read_b128 v[68:71], v234 offset:2048
    v_mfma_f32_16x16x32_bf16 v[12:15], v[100:103], v[80:83], v[12:15]
    buffer_load_dwordx4 v240, s[16:19], s86 offen offset:2048 sc1 lds
    v_mfma_f32_16x16x32_bf16 v[16:19], v[104:107], v[80:83], v[16:19]
    ds_read_b128 v[72:75], v234 offset:3072
    v_mfma_f32_16x16x32_bf16 v[36:39], v[104:107], v[84:87], v[36:39]
    ds_read_b128 v[76:79], v234 offset:4096
    s_waitcnt lgkmcnt(5)
    v_mfma_f32_16x16x32_bf16 v[0:3], v[60:63], v[52:55], v[0:3]
    ds_read_b128 v[80:83], v232 offset:36864
    s_waitcnt lgkmcnt(5)
    v_mfma_f32_16x16x32_bf16 v[20:23], v[60:63], v[56:59], v[20:23]
    buffer_load_dwordx4 v240, s[16:19], s86 offen offset:3072 sc1 lds
    s_waitcnt lgkmcnt(4)
    v_mfma_f32_16x16x32_bf16 v[24:27], v[64:67], v[56:59], v[24:27]
    ds_read_b128 v[88:91], v234 offset:5120
    v_mfma_f32_16x16x32_bf16 v[4:7], v[64:67], v[52:55], v[4:7]
    ds_read_b128 v[84:87], v232 offset:37888
    s_waitcnt lgkmcnt(5)
    v_mfma_f32_16x16x32_bf16 v[8:11], v[68:71], v[52:55], v[8:11]
    s_add_u32 m0, m0, 4096
    s_add_u32 s86, s86, 10240
    buffer_load_dwordx4 v240, s[16:19], s57 offen offset:0 sc1 lds
    v_mfma_f32_16x16x32_bf16 v[28:31], v[68:71], v[56:59], v[28:31]
    ds_read_b128 v[92:95], v234 offset:6144
    s_waitcnt lgkmcnt(5)
    v_mfma_f32_16x16x32_bf16 v[32:35], v[72:75], v[56:59], v[32:35]
    ds_read_b128 v[96:99], v234 offset:7168
    v_mfma_f32_16x16x32_bf16 v[12:15], v[72:75], v[52:55], v[12:15]
    ds_read_b128 v[100:103], v234 offset:8192
    s_waitcnt lgkmcnt(6)
    v_mfma_f32_16x16x32_bf16 v[16:19], v[76:79], v[52:55], v[16:19]
    ds_read_b128 v[104:107], v234 offset:9216
    v_mfma_f32_16x16x32_bf16 v[36:39], v[76:79], v[56:59], v[36:39]
    s_waitcnt lgkmcnt(5)
    v_mfma_f32_16x16x32_bf16 v[0:3], v[88:91], v[80:83], v[0:3]
    s_waitcnt vmcnt(10)
    s_waitcnt lgkmcnt(0)
    s_barrier
    ds_read_b128 v[52:55], v232 offset:49152
    v_mfma_f32_16x16x32_bf16 v[20:23], v[88:91], v[84:87], v[20:23]
    s_add_u32 m0, s87, 106496
    s_add_u32 s57, s86, 4096
    buffer_load_dwordx4 v240, s[16:19], s86 offen offset:0 sc1 lds
    v_mfma_f32_16x16x32_bf16 v[24:27], v[92:95], v[84:87], v[24:27]
    ds_read_b128 v[60:63], v234 offset:20480
    v_mfma_f32_16x16x32_bf16 v[4:7], v[92:95], v[80:83], v[4:7]
    ds_read_b128 v[56:59], v232 offset:50176
    v_mfma_f32_16x16x32_bf16 v[8:11], v[96:99], v[80:83], v[8:11]
    buffer_load_dwordx4 v240, s[16:19], s86 offen offset:1024 sc1 lds
    v_mfma_f32_16x16x32_bf16 v[28:31], v[96:99], v[84:87], v[28:31]
    ds_read_b128 v[64:67], v234 offset:21504
    v_mfma_f32_16x16x32_bf16 v[32:35], v[100:103], v[84:87], v[32:35]
    ds_read_b128 v[68:71], v234 offset:22528
    v_mfma_f32_16x16x32_bf16 v[12:15], v[100:103], v[80:83], v[12:15]
    buffer_load_dwordx4 v240, s[16:19], s86 offen offset:2048 sc1 lds
    v_mfma_f32_16x16x32_bf16 v[16:19], v[104:107], v[80:83], v[16:19]
    ds_read_b128 v[72:75], v234 offset:23552
    v_mfma_f32_16x16x32_bf16 v[36:39], v[104:107], v[84:87], v[36:39]
    ds_read_b128 v[76:79], v234 offset:24576
    s_waitcnt lgkmcnt(5)
    v_mfma_f32_16x16x32_bf16 v[0:3], v[60:63], v[52:55], v[0:3]
    ds_read_b128 v[80:83], v232 offset:53248
    s_waitcnt lgkmcnt(5)
    v_mfma_f32_16x16x32_bf16 v[20:23], v[60:63], v[56:59], v[20:23]
    buffer_load_dwordx4 v240, s[16:19], s86 offen offset:3072 sc1 lds
    s_waitcnt lgkmcnt(4)
    v_mfma_f32_16x16x32_bf16 v[24:27], v[64:67], v[56:59], v[24:27]
    ds_read_b128 v[88:91], v234 offset:25600
    v_mfma_f32_16x16x32_bf16 v[4:7], v[64:67], v[52:55], v[4:7]
    ds_read_b128 v[84:87], v232 offset:54272
    s_waitcnt lgkmcnt(5)
    v_mfma_f32_16x16x32_bf16 v[8:11], v[68:71], v[52:55], v[8:11]
    s_add_u32 m0, m0, 4096
    s_add_u32 s86, s86, 10240
    buffer_load_dwordx4 v240, s[16:19], s57 offen offset:0 sc1 lds
    v_mfma_f32_16x16x32_bf16 v[28:31], v[68:71], v[56:59], v[28:31]
    ds_read_b128 v[92:95], v234 offset:26624
    s_waitcnt lgkmcnt(5)
    v_mfma_f32_16x16x32_bf16 v[32:35], v[72:75], v[56:59], v[32:35]
    ds_read_b128 v[96:99], v234 offset:27648
    v_mfma_f32_16x16x32_bf16 v[12:15], v[72:75], v[52:55], v[12:15]
    ds_read_b128 v[100:103], v234 offset:28672
    s_waitcnt lgkmcnt(6)
    v_mfma_f32_16x16x32_bf16 v[16:19], v[76:79], v[52:55], v[16:19]
    ds_read_b128 v[104:107], v234 offset:29696
    v_mfma_f32_16x16x32_bf16 v[36:39], v[76:79], v[56:59], v[36:39]
    s_waitcnt lgkmcnt(5)
    v_mfma_f32_16x16x32_bf16 v[0:3], v[88:91], v[80:83], v[0:3]
    s_waitcnt vmcnt(10)
    s_waitcnt lgkmcnt(0)
    s_barrier
    ds_read_b128 v[52:55], v232 offset:0
    v_mfma_f32_16x16x32_bf16 v[20:23], v[88:91], v[84:87], v[20:23]
    s_add_u32 m0, s87, 126976
    s_add_u32 s57, s86, 4096
    buffer_load_dwordx4 v240, s[16:19], s86 offen offset:0 sc1 lds
    v_mfma_f32_16x16x32_bf16 v[24:27], v[92:95], v[84:87], v[24:27]
    ds_read_b128 v[60:63], v233 offset:0
    v_mfma_f32_16x16x32_bf16 v[4:7], v[92:95], v[80:83], v[4:7]
    ds_read_b128 v[56:59], v232 offset:1024
    v_mfma_f32_16x16x32_bf16 v[8:11], v[96:99], v[80:83], v[8:11]
    buffer_load_dwordx4 v240, s[16:19], s86 offen offset:1024 sc1 lds
    v_mfma_f32_16x16x32_bf16 v[28:31], v[96:99], v[84:87], v[28:31]
    ds_read_b128 v[64:67], v233 offset:1024
    v_mfma_f32_16x16x32_bf16 v[32:35], v[100:103], v[84:87], v[32:35]
    ds_read_b128 v[68:71], v233 offset:2048
    v_mfma_f32_16x16x32_bf16 v[12:15], v[100:103], v[80:83], v[12:15]
    buffer_load_dwordx4 v240, s[16:19], s86 offen offset:2048 sc1 lds
    v_mfma_f32_16x16x32_bf16 v[16:19], v[104:107], v[80:83], v[16:19]
    ds_read_b128 v[72:75], v233 offset:3072
    v_mfma_f32_16x16x32_bf16 v[36:39], v[104:107], v[84:87], v[36:39]
    ds_read_b128 v[76:79], v233 offset:4096
    s_waitcnt lgkmcnt(5)
    v_mfma_f32_16x16x32_bf16 v[172:175], v[60:63], v[52:55], 0
    ds_read_b128 v[80:83], v232 offset:4096
    s_waitcnt lgkmcnt(5)
    v_mfma_f32_16x16x32_bf16 v[192:195], v[60:63], v[56:59], 0
    buffer_load_dwordx4 v240, s[16:19], s86 offen offset:3072 sc1 lds
    s_waitcnt lgkmcnt(4)
    v_mfma_f32_16x16x32_bf16 v[196:199], v[64:67], v[56:59], 0
    ds_read_b128 v[88:91], v233 offset:5120
    v_mfma_f32_16x16x32_bf16 v[176:179], v[64:67], v[52:55], 0
    ds_read_b128 v[84:87], v232 offset:5120
    s_waitcnt lgkmcnt(5)
    v_mfma_f32_16x16x32_bf16 v[180:183], v[68:71], v[52:55], 0
    s_add_u32 m0, m0, 4096
    s_add_u32 s86, s86, 10240
    buffer_load_dwordx4 v240, s[16:19], s57 offen offset:0 sc1 lds
    v_mfma_f32_16x16x32_bf16 v[200:203], v[68:71], v[56:59], 0
    ds_read_b128 v[92:95], v233 offset:6144
    s_waitcnt lgkmcnt(5)
    v_mfma_f32_16x16x32_bf16 v[204:207], v[72:75], v[56:59], 0
    ds_read_b128 v[96:99], v233 offset:7168
    v_mfma_f32_16x16x32_bf16 v[184:187], v[72:75], v[52:55], 0
    ds_read_b128 v[100:103], v233 offset:8192
    s_waitcnt lgkmcnt(6)
    v_mfma_f32_16x16x32_bf16 v[188:191], v[76:79], v[52:55], 0
    ds_read_b128 v[104:107], v233 offset:9216
    v_mfma_f32_16x16x32_bf16 v[208:211], v[76:79], v[56:59], 0
    s_waitcnt lgkmcnt(5)
    v_mfma_f32_16x16x32_bf16 v[172:175], v[88:91], v[80:83], v[172:175]
    s_waitcnt vmcnt(10)
    s_waitcnt lgkmcnt(0)
    s_barrier
    ds_read_b128 v[52:55], v232 offset:16384
    v_mfma_f32_16x16x32_bf16 v[192:195], v[88:91], v[84:87], v[192:195]
    s_add_u32 m0, s87, 65536
    s_add_u32 s57, s86, 4096
    buffer_load_dwordx4 v240, s[16:19], s86 offen offset:0 sc1 lds
    v_mfma_f32_16x16x32_bf16 v[196:199], v[92:95], v[84:87], v[196:199]
    ds_read_b128 v[60:63], v233 offset:20480
    v_mfma_f32_16x16x32_bf16 v[176:179], v[92:95], v[80:83], v[176:179]
    ds_read_b128 v[56:59], v232 offset:17408
    v_mfma_f32_16x16x32_bf16 v[180:183], v[96:99], v[80:83], v[180:183]
    buffer_load_dwordx4 v240, s[16:19], s86 offen offset:1024 sc1 lds
    v_mfma_f32_16x16x32_bf16 v[200:203], v[96:99], v[84:87], v[200:203]
    ds_read_b128 v[64:67], v233 offset:21504
    v_mfma_f32_16x16x32_bf16 v[204:207], v[100:103], v[84:87], v[204:207]
    ds_read_b128 v[68:71], v233 offset:22528
    v_mfma_f32_16x16x32_bf16 v[184:187], v[100:103], v[80:83], v[184:187]
    buffer_load_dwordx4 v240, s[16:19], s86 offen offset:2048 sc1 lds
    v_mfma_f32_16x16x32_bf16 v[188:191], v[104:107], v[80:83], v[188:191]
    ds_read_b128 v[72:75], v233 offset:23552
    v_mfma_f32_16x16x32_bf16 v[208:211], v[104:107], v[84:87], v[208:211]
    ds_read_b128 v[76:79], v233 offset:24576
    s_waitcnt lgkmcnt(5)
    v_mfma_f32_16x16x32_bf16 v[172:175], v[60:63], v[52:55], v[172:175]
    ds_read_b128 v[80:83], v232 offset:20480
    s_waitcnt lgkmcnt(5)
    v_mfma_f32_16x16x32_bf16 v[192:195], v[60:63], v[56:59], v[192:195]
    buffer_load_dwordx4 v240, s[16:19], s86 offen offset:3072 sc1 lds
    s_waitcnt lgkmcnt(4)
    v_mfma_f32_16x16x32_bf16 v[196:199], v[64:67], v[56:59], v[196:199]
    ds_read_b128 v[88:91], v233 offset:25600
    v_mfma_f32_16x16x32_bf16 v[176:179], v[64:67], v[52:55], v[176:179]
    ds_read_b128 v[84:87], v232 offset:21504
    s_waitcnt lgkmcnt(5)
    v_mfma_f32_16x16x32_bf16 v[180:183], v[68:71], v[52:55], v[180:183]
    s_add_u32 m0, m0, 4096
    s_add_u32 s86, s86, 10240
    buffer_load_dwordx4 v240, s[16:19], s57 offen offset:0 sc1 lds
    v_mfma_f32_16x16x32_bf16 v[200:203], v[68:71], v[56:59], v[200:203]
    ds_read_b128 v[92:95], v233 offset:26624
    s_waitcnt lgkmcnt(5)
    v_mfma_f32_16x16x32_bf16 v[204:207], v[72:75], v[56:59], v[204:207]
    ds_read_b128 v[96:99], v233 offset:27648
    v_mfma_f32_16x16x32_bf16 v[184:187], v[72:75], v[52:55], v[184:187]
    ds_read_b128 v[100:103], v233 offset:28672
    s_waitcnt lgkmcnt(6)
    v_mfma_f32_16x16x32_bf16 v[188:191], v[76:79], v[52:55], v[188:191]
    ds_read_b128 v[104:107], v233 offset:29696
    v_mfma_f32_16x16x32_bf16 v[208:211], v[76:79], v[56:59], v[208:211]
    s_waitcnt lgkmcnt(5)
    v_mfma_f32_16x16x32_bf16 v[172:175], v[88:91], v[80:83], v[172:175]
    s_waitcnt vmcnt(10)
    s_waitcnt lgkmcnt(0)
    s_barrier
    ds_read_b128 v[52:55], v232 offset:32768
    v_mfma_f32_16x16x32_bf16 v[192:195], v[88:91], v[84:87], v[192:195]
    s_add_u32 m0, s87, 86016
    s_add_u32 s57, s86, 4096
    buffer_load_dwordx4 v240, s[16:19], s86 offen offset:0 sc1 lds
    v_mfma_f32_16x16x32_bf16 v[196:199], v[92:95], v[84:87], v[196:199]
    ds_read_b128 v[60:63], v234 offset:0
    v_mfma_f32_16x16x32_bf16 v[176:179], v[92:95], v[80:83], v[176:179]
    ds_read_b128 v[56:59], v232 offset:33792
    v_mfma_f32_16x16x32_bf16 v[180:183], v[96:99], v[80:83], v[180:183]
    buffer_load_dwordx4 v240, s[16:19], s86 offen offset:1024 sc1 lds
    v_mfma_f32_16x16x32_bf16 v[200:203], v[96:99], v[84:87], v[200:203]
    ds_read_b128 v[64:67], v234 offset:1024
    v_mfma_f32_16x16x32_bf16 v[204:207], v[100:103], v[84:87], v[204:207]
    ds_read_b128 v[68:71], v234 offset:2048
    v_mfma_f32_16x16x32_bf16 v[184:187], v[100:103], v[80:83], v[184:187]
    buffer_load_dwordx4 v240, s[16:19], s86 offen offset:2048 sc1 lds
    v_mfma_f32_16x16x32_bf16 v[188:191], v[104:107], v[80:83], v[188:191]
    ds_read_b128 v[72:75], v234 offset:3072
    v_mfma_f32_16x16x32_bf16 v[208:211], v[104:107], v[84:87], v[208:211]
    ds_read_b128 v[76:79], v234 offset:4096
    s_waitcnt lgkmcnt(5)
    v_mfma_f32_16x16x32_bf16 v[172:175], v[60:63], v[52:55], v[172:175]
    ds_read_b128 v[80:83], v232 offset:36864
    s_waitcnt lgkmcnt(5)
    v_mfma_f32_16x16x32_bf16 v[192:195], v[60:63], v[56:59], v[192:195]
    buffer_load_dwordx4 v240, s[16:19], s86 offen offset:3072 sc1 lds
    s_waitcnt lgkmcnt(4)
    v_mfma_f32_16x16x32_bf16 v[196:199], v[64:67], v[56:59], v[196:199]
    ds_read_b128 v[88:91], v234 offset:5120
    v_mfma_f32_16x16x32_bf16 v[176:179], v[64:67], v[52:55], v[176:179]
    ds_read_b128 v[84:87], v232 offset:37888
    s_waitcnt lgkmcnt(5)
    v_mfma_f32_16x16x32_bf16 v[180:183], v[68:71], v[52:55], v[180:183]
    s_add_u32 m0, m0, 4096
    s_add_u32 s86, s86, 10240
    buffer_load_dwordx4 v240, s[16:19], s57 offen offset:0 sc1 lds
    v_mfma_f32_16x16x32_bf16 v[200:203], v[68:71], v[56:59], v[200:203]
    ds_read_b128 v[92:95], v234 offset:6144
    s_waitcnt lgkmcnt(5)
    v_mfma_f32_16x16x32_bf16 v[204:207], v[72:75], v[56:59], v[204:207]
    ds_read_b128 v[96:99], v234 offset:7168
    v_mfma_f32_16x16x32_bf16 v[184:187], v[72:75], v[52:55], v[184:187]
    ds_read_b128 v[100:103], v234 offset:8192
    s_waitcnt lgkmcnt(6)
    v_mfma_f32_16x16x32_bf16 v[188:191], v[76:79], v[52:55], v[188:191]
    ds_read_b128 v[104:107], v234 offset:9216
    v_mfma_f32_16x16x32_bf16 v[208:211], v[76:79], v[56:59], v[208:211]
    s_waitcnt lgkmcnt(5)
    v_mfma_f32_16x16x32_bf16 v[172:175], v[88:91], v[80:83], v[172:175]
    s_waitcnt vmcnt(10)
    s_waitcnt lgkmcnt(0)
    s_barrier
    ds_read_b128 v[52:55], v232 offset:49152
    v_mfma_f32_16x16x32_bf16 v[192:195], v[88:91], v[84:87], v[192:195]
    s_add_u32 m0, s87, 106496
    s_add_u32 s57, s86, 4096
    buffer_load_dwordx4 v240, s[16:19], s86 offen offset:0 sc1 lds
    v_mfma_f32_16x16x32_bf16 v[196:199], v[92:95], v[84:87], v[196:199]
    ds_read_b128 v[60:63], v234 offset:20480
    v_mfma_f32_16x16x32_bf16 v[176:179], v[92:95], v[80:83], v[176:179]
    ds_read_b128 v[56:59], v232 offset:50176
    v_mfma_f32_16x16x32_bf16 v[180:183], v[96:99], v[80:83], v[180:183]
    buffer_load_dwordx4 v240, s[16:19], s86 offen offset:1024 sc1 lds
    v_mfma_f32_16x16x32_bf16 v[200:203], v[96:99], v[84:87], v[200:203]
    ds_read_b128 v[64:67], v234 offset:21504
    v_mfma_f32_16x16x32_bf16 v[204:207], v[100:103], v[84:87], v[204:207]
    ds_read_b128 v[68:71], v234 offset:22528
    v_mfma_f32_16x16x32_bf16 v[184:187], v[100:103], v[80:83], v[184:187]
    buffer_load_dwordx4 v240, s[16:19], s86 offen offset:2048 sc1 lds
    v_mfma_f32_16x16x32_bf16 v[188:191], v[104:107], v[80:83], v[188:191]
    ds_read_b128 v[72:75], v234 offset:23552
    v_mfma_f32_16x16x32_bf16 v[208:211], v[104:107], v[84:87], v[208:211]
    ds_read_b128 v[76:79], v234 offset:24576
    s_waitcnt lgkmcnt(5)
    v_mfma_f32_16x16x32_bf16 v[172:175], v[60:63], v[52:55], v[172:175]
    ds_read_b128 v[80:83], v232 offset:53248
    s_waitcnt lgkmcnt(5)
    v_mfma_f32_16x16x32_bf16 v[192:195], v[60:63], v[56:59], v[192:195]
    buffer_load_dwordx4 v240, s[16:19], s86 offen offset:3072 sc1 lds
    s_waitcnt lgkmcnt(4)
    v_mfma_f32_16x16x32_bf16 v[196:199], v[64:67], v[56:59], v[196:199]
    ds_read_b128 v[88:91], v234 offset:25600
    v_mfma_f32_16x16x32_bf16 v[176:179], v[64:67], v[52:55], v[176:179]
    ds_read_b128 v[84:87], v232 offset:54272
    s_waitcnt lgkmcnt(5)
    v_mfma_f32_16x16x32_bf16 v[180:183], v[68:71], v[52:55], v[180:183]
    s_add_u32 m0, m0, 4096
    s_add_u32 s86, s86, 10240
    buffer_load_dwordx4 v240, s[16:19], s57 offen offset:0 sc1 lds
    v_mfma_f32_16x16x32_bf16 v[200:203], v[68:71], v[56:59], v[200:203]
    ds_read_b128 v[92:95], v234 offset:26624
    s_waitcnt lgkmcnt(5)
    v_mfma_f32_16x16x32_bf16 v[204:207], v[72:75], v[56:59], v[204:207]
    ds_read_b128 v[96:99], v234 offset:27648
    v_mfma_f32_16x16x32_bf16 v[184:187], v[72:75], v[52:55], v[184:187]
    ds_read_b128 v[100:103], v234 offset:28672
    s_waitcnt lgkmcnt(6)
    v_mfma_f32_16x16x32_bf16 v[188:191], v[76:79], v[52:55], v[188:191]
    ds_read_b128 v[104:107], v234 offset:29696
    v_mfma_f32_16x16x32_bf16 v[208:211], v[76:79], v[56:59], v[208:211]
    s_waitcnt lgkmcnt(5)
    v_mfma_f32_16x16x32_bf16 v[172:175], v[88:91], v[80:83], v[172:175]
    s_waitcnt vmcnt(10)
    s_waitcnt lgkmcnt(0)
    s_barrier
    ds_read_b128 v[52:55], v232 offset:0
    v_mfma_f32_16x16x32_bf16 v[192:195], v[88:91], v[84:87], v[192:195]
    s_add_u32 m0, s87, 126976
    s_add_u32 s57, s86, 4096
    buffer_load_dwordx4 v240, s[16:19], s86 offen offset:0 sc1 lds
    v_mfma_f32_16x16x32_bf16 v[196:199], v[92:95], v[84:87], v[196:199]
    ds_read_b128 v[60:63], v233 offset:0
    v_mfma_f32_16x16x32_bf16 v[176:179], v[92:95], v[80:83], v[176:179]
    ds_read_b128 v[56:59], v232 offset:1024
    v_mfma_f32_16x16x32_bf16 v[180:183], v[96:99], v[80:83], v[180:183]
    buffer_load_dwordx4 v240, s[16:19], s86 offen offset:1024 sc1 lds
    v_mfma_f32_16x16x32_bf16 v[200:203], v[96:99], v[84:87], v[200:203]
    ds_read_b128 v[64:67], v233 offset:1024
    v_mfma_f32_16x16x32_bf16 v[204:207], v[100:103], v[84:87], v[204:207]
    ds_read_b128 v[68:71], v233 offset:2048
    v_mfma_f32_16x16x32_bf16 v[184:187], v[100:103], v[80:83], v[184:187]
    buffer_load_dwordx4 v240, s[16:19], s86 offen offset:2048 sc1 lds
    v_mfma_f32_16x16x32_bf16 v[188:191], v[104:107], v[80:83], v[188:191]
    ds_read_b128 v[72:75], v233 offset:3072
    v_mfma_f32_16x16x32_bf16 v[208:211], v[104:107], v[84:87], v[208:211]
    ds_read_b128 v[76:79], v233 offset:4096
    s_waitcnt lgkmcnt(5)
    v_mfma_f32_16x16x32_bf16 v[172:175], v[60:63], v[52:55], v[172:175]
    ds_read_b128 v[80:83], v232 offset:4096
    s_waitcnt lgkmcnt(5)
    v_mfma_f32_16x16x32_bf16 v[192:195], v[60:63], v[56:59], v[192:195]
    buffer_load_dwordx4 v240, s[16:19], s86 offen offset:3072 sc1 lds
    s_waitcnt lgkmcnt(4)
    v_mfma_f32_16x16x32_bf16 v[196:199], v[64:67], v[56:59], v[196:199]
    ds_read_b128 v[88:91], v233 offset:5120
    v_mfma_f32_16x16x32_bf16 v[176:179], v[64:67], v[52:55], v[176:179]
    ds_read_b128 v[84:87], v232 offset:5120
    s_waitcnt lgkmcnt(5)
    v_mfma_f32_16x16x32_bf16 v[180:183], v[68:71], v[52:55], v[180:183]
    s_add_u32 m0, m0, 4096
    s_add_u32 s86, s86, 10240
    buffer_load_dwordx4 v240, s[16:19], s57 offen offset:0 sc1 lds
    v_mfma_f32_16x16x32_bf16 v[200:203], v[68:71], v[56:59], v[200:203]
    ds_read_b128 v[92:95], v233 offset:6144
    s_waitcnt lgkmcnt(5)
    v_mfma_f32_16x16x32_bf16 v[204:207], v[72:75], v[56:59], v[204:207]
    ds_read_b128 v[96:99], v233 offset:7168
    v_mfma_f32_16x16x32_bf16 v[184:187], v[72:75], v[52:55], v[184:187]
    ds_read_b128 v[100:103], v233 offset:8192
    s_waitcnt lgkmcnt(6)
    v_mfma_f32_16x16x32_bf16 v[188:191], v[76:79], v[52:55], v[188:191]
    ds_read_b128 v[104:107], v233 offset:9216
    v_mfma_f32_16x16x32_bf16 v[208:211], v[76:79], v[56:59], v[208:211]
    s_waitcnt lgkmcnt(5)
    v_mfma_f32_16x16x32_bf16 v[172:175], v[88:91], v[80:83], v[172:175]
    s_waitcnt vmcnt(10)
    s_waitcnt lgkmcnt(0)
    s_barrier
    ds_read_b128 v[52:55], v232 offset:16384
    v_mfma_f32_16x16x32_bf16 v[192:195], v[88:91], v[84:87], v[192:195]
    s_add_u32 m0, s87, 65536
    s_add_u32 s57, s76, 4096
    buffer_load_dwordx4 v240, s[16:19], s76 offen offset:0 sc1 lds
    v_mfma_f32_16x16x32_bf16 v[196:199], v[92:95], v[84:87], v[196:199]
    ds_read_b128 v[60:63], v233 offset:20480
    v_mfma_f32_16x16x32_bf16 v[176:179], v[92:95], v[80:83], v[176:179]
    ds_read_b128 v[56:59], v232 offset:17408
    v_mfma_f32_16x16x32_bf16 v[180:183], v[96:99], v[80:83], v[180:183]
    buffer_load_dwordx4 v240, s[16:19], s76 offen offset:1024 sc1 lds
    v_mfma_f32_16x16x32_bf16 v[200:203], v[96:99], v[84:87], v[200:203]
    ds_read_b128 v[64:67], v233 offset:21504
    v_mfma_f32_16x16x32_bf16 v[204:207], v[100:103], v[84:87], v[204:207]
    ds_read_b128 v[68:71], v233 offset:22528
    v_mfma_f32_16x16x32_bf16 v[184:187], v[100:103], v[80:83], v[184:187]
    buffer_load_dwordx4 v240, s[16:19], s76 offen offset:2048 sc1 lds
    v_mfma_f32_16x16x32_bf16 v[188:191], v[104:107], v[80:83], v[188:191]
    ds_read_b128 v[72:75], v233 offset:23552
    v_mfma_f32_16x16x32_bf16 v[208:211], v[104:107], v[84:87], v[208:211]
    ds_read_b128 v[76:79], v233 offset:24576
    s_waitcnt lgkmcnt(5)
    v_mfma_f32_16x16x32_bf16 v[172:175], v[60:63], v[52:55], v[172:175]
    ds_read_b128 v[80:83], v232 offset:20480
    s_waitcnt lgkmcnt(5)
    v_mfma_f32_16x16x32_bf16 v[192:195], v[60:63], v[56:59], v[192:195]
    buffer_load_dwordx4 v240, s[16:19], s76 offen offset:3072 sc1 lds
    s_waitcnt lgkmcnt(4)
    v_mfma_f32_16x16x32_bf16 v[196:199], v[64:67], v[56:59], v[196:199]
    ds_read_b128 v[88:91], v233 offset:25600
    v_mfma_f32_16x16x32_bf16 v[176:179], v[64:67], v[52:55], v[176:179]
    ds_read_b128 v[84:87], v232 offset:21504
    s_waitcnt lgkmcnt(5)
    v_mfma_f32_16x16x32_bf16 v[180:183], v[68:71], v[52:55], v[180:183]
    s_add_u32 m0, m0, 4096
    s_add_u32 s76, s76, 20480
    buffer_load_dwordx4 v240, s[16:19], s57 offen offset:0 sc1 lds
    v_mfma_f32_16x16x32_bf16 v[200:203], v[68:71], v[56:59], v[200:203]
    ds_read_b128 v[92:95], v233 offset:26624
    s_waitcnt lgkmcnt(5)
    v_mfma_f32_16x16x32_bf16 v[204:207], v[72:75], v[56:59], v[204:207]
    ds_read_b128 v[96:99], v233 offset:27648
    v_mfma_f32_16x16x32_bf16 v[184:187], v[72:75], v[52:55], v[184:187]
    ds_read_b128 v[100:103], v233 offset:28672
    s_waitcnt lgkmcnt(6)
    v_mfma_f32_16x16x32_bf16 v[188:191], v[76:79], v[52:55], v[188:191]
    ds_read_b128 v[104:107], v233 offset:29696
    v_mfma_f32_16x16x32_bf16 v[208:211], v[76:79], v[56:59], v[208:211]
    s_waitcnt lgkmcnt(5)
    v_mfma_f32_16x16x32_bf16 v[172:175], v[88:91], v[80:83], v[172:175]
    s_waitcnt vmcnt(10)
    s_waitcnt lgkmcnt(0)
    s_barrier
    ds_read_b128 v[52:55], v232 offset:32768
    v_mfma_f32_16x16x32_bf16 v[192:195], v[88:91], v[84:87], v[192:195]
    s_add_u32 m0, s87, 86016
    s_add_u32 s57, s76, 4096
    buffer_load_dwordx4 v240, s[16:19], s76 offen offset:0 sc1 lds
    v_mfma_f32_16x16x32_bf16 v[196:199], v[92:95], v[84:87], v[196:199]
    ds_read_b128 v[60:63], v234 offset:0
    v_mfma_f32_16x16x32_bf16 v[176:179], v[92:95], v[80:83], v[176:179]
    ds_read_b128 v[56:59], v232 offset:33792
    v_mfma_f32_16x16x32_bf16 v[180:183], v[96:99], v[80:83], v[180:183]
    buffer_load_dwordx4 v240, s[16:19], s76 offen offset:1024 sc1 lds
    v_mfma_f32_16x16x32_bf16 v[200:203], v[96:99], v[84:87], v[200:203]
    ds_read_b128 v[64:67], v234 offset:1024
    v_mfma_f32_16x16x32_bf16 v[204:207], v[100:103], v[84:87], v[204:207]
    ds_read_b128 v[68:71], v234 offset:2048
    v_mfma_f32_16x16x32_bf16 v[184:187], v[100:103], v[80:83], v[184:187]
    buffer_load_dwordx4 v240, s[16:19], s76 offen offset:2048 sc1 lds
    v_mfma_f32_16x16x32_bf16 v[188:191], v[104:107], v[80:83], v[188:191]
    ds_read_b128 v[72:75], v234 offset:3072
    v_mfma_f32_16x16x32_bf16 v[208:211], v[104:107], v[84:87], v[208:211]
    ds_read_b128 v[76:79], v234 offset:4096
    s_waitcnt lgkmcnt(5)
    v_mfma_f32_16x16x32_bf16 v[172:175], v[60:63], v[52:55], v[172:175]
    ds_read_b128 v[80:83], v232 offset:36864
    s_waitcnt lgkmcnt(5)
    v_mfma_f32_16x16x32_bf16 v[192:195], v[60:63], v[56:59], v[192:195]
    buffer_load_dwordx4 v240, s[16:19], s76 offen offset:3072 sc1 lds
    s_waitcnt lgkmcnt(4)
    v_mfma_f32_16x16x32_bf16 v[196:199], v[64:67], v[56:59], v[196:199]
    ds_read_b128 v[88:91], v234 offset:5120
    v_mfma_f32_16x16x32_bf16 v[176:179], v[64:67], v[52:55], v[176:179]
    ds_read_b128 v[84:87], v232 offset:37888
    s_waitcnt lgkmcnt(5)
    v_mfma_f32_16x16x32_bf16 v[180:183], v[68:71], v[52:55], v[180:183]
    s_add_u32 m0, m0, 4096
    s_add_u32 s76, s76, 20480
    buffer_load_dwordx4 v240, s[16:19], s57 offen offset:0 sc1 lds
    v_mfma_f32_16x16x32_bf16 v[200:203], v[68:71], v[56:59], v[200:203]
    ds_read_b128 v[92:95], v234 offset:6144
    s_waitcnt lgkmcnt(5)
    v_mfma_f32_16x16x32_bf16 v[204:207], v[72:75], v[56:59], v[204:207]
    ds_read_b128 v[96:99], v234 offset:7168
    v_mfma_f32_16x16x32_bf16 v[184:187], v[72:75], v[52:55], v[184:187]
    ds_read_b128 v[100:103], v234 offset:8192
    s_waitcnt lgkmcnt(6)
    v_mfma_f32_16x16x32_bf16 v[188:191], v[76:79], v[52:55], v[188:191]
    ds_read_b128 v[104:107], v234 offset:9216
    v_mfma_f32_16x16x32_bf16 v[208:211], v[76:79], v[56:59], v[208:211]
    s_waitcnt lgkmcnt(5)
    v_mfma_f32_16x16x32_bf16 v[172:175], v[88:91], v[80:83], v[172:175]
    s_waitcnt vmcnt(10)
    s_waitcnt lgkmcnt(0)
    s_barrier
    ds_read_b128 v[52:55], v232 offset:49152
    v_mfma_f32_16x16x32_bf16 v[192:195], v[88:91], v[84:87], v[192:195]
    s_add_u32 m0, s87, 106496
    s_add_u32 s57, s76, 4096
    buffer_load_dwordx4 v240, s[16:19], s76 offen offset:0 sc1 lds
    v_mfma_f32_16x16x32_bf16 v[196:199], v[92:95], v[84:87], v[196:199]
    ds_read_b128 v[60:63], v234 offset:20480
    v_mfma_f32_16x16x32_bf16 v[176:179], v[92:95], v[80:83], v[176:179]
    ds_read_b128 v[56:59], v232 offset:50176
    v_mfma_f32_16x16x32_bf16 v[180:183], v[96:99], v[80:83], v[180:183]
    buffer_load_dwordx4 v240, s[16:19], s76 offen offset:1024 sc1 lds
    v_mfma_f32_16x16x32_bf16 v[200:203], v[96:99], v[84:87], v[200:203]
    ds_read_b128 v[64:67], v234 offset:21504
    v_mfma_f32_16x16x32_bf16 v[204:207], v[100:103], v[84:87], v[204:207]
    ds_read_b128 v[68:71], v234 offset:22528
    v_mfma_f32_16x16x32_bf16 v[184:187], v[100:103], v[80:83], v[184:187]
    buffer_load_dwordx4 v240, s[16:19], s76 offen offset:2048 sc1 lds
    v_mfma_f32_16x16x32_bf16 v[188:191], v[104:107], v[80:83], v[188:191]
    ds_read_b128 v[72:75], v234 offset:23552
    v_mfma_f32_16x16x32_bf16 v[208:211], v[104:107], v[84:87], v[208:211]
    ds_read_b128 v[76:79], v234 offset:24576
    s_waitcnt lgkmcnt(5)
    v_mfma_f32_16x16x32_bf16 v[172:175], v[60:63], v[52:55], v[172:175]
    ds_read_b128 v[80:83], v232 offset:53248
    s_waitcnt lgkmcnt(5)
    v_mfma_f32_16x16x32_bf16 v[192:195], v[60:63], v[56:59], v[192:195]
    buffer_load_dwordx4 v240, s[16:19], s76 offen offset:3072 sc1 lds
    s_waitcnt lgkmcnt(4)
    v_mfma_f32_16x16x32_bf16 v[196:199], v[64:67], v[56:59], v[196:199]
    ds_read_b128 v[88:91], v234 offset:25600
    v_mfma_f32_16x16x32_bf16 v[176:179], v[64:67], v[52:55], v[176:179]
    ds_read_b128 v[84:87], v232 offset:54272
    s_waitcnt lgkmcnt(5)
    v_mfma_f32_16x16x32_bf16 v[180:183], v[68:71], v[52:55], v[180:183]
    s_add_u32 m0, m0, 4096
    s_add_u32 s76, s76, 20480
    buffer_load_dwordx4 v240, s[16:19], s57 offen offset:0 sc1 lds
    v_mfma_f32_16x16x32_bf16 v[200:203], v[68:71], v[56:59], v[200:203]
    ds_read_b128 v[92:95], v234 offset:26624
    s_waitcnt lgkmcnt(5)
    v_mfma_f32_16x16x32_bf16 v[204:207], v[72:75], v[56:59], v[204:207]
    ds_read_b128 v[96:99], v234 offset:27648
    v_mfma_f32_16x16x32_bf16 v[184:187], v[72:75], v[52:55], v[184:187]
    ds_read_b128 v[100:103], v234 offset:28672
    s_waitcnt lgkmcnt(6)
    v_mfma_f32_16x16x32_bf16 v[188:191], v[76:79], v[52:55], v[188:191]
    ds_read_b128 v[104:107], v234 offset:29696
    v_mfma_f32_16x16x32_bf16 v[208:211], v[76:79], v[56:59], v[208:211]
    s_waitcnt lgkmcnt(5)
    v_mfma_f32_16x16x32_bf16 v[172:175], v[88:91], v[80:83], v[172:175]
    s_waitcnt vmcnt(10)
    s_waitcnt lgkmcnt(0)
    s_barrier
    v_mfma_f32_16x16x32_bf16 v[192:195], v[88:91], v[84:87], v[192:195]
    ds_read_b128 v[52:55], v236 offset:0
    v_mfma_f32_16x16x32_bf16 v[196:199], v[92:95], v[84:87], v[196:199]
    s_add_u32 m0, s87, 126976
    s_add_u32 s57, s76, 4096
    buffer_load_dwordx4 v240, s[16:19], s76 offen offset:0 sc1 lds
    v_mfma_f32_16x16x32_bf16 v[176:179], v[92:95], v[80:83], v[176:179]
    v_mfma_f32_16x16x32_bf16 v[180:183], v[96:99], v[80:83], v[180:183]
    ds_read_b128 v[56:59], v237 offset:0
    v_mfma_f32_16x16x32_bf16 v[200:203], v[96:99], v[84:87], v[200:203]
    ds_read_b128 v[60:63], v237 offset:1024
    v_mfma_f32_16x16x32_bf16 v[204:207], v[100:103], v[84:87], v[204:207]
    v_mfma_f32_16x16x32_bf16 v[184:187], v[100:103], v[80:83], v[184:187]
    buffer_load_dwordx4 v240, s[16:19], s76 offen offset:1024 sc1 lds
    v_mfma_f32_16x16x32_bf16 v[188:191], v[104:107], v[80:83], v[188:191]
    buffer_load_dwordx4 v240, s[16:19], s76 offen offset:2048 sc1 lds
    v_mfma_f32_16x16x32_bf16 v[208:211], v[104:107], v[84:87], v[208:211]
    s_waitcnt lgkmcnt(1)
    v_mfma_f32_16x16x32_bf16 v[40:43], v[56:59], v[52:55], 0
    ds_read_b128 v[80:83], v236 offset:4096
    buffer_load_dwordx4 v240, s[16:19], s76 offen offset:3072 sc1 lds
    ds_read_b128 v[84:87], v237 offset:5120
    s_waitcnt lgkmcnt(2)
    v_mfma_f32_16x16x32_bf16 v[44:47], v[60:63], v[52:55], 0
    ds_read_b128 v[88:91], v237 offset:6144
    s_add_u32 m0, m0, 4096
    s_add_u32 s76, s76, 20480
    buffer_load_dwordx4 v240, s[16:19], s57 offen offset:0 sc1 lds
    s_waitcnt lgkmcnt(1)
    v_mfma_f32_16x16x32_bf16 v[40:43], v[84:87], v[80:83], v[40:43]
    ds_read_b128 v[52:55], v236 offset:8192
    ds_read_b128 v[56:59], v237 offset:10240
    ds_read_b128 v[60:63], v237 offset:11264
    v_pk_add_f32 v[0:1], v[0:1], v[172:173]
    v_pk_add_f32 v[2:3], v[2:3], v[174:175]
    v_pk_add_f32 v[4:5], v[4:5], v[176:177]
    v_pk_add_f32 v[6:7], v[6:7], v[178:179]
    v_pk_add_f32 v[8:9], v[8:9], v[180:181]
    v_pk_add_f32 v[10:11], v[10:11], v[182:183]
    v_pk_add_f32 v[12:13], v[12:13], v[184:185]
    v_pk_add_f32 v[14:15], v[14:15], v[186:187]
    v_pk_add_f32 v[16:17], v[16:17], v[188:189]
    s_waitcnt lgkmcnt(3)
    v_mfma_f32_16x16x32_bf16 v[44:47], v[88:91], v[80:83], v[44:47]
    v_pk_add_f32 v[18:19], v[18:19], v[190:191]
    v_pk_add_f32 v[20:21], v[20:21], v[192:193]
    v_pk_add_f32 v[22:23], v[22:23], v[194:195]
    v_pk_add_f32 v[24:25], v[24:25], v[196:197]
    v_pk_add_f32 v[26:27], v[26:27], v[198:199]
    v_pk_add_f32 v[28:29], v[28:29], v[200:201]
    v_pk_add_f32 v[30:31], v[30:31], v[202:203]
    v_pk_add_f32 v[32:33], v[32:33], v[204:205]
    v_pk_add_f32 v[34:35], v[34:35], v[206:207]
    v_pk_add_f32 v[36:37], v[36:37], v[208:209]
    v_pk_add_f32 v[38:39], v[38:39], v[210:211]
    s_and_b32 s55, s54, 3
    s_cmp_eq_u32 s55, s79
    s_cbranch_scc1 L_sndlo
    s_lshl_b32 s67, s80, 2
    s_add_u32 s67, s67, s55
    s_lshl_b32 s67, s67, 2
    s_add_u32 s67, s67, s79
    s_mul_i32 s67, s67, 20480
    s_add_u32 s67, s67, 75507712
    v_cvt_pk_bf16_f32 v0, v0, v1
    v_cvt_pk_bf16_f32 v1, v2, v3
    v_cvt_pk_bf16_f32 v2, v4, v5
    v_cvt_pk_bf16_f32 v3, v6, v7
    v_cvt_pk_bf16_f32 v4, v8, v9
    v_cvt_pk_bf16_f32 v5, v10, v11
    v_cvt_pk_bf16_f32 v6, v12, v13
    v_cvt_pk_bf16_f32 v7, v14, v15
    v_cvt_pk_bf16_f32 v8, v16, v17
    v_cvt_pk_bf16_f32 v9, v18, v19
    v_cvt_pk_bf16_f32 v10, v20, v21
    v_cvt_pk_bf16_f32 v11, v22, v23
    v_cvt_pk_bf16_f32 v12, v24, v25
    v_cvt_pk_bf16_f32 v13, v26, v27
    v_cvt_pk_bf16_f32 v14, v28, v29
    v_cvt_pk_bf16_f32 v15, v30, v31
    v_cvt_pk_bf16_f32 v16, v32, v33
    v_cvt_pk_bf16_f32 v17, v34, v35
    v_cvt_pk_bf16_f32 v18, v36, v37
    v_cvt_pk_bf16_f32 v19, v38, v39
    buffer_store_dwordx4 v[0:3], v240, s[16:19], s67 offen offset:0 sc1
    buffer_store_dwordx4 v[4:7], v240, s[16:19], s67 offen offset:1024 sc1
    buffer_store_dwordx4 v[8:11], v240, s[16:19], s67 offen offset:2048 sc1
    buffer_store_dwordx4 v[12:15], v240, s[16:19], s67 offen offset:3072 sc1
    s_add_u32 s67, s67, 4096
    buffer_store_dwordx4 v[16:19], v240, s[16:19], s67 offen offset:0 sc1
L_sndlo:
    s_waitcnt lgkmcnt(1)
    v_mfma_f32_16x16x32_bf16 v[40:43], v[56:59], v[52:55], v[40:43]
    ds_read_b128 v[80:83], v236 offset:12288
    ds_read_b128 v[84:87], v237 offset:15360
    s_waitcnt lgkmcnt(2)
    v_mfma_f32_16x16x32_bf16 v[44:47], v[60:63], v[52:55], v[44:47]
    ds_read_b128 v[88:91], v237 offset:16384
    s_waitcnt lgkmcnt(1)
    v_mfma_f32_16x16x32_bf16 v[40:43], v[84:87], v[80:83], v[40:43]
    s_waitcnt vmcnt(10)
    s_waitcnt lgkmcnt(0)
    s_barrier
    ds_read_b128 v[52:55], v236 offset:16384
    s_add_u32 m0, s87, 65536
    s_add_u32 s57, s76, 4096
    buffer_load_dwordx4 v240, s[16:19], s76 offen offset:0 sc1 lds
    v_mfma_f32_16x16x32_bf16 v[44:47], v[88:91], v[80:83], v[44:47]
    ds_read_b128 v[56:59], v237 offset:20480
    ds_read_b128 v[60:63], v237 offset:21504
    buffer_load_dwordx4 v240, s[16:19], s76 offen offset:1024 sc1 lds
    s_waitcnt lgkmcnt(1)
    v_mfma_f32_16x16x32_bf16 v[40:43], v[56:59], v[52:55], v[40:43]
    ds_read_b128 v[80:83], v236 offset:20480
    buffer_load_dwordx4 v240, s[16:19], s76 offen offset:2048 sc1 lds
    ds_read_b128 v[84:87], v237 offset:25600
    s_waitcnt lgkmcnt(2)
    v_mfma_f32_16x16x32_bf16 v[44:47], v[60:63], v[52:55], v[44:47]
    ds_read_b128 v[88:91], v237 offset:26624
    buffer_load_dwordx4 v240, s[16:19], s76 offen offset:3072 sc1 lds
    s_waitcnt lgkmcnt(1)
    v_mfma_f32_16x16x32_bf16 v[40:43], v[84:87], v[80:83], v[40:43]
    ds_read_b128 v[52:55], v236 offset:24576
    s_add_u32 m0, m0, 4096
    s_add_u32 s76, s76, 20480
    buffer_load_dwordx4 v240, s[16:19], s57 offen offset:0 sc1 lds
    s_waitcnt lgkmcnt(1)
    v_mfma_f32_16x16x32_bf16 v[44:47], v[88:91], v[80:83], v[44:47]
    ds_read_b128 v[56:59], v237 offset:30720
    ds_read_b128 v[60:63], v237 offset:31744
    s_waitcnt lgkmcnt(1)
    v_mfma_f32_16x16x32_bf16 v[40:43], v[56:59], v[52:55], v[40:43]
    ds_read_b128 v[80:83], v236 offset:28672
    ds_read_b128 v[84:87], v237 offset:35840
    s_waitcnt lgkmcnt(2)
    v_mfma_f32_16x16x32_bf16 v[44:47], v[60:63], v[52:55], v[44:47]
    ds_read_b128 v[88:91], v237 offset:36864
    s_waitcnt lgkmcnt(1)
    v_mfma_f32_16x16x32_bf16 v[40:43], v[84:87], v[80:83], v[40:43]
    s_waitcnt vmcnt(10)
    s_waitcnt lgkmcnt(0)
    s_barrier
    ds_read_b128 v[52:55], v236 offset:32768
    v_mfma_f32_16x16x32_bf16 v[44:47], v[88:91], v[80:83], v[44:47]
    ds_read_b128 v[56:59], v238 offset:0
    ds_read_b128 v[60:63], v238 offset:1024
    s_waitcnt lgkmcnt(1)
    v_mfma_f32_16x16x32_bf16 v[40:43], v[56:59], v[52:55], v[40:43]
    ds_read_b128 v[80:83], v236 offset:36864
    ds_read_b128 v[84:87], v238 offset:5120
    s_waitcnt lgkmcnt(2)
    v_mfma_f32_16x16x32_bf16 v[44:47], v[60:63], v[52:55], v[44:47]
    ds_read_b128 v[88:91], v238 offset:6144
    s_waitcnt lgkmcnt(1)
    v_mfma_f32_16x16x32_bf16 v[40:43], v[84:87], v[80:83], v[40:43]
    ds_read_b128 v[52:55], v236 offset:40960
    ds_read_b128 v[56:59], v238 offset:10240
    s_waitcnt lgkmcnt(2)
    v_mfma_f32_16x16x32_bf16 v[44:47], v[88:91], v[80:83], v[44:47]
    ds_read_b128 v[60:63], v238 offset:11264
    s_waitcnt lgkmcnt(1)
    v_mfma_f32_16x16x32_bf16 v[40:43], v[56:59], v[52:55], v[40:43]
    ds_read_b128 v[80:83], v236 offset:45056
    ds_read_b128 v[84:87], v238 offset:15360
    s_waitcnt lgkmcnt(2)
    v_mfma_f32_16x16x32_bf16 v[44:47], v[60:63], v[52:55], v[44:47]
    ds_read_b128 v[88:91], v238 offset:16384
    s_and_b32 s55, s54, 3
    s_cmp_eq_u32 s55, s79
    s_cbranch_scc1 L_sfllo
    s_lshl_b32 s56, s80, 2
    s_add_u32 s55, s55, s56
    s_lshl_b32 s55, s55, 6
    s_lshl_b32 s56, s79, 3
    s_add_u32 s55, s55, s56
    s_add_u32 s55, s55, 73449504
    v_mov_b32 v242, s84
    v_mov_b32 v243, s85
    v_mov_b32 v244, 0
    s_waitcnt vmcnt(5)
    s_mov_b64 exec, 1
    buffer_store_dwordx2 v[242:243], v244, s[16:19], s55 offen sc1
    s_mov_b64 exec, -1
L_sfllo:
    s_waitcnt lgkmcnt(1)
    v_mfma_f32_16x16x32_bf16 v[40:43], v[84:87], v[80:83], v[40:43]
    s_waitcnt vmcnt(5)
    s_waitcnt lgkmcnt(0)
    s_barrier
    ds_read_b128 v[52:55], v236 offset:49152
    v_mfma_f32_16x16x32_bf16 v[44:47], v[88:91], v[80:83], v[44:47]
    ds_read_b128 v[56:59], v238 offset:20480
    ds_read_b128 v[60:63], v238 offset:21504
    s_waitcnt lgkmcnt(1)
    v_mfma_f32_16x16x32_bf16 v[40:43], v[56:59], v[52:55], v[40:43]
    ds_read_b128 v[80:83], v236 offset:53248
    ds_read_b128 v[84:87], v238 offset:25600
    s_waitcnt lgkmcnt(2)
    v_mfma_f32_16x16x32_bf16 v[44:47], v[60:63], v[52:55], v[44:47]
    ds_read_b128 v[88:91], v238 offset:26624
    s_waitcnt lgkmcnt(1)
    v_mfma_f32_16x16x32_bf16 v[40:43], v[84:87], v[80:83], v[40:43]
    ds_read_b128 v[52:55], v236 offset:57344
    ds_read_b128 v[56:59], v238 offset:30720
    s_waitcnt lgkmcnt(2)
    v_mfma_f32_16x16x32_bf16 v[44:47], v[88:91], v[80:83], v[44:47]
    ds_read_b128 v[60:63], v238 offset:31744
    s_waitcnt lgkmcnt(1)
    v_mfma_f32_16x16x32_bf16 v[40:43], v[56:59], v[52:55], v[40:43]
    ds_read_b128 v[80:83], v236 offset:61440
    ds_read_b128 v[84:87], v238 offset:35840
    s_waitcnt lgkmcnt(2)
    v_mfma_f32_16x16x32_bf16 v[44:47], v[60:63], v[52:55], v[44:47]
    ds_read_b128 v[88:91], v238 offset:36864
    s_waitcnt lgkmcnt(1)
    v_mfma_f32_16x16x32_bf16 v[40:43], v[84:87], v[80:83], v[40:43]
    s_waitcnt vmcnt(0)
    s_waitcnt lgkmcnt(0)
    s_barrier
    ds_read_b128 v[52:55], v236 offset:0
    ds_read_b128 v[56:59], v237 offset:0
    v_mfma_f32_16x16x32_bf16 v[44:47], v[88:91], v[80:83], v[44:47]
    ds_read_b128 v[60:63], v237 offset:1024
    s_and_b32 s55, s54, 3
    s_cmp_eq_u32 s55, s79
    s_cbranch_scc0 L_fxrlo
    s_lshl_b32 s67, s80, 2
    s_add_u32 s67, s67, s79
    s_lshl_b32 s55, s67, 6
    s_add_u32 s55, s55, 73449504
    v_bfe_u32 v242, v241, 0, 2
    v_min_u32 v242, 2, v242
    v_add_u32 v242, s79, v242
    v_add_u32 v242, 1, v242
    v_and_b32 v242, 3, v242
    v_lshlrev_b32 v245, 3, v242
    buffer_load_dwordx2 v[238:239], v245, s[16:19], s55 offen sc1
L_fxrlo:
    s_waitcnt lgkmcnt(1)
    v_mfma_f32_16x16x32_bf16 v[40:43], v[56:59], v[52:55], v[40:43]
    ds_read_b128 v[80:83], v236 offset:4096
    ds_read_b128 v[84:87], v237 offset:5120
    s_waitcnt lgkmcnt(2)
    v_mfma_f32_16x16x32_bf16 v[44:47], v[60:63], v[52:55], v[44:47]
    ds_read_b128 v[88:91], v237 offset:6144
    s_waitcnt lgkmcnt(1)
    v_mfma_f32_16x16x32_bf16 v[40:43], v[84:87], v[80:83], v[40:43]
    ds_read_b128 v[52:55], v236 offset:8192
    ds_read_b128 v[56:59], v237 offset:10240
    s_waitcnt lgkmcnt(2)
    v_mfma_f32_16x16x32_bf16 v[44:47], v[88:91], v[80:83], v[44:47]
    ds_read_b128 v[60:63], v237 offset:11264
    s_and_b32 s55, s54, 3
    s_cmp_eq_u32 s55, s79
    s_cbranch_scc0 L_fxtlo
    s_waitcnt vmcnt(0)
    v_xor_b32 v238, s84, v238
    v_xor_b32 v239, s85, v239
    v_or_b32 v238, v238, v239
    v_cmp_ne_u32 vcc, 0, v238
    s_cbranch_vccnz L_fxtlo
    s_mov_b32 s73, 1
    s_mul_i32 s67, s67, 81920
    s_add_u32 s67, s67, 75507712
    s_add_u32 s55, s79, 1
    s_and_b32 s55, s55, 3
    s_mul_i32 s55, s55, 20480
    s_add_u32 s55, s55, s67
    buffer_load_dwordx4 v[112:115], v240, s[16:19], s55 offen offset:0 sc1
    buffer_load_dwordx4 v[116:119], v240, s[16:19], s55 offen offset:1024 sc1
    buffer_load_dwordx4 v[120:123], v240, s[16:19], s55 offen offset:2048 sc1
    buffer_load_dwordx4 v[124:127], v240, s[16:19], s55 offen offset:3072 sc1
    s_add_u32 s55, s55, 4096
    buffer_load_dwordx4 v[128:131], v240, s[16:19], s55 offen offset:0 sc1
    s_add_u32 s55, s79, 2
    s_and_b32 s55, s55, 3
    s_mul_i32 s55, s55, 20480
    s_add_u32 s55, s55, s67
    buffer_load_dwordx4 v[132:135], v240, s[16:19], s55 offen offset:0 sc1
    buffer_load_dwordx4 v[136:139], v240, s[16:19], s55 offen offset:1024 sc1
    buffer_load_dwordx4 v[140:143], v240, s[16:19], s55 offen offset:2048 sc1
    buffer_load_dwordx4 v[144:147], v240, s[16:19], s55 offen offset:3072 sc1
    s_add_u32 s55, s55, 4096
    buffer_load_dwordx4 v[148:151], v240, s[16:19], s55 offen offset:0 sc1
    s_add_u32 s55, s79, 3
    s_and_b32 s55, s55, 3
    s_mul_i32 s55, s55, 20480
    s_add_u32 s55, s55, s67
    buffer_load_dwordx4 v[152:155], v240, s[16:19], s55 offen offset:0 sc1
    buffer_load_dwordx4 v[156:159], v240, s[16:19], s55 offen offset:1024 sc1
    buffer_load_dwordx4 v[160:163], v240, s[16:19], s55 offen offset:2048 sc1
    buffer_load_dwordx4 v[164:167], v240, s[16:19], s55 offen offset:3072 sc1
    s_add_u32 s55, s55, 4096
    buffer_load_dwordx4 v[168:171], v240, s[16:19], s55 offen offset:0 sc1
L_fxtlo:
    s_waitcnt lgkmcnt(1)
    v_mfma_f32_16x16x32_bf16 v[40:43], v[56:59], v[52:55], v[40:43]
    ds_read_b128 v[80:83], v236 offset:12288
    ds_read_b128 v[84:87], v237 offset:15360
    s_waitcnt lgkmcnt(2)
    v_mfma_f32_16x16x32_bf16 v[44:47], v[60:63], v[52:55], v[44:47]
    ds_read_b128 v[88:91], v237 offset:16384
    s_waitcnt lgkmcnt(1)
    v_mfma_f32_16x16x32_bf16 v[40:43], v[84:87], v[80:83], v[40:43]
    s_waitcnt lgkmcnt(0)
    v_mfma_f32_16x16x32_bf16 v[44:47], v[88:91], v[80:83], v[44:47]
    s_nop 5
    v_cvt_pk_bf16_f32 v40, v40, v41
    v_cvt_pk_bf16_f32 v41, v42, v43
    buffer_store_dwordx2 v[40:41], v235, s[44:47], s82 offen offset:1280
    v_cvt_pk_bf16_f32 v44, v44, v45
    v_cvt_pk_bf16_f32 v45, v46, v47
    buffer_store_dwordx2 v[44:45], v235, s[44:47], s82 offen offset:1312
    s_and_b32 s55, s54, 3
    s_cmp_eq_u32 s55, s79
    s_cbranch_scc0 L_o_done
    s_cmp_lg_u32 s73, 0
    s_cbranch_scc1 L_gotlo
    s_lshl_b32 s67, s80, 2
    s_add_u32 s67, s67, s79
    s_lshl_b32 s55, s67, 6
    s_add_u32 s55, s55, 73449504
    v_bfe_u32 v242, v241, 0, 2
    v_min_u32 v242, 2, v242
    v_add_u32 v242, s79, v242
    v_add_u32 v242, 1, v242
    v_and_b32 v242, 3, v242
    v_lshlrev_b32 v245, 3, v242
    s_mov_b32 s56, 1048576
    s_mov_b64 exec, 0x7
L_poll5lo:
    buffer_load_dwordx2 v[246:247], v245, s[16:19], s55 offen sc1
    s_waitcnt vmcnt(0)
    v_xor_b32 v246, s84, v246
    v_xor_b32 v247, s85, v247
    v_or_b32 v246, v246, v247
    v_cmp_ne_u32 vcc, 0, v246
    s_cbranch_vccz L_poll5lo_ok
    s_sleep 4
    s_sub_u32 s56, s56, 1
    s_cmp_lg_u32 s56, 0
    s_cbranch_scc1 L_poll5lo
L_poll5lo_ok:
    s_mov_b64 exec, -1
    s_mul_i32 s67, s67, 81920
    s_add_u32 s67, s67, 75507712
    s_add_u32 s55, s79, 1
    s_and_b32 s55, s55, 3
    s_mul_i32 s55, s55, 20480
    s_add_u32 s55, s55, s67
    buffer_load_dwordx4 v[112:115], v240, s[16:19], s55 offen offset:0 sc1
    buffer_load_dwordx4 v[116:119], v240, s[16:19], s55 offen offset:1024 sc1
    buffer_load_dwordx4 v[120:123], v240, s[16:19], s55 offen offset:2048 sc1
    buffer_load_dwordx4 v[124:127], v240, s[16:19], s55 offen offset:3072 sc1
    s_add_u32 s55, s55, 4096
    buffer_load_dwordx4 v[128:131], v240, s[16:19], s55 offen offset:0 sc1
    s_add_u32 s55, s79, 2
    s_and_b32 s55, s55, 3
    s_mul_i32 s55, s55, 20480
    s_add_u32 s55, s55, s67
    buffer_load_dwordx4 v[132:135], v240, s[16:19], s55 offen offset:0 sc1
    buffer_load_dwordx4 v[136:139], v240, s[16:19], s55 offen offset:1024 sc1
    buffer_load_dwordx4 v[140:143], v240, s[16:19], s55 offen offset:2048 sc1
    buffer_load_dwordx4 v[144:147], v240, s[16:19], s55 offen offset:3072 sc1
    s_add_u32 s55, s55, 4096
    buffer_load_dwordx4 v[148:151], v240, s[16:19], s55 offen offset:0 sc1
    s_add_u32 s55, s79, 3
    s_and_b32 s55, s55, 3
    s_mul_i32 s55, s55, 20480
    s_add_u32 s55, s55, s67
    buffer_load_dwordx4 v[152:155], v240, s[16:19], s55 offen offset:0 sc1
    buffer_load_dwordx4 v[156:159], v240, s[16:19], s55 offen offset:1024 sc1
    buffer_load_dwordx4 v[160:163], v240, s[16:19], s55 offen offset:2048 sc1
    buffer_load_dwordx4 v[164:167], v240, s[16:19], s55 offen offset:3072 sc1
    s_add_u32 s55, s55, 4096
    buffer_load_dwordx4 v[168:171], v240, s[16:19], s55 offen offset:0 sc1
L_gotlo:
    s_waitcnt vmcnt(0)
    s_mov_b32 s55, 0x3f80
    s_mov_b32 s56, 0x3f800000
    v_dot2_f32_bf16 v0, v112, s55, v0
    v_dot2_f32_bf16 v1, v112, s56, v1
    v_dot2_f32_bf16 v2, v113, s55, v2
    v_dot2_f32_bf16 v3, v113, s56, v3
    v_dot2_f32_bf16 v4, v114, s55, v4
    v_dot2_f32_bf16 v5, v114, s56, v5
    v_dot2_f32_bf16 v6, v115, s55, v6
    v_dot2_f32_bf16 v7, v115, s56, v7
    v_dot2_f32_bf16 v8, v116, s55, v8
    v_dot2_f32_bf16 v9, v116, s56, v9
    v_dot2_f32_bf16 v10, v117, s55, v10
    v_dot2_f32_bf16 v11, v117, s56, v11
    v_dot2_f32_bf16 v12, v118, s55, v12
    v_dot2_f32_bf16 v13, v118, s56, v13
    v_dot2_f32_bf16 v14, v119, s55, v14
    v_dot2_f32_bf16 v15, v119, s56, v15
    v_dot2_f32_bf16 v16, v120, s55, v16
    v_dot2_f32_bf16 v17, v120, s56, v17
    v_dot2_f32_bf16 v18, v121, s55, v18
    v_dot2_f32_bf16 v19, v121, s56, v19
    v_dot2_f32_bf16 v20, v122, s55, v20
    v_dot2_f32_bf16 v21, v122, s56, v21
    v_dot2_f32_bf16 v22, v123, s55, v22
    v_dot2_f32_bf16 v23, v123, s56, v23
    v_dot2_f32_bf16 v24, v124, s55, v24
    v_dot2_f32_bf16 v25, v124, s56, v25
    v_dot2_f32_bf16 v26, v125, s55, v26
    v_dot2_f32_bf16 v27, v125, s56, v27
    v_dot2_f32_bf16 v28, v126, s55, v28
    v_dot2_f32_bf16 v29, v126, s56, v29
    v_dot2_f32_bf16 v30, v127, s55, v30
    v_dot2_f32_bf16 v31, v127, s56, v31
    v_dot2_f32_bf16 v32, v128, s55, v32
    v_dot2_f32_bf16 v33, v128, s56, v33
    v_dot2_f32_bf16 v34, v129, s55, v34
    v_dot2_f32_bf16 v35, v129, s56, v35
    v_dot2_f32_bf16 v36, v130, s55, v36
    v_dot2_f32_bf16 v37, v130, s56, v37
    v_dot2_f32_bf16 v38, v131, s55, v38
    v_dot2_f32_bf16 v39, v131, s56, v39
    v_dot2_f32_bf16 v0, v132, s55, v0
    v_dot2_f32_bf16 v1, v132, s56, v1
    v_dot2_f32_bf16 v2, v133, s55, v2
    v_dot2_f32_bf16 v3, v133, s56, v3
    v_dot2_f32_bf16 v4, v134, s55, v4
    v_dot2_f32_bf16 v5, v134, s56, v5
    v_dot2_f32_bf16 v6, v135, s55, v6
    v_dot2_f32_bf16 v7, v135, s56, v7
    v_dot2_f32_bf16 v8, v136, s55, v8
    v_dot2_f32_bf16 v9, v136, s56, v9
    v_dot2_f32_bf16 v10, v137, s55, v10
    v_dot2_f32_bf16 v11, v137, s56, v11
    v_dot2_f32_bf16 v12, v138, s55, v12
    v_dot2_f32_bf16 v13, v138, s56, v13
    v_dot2_f32_bf16 v14, v139, s55, v14
    v_dot2_f32_bf16 v15, v139, s56, v15
    v_dot2_f32_bf16 v16, v140, s55, v16
    v_dot2_f32_bf16 v17, v140, s56, v17
    v_dot2_f32_bf16 v18, v141, s55, v18
    v_dot2_f32_bf16 v19, v141, s56, v19
    v_dot2_f32_bf16 v20, v142, s55, v20
    v_dot2_f32_bf16 v21, v142, s56, v21
    v_dot2_f32_bf16 v22, v143, s55, v22
    v_dot2_f32_bf16 v23, v143, s56, v23
    v_dot2_f32_bf16 v24, v144, s55, v24
    v_dot2_f32_bf16 v25, v144, s56, v25
    v_dot2_f32_bf16 v26, v145, s55, v26
    v_dot2_f32_bf16 v27, v145, s56, v27
    v_dot2_f32_bf16 v28, v146, s55, v28
    v_dot2_f32_bf16 v29, v146, s56, v29
    v_dot2_f32_bf16 v30, v147, s55, v30
    v_dot2_f32_bf16 v31, v147, s56, v31
    v_dot2_f32_bf16 v32, v148, s55, v32
    v_dot2_f32_bf16 v33, v148, s56, v33
    v_dot2_f32_bf16 v34, v149, s55, v34
    v_dot2_f32_bf16 v35, v149, s56, v35
    v_dot2_f32_bf16 v36, v150, s55, v36
    v_dot2_f32_bf16 v37, v150, s56, v37
    v_dot2_f32_bf16 v38, v151, s55, v38
    v_dot2_f32_bf16 v39, v151, s56, v39
    v_dot2_f32_bf16 v0, v152, s55, v0
    v_dot2_f32_bf16 v1, v152, s56, v1
    v_dot2_f32_bf16 v2, v153, s55, v2
    v_dot2_f32_bf16 v3, v153, s56, v3
    v_dot2_f32_bf16 v4, v154, s55, v4
    v_dot2_f32_bf16 v5, v154, s56, v5
    v_dot2_f32_bf16 v6, v155, s55, v6
    v_dot2_f32_bf16 v7, v155, s56, v7
    v_dot2_f32_bf16 v8, v156, s55, v8
    v_dot2_f32_bf16 v9, v156, s56, v9
    v_dot2_f32_bf16 v10, v157, s55, v10
    v_dot2_f32_bf16 v11, v157, s56, v11
    v_dot2_f32_bf16 v12, v158, s55, v12
    v_dot2_f32_bf16 v13, v158, s56, v13
    v_dot2_f32_bf16 v14, v159, s55, v14
    v_dot2_f32_bf16 v15, v159, s56, v15
    v_dot2_f32_bf16 v16, v160, s55, v16
    v_dot2_f32_bf16 v17, v160, s56, v17
    v_dot2_f32_bf16 v18, v161, s55, v18
    v_dot2_f32_bf16 v19, v161, s56, v19
    v_dot2_f32_bf16 v20, v162, s55, v20
    v_dot2_f32_bf16 v21, v162, s56, v21
    v_dot2_f32_bf16 v22, v163, s55, v22
    v_dot2_f32_bf16 v23, v163, s56, v23
    v_dot2_f32_bf16 v24, v164, s55, v24
    v_dot2_f32_bf16 v25, v164, s56, v25
    v_dot2_f32_bf16 v26, v165, s55, v26
    v_dot2_f32_bf16 v27, v165, s56, v27
    v_dot2_f32_bf16 v28, v166, s55, v28
    v_dot2_f32_bf16 v29, v166, s56, v29
    v_dot2_f32_bf16 v30, v167, s55, v30
    v_dot2_f32_bf16 v31, v167, s56, v31
    v_dot2_f32_bf16 v32, v168, s55, v32
    v_dot2_f32_bf16 v33, v168, s56, v33
    v_dot2_f32_bf16 v34, v169, s55, v34
    v_dot2_f32_bf16 v35, v169, s56, v35
    v_dot2_f32_bf16 v36, v170, s55, v36
    v_dot2_f32_bf16 v37, v170, s56, v37
    v_dot2_f32_bf16 v38, v171, s55, v38
    v_dot2_f32_bf16 v39, v171, s56, v39
    s_add_u32 s55, s88, 40960
    v_cvt_pk_bf16_f32 v0, v0, v1
    v_cvt_pk_bf16_f32 v1, v2, v3
    buffer_store_dwordx2 v[0:1], v235, s[44:47], s88 offen offset:0
    v_cvt_pk_bf16_f32 v4, v4, v5
    v_cvt_pk_bf16_f32 v5, v6, v7
    buffer_store_dwordx2 v[4:5], v235, s[44:47], s88 offen offset:32
    v_cvt_pk_bf16_f32 v8, v8, v9
    v_cvt_pk_bf16_f32 v9, v10, v11
    buffer_store_dwordx2 v[8:9], v235, s[44:47], s88 offen offset:64
    v_cvt_pk_bf16_f32 v12, v12, v13
    v_cvt_pk_bf16_f32 v13, v14, v15
    buffer_store_dwordx2 v[12:13], v235, s[44:47], s88 offen offset:96
    v_cvt_pk_bf16_f32 v16, v16, v17
    v_cvt_pk_bf16_f32 v17, v18, v19
    buffer_store_dwordx2 v[16:17], v235, s[44:47], s88 offen offset:128
    v_cvt_pk_bf16_f32 v20, v20, v21
    v_cvt_pk_bf16_f32 v21, v22, v23
    buffer_store_dwordx2 v[20:21], v235, s[44:47], s55 offen offset:0
    v_cvt_pk_bf16_f32 v24, v24, v25
    v_cvt_pk_bf16_f32 v25, v26, v27
    buffer_store_dwordx2 v[24:25], v235, s[44:47], s55 offen offset:32
    v_cvt_pk_bf16_f32 v28, v28, v29
    v_cvt_pk_bf16_f32 v29, v30, v31
    buffer_store_dwordx2 v[28:29], v235, s[44:47], s55 offen offset:64
    v_cvt_pk_bf16_f32 v32, v32, v33
    v_cvt_pk_bf16_f32 v33, v34, v35
    buffer_store_dwordx2 v[32:33], v235, s[44:47], s55 offen offset:96
    v_cvt_pk_bf16_f32 v36, v36, v37
    v_cvt_pk_bf16_f32 v37, v38, v39
    buffer_store_dwordx2 v[36:37], v235, s[44:47], s55 offen offset:128
L_o_done:
L_stop:
L_end:
    s_endpgm
.section .rodata,"a"
.p2align 6
.amdhsa_kernel concat_heads__compressed_kv_cla__sliding_local_dilated__prompt_kernel
  .amdhsa_next_free_vgpr 256
  .amdhsa_next_free_sgpr 100
  .amdhsa_accum_offset 256
  .amdhsa_group_segment_fixed_size 0
  .amdhsa_kernarg_size 96
  .amdhsa_user_sgpr_count 2
  .amdhsa_user_sgpr_kernarg_segment_ptr 1
  .amdhsa_system_sgpr_workgroup_id_x 1
.end_amdhsa_kernel
```
